```python
import torch

def _softmax(x, axis=-1):
    return torch.softmax(x, dim=axis)

def _gelu(x):
    return torch.nn.functional.gelu(x, approximate='tanh')

def _silu(x):
    return torch.nn.functional.silu(x)

def _sigmoid(x):
    return torch.sigmoid(x)

def _layernorm(x, axis=-1, eps=1e-05):
    m = x.mean(dim=axis, keepdim=True)
    v = x.var(dim=axis, keepdim=True, unbiased=False)
    return (x - m) / torch.sqrt(v + eps)

def _scatter_add(tgt, idx, src, axis=0):
    return tgt.clone().index_add_(axis, idx, src)

def _segment_sum(src, seg, n):
    out = torch.zeros((n,) + src.shape[1:], dtype=src.dtype)
    return out.index_add_(0, seg, src)

def _pad(x, pw):
    flat = tuple((v for pair in reversed(pw) for v in pair))
    return torch.nn.functional.pad(x, flat)
kernel_name = 'interleave_layers__memory_aug_recurrent_mem_tr__dense_activation_relu__prompt'

def setup_inputs():

    _w = lambda a: (lambda t: t.to(torch.bfloat16) if t.is_floating_point() else t)(torch.as_tensor(a))

    def _A_setup():
        B, S, Dm = (1, 2048, 512)
        H, Dh = (32, 128)
        M, seg = (8, 32)
        seg = min(seg, S)
        S = S // seg * seg
        return {'x': _w((lambda *s: torch.randn(*s, dtype=torch.bfloat16) * 0.05)(B, S, Dm)), 'mem0': _w((lambda *s: torch.randn(*s, dtype=torch.bfloat16) * 0.8)(B, M, Dm)), 'Wq': _w((lambda *s: torch.randn(*s, dtype=torch.bfloat16) * 0.8)(Dm, H, Dh) * Dm ** (-0.5)), 'Wk': _w((lambda *s: torch.randn(*s, dtype=torch.bfloat16) * 0.8)(Dm, H, Dh) * Dm ** (-0.5)), 'Wv': _w((lambda *s: torch.randn(*s, dtype=torch.bfloat16) * 0.8)(Dm, H, Dh) * Dm ** (-0.5)), 'Wo': _w((lambda *s: torch.randn(*s, dtype=torch.bfloat16) * 0.8)(H, Dh, Dm) * (H * Dh) ** (-0.5)), 'seg_len': seg}
    _A_in = _A_setup()

    def _B_setup():
        B, S, D, Dff = (1, 2048, 512, 1376)
        return {'x': _w((lambda *s: torch.randn(*s, dtype=torch.bfloat16) * 0.05)(B, S, D)), 'w1': _w((lambda *s: torch.randn(*s, dtype=torch.bfloat16) * 0.05)(D, Dff)), 'w2': _w((lambda *s: torch.randn(*s, dtype=torch.bfloat16) * 0.05)(Dff, D))}
    _B_in = _B_setup()
    return {'A_x': _A_in['x'], 'A_mem0': _A_in['mem0'], 'A_Wq': _A_in['Wq'], 'A_Wk': _A_in['Wk'], 'A_Wv': _A_in['Wv'], 'A_Wo': _A_in['Wo'], 'A_seg_len': _A_in['seg_len'], 'B_x': _B_in['x'], 'B_w1': _B_in['w1'], 'B_w2': _B_in['w2']}

def reference(A_x, A_mem0, A_Wq, A_Wk, A_Wv, A_Wo, A_seg_len, B_x, B_w1, B_w2):

    def _A_ref(x, mem0, Wq, Wk, Wv, Wo, seg_len):
        B, S, Dm = x.shape
        H, Dh = (Wq.shape[1], Wq.shape[2])
        M = mem0.shape[1]
        scale = Dh ** (-0.5)
        n_seg = S // seg_len
        L = M + seg_len
        idx = torch.arange(L)
        mask = (idx[:, None] < M) | (idx[:, None] >= idx[None, :])
        mem = mem0
        outs = []
        for s in range(n_seg):
            xs = x[:, s * seg_len:(s + 1) * seg_len, :].clone()
            h = torch.concatenate([mem, xs], axis=1)
            q = torch.einsum('btd,dhe->bhte', h, Wq)
            k = torch.einsum('btd,dhe->bhte', h, Wk)
            v = torch.einsum('btd,dhe->bhte', h, Wv)
            scores = torch.einsum('bhqe,bhke->bhqk', q, k) * scale
            scores = torch.where(mask[None, None], scores, -1000000000.0)
            p = _softmax(scores, axis=-1)
            o = torch.einsum('bhqk,bhke->bhqe', p, v)
            o = torch.einsum('bhte,hed->btd', o, Wo)
            mem = o[:, :M, :].clone()
            outs.append(o[:, M:, :])
        return torch.concatenate(outs, axis=1)

    def _B_ref(x, w1, w2):
        h = torch.einsum('bsd,df->bsf', x, w1)
        zero = torch.zeros_like(h)
        h = torch.maximum(h, zero)
        return torch.einsum('bsf,fd->bsd', h, w2)
    x = A_x
    x = x + _A_ref(_layernorm(x, axis=-1), A_mem0, A_Wq, A_Wk, A_Wv, A_Wo, A_seg_len)
    x = x + _B_ref(_layernorm(x, axis=-1), B_w1, B_w2)
    x = x + _A_ref(_layernorm(x, axis=-1), A_mem0, A_Wq, A_Wk, A_Wv, A_Wo, A_seg_len)
    x = x + _B_ref(_layernorm(x, axis=-1), B_w1, B_w2)
    return x
```

```asm
; @launch grid=(256,1,1) block=(256,1,1) lds=163840
.amdgcn_target "amdgcn-amd-amdhsa--gfx950"
.text
.globl interleave_layers__memory_aug_recurrent_mem_tr__dense_activation_relu__prompt_kernel
.p2align 8
.type interleave_layers__memory_aug_recurrent_mem_tr__dense_activation_relu__prompt_kernel,@function
interleave_layers__memory_aug_recurrent_mem_tr__dense_activation_relu__prompt_kernel:
  s_cmp_ge_u32 s2, 256
  s_cbranch_scc1 the_end
  s_load_dwordx16 s[64:79], s[0:1], 0
  s_load_dwordx8 s[80:87], s[0:1], 64
  s_load_dwordx2 s[88:89], s[0:1], 96
  s_memrealtime s[90:91]
  s_getreg_b32 s30, hwreg(HW_REG_XCC_ID)
  s_and_b32 s30, s30, 15
  s_mov_b32 s3, 400000
  s_mov_b32 s5, 0
  s_mov_b32 s6, 0
  s_mov_b32 s7, 0
  v_lshrrev_b32 v1, 6, v0
  s_nop 0
  v_readfirstlane_b32 s4, v1
  v_and_b32 v1, 63, v0
  s_lshl_b32 s31, s30, 2
  s_lshr_b32 s31, 0x65217430, s31
  s_and_b32 s31, s31, 7
  s_cmp_lt_u32 s30, 8
  s_cselect_b32 s30, s31, s30
  s_waitcnt lgkmcnt(0)
  s_mov_b32 s8, s88
  s_mov_b32 s9, s89
  s_mov_b32 s10, 0x10000000
  s_mov_b32 s11, 0x20000
  s_mov_b32 s24, s86
  s_mov_b32 s25, s87
  s_mov_b32 s26, 256
  s_mov_b32 s27, 0x20000
  s_cmp_eq_u32 s4, 0
  s_cbranch_scc0 pro_nt
  s_lshl_b32 s31, s30, 2
  s_cmp_lt_u32 s30, 1
  s_cselect_b32 s32, 0, 128
  s_add_u32 s31, s31, s32
  s_mov_b64 exec, 1
  v_mov_b32 v2, s31
  v_mov_b32 v3, 1
  buffer_atomic_add v3, v2, s[24:27], 0 offen sc0 sc1
  s_mul_i32 s31, s30, 300
  s_add_u32 s90, s90, s31
  s_add_u32 s90, s90, 340
  s_or_b32 s90, s90, 3
  v_mov_b32 v8, s90
  v_mov_b32 v9, 0
  s_cmp_lt_u32 s30, 2
  s_cbranch_scc0 pro_nc
  s_lshl_b32 s31, s30, 2
  buffer_atomic_cmpswap v[8:9], off, s[24:27], s31 offset:64 sc0 sc1
pro_nc:
  v_mov_b32 v2, 0
  s_waitcnt vmcnt(0)
  v_mov_b32 v9, s90
  v_cmp_eq_u32 vcc, 0, v8
  s_nop 1
  v_cndmask_b32 v8, v8, v9, vcc
  ds_write2_b32 v2, v3, v8 offset1:1
  s_mov_b64 exec, -1
pro_nt:
  s_waitcnt vmcnt(0) lgkmcnt(0)
  s_barrier
  v_mov_b32 v2, 0
  ds_read2_b32 v[8:9], v2 offset1:1
  s_waitcnt lgkmcnt(0)
  v_readfirstlane_b32 s6, v8
  v_readfirstlane_b32 s99, v9
  s_barrier
  s_mov_b32 s5, s30
  s_cmp_lt_u32 s30, 8
  s_cselect_b32 s31, 32, 0
  s_cmp_lt_u32 s6, s31
  s_cbranch_scc1 pro_done
  s_sub_u32 s32, s6, s31
pro_ov:
  s_sub_u32 s3, s3, 1
  s_cbranch_scc1 bail_1
  s_sleep 8
  v_and_b32 v5, 15, v1
  v_lshlrev_b32 v5, 2, v5
  v_add_u32 v4, 128, v5
  v_cmp_gt_u32 vcc, 4, v5
  s_nop 1
  v_cndmask_b32 v5, v4, v5, vcc
  buffer_load_dword v4, v5, s[24:27], 0 offen sc1
  s_waitcnt vmcnt(0)
  v_readlane_b32 s33, v4, 0
  v_readlane_b32 s34, v4, 1
  s_nop 0
  s_add_u32 s33, s33, s34
  v_readlane_b32 s34, v4, 2
  s_nop 0
  s_add_u32 s33, s33, s34
  v_readlane_b32 s34, v4, 3
  s_nop 0
  s_add_u32 s33, s33, s34
  v_readlane_b32 s34, v4, 4
  s_nop 0
  s_add_u32 s33, s33, s34
  v_readlane_b32 s34, v4, 5
  s_nop 0
  s_add_u32 s33, s33, s34
  v_readlane_b32 s34, v4, 6
  s_nop 0
  s_add_u32 s33, s33, s34
  v_readlane_b32 s34, v4, 7
  s_nop 0
  s_add_u32 s33, s33, s34
  v_readlane_b32 s34, v4, 8
  s_nop 0
  s_add_u32 s33, s33, s34
  v_readlane_b32 s34, v4, 9
  s_nop 0
  s_add_u32 s33, s33, s34
  v_readlane_b32 s34, v4, 10
  s_nop 0
  s_add_u32 s33, s33, s34
  v_readlane_b32 s34, v4, 11
  s_nop 0
  s_add_u32 s33, s33, s34
  v_readlane_b32 s34, v4, 12
  s_nop 0
  s_add_u32 s33, s33, s34
  v_readlane_b32 s34, v4, 13
  s_nop 0
  s_add_u32 s33, s33, s34
  v_readlane_b32 s34, v4, 14
  s_nop 0
  s_add_u32 s33, s33, s34
  v_readlane_b32 s34, v4, 15
  s_nop 0
  s_add_u32 s33, s33, s34
  s_cmp_lt_u32 s33, 256
  s_cbranch_scc1 pro_ov
  v_readlane_b32 s34, v4, 0
  s_nop 0
  s_max_u32 s34, s34, 32
  s_sub_u32 s34, s34, 32
  s_cmp_gt_u32 s30, 0
  s_cselect_b32 s34, s34, 0
  s_add_u32 s32, s32, s34
  v_readlane_b32 s34, v4, 1
  s_nop 0
  s_max_u32 s34, s34, 32
  s_sub_u32 s34, s34, 32
  s_cmp_gt_u32 s30, 1
  s_cselect_b32 s34, s34, 0
  s_add_u32 s32, s32, s34
  v_readlane_b32 s34, v4, 2
  s_nop 0
  s_max_u32 s34, s34, 32
  s_sub_u32 s34, s34, 32
  s_cmp_gt_u32 s30, 2
  s_cselect_b32 s34, s34, 0
  s_add_u32 s32, s32, s34
  v_readlane_b32 s34, v4, 3
  s_nop 0
  s_max_u32 s34, s34, 32
  s_sub_u32 s34, s34, 32
  s_cmp_gt_u32 s30, 3
  s_cselect_b32 s34, s34, 0
  s_add_u32 s32, s32, s34
  v_readlane_b32 s34, v4, 4
  s_nop 0
  s_max_u32 s34, s34, 32
  s_sub_u32 s34, s34, 32
  s_cmp_gt_u32 s30, 4
  s_cselect_b32 s34, s34, 0
  s_add_u32 s32, s32, s34
  v_readlane_b32 s34, v4, 5
  s_nop 0
  s_max_u32 s34, s34, 32
  s_sub_u32 s34, s34, 32
  s_cmp_gt_u32 s30, 5
  s_cselect_b32 s34, s34, 0
  s_add_u32 s32, s32, s34
  v_readlane_b32 s34, v4, 6
  s_nop 0
  s_max_u32 s34, s34, 32
  s_sub_u32 s34, s34, 32
  s_cmp_gt_u32 s30, 6
  s_cselect_b32 s34, s34, 0
  s_add_u32 s32, s32, s34
  v_readlane_b32 s34, v4, 7
  s_nop 0
  s_max_u32 s34, s34, 32
  s_sub_u32 s34, s34, 32
  s_cmp_gt_u32 s30, 7
  s_cselect_b32 s34, s34, 0
  s_add_u32 s32, s32, s34
  v_readlane_b32 s34, v4, 8
  s_nop 0
  s_max_u32 s34, s34, 0
  s_sub_u32 s34, s34, 0
  s_cmp_gt_u32 s30, 8
  s_cselect_b32 s34, s34, 0
  s_add_u32 s32, s32, s34
  v_readlane_b32 s34, v4, 9
  s_nop 0
  s_max_u32 s34, s34, 0
  s_sub_u32 s34, s34, 0
  s_cmp_gt_u32 s30, 9
  s_cselect_b32 s34, s34, 0
  s_add_u32 s32, s32, s34
  v_readlane_b32 s34, v4, 10
  s_nop 0
  s_max_u32 s34, s34, 0
  s_sub_u32 s34, s34, 0
  s_cmp_gt_u32 s30, 10
  s_cselect_b32 s34, s34, 0
  s_add_u32 s32, s32, s34
  v_readlane_b32 s34, v4, 11
  s_nop 0
  s_max_u32 s34, s34, 0
  s_sub_u32 s34, s34, 0
  s_cmp_gt_u32 s30, 11
  s_cselect_b32 s34, s34, 0
  s_add_u32 s32, s32, s34
  v_readlane_b32 s34, v4, 12
  s_nop 0
  s_max_u32 s34, s34, 0
  s_sub_u32 s34, s34, 0
  s_cmp_gt_u32 s30, 12
  s_cselect_b32 s34, s34, 0
  s_add_u32 s32, s32, s34
  v_readlane_b32 s34, v4, 13
  s_nop 0
  s_max_u32 s34, s34, 0
  s_sub_u32 s34, s34, 0
  s_cmp_gt_u32 s30, 13
  s_cselect_b32 s34, s34, 0
  s_add_u32 s32, s32, s34
  v_readlane_b32 s34, v4, 14
  s_nop 0
  s_max_u32 s34, s34, 0
  s_sub_u32 s34, s34, 0
  s_cmp_gt_u32 s30, 14
  s_cselect_b32 s34, s34, 0
  s_add_u32 s32, s32, s34
  v_readlane_b32 s34, v4, 0
  s_nop 0
  s_min_u32 s34, s34, 32
  s_mov_b32 s5, 0
  s_add_u32 s6, s34, s32
  s_cmp_lt_u32 s6, 32
  s_cbranch_scc1 pro_done
  s_sub_u32 s32, s6, 32
  v_readlane_b32 s34, v4, 1
  s_nop 0
  s_min_u32 s34, s34, 32
  s_mov_b32 s5, 1
  s_add_u32 s6, s34, s32
  s_cmp_lt_u32 s6, 32
  s_cbranch_scc1 pro_done
  s_sub_u32 s32, s6, 32
  v_readlane_b32 s34, v4, 2
  s_nop 0
  s_min_u32 s34, s34, 32
  s_mov_b32 s5, 2
  s_add_u32 s6, s34, s32
  s_cmp_lt_u32 s6, 32
  s_cbranch_scc1 pro_done
  s_sub_u32 s32, s6, 32
  v_readlane_b32 s34, v4, 3
  s_nop 0
  s_min_u32 s34, s34, 32
  s_mov_b32 s5, 3
  s_add_u32 s6, s34, s32
  s_cmp_lt_u32 s6, 32
  s_cbranch_scc1 pro_done
  s_sub_u32 s32, s6, 32
  v_readlane_b32 s34, v4, 4
  s_nop 0
  s_min_u32 s34, s34, 32
  s_mov_b32 s5, 4
  s_add_u32 s6, s34, s32
  s_cmp_lt_u32 s6, 32
  s_cbranch_scc1 pro_done
  s_sub_u32 s32, s6, 32
  v_readlane_b32 s34, v4, 5
  s_nop 0
  s_min_u32 s34, s34, 32
  s_mov_b32 s5, 5
  s_add_u32 s6, s34, s32
  s_cmp_lt_u32 s6, 32
  s_cbranch_scc1 pro_done
  s_sub_u32 s32, s6, 32
  v_readlane_b32 s34, v4, 6
  s_nop 0
  s_min_u32 s34, s34, 32
  s_mov_b32 s5, 6
  s_add_u32 s6, s34, s32
  s_cmp_lt_u32 s6, 32
  s_cbranch_scc1 pro_done
  s_sub_u32 s32, s6, 32
  v_readlane_b32 s34, v4, 7
  s_nop 0
  s_min_u32 s34, s34, 32
  s_mov_b32 s5, 7
  s_add_u32 s6, s34, s32
  s_cmp_lt_u32 s6, 32
  s_cbranch_scc1 pro_done
  s_sub_u32 s32, s6, 32
  s_branch the_end
pro_done:
  s_and_b32 s6, s6, 31
  s_and_b32 s5, s5, 7
  s_cmp_ge_u32 s5, 5
  s_cbranch_scc1 role_qkv
  s_cmp_eq_u32 s5, 4
  s_cbranch_scc1 role_ffn
  s_and_b32 s7, s5, 1
  s_cmp_lt_u32 s5, 2
  s_cbranch_scc1 role_chain
  s_mov_b32 s12, s64
  s_mov_b32 s13, s65
  s_mov_b32 s14, 0x200000
  s_mov_b32 s15, 0x20000
  s_lshl_b32 s31, s7, 5
  s_add_u32 s31, s31, s6
  s_lshl_b32 s31, s31, 2
  s_add_u32 s36, s31, s4
  s_lshl_b32 s37, s36, 10
  v_lshlrev_b32 v2, 4, v1
  s_add_u32 s31, s37, 0
  buffer_load_dwordx4 v[16:19], v2, s[12:15], s31 offen
  s_add_u32 s31, s37, 262144
  buffer_load_dwordx4 v[20:23], v2, s[12:15], s31 offen
  s_add_u32 s31, s37, 524288
  buffer_load_dwordx4 v[24:27], v2, s[12:15], s31 offen
  s_add_u32 s31, s37, 786432
  buffer_load_dwordx4 v[28:31], v2, s[12:15], s31 offen
  s_add_u32 s31, s37, 1048576
  buffer_load_dwordx4 v[32:35], v2, s[12:15], s31 offen
  s_add_u32 s31, s37, 1310720
  buffer_load_dwordx4 v[36:39], v2, s[12:15], s31 offen
  s_add_u32 s31, s37, 1572864
  buffer_load_dwordx4 v[40:43], v2, s[12:15], s31 offen
  s_add_u32 s31, s37, 1835008
  buffer_load_dwordx4 v[44:47], v2, s[12:15], s31 offen
  s_waitcnt vmcnt(7)
  v_lshlrev_b32 v4, 16, v16
  v_and_b32 v5, 0xffff0000, v16
  v_lshlrev_b32 v6, 16, v17
  v_and_b32 v7, 0xffff0000, v17
  v_lshlrev_b32 v8, 16, v18
  v_and_b32 v9, 0xffff0000, v18
  v_lshlrev_b32 v10, 16, v19
  v_and_b32 v11, 0xffff0000, v19
  v_add_f32 v12, v4, v5
  v_add_f32 v13, v6, v7
  v_add_f32 v12, v12, v8
  v_add_f32 v13, v13, v9
  v_add_f32 v12, v12, v10
  v_add_f32 v13, v13, v11
  v_add_f32 v12, v12, v13
  s_nop 1
  v_add_f32_dpp v12, v12, v12 row_ror:8 row_mask:0xf bank_mask:0xf
  s_nop 1
  v_add_f32_dpp v12, v12, v12 row_ror:4 row_mask:0xf bank_mask:0xf
  s_nop 1
  v_add_f32_dpp v12, v12, v12 row_ror:2 row_mask:0xf bank_mask:0xf
  s_nop 1
  v_add_f32_dpp v12, v12, v12 row_ror:1 row_mask:0xf bank_mask:0xf
  v_mov_b32 v13, v12
  s_nop 1
  v_permlane16_swap_b32 v13, v12
  v_add_f32 v12, v12, v13
  v_mov_b32 v13, v12
  s_nop 1
  v_permlane32_swap_b32 v13, v12
  v_add_f32 v12, v12, v13
  v_mul_f32 v12, 0x3b000000, v12
  v_sub_f32 v4, v4, v12
  v_sub_f32 v5, v5, v12
  v_sub_f32 v6, v6, v12
  v_sub_f32 v7, v7, v12
  v_sub_f32 v8, v8, v12
  v_sub_f32 v9, v9, v12
  v_sub_f32 v10, v10, v12
  v_sub_f32 v11, v11, v12
  v_mul_f32 v12, v4, v4
  v_mul_f32 v13, v5, v5
  v_fmac_f32 v12, v6, v6
  v_fmac_f32 v13, v7, v7
  v_fmac_f32 v12, v8, v8
  v_fmac_f32 v13, v9, v9
  v_fmac_f32 v12, v10, v10
  v_fmac_f32 v13, v11, v11
  v_add_f32 v12, v12, v13
  s_nop 1
  v_add_f32_dpp v12, v12, v12 row_ror:8 row_mask:0xf bank_mask:0xf
  s_nop 1
  v_add_f32_dpp v12, v12, v12 row_ror:4 row_mask:0xf bank_mask:0xf
  s_nop 1
  v_add_f32_dpp v12, v12, v12 row_ror:2 row_mask:0xf bank_mask:0xf
  s_nop 1
  v_add_f32_dpp v12, v12, v12 row_ror:1 row_mask:0xf bank_mask:0xf
  v_mov_b32 v13, v12
  s_nop 1
  v_permlane16_swap_b32 v13, v12
  v_add_f32 v12, v12, v13
  v_mov_b32 v13, v12
  s_nop 1
  v_permlane32_swap_b32 v13, v12
  v_add_f32 v12, v12, v13
  v_mov_b32 v13, 0x3727c5ac
  v_fmac_f32 v13, 0x3b000000, v12
  v_rsq_f32 v13, v13
  s_nop 0
  v_mul_f32 v4, v4, v13
  v_mul_f32 v5, v5, v13
  v_mul_f32 v6, v6, v13
  v_mul_f32 v7, v7, v13
  v_mul_f32 v8, v8, v13
  v_mul_f32 v9, v9, v13
  v_mul_f32 v10, v10, v13
  v_mul_f32 v11, v11, v13
  v_cvt_pk_bf16_f32 v16, v4, v5
  v_cvt_pk_bf16_f32 v17, v6, v7
  v_cvt_pk_bf16_f32 v18, v8, v9
  v_cvt_pk_bf16_f32 v19, v10, v11
  v_min_u32 v16, -2, v16
  s_add_u32 s31, s37, 1048576
  buffer_store_dwordx4 v[16:19], v2, s[8:11], s31 offen sc1
  s_waitcnt vmcnt(7)
  v_lshlrev_b32 v4, 16, v20
  v_and_b32 v5, 0xffff0000, v20
  v_lshlrev_b32 v6, 16, v21
  v_and_b32 v7, 0xffff0000, v21
  v_lshlrev_b32 v8, 16, v22
  v_and_b32 v9, 0xffff0000, v22
  v_lshlrev_b32 v10, 16, v23
  v_and_b32 v11, 0xffff0000, v23
  v_add_f32 v12, v4, v5
  v_add_f32 v13, v6, v7
  v_add_f32 v12, v12, v8
  v_add_f32 v13, v13, v9
  v_add_f32 v12, v12, v10
  v_add_f32 v13, v13, v11
  v_add_f32 v12, v12, v13
  s_nop 1
  v_add_f32_dpp v12, v12, v12 row_ror:8 row_mask:0xf bank_mask:0xf
  s_nop 1
  v_add_f32_dpp v12, v12, v12 row_ror:4 row_mask:0xf bank_mask:0xf
  s_nop 1
  v_add_f32_dpp v12, v12, v12 row_ror:2 row_mask:0xf bank_mask:0xf
  s_nop 1
  v_add_f32_dpp v12, v12, v12 row_ror:1 row_mask:0xf bank_mask:0xf
  v_mov_b32 v13, v12
  s_nop 1
  v_permlane16_swap_b32 v13, v12
  v_add_f32 v12, v12, v13
  v_mov_b32 v13, v12
  s_nop 1
  v_permlane32_swap_b32 v13, v12
  v_add_f32 v12, v12, v13
  v_mul_f32 v12, 0x3b000000, v12
  v_sub_f32 v4, v4, v12
  v_sub_f32 v5, v5, v12
  v_sub_f32 v6, v6, v12
  v_sub_f32 v7, v7, v12
  v_sub_f32 v8, v8, v12
  v_sub_f32 v9, v9, v12
  v_sub_f32 v10, v10, v12
  v_sub_f32 v11, v11, v12
  v_mul_f32 v12, v4, v4
  v_mul_f32 v13, v5, v5
  v_fmac_f32 v12, v6, v6
  v_fmac_f32 v13, v7, v7
  v_fmac_f32 v12, v8, v8
  v_fmac_f32 v13, v9, v9
  v_fmac_f32 v12, v10, v10
  v_fmac_f32 v13, v11, v11
  v_add_f32 v12, v12, v13
  s_nop 1
  v_add_f32_dpp v12, v12, v12 row_ror:8 row_mask:0xf bank_mask:0xf
  s_nop 1
  v_add_f32_dpp v12, v12, v12 row_ror:4 row_mask:0xf bank_mask:0xf
  s_nop 1
  v_add_f32_dpp v12, v12, v12 row_ror:2 row_mask:0xf bank_mask:0xf
  s_nop 1
  v_add_f32_dpp v12, v12, v12 row_ror:1 row_mask:0xf bank_mask:0xf
  v_mov_b32 v13, v12
  s_nop 1
  v_permlane16_swap_b32 v13, v12
  v_add_f32 v12, v12, v13
  v_mov_b32 v13, v12
  s_nop 1
  v_permlane32_swap_b32 v13, v12
  v_add_f32 v12, v12, v13
  v_mov_b32 v13, 0x3727c5ac
  v_fmac_f32 v13, 0x3b000000, v12
  v_rsq_f32 v13, v13
  s_nop 0
  v_mul_f32 v4, v4, v13
  v_mul_f32 v5, v5, v13
  v_mul_f32 v6, v6, v13
  v_mul_f32 v7, v7, v13
  v_mul_f32 v8, v8, v13
  v_mul_f32 v9, v9, v13
  v_mul_f32 v10, v10, v13
  v_mul_f32 v11, v11, v13
  v_cvt_pk_bf16_f32 v20, v4, v5
  v_cvt_pk_bf16_f32 v21, v6, v7
  v_cvt_pk_bf16_f32 v22, v8, v9
  v_cvt_pk_bf16_f32 v23, v10, v11
  v_min_u32 v20, -2, v20
  s_add_u32 s31, s37, 1310720
  buffer_store_dwordx4 v[20:23], v2, s[8:11], s31 offen sc1
  s_waitcnt vmcnt(7)
  v_lshlrev_b32 v4, 16, v24
  v_and_b32 v5, 0xffff0000, v24
  v_lshlrev_b32 v6, 16, v25
  v_and_b32 v7, 0xffff0000, v25
  v_lshlrev_b32 v8, 16, v26
  v_and_b32 v9, 0xffff0000, v26
  v_lshlrev_b32 v10, 16, v27
  v_and_b32 v11, 0xffff0000, v27
  v_add_f32 v12, v4, v5
  v_add_f32 v13, v6, v7
  v_add_f32 v12, v12, v8
  v_add_f32 v13, v13, v9
  v_add_f32 v12, v12, v10
  v_add_f32 v13, v13, v11
  v_add_f32 v12, v12, v13
  s_nop 1
  v_add_f32_dpp v12, v12, v12 row_ror:8 row_mask:0xf bank_mask:0xf
  s_nop 1
  v_add_f32_dpp v12, v12, v12 row_ror:4 row_mask:0xf bank_mask:0xf
  s_nop 1
  v_add_f32_dpp v12, v12, v12 row_ror:2 row_mask:0xf bank_mask:0xf
  s_nop 1
  v_add_f32_dpp v12, v12, v12 row_ror:1 row_mask:0xf bank_mask:0xf
  v_mov_b32 v13, v12
  s_nop 1
  v_permlane16_swap_b32 v13, v12
  v_add_f32 v12, v12, v13
  v_mov_b32 v13, v12
  s_nop 1
  v_permlane32_swap_b32 v13, v12
  v_add_f32 v12, v12, v13
  v_mul_f32 v12, 0x3b000000, v12
  v_sub_f32 v4, v4, v12
  v_sub_f32 v5, v5, v12
  v_sub_f32 v6, v6, v12
  v_sub_f32 v7, v7, v12
  v_sub_f32 v8, v8, v12
  v_sub_f32 v9, v9, v12
  v_sub_f32 v10, v10, v12
  v_sub_f32 v11, v11, v12
  v_mul_f32 v12, v4, v4
  v_mul_f32 v13, v5, v5
  v_fmac_f32 v12, v6, v6
  v_fmac_f32 v13, v7, v7
  v_fmac_f32 v12, v8, v8
  v_fmac_f32 v13, v9, v9
  v_fmac_f32 v12, v10, v10
  v_fmac_f32 v13, v11, v11
  v_add_f32 v12, v12, v13
  s_nop 1
  v_add_f32_dpp v12, v12, v12 row_ror:8 row_mask:0xf bank_mask:0xf
  s_nop 1
  v_add_f32_dpp v12, v12, v12 row_ror:4 row_mask:0xf bank_mask:0xf
  s_nop 1
  v_add_f32_dpp v12, v12, v12 row_ror:2 row_mask:0xf bank_mask:0xf
  s_nop 1
  v_add_f32_dpp v12, v12, v12 row_ror:1 row_mask:0xf bank_mask:0xf
  v_mov_b32 v13, v12
  s_nop 1
  v_permlane16_swap_b32 v13, v12
  v_add_f32 v12, v12, v13
  v_mov_b32 v13, v12
  s_nop 1
  v_permlane32_swap_b32 v13, v12
  v_add_f32 v12, v12, v13
  v_mov_b32 v13, 0x3727c5ac
  v_fmac_f32 v13, 0x3b000000, v12
  v_rsq_f32 v13, v13
  s_nop 0
  v_mul_f32 v4, v4, v13
  v_mul_f32 v5, v5, v13
  v_mul_f32 v6, v6, v13
  v_mul_f32 v7, v7, v13
  v_mul_f32 v8, v8, v13
  v_mul_f32 v9, v9, v13
  v_mul_f32 v10, v10, v13
  v_mul_f32 v11, v11, v13
  v_cvt_pk_bf16_f32 v24, v4, v5
  v_cvt_pk_bf16_f32 v25, v6, v7
  v_cvt_pk_bf16_f32 v26, v8, v9
  v_cvt_pk_bf16_f32 v27, v10, v11
  v_min_u32 v24, -2, v24
  s_add_u32 s31, s37, 1572864
  buffer_store_dwordx4 v[24:27], v2, s[8:11], s31 offen sc1
  s_waitcnt vmcnt(7)
  v_lshlrev_b32 v4, 16, v28
  v_and_b32 v5, 0xffff0000, v28
  v_lshlrev_b32 v6, 16, v29
  v_and_b32 v7, 0xffff0000, v29
  v_lshlrev_b32 v8, 16, v30
  v_and_b32 v9, 0xffff0000, v30
  v_lshlrev_b32 v10, 16, v31
  v_and_b32 v11, 0xffff0000, v31
  v_add_f32 v12, v4, v5
  v_add_f32 v13, v6, v7
  v_add_f32 v12, v12, v8
  v_add_f32 v13, v13, v9
  v_add_f32 v12, v12, v10
  v_add_f32 v13, v13, v11
  v_add_f32 v12, v12, v13
  s_nop 1
  v_add_f32_dpp v12, v12, v12 row_ror:8 row_mask:0xf bank_mask:0xf
  s_nop 1
  v_add_f32_dpp v12, v12, v12 row_ror:4 row_mask:0xf bank_mask:0xf
  s_nop 1
  v_add_f32_dpp v12, v12, v12 row_ror:2 row_mask:0xf bank_mask:0xf
  s_nop 1
  v_add_f32_dpp v12, v12, v12 row_ror:1 row_mask:0xf bank_mask:0xf
  v_mov_b32 v13, v12
  s_nop 1
  v_permlane16_swap_b32 v13, v12
  v_add_f32 v12, v12, v13
  v_mov_b32 v13, v12
  s_nop 1
  v_permlane32_swap_b32 v13, v12
  v_add_f32 v12, v12, v13
  v_mul_f32 v12, 0x3b000000, v12
  v_sub_f32 v4, v4, v12
  v_sub_f32 v5, v5, v12
  v_sub_f32 v6, v6, v12
  v_sub_f32 v7, v7, v12
  v_sub_f32 v8, v8, v12
  v_sub_f32 v9, v9, v12
  v_sub_f32 v10, v10, v12
  v_sub_f32 v11, v11, v12
  v_mul_f32 v12, v4, v4
  v_mul_f32 v13, v5, v5
  v_fmac_f32 v12, v6, v6
  v_fmac_f32 v13, v7, v7
  v_fmac_f32 v12, v8, v8
  v_fmac_f32 v13, v9, v9
  v_fmac_f32 v12, v10, v10
  v_fmac_f32 v13, v11, v11
  v_add_f32 v12, v12, v13
  s_nop 1
  v_add_f32_dpp v12, v12, v12 row_ror:8 row_mask:0xf bank_mask:0xf
  s_nop 1
  v_add_f32_dpp v12, v12, v12 row_ror:4 row_mask:0xf bank_mask:0xf
  s_nop 1
  v_add_f32_dpp v12, v12, v12 row_ror:2 row_mask:0xf bank_mask:0xf
  s_nop 1
  v_add_f32_dpp v12, v12, v12 row_ror:1 row_mask:0xf bank_mask:0xf
  v_mov_b32 v13, v12
  s_nop 1
  v_permlane16_swap_b32 v13, v12
  v_add_f32 v12, v12, v13
  v_mov_b32 v13, v12
  s_nop 1
  v_permlane32_swap_b32 v13, v12
  v_add_f32 v12, v12, v13
  v_mov_b32 v13, 0x3727c5ac
  v_fmac_f32 v13, 0x3b000000, v12
  v_rsq_f32 v13, v13
  s_nop 0
  v_mul_f32 v4, v4, v13
  v_mul_f32 v5, v5, v13
  v_mul_f32 v6, v6, v13
  v_mul_f32 v7, v7, v13
  v_mul_f32 v8, v8, v13
  v_mul_f32 v9, v9, v13
  v_mul_f32 v10, v10, v13
  v_mul_f32 v11, v11, v13
  v_cvt_pk_bf16_f32 v28, v4, v5
  v_cvt_pk_bf16_f32 v29, v6, v7
  v_cvt_pk_bf16_f32 v30, v8, v9
  v_cvt_pk_bf16_f32 v31, v10, v11
  v_min_u32 v28, -2, v28
  s_add_u32 s31, s37, 1835008
  buffer_store_dwordx4 v[28:31], v2, s[8:11], s31 offen sc1
  s_waitcnt vmcnt(7)
  v_lshlrev_b32 v4, 16, v32
  v_and_b32 v5, 0xffff0000, v32
  v_lshlrev_b32 v6, 16, v33
  v_and_b32 v7, 0xffff0000, v33
  v_lshlrev_b32 v8, 16, v34
  v_and_b32 v9, 0xffff0000, v34
  v_lshlrev_b32 v10, 16, v35
  v_and_b32 v11, 0xffff0000, v35
  v_add_f32 v12, v4, v5
  v_add_f32 v13, v6, v7
  v_add_f32 v12, v12, v8
  v_add_f32 v13, v13, v9
  v_add_f32 v12, v12, v10
  v_add_f32 v13, v13, v11
  v_add_f32 v12, v12, v13
  s_nop 1
  v_add_f32_dpp v12, v12, v12 row_ror:8 row_mask:0xf bank_mask:0xf
  s_nop 1
  v_add_f32_dpp v12, v12, v12 row_ror:4 row_mask:0xf bank_mask:0xf
  s_nop 1
  v_add_f32_dpp v12, v12, v12 row_ror:2 row_mask:0xf bank_mask:0xf
  s_nop 1
  v_add_f32_dpp v12, v12, v12 row_ror:1 row_mask:0xf bank_mask:0xf
  v_mov_b32 v13, v12
  s_nop 1
  v_permlane16_swap_b32 v13, v12
  v_add_f32 v12, v12, v13
  v_mov_b32 v13, v12
  s_nop 1
  v_permlane32_swap_b32 v13, v12
  v_add_f32 v12, v12, v13
  v_mul_f32 v12, 0x3b000000, v12
  v_sub_f32 v4, v4, v12
  v_sub_f32 v5, v5, v12
  v_sub_f32 v6, v6, v12
  v_sub_f32 v7, v7, v12
  v_sub_f32 v8, v8, v12
  v_sub_f32 v9, v9, v12
  v_sub_f32 v10, v10, v12
  v_sub_f32 v11, v11, v12
  v_mul_f32 v12, v4, v4
  v_mul_f32 v13, v5, v5
  v_fmac_f32 v12, v6, v6
  v_fmac_f32 v13, v7, v7
  v_fmac_f32 v12, v8, v8
  v_fmac_f32 v13, v9, v9
  v_fmac_f32 v12, v10, v10
  v_fmac_f32 v13, v11, v11
  v_add_f32 v12, v12, v13
  s_nop 1
  v_add_f32_dpp v12, v12, v12 row_ror:8 row_mask:0xf bank_mask:0xf
  s_nop 1
  v_add_f32_dpp v12, v12, v12 row_ror:4 row_mask:0xf bank_mask:0xf
  s_nop 1
  v_add_f32_dpp v12, v12, v12 row_ror:2 row_mask:0xf bank_mask:0xf
  s_nop 1
  v_add_f32_dpp v12, v12, v12 row_ror:1 row_mask:0xf bank_mask:0xf
  v_mov_b32 v13, v12
  s_nop 1
  v_permlane16_swap_b32 v13, v12
  v_add_f32 v12, v12, v13
  v_mov_b32 v13, v12
  s_nop 1
  v_permlane32_swap_b32 v13, v12
  v_add_f32 v12, v12, v13
  v_mov_b32 v13, 0x3727c5ac
  v_fmac_f32 v13, 0x3b000000, v12
  v_rsq_f32 v13, v13
  s_nop 0
  v_mul_f32 v4, v4, v13
  v_mul_f32 v5, v5, v13
  v_mul_f32 v6, v6, v13
  v_mul_f32 v7, v7, v13
  v_mul_f32 v8, v8, v13
  v_mul_f32 v9, v9, v13
  v_mul_f32 v10, v10, v13
  v_mul_f32 v11, v11, v13
  v_cvt_pk_bf16_f32 v32, v4, v5
  v_cvt_pk_bf16_f32 v33, v6, v7
  v_cvt_pk_bf16_f32 v34, v8, v9
  v_cvt_pk_bf16_f32 v35, v10, v11
  v_min_u32 v32, -2, v32
  s_add_u32 s31, s37, 2097152
  buffer_store_dwordx4 v[32:35], v2, s[8:11], s31 offen sc1
  s_waitcnt vmcnt(7)
  v_lshlrev_b32 v4, 16, v36
  v_and_b32 v5, 0xffff0000, v36
  v_lshlrev_b32 v6, 16, v37
  v_and_b32 v7, 0xffff0000, v37
  v_lshlrev_b32 v8, 16, v38
  v_and_b32 v9, 0xffff0000, v38
  v_lshlrev_b32 v10, 16, v39
  v_and_b32 v11, 0xffff0000, v39
  v_add_f32 v12, v4, v5
  v_add_f32 v13, v6, v7
  v_add_f32 v12, v12, v8
  v_add_f32 v13, v13, v9
  v_add_f32 v12, v12, v10
  v_add_f32 v13, v13, v11
  v_add_f32 v12, v12, v13
  s_nop 1
  v_add_f32_dpp v12, v12, v12 row_ror:8 row_mask:0xf bank_mask:0xf
  s_nop 1
  v_add_f32_dpp v12, v12, v12 row_ror:4 row_mask:0xf bank_mask:0xf
  s_nop 1
  v_add_f32_dpp v12, v12, v12 row_ror:2 row_mask:0xf bank_mask:0xf
  s_nop 1
  v_add_f32_dpp v12, v12, v12 row_ror:1 row_mask:0xf bank_mask:0xf
  v_mov_b32 v13, v12
  s_nop 1
  v_permlane16_swap_b32 v13, v12
  v_add_f32 v12, v12, v13
  v_mov_b32 v13, v12
  s_nop 1
  v_permlane32_swap_b32 v13, v12
  v_add_f32 v12, v12, v13
  v_mul_f32 v12, 0x3b000000, v12
  v_sub_f32 v4, v4, v12
  v_sub_f32 v5, v5, v12
  v_sub_f32 v6, v6, v12
  v_sub_f32 v7, v7, v12
  v_sub_f32 v8, v8, v12
  v_sub_f32 v9, v9, v12
  v_sub_f32 v10, v10, v12
  v_sub_f32 v11, v11, v12
  v_mul_f32 v12, v4, v4
  v_mul_f32 v13, v5, v5
  v_fmac_f32 v12, v6, v6
  v_fmac_f32 v13, v7, v7
  v_fmac_f32 v12, v8, v8
  v_fmac_f32 v13, v9, v9
  v_fmac_f32 v12, v10, v10
  v_fmac_f32 v13, v11, v11
  v_add_f32 v12, v12, v13
  s_nop 1
  v_add_f32_dpp v12, v12, v12 row_ror:8 row_mask:0xf bank_mask:0xf
  s_nop 1
  v_add_f32_dpp v12, v12, v12 row_ror:4 row_mask:0xf bank_mask:0xf
  s_nop 1
  v_add_f32_dpp v12, v12, v12 row_ror:2 row_mask:0xf bank_mask:0xf
  s_nop 1
  v_add_f32_dpp v12, v12, v12 row_ror:1 row_mask:0xf bank_mask:0xf
  v_mov_b32 v13, v12
  s_nop 1
  v_permlane16_swap_b32 v13, v12
  v_add_f32 v12, v12, v13
  v_mov_b32 v13, v12
  s_nop 1
  v_permlane32_swap_b32 v13, v12
  v_add_f32 v12, v12, v13
  v_mov_b32 v13, 0x3727c5ac
  v_fmac_f32 v13, 0x3b000000, v12
  v_rsq_f32 v13, v13
  s_nop 0
  v_mul_f32 v4, v4, v13
  v_mul_f32 v5, v5, v13
  v_mul_f32 v6, v6, v13
  v_mul_f32 v7, v7, v13
  v_mul_f32 v8, v8, v13
  v_mul_f32 v9, v9, v13
  v_mul_f32 v10, v10, v13
  v_mul_f32 v11, v11, v13
  v_cvt_pk_bf16_f32 v36, v4, v5
  v_cvt_pk_bf16_f32 v37, v6, v7
  v_cvt_pk_bf16_f32 v38, v8, v9
  v_cvt_pk_bf16_f32 v39, v10, v11
  v_min_u32 v36, -2, v36
  s_add_u32 s31, s37, 2359296
  buffer_store_dwordx4 v[36:39], v2, s[8:11], s31 offen sc1
  s_waitcnt vmcnt(7)
  v_lshlrev_b32 v4, 16, v40
  v_and_b32 v5, 0xffff0000, v40
  v_lshlrev_b32 v6, 16, v41
  v_and_b32 v7, 0xffff0000, v41
  v_lshlrev_b32 v8, 16, v42
  v_and_b32 v9, 0xffff0000, v42
  v_lshlrev_b32 v10, 16, v43
  v_and_b32 v11, 0xffff0000, v43
  v_add_f32 v12, v4, v5
  v_add_f32 v13, v6, v7
  v_add_f32 v12, v12, v8
  v_add_f32 v13, v13, v9
  v_add_f32 v12, v12, v10
  v_add_f32 v13, v13, v11
  v_add_f32 v12, v12, v13
  s_nop 1
  v_add_f32_dpp v12, v12, v12 row_ror:8 row_mask:0xf bank_mask:0xf
  s_nop 1
  v_add_f32_dpp v12, v12, v12 row_ror:4 row_mask:0xf bank_mask:0xf
  s_nop 1
  v_add_f32_dpp v12, v12, v12 row_ror:2 row_mask:0xf bank_mask:0xf
  s_nop 1
  v_add_f32_dpp v12, v12, v12 row_ror:1 row_mask:0xf bank_mask:0xf
  v_mov_b32 v13, v12
  s_nop 1
  v_permlane16_swap_b32 v13, v12
  v_add_f32 v12, v12, v13
  v_mov_b32 v13, v12
  s_nop 1
  v_permlane32_swap_b32 v13, v12
  v_add_f32 v12, v12, v13
  v_mul_f32 v12, 0x3b000000, v12
  v_sub_f32 v4, v4, v12
  v_sub_f32 v5, v5, v12
  v_sub_f32 v6, v6, v12
  v_sub_f32 v7, v7, v12
  v_sub_f32 v8, v8, v12
  v_sub_f32 v9, v9, v12
  v_sub_f32 v10, v10, v12
  v_sub_f32 v11, v11, v12
  v_mul_f32 v12, v4, v4
  v_mul_f32 v13, v5, v5
  v_fmac_f32 v12, v6, v6
  v_fmac_f32 v13, v7, v7
  v_fmac_f32 v12, v8, v8
  v_fmac_f32 v13, v9, v9
  v_fmac_f32 v12, v10, v10
  v_fmac_f32 v13, v11, v11
  v_add_f32 v12, v12, v13
  s_nop 1
  v_add_f32_dpp v12, v12, v12 row_ror:8 row_mask:0xf bank_mask:0xf
  s_nop 1
  v_add_f32_dpp v12, v12, v12 row_ror:4 row_mask:0xf bank_mask:0xf
  s_nop 1
  v_add_f32_dpp v12, v12, v12 row_ror:2 row_mask:0xf bank_mask:0xf
  s_nop 1
  v_add_f32_dpp v12, v12, v12 row_ror:1 row_mask:0xf bank_mask:0xf
  v_mov_b32 v13, v12
  s_nop 1
  v_permlane16_swap_b32 v13, v12
  v_add_f32 v12, v12, v13
  v_mov_b32 v13, v12
  s_nop 1
  v_permlane32_swap_b32 v13, v12
  v_add_f32 v12, v12, v13
  v_mov_b32 v13, 0x3727c5ac
  v_fmac_f32 v13, 0x3b000000, v12
  v_rsq_f32 v13, v13
  s_nop 0
  v_mul_f32 v4, v4, v13
  v_mul_f32 v5, v5, v13
  v_mul_f32 v6, v6, v13
  v_mul_f32 v7, v7, v13
  v_mul_f32 v8, v8, v13
  v_mul_f32 v9, v9, v13
  v_mul_f32 v10, v10, v13
  v_mul_f32 v11, v11, v13
  v_cvt_pk_bf16_f32 v40, v4, v5
  v_cvt_pk_bf16_f32 v41, v6, v7
  v_cvt_pk_bf16_f32 v42, v8, v9
  v_cvt_pk_bf16_f32 v43, v10, v11
  v_min_u32 v40, -2, v40
  s_add_u32 s31, s37, 2621440
  buffer_store_dwordx4 v[40:43], v2, s[8:11], s31 offen sc1
  s_waitcnt vmcnt(7)
  v_lshlrev_b32 v4, 16, v44
  v_and_b32 v5, 0xffff0000, v44
  v_lshlrev_b32 v6, 16, v45
  v_and_b32 v7, 0xffff0000, v45
  v_lshlrev_b32 v8, 16, v46
  v_and_b32 v9, 0xffff0000, v46
  v_lshlrev_b32 v10, 16, v47
  v_and_b32 v11, 0xffff0000, v47
  v_add_f32 v12, v4, v5
  v_add_f32 v13, v6, v7
  v_add_f32 v12, v12, v8
  v_add_f32 v13, v13, v9
  v_add_f32 v12, v12, v10
  v_add_f32 v13, v13, v11
  v_add_f32 v12, v12, v13
  s_nop 1
  v_add_f32_dpp v12, v12, v12 row_ror:8 row_mask:0xf bank_mask:0xf
  s_nop 1
  v_add_f32_dpp v12, v12, v12 row_ror:4 row_mask:0xf bank_mask:0xf
  s_nop 1
  v_add_f32_dpp v12, v12, v12 row_ror:2 row_mask:0xf bank_mask:0xf
  s_nop 1
  v_add_f32_dpp v12, v12, v12 row_ror:1 row_mask:0xf bank_mask:0xf
  v_mov_b32 v13, v12
  s_nop 1
  v_permlane16_swap_b32 v13, v12
  v_add_f32 v12, v12, v13
  v_mov_b32 v13, v12
  s_nop 1
  v_permlane32_swap_b32 v13, v12
  v_add_f32 v12, v12, v13
  v_mul_f32 v12, 0x3b000000, v12
  v_sub_f32 v4, v4, v12
  v_sub_f32 v5, v5, v12
  v_sub_f32 v6, v6, v12
  v_sub_f32 v7, v7, v12
  v_sub_f32 v8, v8, v12
  v_sub_f32 v9, v9, v12
  v_sub_f32 v10, v10, v12
  v_sub_f32 v11, v11, v12
  v_mul_f32 v12, v4, v4
  v_mul_f32 v13, v5, v5
  v_fmac_f32 v12, v6, v6
  v_fmac_f32 v13, v7, v7
  v_fmac_f32 v12, v8, v8
  v_fmac_f32 v13, v9, v9
  v_fmac_f32 v12, v10, v10
  v_fmac_f32 v13, v11, v11
  v_add_f32 v12, v12, v13
  s_nop 1
  v_add_f32_dpp v12, v12, v12 row_ror:8 row_mask:0xf bank_mask:0xf
  s_nop 1
  v_add_f32_dpp v12, v12, v12 row_ror:4 row_mask:0xf bank_mask:0xf
  s_nop 1
  v_add_f32_dpp v12, v12, v12 row_ror:2 row_mask:0xf bank_mask:0xf
  s_nop 1
  v_add_f32_dpp v12, v12, v12 row_ror:1 row_mask:0xf bank_mask:0xf
  v_mov_b32 v13, v12
  s_nop 1
  v_permlane16_swap_b32 v13, v12
  v_add_f32 v12, v12, v13
  v_mov_b32 v13, v12
  s_nop 1
  v_permlane32_swap_b32 v13, v12
  v_add_f32 v12, v12, v13
  v_mov_b32 v13, 0x3727c5ac
  v_fmac_f32 v13, 0x3b000000, v12
  v_rsq_f32 v13, v13
  s_nop 0
  v_mul_f32 v4, v4, v13
  v_mul_f32 v5, v5, v13
  v_mul_f32 v6, v6, v13
  v_mul_f32 v7, v7, v13
  v_mul_f32 v8, v8, v13
  v_mul_f32 v9, v9, v13
  v_mul_f32 v10, v10, v13
  v_mul_f32 v11, v11, v13
  v_cvt_pk_bf16_f32 v44, v4, v5
  v_cvt_pk_bf16_f32 v45, v6, v7
  v_cvt_pk_bf16_f32 v46, v8, v9
  v_cvt_pk_bf16_f32 v47, v10, v11
  v_min_u32 v44, -2, v44
  s_add_u32 s31, s37, 2883584
  buffer_store_dwordx4 v[44:47], v2, s[8:11], s31 offen sc1
  v_mov_b32 v5, 80
  s_mov_b64 exec, 1
wd_1:
  buffer_load_dword v4, v5, s[24:27], 0 offen sc1
  s_waitcnt vmcnt(0)
  v_cmp_gt_u32 vcc, 1, v4
  s_cbranch_vccz wdd_2
  s_sub_u32 s3, s3, 1
  s_cbranch_scc1 bail_5
  s_sleep 8
  s_branch wd_1
wdd_2:
  s_mov_b64 exec, -1
  s_waitcnt vmcnt(0)
  s_lshl_b32 s31, s36, 7
  s_add_u32 s31, s31, 81920
  v_mov_b32 v4, 8
  v_mov_b32 v5, 0
  s_mov_b64 exec, 1
  buffer_store_dword v4, v5, s[8:11], s31 offen sc1
  s_mov_b64 exec, -1
  v_lshlrev_b32 v2, 4, v0
  v_mov_b32 v4, 0
  v_mov_b32 v5, 0
  v_mov_b32 v6, 0
  v_mov_b32 v7, 0
  v_mov_b32 v3, v2
  s_mul_i32 s31, s7, 1048576
  s_mul_i32 s32, s6, 20480
  s_add_u32 s31, s31, s32
  s_add_u32 s31, s31, 16777216
  buffer_store_dwordx4 v[4:7], v3, s[8:11], s31 offen sc1
  s_add_u32 s31, s31, 4096
  buffer_store_dwordx4 v[4:7], v3, s[8:11], s31 offen sc1
  s_add_u32 s31, s31, 4096
  buffer_store_dwordx4 v[4:7], v3, s[8:11], s31 offen sc1
  s_add_u32 s31, s31, 4096
  buffer_store_dwordx4 v[4:7], v3, s[8:11], s31 offen sc1
  s_add_u32 s31, s31, 4096
  buffer_store_dwordx4 v[4:7], v3, s[8:11], s31 offen sc1
  s_add_u32 s31, s31, 4096
  s_mov_b32 s12, s66
  s_mov_b32 s13, s67
  s_mov_b32 s14, 8192
  s_mov_b32 s15, 0x20000
  s_cmp_lt_u32 s6, 8
  s_cbranch_scc0 init_nomem
  v_mov_b32 v8, -1
  v_mov_b32 v9, -1
  v_mov_b32 v10, -1
  v_mov_b32 v11, -1
  s_cmp_lt_u32 s6, 2
  s_cbranch_scc0 init_poison
  v_bfe_u32 v12, v0, 2, 2
  v_lshlrev_b32 v12, 11, v12
  v_and_b32 v13, 1, v0
  v_lshl_add_u32 v12, v13, 10, v12
  v_lshrrev_b32 v13, 4, v0
  v_lshl_add_u32 v12, v13, 5, v12
  v_bfe_u32 v13, v0, 1, 1
  v_lshl_add_u32 v12, v13, 2, v12
  s_lshl_b32 s31, s6, 9
  buffer_load_dword v8, v12, s[12:15], s31 offen
  buffer_load_dword v9, v12, s[12:15], s31 offen offset:8
  buffer_load_dword v10, v12, s[12:15], s31 offen offset:16
  buffer_load_dword v11, v12, s[12:15], s31 offen offset:24
  s_waitcnt vmcnt(0)
  v_min_u32 v8, -2, v8
  v_min_u32 v9, -2, v9
  v_min_u32 v10, -2, v10
  v_min_u32 v11, -2, v11
  v_bfe_u32 v2, v0, 3, 4
  v_lshlrev_b32 v2, 8, v2
  v_lshrrev_b32 v12, 7, v0
  v_lshl_add_u32 v2, v12, 7, v2
  v_and_b32 v12, 7, v0
  v_lshl_add_u32 v2, v12, 4, v2
init_poison:
  s_lshl_b32 s31, s7, 20
  s_lshl_b32 s32, s6, 12
  s_add_u32 s31, s31, s32
  s_add_u32 s31, s31, 17432576
  buffer_store_dwordx4 v[8:11], v2, s[8:11], s31 offen sc1
init_nomem:
  s_lshl_b32 s31, s7, 5
  s_add_u32 s31, s31, s6
  s_lshl_b32 s31, s31, 10
  v_lshlrev_b32 v3, 2, v0
  v_mov_b32 v4, -1
  s_add_u32 s32, s31, 3145728
  buffer_store_dword v4, v3, s[8:11], s32 offen sc1
  s_add_u32 s32, s31, 5242880
  buffer_store_dword v4, v3, s[8:11], s32 offen sc1
  s_add_u32 s32, s31, 7340032
  buffer_store_dword v4, v3, s[8:11], s32 offen sc1
  s_add_u32 s32, s31, 9437184
  buffer_store_dword v4, v3, s[8:11], s32 offen sc1
  s_add_u32 s32, s31, 11534336
  buffer_store_dword v4, v3, s[8:11], s32 offen sc1
  s_add_u32 s32, s31, 13631488
  buffer_store_dword v4, v3, s[8:11], s32 offen sc1
  s_lshl_b32 s31, s7, 23
  s_lshl_b32 s32, s6, 12
  s_add_u32 s31, s31, s32
  s_add_u32 s31, s31, 25165824
  buffer_store_dword v4, v3, s[8:11], s31 offen offset:0 sc1
  buffer_store_dword v4, v3, s[8:11], s31 offen offset:1024 sc1
  buffer_store_dword v4, v3, s[8:11], s31 offen offset:2048 sc1
  buffer_store_dword v4, v3, s[8:11], s31 offen offset:3072 sc1
  s_waitcnt vmcnt(0)
  s_barrier
  s_cmp_eq_u32 s4, 0
  s_cbranch_scc0 init_d1
  s_lshl_b32 s31, s7, 2
  s_mov_b64 exec, 1
  v_mov_b32 v8, 1
  buffer_atomic_add v8, off, s[24:27], s31 offset:208 sc0 sc1
  s_waitcnt vmcnt(0)
  v_cmp_eq_u32 vcc, 31, v8
  s_cbranch_vccz ci_3
  v_mov_b32 v8, 1
  buffer_store_dword v8, off, s[24:27], s31 offset:96 sc1
ci_3:
  s_mov_b64 exec, -1
init_d1:
  s_lshl_b32 s31, s7, 22
  s_mul_i32 s32, s6, 49152
  s_add_u32 s31, s31, s32
  s_add_u32 s31, s31, 142606336
  s_lshl_b32 s32, s4, 10
  v_lshl_add_u32 v3, v1, 4, s32
  v_mov_b32 v4, 0
  v_mov_b32 v5, 0
  v_mov_b32 v6, 0
  v_mov_b32 v7, 0
dm_7:
  v_and_b32 v11, 15, v1
  v_lshlrev_b32 v11, 2, v11
  v_add_u32 v10, 128, v11
  v_cmp_gt_u32 vcc, 4, v11
  s_nop 1
  v_cndmask_b32 v11, v10, v11, vcc
  buffer_load_dword v10, v11, s[24:27], 0 offen sc1
  s_waitcnt vmcnt(0)
  v_readlane_b32 s34, v10, s5
  s_nop 0
  s_cmp_ge_u32 s34, 32
  s_cbranch_scc1 dmf_8
  v_readlane_b32 s33, v10, 0
  v_readlane_b32 s34, v10, 1
  s_nop 0
  s_add_u32 s33, s33, s34
  v_readlane_b32 s34, v10, 2
  s_nop 0
  s_add_u32 s33, s33, s34
  v_readlane_b32 s34, v10, 3
  s_nop 0
  s_add_u32 s33, s33, s34
  v_readlane_b32 s34, v10, 4
  s_nop 0
  s_add_u32 s33, s33, s34
  v_readlane_b32 s34, v10, 5
  s_nop 0
  s_add_u32 s33, s33, s34
  v_readlane_b32 s34, v10, 6
  s_nop 0
  s_add_u32 s33, s33, s34
  v_readlane_b32 s34, v10, 7
  s_nop 0
  s_add_u32 s33, s33, s34
  v_readlane_b32 s34, v10, 8
  s_nop 0
  s_add_u32 s33, s33, s34
  v_readlane_b32 s34, v10, 9
  s_nop 0
  s_add_u32 s33, s33, s34
  v_readlane_b32 s34, v10, 10
  s_nop 0
  s_add_u32 s33, s33, s34
  v_readlane_b32 s34, v10, 11
  s_nop 0
  s_add_u32 s33, s33, s34
  v_readlane_b32 s34, v10, 12
  s_nop 0
  s_add_u32 s33, s33, s34
  v_readlane_b32 s34, v10, 13
  s_nop 0
  s_add_u32 s33, s33, s34
  v_readlane_b32 s34, v10, 14
  s_nop 0
  s_add_u32 s33, s33, s34
  v_readlane_b32 s34, v10, 15
  s_nop 0
  s_add_u32 s33, s33, s34
  s_cmp_ge_u32 s33, 256
  s_cbranch_scc1 ri_4
  s_sub_u32 s3, s3, 1
  s_cbranch_scc1 bail_2
  s_sleep 8
  s_branch dm_7
dmf_8:
  buffer_store_dwordx4 v[4:7], v3, s[8:11], s31 offen
  s_add_u32 s31, s31, 4096
  buffer_store_dwordx4 v[4:7], v3, s[8:11], s31 offen
  s_add_u32 s31, s31, 4096
  buffer_store_dwordx4 v[4:7], v3, s[8:11], s31 offen
  s_add_u32 s31, s31, 4096
  buffer_store_dwordx4 v[4:7], v3, s[8:11], s31 offen
  s_add_u32 s31, s31, 4096
  buffer_store_dwordx4 v[4:7], v3, s[8:11], s31 offen
  s_add_u32 s31, s31, 4096
  buffer_store_dwordx4 v[4:7], v3, s[8:11], s31 offen
  s_add_u32 s31, s31, 4096
  buffer_store_dwordx4 v[4:7], v3, s[8:11], s31 offen
  s_add_u32 s31, s31, 4096
  buffer_store_dwordx4 v[4:7], v3, s[8:11], s31 offen
  s_add_u32 s31, s31, 4096
  buffer_store_dwordx4 v[4:7], v3, s[8:11], s31 offen
  s_add_u32 s31, s31, 4096
  buffer_store_dwordx4 v[4:7], v3, s[8:11], s31 offen
  s_add_u32 s31, s31, 4096
  buffer_store_dwordx4 v[4:7], v3, s[8:11], s31 offen
  s_add_u32 s31, s31, 4096
  buffer_store_dwordx4 v[4:7], v3, s[8:11], s31 offen
  s_add_u32 s31, s31, 4096
  s_branch rie_5
ri_4:
  buffer_store_dwordx4 v[4:7], v3, s[8:11], s31 offen sc1
  s_add_u32 s31, s31, 4096
  buffer_store_dwordx4 v[4:7], v3, s[8:11], s31 offen sc1
  s_add_u32 s31, s31, 4096
  buffer_store_dwordx4 v[4:7], v3, s[8:11], s31 offen sc1
  s_add_u32 s31, s31, 4096
  buffer_store_dwordx4 v[4:7], v3, s[8:11], s31 offen sc1
  s_add_u32 s31, s31, 4096
  buffer_store_dwordx4 v[4:7], v3, s[8:11], s31 offen sc1
  s_add_u32 s31, s31, 4096
  buffer_store_dwordx4 v[4:7], v3, s[8:11], s31 offen sc1
  s_add_u32 s31, s31, 4096
  buffer_store_dwordx4 v[4:7], v3, s[8:11], s31 offen sc1
  s_add_u32 s31, s31, 4096
  buffer_store_dwordx4 v[4:7], v3, s[8:11], s31 offen sc1
  s_add_u32 s31, s31, 4096
  buffer_store_dwordx4 v[4:7], v3, s[8:11], s31 offen sc1
  s_add_u32 s31, s31, 4096
  buffer_store_dwordx4 v[4:7], v3, s[8:11], s31 offen sc1
  s_add_u32 s31, s31, 4096
  buffer_store_dwordx4 v[4:7], v3, s[8:11], s31 offen sc1
  s_add_u32 s31, s31, 4096
  buffer_store_dwordx4 v[4:7], v3, s[8:11], s31 offen sc1
  s_add_u32 s31, s31, 4096
rie_5:
  s_waitcnt vmcnt(0)
  s_barrier
  s_cmp_eq_u32 s4, 0
  s_cbranch_scc0 rid_6
  s_mov_b64 exec, 1
  v_mov_b32 v8, 1
  buffer_atomic_add v8, off, s[24:27], 0 offset:196 sc0 sc1
  s_waitcnt vmcnt(0)
  v_cmp_eq_u32 vcc, 95, v8
  s_cbranch_vccz ci_9
  v_mov_b32 v8, 1
  buffer_store_dword v8, off, s[24:27], 0 offset:84 sc1
ci_9:
  s_mov_b64 exec, -1
rid_6:
  v_lshlrev_b32 v2, 2, v1
  v_add_u32 v2, 16384, v2
  v_mov_b32 v3, 0
  ds_write_b32 v2, v3
  s_waitcnt lgkmcnt(0)
  s_barrier
  v_mov_b32 v2, 16384
  v_lshlrev_b32 v3, 4, v1
  s_mov_b32 s20, 0
  s_mov_b32 s44, 1
  s_mov_b32 s22, 0
  s_cmp_eq_u32 s4, 0
  s_cbranch_scc1 ao_A
  s_cmp_eq_u32 s4, 3
  s_cbranch_scc1 ao_R
  s_mov_b32 s12, s74
  s_mov_b32 s13, s75
  s_mov_b32 s14, 4194304
  s_mov_b32 s15, 0x20000
  s_sub_u32 s36, s4, 1
  s_and_b32 s33, s6, 1
  s_lshl_b32 s33, s33, 1
  s_add_u32 s45, s33, s36
  s_lshl_b32 s33, s45, 8
  s_lshl_b32 s37, s6, 17
  s_add_u32 s37, s37, s33
  s_xor_b32 s46, s37, 0x20000
  v_bfe_u32 v4, v1, 4, 1
  v_lshlrev_b32 v4, 14, v4
  v_lshrrev_b32 v5, 5, v1
  v_lshl_add_u32 v4, v5, 12, v4
  v_and_b32 v5, 15, v1
  v_lshl_add_u32 v4, v5, 4, v4
  s_mov_b32 s58, 0x05040100
  s_mov_b32 s59, 0x07060302
  s_add_u32 s33, s37, 0
  buffer_load_dwordx4 v[16:19], v4, s[12:15], s33 offen
  s_add_u32 s33, s37, 1024
  buffer_load_dwordx4 v[20:23], v4, s[12:15], s33 offen
  s_add_u32 s33, s37, 2048
  buffer_load_dwordx4 v[24:27], v4, s[12:15], s33 offen
  s_add_u32 s33, s37, 3072
  buffer_load_dwordx4 v[28:31], v4, s[12:15], s33 offen
  s_add_u32 s33, s37, 8192
  buffer_load_dwordx4 v[32:35], v4, s[12:15], s33 offen
  s_add_u32 s33, s37, 9216
  buffer_load_dwordx4 v[36:39], v4, s[12:15], s33 offen
  s_add_u32 s33, s37, 10240
  buffer_load_dwordx4 v[40:43], v4, s[12:15], s33 offen
  s_add_u32 s33, s37, 11264
  buffer_load_dwordx4 v[44:47], v4, s[12:15], s33 offen
  s_add_u32 s33, s37, 32768
  buffer_load_dwordx4 v[48:51], v4, s[12:15], s33 offen
  s_add_u32 s33, s37, 33792
  buffer_load_dwordx4 v[52:55], v4, s[12:15], s33 offen
  s_add_u32 s33, s37, 34816
  buffer_load_dwordx4 v[56:59], v4, s[12:15], s33 offen
  s_add_u32 s33, s37, 35840
  buffer_load_dwordx4 v[60:63], v4, s[12:15], s33 offen
  s_add_u32 s33, s37, 40960
  buffer_load_dwordx4 v[64:67], v4, s[12:15], s33 offen
  s_add_u32 s33, s37, 41984
  buffer_load_dwordx4 v[68:71], v4, s[12:15], s33 offen
  s_add_u32 s33, s37, 43008
  buffer_load_dwordx4 v[72:75], v4, s[12:15], s33 offen
  s_add_u32 s33, s37, 44032
  buffer_load_dwordx4 v[76:79], v4, s[12:15], s33 offen
  s_add_u32 s33, s37, 65536
  buffer_load_dwordx4 v[80:83], v4, s[12:15], s33 offen
  s_add_u32 s33, s37, 66560
  buffer_load_dwordx4 v[84:87], v4, s[12:15], s33 offen
  s_add_u32 s33, s37, 67584
  buffer_load_dwordx4 v[88:91], v4, s[12:15], s33 offen
  s_add_u32 s33, s37, 68608
  buffer_load_dwordx4 v[92:95], v4, s[12:15], s33 offen
  s_add_u32 s33, s37, 73728
  buffer_load_dwordx4 v[96:99], v4, s[12:15], s33 offen
  s_add_u32 s33, s37, 74752
  buffer_load_dwordx4 v[100:103], v4, s[12:15], s33 offen
  s_add_u32 s33, s37, 75776
  buffer_load_dwordx4 v[104:107], v4, s[12:15], s33 offen
  s_add_u32 s33, s37, 76800
  buffer_load_dwordx4 v[108:111], v4, s[12:15], s33 offen
  s_add_u32 s33, s37, 98304
  buffer_load_dwordx4 v[112:115], v4, s[12:15], s33 offen
  s_add_u32 s33, s37, 99328
  buffer_load_dwordx4 v[116:119], v4, s[12:15], s33 offen
  s_add_u32 s33, s37, 100352
  buffer_load_dwordx4 v[120:123], v4, s[12:15], s33 offen
  s_add_u32 s33, s37, 101376
  buffer_load_dwordx4 v[124:127], v4, s[12:15], s33 offen
  s_add_u32 s33, s37, 106496
  buffer_load_dwordx4 v[128:131], v4, s[12:15], s33 offen
  s_add_u32 s33, s37, 107520
  buffer_load_dwordx4 v[132:135], v4, s[12:15], s33 offen
  s_add_u32 s33, s37, 108544
  buffer_load_dwordx4 v[136:139], v4, s[12:15], s33 offen
  s_add_u32 s33, s37, 109568
  buffer_load_dwordx4 v[140:143], v4, s[12:15], s33 offen
  s_waitcnt vmcnt(24)
  v_perm_b32 v144, v20, v16, s58
  v_accvgpr_write_b32 a0, v144
  v_perm_b32 v145, v28, v24, s58
  v_accvgpr_write_b32 a1, v145
  v_perm_b32 v144, v36, v32, s58
  v_accvgpr_write_b32 a2, v144
  v_perm_b32 v145, v44, v40, s58
  v_accvgpr_write_b32 a3, v145
  v_perm_b32 v144, v20, v16, s59
  v_accvgpr_write_b32 a32, v144
  v_perm_b32 v145, v28, v24, s59
  v_accvgpr_write_b32 a33, v145
  v_perm_b32 v144, v36, v32, s59
  v_accvgpr_write_b32 a34, v144
  v_perm_b32 v145, v44, v40, s59
  v_accvgpr_write_b32 a35, v145
  v_perm_b32 v144, v21, v17, s58
  v_accvgpr_write_b32 a64, v144
  v_perm_b32 v145, v29, v25, s58
  v_accvgpr_write_b32 a65, v145
  v_perm_b32 v144, v37, v33, s58
  v_accvgpr_write_b32 a66, v144
  v_perm_b32 v145, v45, v41, s58
  v_accvgpr_write_b32 a67, v145
  v_perm_b32 v144, v21, v17, s59
  v_accvgpr_write_b32 a96, v144
  v_perm_b32 v145, v29, v25, s59
  v_accvgpr_write_b32 a97, v145
  v_perm_b32 v144, v37, v33, s59
  v_accvgpr_write_b32 a98, v144
  v_perm_b32 v145, v45, v41, s59
  v_accvgpr_write_b32 a99, v145
  v_perm_b32 v144, v22, v18, s58
  v_accvgpr_write_b32 a128, v144
  v_perm_b32 v145, v30, v26, s58
  v_accvgpr_write_b32 a129, v145
  v_perm_b32 v144, v38, v34, s58
  v_accvgpr_write_b32 a130, v144
  v_perm_b32 v145, v46, v42, s58
  v_accvgpr_write_b32 a131, v145
  v_perm_b32 v144, v22, v18, s59
  v_accvgpr_write_b32 a160, v144
  v_perm_b32 v145, v30, v26, s59
  v_accvgpr_write_b32 a161, v145
  v_perm_b32 v144, v38, v34, s59
  v_accvgpr_write_b32 a162, v144
  v_perm_b32 v145, v46, v42, s59
  v_accvgpr_write_b32 a163, v145
  v_perm_b32 v144, v23, v19, s58
  v_accvgpr_write_b32 a192, v144
  v_perm_b32 v145, v31, v27, s58
  v_accvgpr_write_b32 a193, v145
  v_perm_b32 v144, v39, v35, s58
  v_accvgpr_write_b32 a194, v144
  v_perm_b32 v145, v47, v43, s58
  v_accvgpr_write_b32 a195, v145
  v_perm_b32 v144, v23, v19, s59
  v_accvgpr_write_b32 a224, v144
  v_perm_b32 v145, v31, v27, s59
  v_accvgpr_write_b32 a225, v145
  v_perm_b32 v144, v39, v35, s59
  v_accvgpr_write_b32 a226, v144
  v_perm_b32 v145, v47, v43, s59
  v_accvgpr_write_b32 a227, v145
  s_add_u32 s33, s46, 0
  buffer_load_dwordx4 v[16:19], v4, s[12:15], s33 offen
  s_add_u32 s33, s46, 1024
  buffer_load_dwordx4 v[20:23], v4, s[12:15], s33 offen
  s_add_u32 s33, s46, 2048
  buffer_load_dwordx4 v[24:27], v4, s[12:15], s33 offen
  s_add_u32 s33, s46, 3072
  buffer_load_dwordx4 v[28:31], v4, s[12:15], s33 offen
  s_add_u32 s33, s46, 8192
  buffer_load_dwordx4 v[32:35], v4, s[12:15], s33 offen
  s_add_u32 s33, s46, 9216
  buffer_load_dwordx4 v[36:39], v4, s[12:15], s33 offen
  s_add_u32 s33, s46, 10240
  buffer_load_dwordx4 v[40:43], v4, s[12:15], s33 offen
  s_add_u32 s33, s46, 11264
  buffer_load_dwordx4 v[44:47], v4, s[12:15], s33 offen
  s_waitcnt vmcnt(24)
  v_perm_b32 v144, v52, v48, s58
  v_accvgpr_write_b32 a4, v144
  v_perm_b32 v145, v60, v56, s58
  v_accvgpr_write_b32 a5, v145
  v_perm_b32 v144, v68, v64, s58
  v_accvgpr_write_b32 a6, v144
  v_perm_b32 v145, v76, v72, s58
  v_accvgpr_write_b32 a7, v145
  v_perm_b32 v144, v52, v48, s59
  v_accvgpr_write_b32 a36, v144
  v_perm_b32 v145, v60, v56, s59
  v_accvgpr_write_b32 a37, v145
  v_perm_b32 v144, v68, v64, s59
  v_accvgpr_write_b32 a38, v144
  v_perm_b32 v145, v76, v72, s59
  v_accvgpr_write_b32 a39, v145
  v_perm_b32 v144, v53, v49, s58
  v_accvgpr_write_b32 a68, v144
  v_perm_b32 v145, v61, v57, s58
  v_accvgpr_write_b32 a69, v145
  v_perm_b32 v144, v69, v65, s58
  v_accvgpr_write_b32 a70, v144
  v_perm_b32 v145, v77, v73, s58
  v_accvgpr_write_b32 a71, v145
  v_perm_b32 v144, v53, v49, s59
  v_accvgpr_write_b32 a100, v144
  v_perm_b32 v145, v61, v57, s59
  v_accvgpr_write_b32 a101, v145
  v_perm_b32 v144, v69, v65, s59
  v_accvgpr_write_b32 a102, v144
  v_perm_b32 v145, v77, v73, s59
  v_accvgpr_write_b32 a103, v145
  v_perm_b32 v144, v54, v50, s58
  v_accvgpr_write_b32 a132, v144
  v_perm_b32 v145, v62, v58, s58
  v_accvgpr_write_b32 a133, v145
  v_perm_b32 v144, v70, v66, s58
  v_accvgpr_write_b32 a134, v144
  v_perm_b32 v145, v78, v74, s58
  v_accvgpr_write_b32 a135, v145
  v_perm_b32 v144, v54, v50, s59
  v_accvgpr_write_b32 a164, v144
  v_perm_b32 v145, v62, v58, s59
  v_accvgpr_write_b32 a165, v145
  v_perm_b32 v144, v70, v66, s59
  v_accvgpr_write_b32 a166, v144
  v_perm_b32 v145, v78, v74, s59
  v_accvgpr_write_b32 a167, v145
  v_perm_b32 v144, v55, v51, s58
  v_accvgpr_write_b32 a196, v144
  v_perm_b32 v145, v63, v59, s58
  v_accvgpr_write_b32 a197, v145
  v_perm_b32 v144, v71, v67, s58
  v_accvgpr_write_b32 a198, v144
  v_perm_b32 v145, v79, v75, s58
  v_accvgpr_write_b32 a199, v145
  v_perm_b32 v144, v55, v51, s59
  v_accvgpr_write_b32 a228, v144
  v_perm_b32 v145, v63, v59, s59
  v_accvgpr_write_b32 a229, v145
  v_perm_b32 v144, v71, v67, s59
  v_accvgpr_write_b32 a230, v144
  v_perm_b32 v145, v79, v75, s59
  v_accvgpr_write_b32 a231, v145
  s_add_u32 s33, s46, 32768
  buffer_load_dwordx4 v[48:51], v4, s[12:15], s33 offen
  s_add_u32 s33, s46, 33792
  buffer_load_dwordx4 v[52:55], v4, s[12:15], s33 offen
  s_add_u32 s33, s46, 34816
  buffer_load_dwordx4 v[56:59], v4, s[12:15], s33 offen
  s_add_u32 s33, s46, 35840
  buffer_load_dwordx4 v[60:63], v4, s[12:15], s33 offen
  s_add_u32 s33, s46, 40960
  buffer_load_dwordx4 v[64:67], v4, s[12:15], s33 offen
  s_add_u32 s33, s46, 41984
  buffer_load_dwordx4 v[68:71], v4, s[12:15], s33 offen
  s_add_u32 s33, s46, 43008
  buffer_load_dwordx4 v[72:75], v4, s[12:15], s33 offen
  s_add_u32 s33, s46, 44032
  buffer_load_dwordx4 v[76:79], v4, s[12:15], s33 offen
  s_waitcnt vmcnt(24)
  v_perm_b32 v144, v84, v80, s58
  v_accvgpr_write_b32 a8, v144
  v_perm_b32 v145, v92, v88, s58
  v_accvgpr_write_b32 a9, v145
  v_perm_b32 v144, v100, v96, s58
  v_accvgpr_write_b32 a10, v144
  v_perm_b32 v145, v108, v104, s58
  v_accvgpr_write_b32 a11, v145
  v_perm_b32 v144, v84, v80, s59
  v_accvgpr_write_b32 a40, v144
  v_perm_b32 v145, v92, v88, s59
  v_accvgpr_write_b32 a41, v145
  v_perm_b32 v144, v100, v96, s59
  v_accvgpr_write_b32 a42, v144
  v_perm_b32 v145, v108, v104, s59
  v_accvgpr_write_b32 a43, v145
  v_perm_b32 v144, v85, v81, s58
  v_accvgpr_write_b32 a72, v144
  v_perm_b32 v145, v93, v89, s58
  v_accvgpr_write_b32 a73, v145
  v_perm_b32 v144, v101, v97, s58
  v_accvgpr_write_b32 a74, v144
  v_perm_b32 v145, v109, v105, s58
  v_accvgpr_write_b32 a75, v145
  v_perm_b32 v144, v85, v81, s59
  v_accvgpr_write_b32 a104, v144
  v_perm_b32 v145, v93, v89, s59
  v_accvgpr_write_b32 a105, v145
  v_perm_b32 v144, v101, v97, s59
  v_accvgpr_write_b32 a106, v144
  v_perm_b32 v145, v109, v105, s59
  v_accvgpr_write_b32 a107, v145
  v_perm_b32 v144, v86, v82, s58
  v_accvgpr_write_b32 a136, v144
  v_perm_b32 v145, v94, v90, s58
  v_accvgpr_write_b32 a137, v145
  v_perm_b32 v144, v102, v98, s58
  v_accvgpr_write_b32 a138, v144
  v_perm_b32 v145, v110, v106, s58
  v_accvgpr_write_b32 a139, v145
  v_perm_b32 v144, v86, v82, s59
  v_accvgpr_write_b32 a168, v144
  v_perm_b32 v145, v94, v90, s59
  v_accvgpr_write_b32 a169, v145
  v_perm_b32 v144, v102, v98, s59
  v_accvgpr_write_b32 a170, v144
  v_perm_b32 v145, v110, v106, s59
  v_accvgpr_write_b32 a171, v145
  v_perm_b32 v144, v87, v83, s58
  v_accvgpr_write_b32 a200, v144
  v_perm_b32 v145, v95, v91, s58
  v_accvgpr_write_b32 a201, v145
  v_perm_b32 v144, v103, v99, s58
  v_accvgpr_write_b32 a202, v144
  v_perm_b32 v145, v111, v107, s58
  v_accvgpr_write_b32 a203, v145
  v_perm_b32 v144, v87, v83, s59
  v_accvgpr_write_b32 a232, v144
  v_perm_b32 v145, v95, v91, s59
  v_accvgpr_write_b32 a233, v145
  v_perm_b32 v144, v103, v99, s59
  v_accvgpr_write_b32 a234, v144
  v_perm_b32 v145, v111, v107, s59
  v_accvgpr_write_b32 a235, v145
  s_add_u32 s33, s46, 65536
  buffer_load_dwordx4 v[80:83], v4, s[12:15], s33 offen
  s_add_u32 s33, s46, 66560
  buffer_load_dwordx4 v[84:87], v4, s[12:15], s33 offen
  s_add_u32 s33, s46, 67584
  buffer_load_dwordx4 v[88:91], v4, s[12:15], s33 offen
  s_add_u32 s33, s46, 68608
  buffer_load_dwordx4 v[92:95], v4, s[12:15], s33 offen
  s_add_u32 s33, s46, 73728
  buffer_load_dwordx4 v[96:99], v4, s[12:15], s33 offen
  s_add_u32 s33, s46, 74752
  buffer_load_dwordx4 v[100:103], v4, s[12:15], s33 offen
  s_add_u32 s33, s46, 75776
  buffer_load_dwordx4 v[104:107], v4, s[12:15], s33 offen
  s_add_u32 s33, s46, 76800
  buffer_load_dwordx4 v[108:111], v4, s[12:15], s33 offen
  s_waitcnt vmcnt(24)
  v_perm_b32 v144, v116, v112, s58
  v_accvgpr_write_b32 a12, v144
  v_perm_b32 v145, v124, v120, s58
  v_accvgpr_write_b32 a13, v145
  v_perm_b32 v144, v132, v128, s58
  v_accvgpr_write_b32 a14, v144
  v_perm_b32 v145, v140, v136, s58
  v_accvgpr_write_b32 a15, v145
  v_perm_b32 v144, v116, v112, s59
  v_accvgpr_write_b32 a44, v144
  v_perm_b32 v145, v124, v120, s59
  v_accvgpr_write_b32 a45, v145
  v_perm_b32 v144, v132, v128, s59
  v_accvgpr_write_b32 a46, v144
  v_perm_b32 v145, v140, v136, s59
  v_accvgpr_write_b32 a47, v145
  v_perm_b32 v144, v117, v113, s58
  v_accvgpr_write_b32 a76, v144
  v_perm_b32 v145, v125, v121, s58
  v_accvgpr_write_b32 a77, v145
  v_perm_b32 v144, v133, v129, s58
  v_accvgpr_write_b32 a78, v144
  v_perm_b32 v145, v141, v137, s58
  v_accvgpr_write_b32 a79, v145
  v_perm_b32 v144, v117, v113, s59
  v_accvgpr_write_b32 a108, v144
  v_perm_b32 v145, v125, v121, s59
  v_accvgpr_write_b32 a109, v145
  v_perm_b32 v144, v133, v129, s59
  v_accvgpr_write_b32 a110, v144
  v_perm_b32 v145, v141, v137, s59
  v_accvgpr_write_b32 a111, v145
  v_perm_b32 v144, v118, v114, s58
  v_accvgpr_write_b32 a140, v144
  v_perm_b32 v145, v126, v122, s58
  v_accvgpr_write_b32 a141, v145
  v_perm_b32 v144, v134, v130, s58
  v_accvgpr_write_b32 a142, v144
  v_perm_b32 v145, v142, v138, s58
  v_accvgpr_write_b32 a143, v145
  v_perm_b32 v144, v118, v114, s59
  v_accvgpr_write_b32 a172, v144
  v_perm_b32 v145, v126, v122, s59
  v_accvgpr_write_b32 a173, v145
  v_perm_b32 v144, v134, v130, s59
  v_accvgpr_write_b32 a174, v144
  v_perm_b32 v145, v142, v138, s59
  v_accvgpr_write_b32 a175, v145
  v_perm_b32 v144, v119, v115, s58
  v_accvgpr_write_b32 a204, v144
  v_perm_b32 v145, v127, v123, s58
  v_accvgpr_write_b32 a205, v145
  v_perm_b32 v144, v135, v131, s58
  v_accvgpr_write_b32 a206, v144
  v_perm_b32 v145, v143, v139, s58
  v_accvgpr_write_b32 a207, v145
  v_perm_b32 v144, v119, v115, s59
  v_accvgpr_write_b32 a236, v144
  v_perm_b32 v145, v127, v123, s59
  v_accvgpr_write_b32 a237, v145
  v_perm_b32 v144, v135, v131, s59
  v_accvgpr_write_b32 a238, v144
  v_perm_b32 v145, v143, v139, s59
  v_accvgpr_write_b32 a239, v145
  s_add_u32 s33, s46, 98304
  buffer_load_dwordx4 v[112:115], v4, s[12:15], s33 offen
  s_add_u32 s33, s46, 99328
  buffer_load_dwordx4 v[116:119], v4, s[12:15], s33 offen
  s_add_u32 s33, s46, 100352
  buffer_load_dwordx4 v[120:123], v4, s[12:15], s33 offen
  s_add_u32 s33, s46, 101376
  buffer_load_dwordx4 v[124:127], v4, s[12:15], s33 offen
  s_add_u32 s33, s46, 106496
  buffer_load_dwordx4 v[128:131], v4, s[12:15], s33 offen
  s_add_u32 s33, s46, 107520
  buffer_load_dwordx4 v[132:135], v4, s[12:15], s33 offen
  s_add_u32 s33, s46, 108544
  buffer_load_dwordx4 v[136:139], v4, s[12:15], s33 offen
  s_add_u32 s33, s46, 109568
  buffer_load_dwordx4 v[140:143], v4, s[12:15], s33 offen
  s_waitcnt vmcnt(24)
  v_perm_b32 v144, v20, v16, s58
  v_accvgpr_write_b32 a16, v144
  v_perm_b32 v145, v28, v24, s58
  v_accvgpr_write_b32 a17, v145
  v_perm_b32 v144, v36, v32, s58
  v_accvgpr_write_b32 a18, v144
  v_perm_b32 v145, v44, v40, s58
  v_accvgpr_write_b32 a19, v145
  v_perm_b32 v144, v20, v16, s59
  v_accvgpr_write_b32 a48, v144
  v_perm_b32 v145, v28, v24, s59
  v_accvgpr_write_b32 a49, v145
  v_perm_b32 v144, v36, v32, s59
  v_accvgpr_write_b32 a50, v144
  v_perm_b32 v145, v44, v40, s59
  v_accvgpr_write_b32 a51, v145
  v_perm_b32 v144, v21, v17, s58
  v_accvgpr_write_b32 a80, v144
  v_perm_b32 v145, v29, v25, s58
  v_accvgpr_write_b32 a81, v145
  v_perm_b32 v144, v37, v33, s58
  v_accvgpr_write_b32 a82, v144
  v_perm_b32 v145, v45, v41, s58
  v_accvgpr_write_b32 a83, v145
  v_perm_b32 v144, v21, v17, s59
  v_accvgpr_write_b32 a112, v144
  v_perm_b32 v145, v29, v25, s59
  v_accvgpr_write_b32 a113, v145
  v_perm_b32 v144, v37, v33, s59
  v_accvgpr_write_b32 a114, v144
  v_perm_b32 v145, v45, v41, s59
  v_accvgpr_write_b32 a115, v145
  v_perm_b32 v144, v22, v18, s58
  v_accvgpr_write_b32 a144, v144
  v_perm_b32 v145, v30, v26, s58
  v_accvgpr_write_b32 a145, v145
  v_perm_b32 v144, v38, v34, s58
  v_accvgpr_write_b32 a146, v144
  v_perm_b32 v145, v46, v42, s58
  v_accvgpr_write_b32 a147, v145
  v_perm_b32 v144, v22, v18, s59
  v_accvgpr_write_b32 a176, v144
  v_perm_b32 v145, v30, v26, s59
  v_accvgpr_write_b32 a177, v145
  v_perm_b32 v144, v38, v34, s59
  v_accvgpr_write_b32 a178, v144
  v_perm_b32 v145, v46, v42, s59
  v_accvgpr_write_b32 a179, v145
  v_perm_b32 v144, v23, v19, s58
  v_accvgpr_write_b32 a208, v144
  v_perm_b32 v145, v31, v27, s58
  v_accvgpr_write_b32 a209, v145
  v_perm_b32 v144, v39, v35, s58
  v_accvgpr_write_b32 a210, v144
  v_perm_b32 v145, v47, v43, s58
  v_accvgpr_write_b32 a211, v145
  v_perm_b32 v144, v23, v19, s59
  v_accvgpr_write_b32 a240, v144
  v_perm_b32 v145, v31, v27, s59
  v_accvgpr_write_b32 a241, v145
  v_perm_b32 v144, v39, v35, s59
  v_accvgpr_write_b32 a242, v144
  v_perm_b32 v145, v47, v43, s59
  v_accvgpr_write_b32 a243, v145
  s_waitcnt vmcnt(16)
  v_perm_b32 v144, v52, v48, s58
  v_accvgpr_write_b32 a20, v144
  v_perm_b32 v145, v60, v56, s58
  v_accvgpr_write_b32 a21, v145
  v_perm_b32 v144, v68, v64, s58
  v_accvgpr_write_b32 a22, v144
  v_perm_b32 v145, v76, v72, s58
  v_accvgpr_write_b32 a23, v145
  v_perm_b32 v144, v52, v48, s59
  v_accvgpr_write_b32 a52, v144
  v_perm_b32 v145, v60, v56, s59
  v_accvgpr_write_b32 a53, v145
  v_perm_b32 v144, v68, v64, s59
  v_accvgpr_write_b32 a54, v144
  v_perm_b32 v145, v76, v72, s59
  v_accvgpr_write_b32 a55, v145
  v_perm_b32 v144, v53, v49, s58
  v_accvgpr_write_b32 a84, v144
  v_perm_b32 v145, v61, v57, s58
  v_accvgpr_write_b32 a85, v145
  v_perm_b32 v144, v69, v65, s58
  v_accvgpr_write_b32 a86, v144
  v_perm_b32 v145, v77, v73, s58
  v_accvgpr_write_b32 a87, v145
  v_perm_b32 v144, v53, v49, s59
  v_accvgpr_write_b32 a116, v144
  v_perm_b32 v145, v61, v57, s59
  v_accvgpr_write_b32 a117, v145
  v_perm_b32 v144, v69, v65, s59
  v_accvgpr_write_b32 a118, v144
  v_perm_b32 v145, v77, v73, s59
  v_accvgpr_write_b32 a119, v145
  v_perm_b32 v144, v54, v50, s58
  v_accvgpr_write_b32 a148, v144
  v_perm_b32 v145, v62, v58, s58
  v_accvgpr_write_b32 a149, v145
  v_perm_b32 v144, v70, v66, s58
  v_accvgpr_write_b32 a150, v144
  v_perm_b32 v145, v78, v74, s58
  v_accvgpr_write_b32 a151, v145
  v_perm_b32 v144, v54, v50, s59
  v_accvgpr_write_b32 a180, v144
  v_perm_b32 v145, v62, v58, s59
  v_accvgpr_write_b32 a181, v145
  v_perm_b32 v144, v70, v66, s59
  v_accvgpr_write_b32 a182, v144
  v_perm_b32 v145, v78, v74, s59
  v_accvgpr_write_b32 a183, v145
  v_perm_b32 v144, v55, v51, s58
  v_accvgpr_write_b32 a212, v144
  v_perm_b32 v145, v63, v59, s58
  v_accvgpr_write_b32 a213, v145
  v_perm_b32 v144, v71, v67, s58
  v_accvgpr_write_b32 a214, v144
  v_perm_b32 v145, v79, v75, s58
  v_accvgpr_write_b32 a215, v145
  v_perm_b32 v144, v55, v51, s59
  v_accvgpr_write_b32 a244, v144
  v_perm_b32 v145, v63, v59, s59
  v_accvgpr_write_b32 a245, v145
  v_perm_b32 v144, v71, v67, s59
  v_accvgpr_write_b32 a246, v144
  v_perm_b32 v145, v79, v75, s59
  v_accvgpr_write_b32 a247, v145
  s_waitcnt vmcnt(8)
  v_perm_b32 v144, v84, v80, s58
  v_accvgpr_write_b32 a24, v144
  v_perm_b32 v145, v92, v88, s58
  v_accvgpr_write_b32 a25, v145
  v_perm_b32 v144, v100, v96, s58
  v_accvgpr_write_b32 a26, v144
  v_perm_b32 v145, v108, v104, s58
  v_accvgpr_write_b32 a27, v145
  v_perm_b32 v144, v84, v80, s59
  v_accvgpr_write_b32 a56, v144
  v_perm_b32 v145, v92, v88, s59
  v_accvgpr_write_b32 a57, v145
  v_perm_b32 v144, v100, v96, s59
  v_accvgpr_write_b32 a58, v144
  v_perm_b32 v145, v108, v104, s59
  v_accvgpr_write_b32 a59, v145
  v_perm_b32 v144, v85, v81, s58
  v_accvgpr_write_b32 a88, v144
  v_perm_b32 v145, v93, v89, s58
  v_accvgpr_write_b32 a89, v145
  v_perm_b32 v144, v101, v97, s58
  v_accvgpr_write_b32 a90, v144
  v_perm_b32 v145, v109, v105, s58
  v_accvgpr_write_b32 a91, v145
  v_perm_b32 v144, v85, v81, s59
  v_accvgpr_write_b32 a120, v144
  v_perm_b32 v145, v93, v89, s59
  v_accvgpr_write_b32 a121, v145
  v_perm_b32 v144, v101, v97, s59
  v_accvgpr_write_b32 a122, v144
  v_perm_b32 v145, v109, v105, s59
  v_accvgpr_write_b32 a123, v145
  v_perm_b32 v144, v86, v82, s58
  v_accvgpr_write_b32 a152, v144
  v_perm_b32 v145, v94, v90, s58
  v_accvgpr_write_b32 a153, v145
  v_perm_b32 v144, v102, v98, s58
  v_accvgpr_write_b32 a154, v144
  v_perm_b32 v145, v110, v106, s58
  v_accvgpr_write_b32 a155, v145
  v_perm_b32 v144, v86, v82, s59
  v_accvgpr_write_b32 a184, v144
  v_perm_b32 v145, v94, v90, s59
  v_accvgpr_write_b32 a185, v145
  v_perm_b32 v144, v102, v98, s59
  v_accvgpr_write_b32 a186, v144
  v_perm_b32 v145, v110, v106, s59
  v_accvgpr_write_b32 a187, v145
  v_perm_b32 v144, v87, v83, s58
  v_accvgpr_write_b32 a216, v144
  v_perm_b32 v145, v95, v91, s58
  v_accvgpr_write_b32 a217, v145
  v_perm_b32 v144, v103, v99, s58
  v_accvgpr_write_b32 a218, v144
  v_perm_b32 v145, v111, v107, s58
  v_accvgpr_write_b32 a219, v145
  v_perm_b32 v144, v87, v83, s59
  v_accvgpr_write_b32 a248, v144
  v_perm_b32 v145, v95, v91, s59
  v_accvgpr_write_b32 a249, v145
  v_perm_b32 v144, v103, v99, s59
  v_accvgpr_write_b32 a250, v144
  v_perm_b32 v145, v111, v107, s59
  v_accvgpr_write_b32 a251, v145
  s_waitcnt vmcnt(0)
  v_perm_b32 v144, v116, v112, s58
  v_accvgpr_write_b32 a28, v144
  v_perm_b32 v145, v124, v120, s58
  v_accvgpr_write_b32 a29, v145
  v_perm_b32 v144, v132, v128, s58
  v_accvgpr_write_b32 a30, v144
  v_perm_b32 v145, v140, v136, s58
  v_accvgpr_write_b32 a31, v145
  v_perm_b32 v144, v116, v112, s59
  v_accvgpr_write_b32 a60, v144
  v_perm_b32 v145, v124, v120, s59
  v_accvgpr_write_b32 a61, v145
  v_perm_b32 v144, v132, v128, s59
  v_accvgpr_write_b32 a62, v144
  v_perm_b32 v145, v140, v136, s59
  v_accvgpr_write_b32 a63, v145
  v_perm_b32 v144, v117, v113, s58
  v_accvgpr_write_b32 a92, v144
  v_perm_b32 v145, v125, v121, s58
  v_accvgpr_write_b32 a93, v145
  v_perm_b32 v144, v133, v129, s58
  v_accvgpr_write_b32 a94, v144
  v_perm_b32 v145, v141, v137, s58
  v_accvgpr_write_b32 a95, v145
  v_perm_b32 v144, v117, v113, s59
  v_accvgpr_write_b32 a124, v144
  v_perm_b32 v145, v125, v121, s59
  v_accvgpr_write_b32 a125, v145
  v_perm_b32 v144, v133, v129, s59
  v_accvgpr_write_b32 a126, v144
  v_perm_b32 v145, v141, v137, s59
  v_accvgpr_write_b32 a127, v145
  v_perm_b32 v144, v118, v114, s58
  v_accvgpr_write_b32 a156, v144
  v_perm_b32 v145, v126, v122, s58
  v_accvgpr_write_b32 a157, v145
  v_perm_b32 v144, v134, v130, s58
  v_accvgpr_write_b32 a158, v144
  v_perm_b32 v145, v142, v138, s58
  v_accvgpr_write_b32 a159, v145
  v_perm_b32 v144, v118, v114, s59
  v_accvgpr_write_b32 a188, v144
  v_perm_b32 v145, v126, v122, s59
  v_accvgpr_write_b32 a189, v145
  v_perm_b32 v144, v134, v130, s59
  v_accvgpr_write_b32 a190, v144
  v_perm_b32 v145, v142, v138, s59
  v_accvgpr_write_b32 a191, v145
  v_perm_b32 v144, v119, v115, s58
  v_accvgpr_write_b32 a220, v144
  v_perm_b32 v145, v127, v123, s58
  v_accvgpr_write_b32 a221, v145
  v_perm_b32 v144, v135, v131, s58
  v_accvgpr_write_b32 a222, v144
  v_perm_b32 v145, v143, v139, s58
  v_accvgpr_write_b32 a223, v145
  v_perm_b32 v144, v119, v115, s59
  v_accvgpr_write_b32 a252, v144
  v_perm_b32 v145, v127, v123, s59
  v_accvgpr_write_b32 a253, v145
  v_perm_b32 v144, v135, v131, s59
  v_accvgpr_write_b32 a254, v144
  v_perm_b32 v145, v143, v139, s59
  v_accvgpr_write_b32 a255, v145
  v_mov_b32 v5, 84
  s_mov_b64 exec, 1
wd_10:
  buffer_load_dword v4, v5, s[24:27], 0 offen sc1
  s_waitcnt vmcnt(0)
  v_cmp_gt_u32 vcc, 1, v4
  s_cbranch_vccz wdd_11
  s_sub_u32 s3, s3, 1
  s_cbranch_scc1 bail_20
  s_sleep 8
  s_branch wd_10
wdd_11:
  s_mov_b64 exec, -1
  v_lshrrev_b32 v6, 4, v1
  v_mul_u32_u24 v6, 65536, v6
  v_and_b32 v7, 15, v1
  v_lshl_add_u32 v6, v7, 4, v6
  s_lshl_b32 s38, s7, 22
  s_add_u32 s38, s38, 142606336
  s_xor_b32 s33, s6, 1
  s_lshl_b32 s33, s33, 13
  s_add_u32 s47, s38, s33
  s_add_u32 s47, s47, 1048576
  s_lshr_b32 s33, s6, 1
  s_lshl_b32 s33, s33, 10
  s_add_u32 s38, s38, s33
  s_lshl_b32 s33, s45, 8
  s_add_u32 s38, s38, s33
  s_lshl_b32 s33, s36, 2
  v_add_u32 v7, s33, v2
  s_lshl_b32 s33, s7, 7
  s_add_u32 s39, s33, 147456
  s_lshl_b32 s33, s7, 9
  s_lshl_b32 s34, s36, 7
  s_add_u32 s33, s33, s34
  s_lshl_b32 s34, s6, 2
  s_add_u32 s33, s33, s34
  s_add_u32 s41, s33, 151552
  s_lshl_b32 s33, s7, 8
  s_lshl_b32 s34, s6, 3
  s_add_u32 s33, s33, s34
  s_lshl_b32 s34, s36, 2
  s_add_u32 s33, s33, s34
  s_add_u32 s42, s33, 154624
  v_and_b32 v12, 31, v1
  v_lshlrev_b32 v12, 2, v12
  v_bfe_u32 v8, v1, 4, 1
  v_lshlrev_b32 v8, 10, v8
  v_lshrrev_b32 v11, 5, v1
  v_lshl_add_u32 v8, v11, 9, v8
  v_and_b32 v11, 15, v1
  v_lshl_add_u32 v8, v11, 4, v8
  v_mov_b32 v15, v8
  v_mov_b32 v144, 0
  v_mov_b32 v148, 0
  v_mov_b32 v152, 0
  v_mov_b32 v156, 0
  v_mov_b32 v160, 0
  v_mov_b32 v164, 0
  v_mov_b32 v168, 0
  v_mov_b32 v172, 0
dm_12:
  v_and_b32 v5, 15, v1
  v_lshlrev_b32 v5, 2, v5
  v_add_u32 v4, 128, v5
  v_cmp_gt_u32 vcc, 4, v5
  s_nop 1
  v_cndmask_b32 v5, v4, v5, vcc
  buffer_load_dword v4, v5, s[24:27], 0 offen sc1
  s_waitcnt vmcnt(0)
  v_readlane_b32 s34, v4, s5
  s_nop 0
  s_cmp_ge_u32 s34, 32
  s_cbranch_scc1 dmf_13
  v_readlane_b32 s33, v4, 0
  v_readlane_b32 s34, v4, 1
  s_nop 0
  s_add_u32 s33, s33, s34
  v_readlane_b32 s34, v4, 2
  s_nop 0
  s_add_u32 s33, s33, s34
  v_readlane_b32 s34, v4, 3
  s_nop 0
  s_add_u32 s33, s33, s34
  v_readlane_b32 s34, v4, 4
  s_nop 0
  s_add_u32 s33, s33, s34
  v_readlane_b32 s34, v4, 5
  s_nop 0
  s_add_u32 s33, s33, s34
  v_readlane_b32 s34, v4, 6
  s_nop 0
  s_add_u32 s33, s33, s34
  v_readlane_b32 s34, v4, 7
  s_nop 0
  s_add_u32 s33, s33, s34
  v_readlane_b32 s34, v4, 8
  s_nop 0
  s_add_u32 s33, s33, s34
  v_readlane_b32 s34, v4, 9
  s_nop 0
  s_add_u32 s33, s33, s34
  v_readlane_b32 s34, v4, 10
  s_nop 0
  s_add_u32 s33, s33, s34
  v_readlane_b32 s34, v4, 11
  s_nop 0
  s_add_u32 s33, s33, s34
  v_readlane_b32 s34, v4, 12
  s_nop 0
  s_add_u32 s33, s33, s34
  v_readlane_b32 s34, v4, 13
  s_nop 0
  s_add_u32 s33, s33, s34
  v_readlane_b32 s34, v4, 14
  s_nop 0
  s_add_u32 s33, s33, s34
  v_readlane_b32 s34, v4, 15
  s_nop 0
  s_add_u32 s33, s33, s34
  s_cmp_ge_u32 s33, 256
  s_cbranch_scc1 aows_top0
  s_sub_u32 s3, s3, 1
  s_cbranch_scc1 bail_2
  s_sleep 8
  s_branch dm_12
dmf_13:
aowf_top0:
  s_add_u32 s21, s20, 1
ls_14:
  ds_read_b32 v10, v2 offset:0
  s_waitcnt lgkmcnt(0)
  v_cmp_gt_i32 vcc, s21, v10
  s_cbranch_vccz lsd_15
  s_sub_u32 s3, s3, 1
  s_cbranch_scc1 bail_21
  s_sleep 1
  s_branch ls_14
lsd_15:
  ds_read_b128 v[16:19], v8 offset:0
  ds_read_b128 v[20:23], v8 offset:2048
  ds_read_b128 v[24:27], v8 offset:4096
  ds_read_b128 v[28:31], v8 offset:6144
  ds_read_b128 v[32:35], v8 offset:256
  ds_read_b128 v[36:39], v8 offset:2304
  ds_read_b128 v[40:43], v8 offset:4352
  ds_read_b128 v[44:47], v8 offset:6400
  s_lshr_b32 s48, s20, 1
  s_and_b32 s48, s48, 1
  s_xor_b32 s48, s48, 1
  s_add_u32 s49, s47, 0
  s_add_u32 s50, s49, 4096
  s_add_u32 s52, s47, 262144
  s_add_u32 s53, s52, 4096
  v_mov_b32 v9, s21
  s_add_u32 s44, s44, 1
  s_cmp_eq_u32 s44, 2
  s_cselect_b32 s44, 0, s44
  s_cselect_b32 s23, 1, 0
  s_xor_b32 s22, s22, s23
  s_lshl_b32 s23, s44, 19
  s_add_u32 s23, s23, s38
  s_waitcnt lgkmcnt(7)
  v_mfma_f32_16x16x32_bf16 v[80:83], v[16:19], a[0:3], 0
  s_waitcnt vmcnt(8)
  v_xor_b32 v14, s48, v144
  v_bitop3_b32 v14, v14, s48, v148 bitop3:0xf6
  v_mfma_f32_16x16x32_bf16 v[84:87], v[16:19], a[32:35], 0
  v_bitop3_b32 v14, v14, s48, v152 bitop3:0xf6
  v_bitop3_b32 v14, v14, s48, v156 bitop3:0xf6
  v_mfma_f32_16x16x32_bf16 v[88:91], v[16:19], a[64:67], 0
  v_bitop3_b32 v14, v14, s48, v160 bitop3:0xf6
  v_bitop3_b32 v14, v14, s48, v164 bitop3:0xf6
  v_mfma_f32_16x16x32_bf16 v[92:95], v[16:19], a[96:99], 0
  v_bitop3_b32 v14, v14, s48, v168 bitop3:0xf6
  v_bitop3_b32 v14, v14, s48, v172 bitop3:0xf6
  v_mfma_f32_16x16x32_bf16 v[96:99], v[16:19], a[128:131], 0
  v_and_b32 v14, 1, v14
  v_cmp_ne_u32 vcc, 0, v14
  v_mfma_f32_16x16x32_bf16 v[100:103], v[16:19], a[160:163], 0
  v_mfma_f32_16x16x32_bf16 v[104:107], v[16:19], a[192:195], 0
  v_mfma_f32_16x16x32_bf16 v[108:111], v[16:19], a[224:227], 0
  s_waitcnt lgkmcnt(6)
  v_mfma_f32_16x16x32_bf16 v[80:83], v[20:23], a[4:7], v[80:83]
  v_mfma_f32_16x16x32_bf16 v[84:87], v[20:23], a[36:39], v[84:87]
  v_mfma_f32_16x16x32_bf16 v[88:91], v[20:23], a[68:71], v[88:91]
  v_mfma_f32_16x16x32_bf16 v[92:95], v[20:23], a[100:103], v[92:95]
  v_mfma_f32_16x16x32_bf16 v[96:99], v[20:23], a[132:135], v[96:99]
  s_cbranch_vccnz aowf0_ld
aowf0_lk:
  v_mfma_f32_16x16x32_bf16 v[100:103], v[20:23], a[164:167], v[100:103]
  v_mfma_f32_16x16x32_bf16 v[104:107], v[20:23], a[196:199], v[104:107]
  v_mfma_f32_16x16x32_bf16 v[108:111], v[20:23], a[228:231], v[108:111]
  s_waitcnt lgkmcnt(5)
  v_mfma_f32_16x16x32_bf16 v[80:83], v[24:27], a[8:11], v[80:83]
  v_mfma_f32_16x16x32_bf16 v[84:87], v[24:27], a[40:43], v[84:87]
  v_mfma_f32_16x16x32_bf16 v[88:91], v[24:27], a[72:75], v[88:91]
  v_mfma_f32_16x16x32_bf16 v[92:95], v[24:27], a[104:107], v[92:95]
  v_mfma_f32_16x16x32_bf16 v[96:99], v[24:27], a[136:139], v[96:99]
  v_mfma_f32_16x16x32_bf16 v[100:103], v[24:27], a[168:171], v[100:103]
  v_mfma_f32_16x16x32_bf16 v[104:107], v[24:27], a[200:203], v[104:107]
  v_mfma_f32_16x16x32_bf16 v[108:111], v[24:27], a[232:235], v[108:111]
  s_waitcnt lgkmcnt(4)
  v_mfma_f32_16x16x32_bf16 v[80:83], v[28:31], a[12:15], v[80:83]
  v_mfma_f32_16x16x32_bf16 v[84:87], v[28:31], a[44:47], v[84:87]
  v_mfma_f32_16x16x32_bf16 v[88:91], v[28:31], a[76:79], v[88:91]
  v_mfma_f32_16x16x32_bf16 v[92:95], v[28:31], a[108:111], v[92:95]
  v_mfma_f32_16x16x32_bf16 v[96:99], v[28:31], a[140:143], v[96:99]
  v_mfma_f32_16x16x32_bf16 v[100:103], v[28:31], a[172:175], v[100:103]
  v_mfma_f32_16x16x32_bf16 v[104:107], v[28:31], a[204:207], v[104:107]
  v_mfma_f32_16x16x32_bf16 v[108:111], v[28:31], a[236:239], v[108:111]
  s_waitcnt lgkmcnt(3)
  v_mfma_f32_16x16x32_bf16 v[112:115], v[32:35], a[0:3], 0
  v_mfma_f32_16x16x32_bf16 v[116:119], v[32:35], a[32:35], 0
  v_mfma_f32_16x16x32_bf16 v[120:123], v[32:35], a[64:67], 0
  v_mfma_f32_16x16x32_bf16 v[124:127], v[32:35], a[96:99], 0
  v_mfma_f32_16x16x32_bf16 v[128:131], v[32:35], a[128:131], 0
  v_mfma_f32_16x16x32_bf16 v[132:135], v[32:35], a[160:163], 0
  v_mfma_f32_16x16x32_bf16 v[136:139], v[32:35], a[192:195], 0
  v_mfma_f32_16x16x32_bf16 v[140:143], v[32:35], a[224:227], 0
  s_waitcnt lgkmcnt(2)
  v_mfma_f32_16x16x32_bf16 v[112:115], v[36:39], a[4:7], v[112:115]
  v_mfma_f32_16x16x32_bf16 v[116:119], v[36:39], a[36:39], v[116:119]
  v_mfma_f32_16x16x32_bf16 v[120:123], v[36:39], a[68:71], v[120:123]
  v_mfma_f32_16x16x32_bf16 v[124:127], v[36:39], a[100:103], v[124:127]
  s_sub_u32 s40, s20, 1
  v_mfma_f32_16x16x32_bf16 v[128:131], v[36:39], a[132:135], v[128:131]
  buffer_load_dword v13, v12, s[8:11], s39 offen sc1
  v_mfma_f32_16x16x32_bf16 v[132:135], v[36:39], a[164:167], v[132:135]
  v_mfma_f32_16x16x32_bf16 v[136:139], v[36:39], a[196:199], v[136:139]
  v_mfma_f32_16x16x32_bf16 v[140:143], v[36:39], a[228:231], v[140:143]
  s_waitcnt lgkmcnt(1)
  v_mfma_f32_16x16x32_bf16 v[112:115], v[40:43], a[8:11], v[112:115]
  v_mfma_f32_16x16x32_bf16 v[116:119], v[40:43], a[40:43], v[116:119]
  v_mfma_f32_16x16x32_bf16 v[120:123], v[40:43], a[72:75], v[120:123]
  v_mfma_f32_16x16x32_bf16 v[124:127], v[40:43], a[104:107], v[124:127]
  v_mfma_f32_16x16x32_bf16 v[128:131], v[40:43], a[136:139], v[128:131]
  v_mfma_f32_16x16x32_bf16 v[132:135], v[40:43], a[168:171], v[132:135]
  v_mfma_f32_16x16x32_bf16 v[136:139], v[40:43], a[200:203], v[136:139]
  v_mfma_f32_16x16x32_bf16 v[140:143], v[40:43], a[232:235], v[140:143]
  s_waitcnt lgkmcnt(0)
  v_mfma_f32_16x16x32_bf16 v[112:115], v[44:47], a[12:15], v[112:115]
  ds_write_b32 v7, v9 offset:4
  v_mfma_f32_16x16x32_bf16 v[116:119], v[44:47], a[44:47], v[116:119]
  s_waitcnt vmcnt(1)
  v_xor_b32 v14, s48, v144
  v_bitop3_b32 v14, v14, s48, v148 bitop3:0xf6
  v_mfma_f32_16x16x32_bf16 v[120:123], v[44:47], a[76:79], v[120:123]
  v_bitop3_b32 v14, v14, s48, v152 bitop3:0xf6
  v_bitop3_b32 v14, v14, s48, v156 bitop3:0xf6
  v_mfma_f32_16x16x32_bf16 v[124:127], v[44:47], a[108:111], v[124:127]
  v_bitop3_b32 v14, v14, s48, v160 bitop3:0xf6
  v_bitop3_b32 v14, v14, s48, v164 bitop3:0xf6
  v_mfma_f32_16x16x32_bf16 v[128:131], v[44:47], a[140:143], v[128:131]
  v_bitop3_b32 v14, v14, s48, v168 bitop3:0xf6
  v_bitop3_b32 v14, v14, s48, v172 bitop3:0xf6
  v_mfma_f32_16x16x32_bf16 v[132:135], v[44:47], a[172:175], v[132:135]
  v_and_b32 v14, 1, v14
  v_cmp_ne_u32 vcc, 0, v14
  v_mfma_f32_16x16x32_bf16 v[136:139], v[44:47], a[204:207], v[136:139]
  v_mfma_f32_16x16x32_bf16 v[140:143], v[44:47], a[236:239], v[140:143]
  s_cbranch_vccnz aowf0_pr
aowf0_pok:
  v_mfma_f32_16x16x32_bf16 v[80:83], v[144:147], a[16:19], v[80:83]
  s_mov_b64 exec, 1
  buffer_store_dword v9, off, s[8:11], s42
  s_mov_b64 exec, -1
  v_mfma_f32_16x16x32_bf16 v[84:87], v[144:147], a[48:51], v[84:87]
  v_mfma_f32_16x16x32_bf16 v[88:91], v[144:147], a[80:83], v[88:91]
  v_mfma_f32_16x16x32_bf16 v[92:95], v[144:147], a[112:115], v[92:95]
  v_mfma_f32_16x16x32_bf16 v[96:99], v[144:147], a[144:147], v[96:99]
  v_mfma_f32_16x16x32_bf16 v[100:103], v[144:147], a[176:179], v[100:103]
  v_mfma_f32_16x16x32_bf16 v[104:107], v[144:147], a[208:211], v[104:107]
  v_mfma_f32_16x16x32_bf16 v[108:111], v[144:147], a[240:243], v[108:111]
  v_mfma_f32_16x16x32_bf16 v[80:83], v[148:151], a[20:23], v[80:83]
  buffer_load_dword v11, v12, s[8:11], s39 offen sc1
  v_mfma_f32_16x16x32_bf16 v[84:87], v[148:151], a[52:55], v[84:87]
  v_mfma_f32_16x16x32_bf16 v[88:91], v[148:151], a[84:87], v[88:91]
  v_mfma_f32_16x16x32_bf16 v[92:95], v[148:151], a[116:119], v[92:95]
  v_mfma_f32_16x16x32_bf16 v[96:99], v[148:151], a[148:151], v[96:99]
  buffer_load_dwordx4 v[176:179], v15, s[8:11], s52 offen offset:0 sc1
  v_mfma_f32_16x16x32_bf16 v[100:103], v[148:151], a[180:183], v[100:103]
  v_mfma_f32_16x16x32_bf16 v[104:107], v[148:151], a[212:215], v[104:107]
  buffer_load_dwordx4 v[180:183], v15, s[8:11], s52 offen offset:2048 sc1
  v_mfma_f32_16x16x32_bf16 v[108:111], v[148:151], a[244:247], v[108:111]
  v_mfma_f32_16x16x32_bf16 v[80:83], v[152:155], a[24:27], v[80:83]
  buffer_load_dwordx4 v[184:187], v15, s[8:11], s53 offen offset:0 sc1
  v_mfma_f32_16x16x32_bf16 v[84:87], v[152:155], a[56:59], v[84:87]
  v_mfma_f32_16x16x32_bf16 v[88:91], v[152:155], a[88:91], v[88:91]
  buffer_load_dwordx4 v[188:191], v15, s[8:11], s53 offen offset:2048 sc1
  v_mfma_f32_16x16x32_bf16 v[92:95], v[152:155], a[120:123], v[92:95]
  v_mfma_f32_16x16x32_bf16 v[96:99], v[152:155], a[152:155], v[96:99]
  buffer_load_dwordx4 v[192:195], v15, s[8:11], s52 offen offset:256 sc1
  v_mfma_f32_16x16x32_bf16 v[100:103], v[152:155], a[184:187], v[100:103]
  v_mfma_f32_16x16x32_bf16 v[104:107], v[152:155], a[216:219], v[104:107]
  buffer_load_dwordx4 v[196:199], v15, s[8:11], s52 offen offset:2304 sc1
  v_mfma_f32_16x16x32_bf16 v[108:111], v[152:155], a[248:251], v[108:111]
  v_mfma_f32_16x16x32_bf16 v[80:83], v[156:159], a[28:31], v[80:83]
  buffer_load_dwordx4 v[200:203], v15, s[8:11], s53 offen offset:256 sc1
  v_mfma_f32_16x16x32_bf16 v[84:87], v[156:159], a[60:63], v[84:87]
  v_mfma_f32_16x16x32_bf16 v[88:91], v[156:159], a[92:95], v[88:91]
  buffer_load_dwordx4 v[204:207], v15, s[8:11], s53 offen offset:2304 sc1
  v_mfma_f32_16x16x32_bf16 v[92:95], v[156:159], a[124:127], v[92:95]
  v_mfma_f32_16x16x32_bf16 v[96:99], v[156:159], a[156:159], v[96:99]
  s_waitcnt vmcnt(10)
  v_cmp_gt_i32 vcc, s40, v13
  v_mfma_f32_16x16x32_bf16 v[100:103], v[156:159], a[188:191], v[100:103]
  v_mfma_f32_16x16x32_bf16 v[104:107], v[156:159], a[220:223], v[104:107]
  s_and_b32 s33, vcc_lo, 0xffff
  v_mfma_f32_16x16x32_bf16 v[108:111], v[156:159], a[252:255], v[108:111]
  s_cbranch_scc1 aowf0_rw0
aowf0_rok0:
  v_mfma_f32_16x16x32_bf16 v[112:115], v[160:163], a[16:19], v[112:115]
  v_mfma_f32_16x16x32_bf16 v[116:119], v[160:163], a[48:51], v[116:119]
  v_cvt_pk_bf16_f32 v48, v80, v84
  v_cvt_pk_bf16_f32 v49, v88, v92
  v_mfma_f32_16x16x32_bf16 v[120:123], v[160:163], a[80:83], v[120:123]
  v_cvt_pk_bf16_f32 v50, v96, v100
  v_cvt_pk_bf16_f32 v51, v104, v108
  v_mfma_f32_16x16x32_bf16 v[124:127], v[160:163], a[112:115], v[124:127]
  v_and_or_b32 v48, v48, -2, s22
  v_mfma_f32_16x16x32_bf16 v[128:131], v[160:163], a[144:147], v[128:131]
  s_add_u32 s33, s23, 0
  v_mfma_f32_16x16x32_bf16 v[132:135], v[160:163], a[176:179], v[132:135]
  buffer_store_dwordx4 v[48:51], v6, s[8:11], s33 offen
  v_cvt_pk_bf16_f32 v52, v81, v85
  v_cvt_pk_bf16_f32 v53, v89, v93
  v_mfma_f32_16x16x32_bf16 v[136:139], v[160:163], a[208:211], v[136:139]
  v_cvt_pk_bf16_f32 v54, v97, v101
  v_cvt_pk_bf16_f32 v55, v105, v109
  v_mfma_f32_16x16x32_bf16 v[140:143], v[160:163], a[240:243], v[140:143]
  v_and_or_b32 v52, v52, -2, s22
  v_mfma_f32_16x16x32_bf16 v[112:115], v[164:167], a[20:23], v[112:115]
  s_add_u32 s33, s23, 16384
  v_mfma_f32_16x16x32_bf16 v[116:119], v[164:167], a[52:55], v[116:119]
  buffer_store_dwordx4 v[52:55], v6, s[8:11], s33 offen
  v_cvt_pk_bf16_f32 v56, v82, v86
  v_cvt_pk_bf16_f32 v57, v90, v94
  v_mfma_f32_16x16x32_bf16 v[120:123], v[164:167], a[84:87], v[120:123]
  v_cvt_pk_bf16_f32 v58, v98, v102
  v_cvt_pk_bf16_f32 v59, v106, v110
  v_mfma_f32_16x16x32_bf16 v[124:127], v[164:167], a[116:119], v[124:127]
  v_and_or_b32 v56, v56, -2, s22
  v_mfma_f32_16x16x32_bf16 v[128:131], v[164:167], a[148:151], v[128:131]
  s_add_u32 s33, s23, 32768
  v_mfma_f32_16x16x32_bf16 v[132:135], v[164:167], a[180:183], v[132:135]
  buffer_store_dwordx4 v[56:59], v6, s[8:11], s33 offen
  v_cvt_pk_bf16_f32 v60, v83, v87
  v_cvt_pk_bf16_f32 v61, v91, v95
  v_mfma_f32_16x16x32_bf16 v[136:139], v[164:167], a[212:215], v[136:139]
  v_cvt_pk_bf16_f32 v62, v99, v103
  v_cvt_pk_bf16_f32 v63, v107, v111
  v_mfma_f32_16x16x32_bf16 v[140:143], v[164:167], a[244:247], v[140:143]
  v_and_or_b32 v60, v60, -2, s22
  v_mfma_f32_16x16x32_bf16 v[112:115], v[168:171], a[24:27], v[112:115]
  s_add_u32 s33, s23, 49152
  v_mfma_f32_16x16x32_bf16 v[116:119], v[168:171], a[56:59], v[116:119]
  buffer_store_dwordx4 v[60:63], v6, s[8:11], s33 offen
  v_mfma_f32_16x16x32_bf16 v[120:123], v[168:171], a[88:91], v[120:123]
  ds_write_b32 v7, v9 offset:12
  v_mfma_f32_16x16x32_bf16 v[124:127], v[168:171], a[120:123], v[124:127]
  v_mfma_f32_16x16x32_bf16 v[128:131], v[168:171], a[152:155], v[128:131]
  v_mfma_f32_16x16x32_bf16 v[132:135], v[168:171], a[184:187], v[132:135]
  v_mfma_f32_16x16x32_bf16 v[136:139], v[168:171], a[216:219], v[136:139]
  v_mfma_f32_16x16x32_bf16 v[140:143], v[168:171], a[248:251], v[140:143]
  v_mfma_f32_16x16x32_bf16 v[112:115], v[172:175], a[28:31], v[112:115]
  v_mfma_f32_16x16x32_bf16 v[116:119], v[172:175], a[60:63], v[116:119]
  v_mfma_f32_16x16x32_bf16 v[120:123], v[172:175], a[92:95], v[120:123]
  v_mfma_f32_16x16x32_bf16 v[124:127], v[172:175], a[124:127], v[124:127]
  s_waitcnt vmcnt(12)
  v_cmp_gt_i32 vcc, s40, v11
  v_mfma_f32_16x16x32_bf16 v[128:131], v[172:175], a[156:159], v[128:131]
  v_mfma_f32_16x16x32_bf16 v[132:135], v[172:175], a[188:191], v[132:135]
  v_mfma_f32_16x16x32_bf16 v[136:139], v[172:175], a[220:223], v[136:139]
  s_cbranch_vccnz aowf0_rw1
aowf0_rok1:
  v_mfma_f32_16x16x32_bf16 v[140:143], v[172:175], a[252:255], v[140:143]
  v_cvt_pk_bf16_f32 v64, v112, v116
  v_cvt_pk_bf16_f32 v65, v120, v124
  v_cvt_pk_bf16_f32 v66, v128, v132
  s_nop 4
  v_cvt_pk_bf16_f32 v67, v136, v140
  v_and_or_b32 v64, v64, -2, s22
  s_add_u32 s33, s23, 262144
  buffer_store_dwordx4 v[64:67], v6, s[8:11], s33 offen
  v_cvt_pk_bf16_f32 v68, v113, v117
  v_cvt_pk_bf16_f32 v69, v121, v125
  v_cvt_pk_bf16_f32 v70, v129, v133
  v_cvt_pk_bf16_f32 v71, v137, v141
  v_and_or_b32 v68, v68, -2, s22
  s_add_u32 s33, s23, 278528
  buffer_store_dwordx4 v[68:71], v6, s[8:11], s33 offen
  v_cvt_pk_bf16_f32 v72, v114, v118
  v_cvt_pk_bf16_f32 v73, v122, v126
  v_cvt_pk_bf16_f32 v74, v130, v134
  v_cvt_pk_bf16_f32 v75, v138, v142
  v_and_or_b32 v72, v72, -2, s22
  s_add_u32 s33, s23, 294912
  buffer_store_dwordx4 v[72:75], v6, s[8:11], s33 offen
  v_cvt_pk_bf16_f32 v76, v115, v119
  v_cvt_pk_bf16_f32 v77, v123, v127
  v_cvt_pk_bf16_f32 v78, v131, v135
  v_cvt_pk_bf16_f32 v79, v139, v143
  v_and_or_b32 v76, v76, -2, s22
  s_add_u32 s33, s23, 311296
  buffer_store_dwordx4 v[76:79], v6, s[8:11], s33 offen
  ds_write_b32 v7, v9 offset:20
  s_mov_b32 s20, s21
aowf_top1:
  s_add_u32 s21, s20, 1
ls_16:
  ds_read_b32 v10, v2 offset:0
  s_waitcnt lgkmcnt(0)
  v_cmp_gt_i32 vcc, s21, v10
  s_cbranch_vccz lsd_17
  s_sub_u32 s3, s3, 1
  s_cbranch_scc1 bail_21
  s_sleep 1
  s_branch ls_16
lsd_17:
  ds_read_b128 v[16:19], v8 offset:8192
  ds_read_b128 v[20:23], v8 offset:10240
  ds_read_b128 v[24:27], v8 offset:12288
  ds_read_b128 v[28:31], v8 offset:14336
  ds_read_b128 v[32:35], v8 offset:8448
  ds_read_b128 v[36:39], v8 offset:10496
  ds_read_b128 v[40:43], v8 offset:12544
  ds_read_b128 v[44:47], v8 offset:14592
  s_lshr_b32 s48, s20, 1
  s_and_b32 s48, s48, 1
  s_xor_b32 s48, s48, 1
  s_add_u32 s49, s47, 262144
  s_add_u32 s50, s49, 4096
  s_add_u32 s52, s47, 0
  s_add_u32 s53, s52, 4096
  v_mov_b32 v9, s21
  s_add_u32 s44, s44, 1
  s_cmp_eq_u32 s44, 2
  s_cselect_b32 s44, 0, s44
  s_cselect_b32 s23, 1, 0
  s_xor_b32 s22, s22, s23
  s_lshl_b32 s23, s44, 19
  s_add_u32 s23, s23, s38
  s_waitcnt lgkmcnt(7)
  v_mfma_f32_16x16x32_bf16 v[80:83], v[16:19], a[0:3], 0
  s_waitcnt vmcnt(8)
  v_xor_b32 v14, s48, v176
  v_bitop3_b32 v14, v14, s48, v180 bitop3:0xf6
  v_mfma_f32_16x16x32_bf16 v[84:87], v[16:19], a[32:35], 0
  v_bitop3_b32 v14, v14, s48, v184 bitop3:0xf6
  v_bitop3_b32 v14, v14, s48, v188 bitop3:0xf6
  v_mfma_f32_16x16x32_bf16 v[88:91], v[16:19], a[64:67], 0
  v_bitop3_b32 v14, v14, s48, v192 bitop3:0xf6
  v_bitop3_b32 v14, v14, s48, v196 bitop3:0xf6
  v_mfma_f32_16x16x32_bf16 v[92:95], v[16:19], a[96:99], 0
  v_bitop3_b32 v14, v14, s48, v200 bitop3:0xf6
  v_bitop3_b32 v14, v14, s48, v204 bitop3:0xf6
  v_mfma_f32_16x16x32_bf16 v[96:99], v[16:19], a[128:131], 0
  v_and_b32 v14, 1, v14
  v_cmp_ne_u32 vcc, 0, v14
  v_mfma_f32_16x16x32_bf16 v[100:103], v[16:19], a[160:163], 0
  v_mfma_f32_16x16x32_bf16 v[104:107], v[16:19], a[192:195], 0
  v_mfma_f32_16x16x32_bf16 v[108:111], v[16:19], a[224:227], 0
  s_waitcnt lgkmcnt(6)
  v_mfma_f32_16x16x32_bf16 v[80:83], v[20:23], a[4:7], v[80:83]
  v_mfma_f32_16x16x32_bf16 v[84:87], v[20:23], a[36:39], v[84:87]
  v_mfma_f32_16x16x32_bf16 v[88:91], v[20:23], a[68:71], v[88:91]
  v_mfma_f32_16x16x32_bf16 v[92:95], v[20:23], a[100:103], v[92:95]
  v_mfma_f32_16x16x32_bf16 v[96:99], v[20:23], a[132:135], v[96:99]
  s_cbranch_vccnz aowf1_ld
aowf1_lk:
  v_mfma_f32_16x16x32_bf16 v[100:103], v[20:23], a[164:167], v[100:103]
  v_mfma_f32_16x16x32_bf16 v[104:107], v[20:23], a[196:199], v[104:107]
  v_mfma_f32_16x16x32_bf16 v[108:111], v[20:23], a[228:231], v[108:111]
  s_waitcnt lgkmcnt(5)
  v_mfma_f32_16x16x32_bf16 v[80:83], v[24:27], a[8:11], v[80:83]
  v_mfma_f32_16x16x32_bf16 v[84:87], v[24:27], a[40:43], v[84:87]
  v_mfma_f32_16x16x32_bf16 v[88:91], v[24:27], a[72:75], v[88:91]
  v_mfma_f32_16x16x32_bf16 v[92:95], v[24:27], a[104:107], v[92:95]
  v_mfma_f32_16x16x32_bf16 v[96:99], v[24:27], a[136:139], v[96:99]
  v_mfma_f32_16x16x32_bf16 v[100:103], v[24:27], a[168:171], v[100:103]
  v_mfma_f32_16x16x32_bf16 v[104:107], v[24:27], a[200:203], v[104:107]
  v_mfma_f32_16x16x32_bf16 v[108:111], v[24:27], a[232:235], v[108:111]
  s_waitcnt lgkmcnt(4)
  v_mfma_f32_16x16x32_bf16 v[80:83], v[28:31], a[12:15], v[80:83]
  v_mfma_f32_16x16x32_bf16 v[84:87], v[28:31], a[44:47], v[84:87]
  v_mfma_f32_16x16x32_bf16 v[88:91], v[28:31], a[76:79], v[88:91]
  v_mfma_f32_16x16x32_bf16 v[92:95], v[28:31], a[108:111], v[92:95]
  v_mfma_f32_16x16x32_bf16 v[96:99], v[28:31], a[140:143], v[96:99]
  v_mfma_f32_16x16x32_bf16 v[100:103], v[28:31], a[172:175], v[100:103]
  v_mfma_f32_16x16x32_bf16 v[104:107], v[28:31], a[204:207], v[104:107]
  v_mfma_f32_16x16x32_bf16 v[108:111], v[28:31], a[236:239], v[108:111]
  s_waitcnt lgkmcnt(3)
  v_mfma_f32_16x16x32_bf16 v[112:115], v[32:35], a[0:3], 0
  v_mfma_f32_16x16x32_bf16 v[116:119], v[32:35], a[32:35], 0
  v_mfma_f32_16x16x32_bf16 v[120:123], v[32:35], a[64:67], 0
  v_mfma_f32_16x16x32_bf16 v[124:127], v[32:35], a[96:99], 0
  v_mfma_f32_16x16x32_bf16 v[128:131], v[32:35], a[128:131], 0
  v_mfma_f32_16x16x32_bf16 v[132:135], v[32:35], a[160:163], 0
  v_mfma_f32_16x16x32_bf16 v[136:139], v[32:35], a[192:195], 0
  v_mfma_f32_16x16x32_bf16 v[140:143], v[32:35], a[224:227], 0
  s_waitcnt lgkmcnt(2)
  v_mfma_f32_16x16x32_bf16 v[112:115], v[36:39], a[4:7], v[112:115]
  v_mfma_f32_16x16x32_bf16 v[116:119], v[36:39], a[36:39], v[116:119]
  v_mfma_f32_16x16x32_bf16 v[120:123], v[36:39], a[68:71], v[120:123]
  v_mfma_f32_16x16x32_bf16 v[124:127], v[36:39], a[100:103], v[124:127]
  s_sub_u32 s40, s20, 1
  v_mfma_f32_16x16x32_bf16 v[128:131], v[36:39], a[132:135], v[128:131]
  buffer_load_dword v13, v12, s[8:11], s39 offen sc1
  v_mfma_f32_16x16x32_bf16 v[132:135], v[36:39], a[164:167], v[132:135]
  v_mfma_f32_16x16x32_bf16 v[136:139], v[36:39], a[196:199], v[136:139]
  v_mfma_f32_16x16x32_bf16 v[140:143], v[36:39], a[228:231], v[140:143]
  s_waitcnt lgkmcnt(1)
  v_mfma_f32_16x16x32_bf16 v[112:115], v[40:43], a[8:11], v[112:115]
  v_mfma_f32_16x16x32_bf16 v[116:119], v[40:43], a[40:43], v[116:119]
  v_mfma_f32_16x16x32_bf16 v[120:123], v[40:43], a[72:75], v[120:123]
  v_mfma_f32_16x16x32_bf16 v[124:127], v[40:43], a[104:107], v[124:127]
  v_mfma_f32_16x16x32_bf16 v[128:131], v[40:43], a[136:139], v[128:131]
  v_mfma_f32_16x16x32_bf16 v[132:135], v[40:43], a[168:171], v[132:135]
  v_mfma_f32_16x16x32_bf16 v[136:139], v[40:43], a[200:203], v[136:139]
  v_mfma_f32_16x16x32_bf16 v[140:143], v[40:43], a[232:235], v[140:143]
  s_waitcnt lgkmcnt(0)
  v_mfma_f32_16x16x32_bf16 v[112:115], v[44:47], a[12:15], v[112:115]
  ds_write_b32 v7, v9 offset:4
  v_mfma_f32_16x16x32_bf16 v[116:119], v[44:47], a[44:47], v[116:119]
  s_waitcnt vmcnt(1)
  v_xor_b32 v14, s48, v176
  v_bitop3_b32 v14, v14, s48, v180 bitop3:0xf6
  v_mfma_f32_16x16x32_bf16 v[120:123], v[44:47], a[76:79], v[120:123]
  v_bitop3_b32 v14, v14, s48, v184 bitop3:0xf6
  v_bitop3_b32 v14, v14, s48, v188 bitop3:0xf6
  v_mfma_f32_16x16x32_bf16 v[124:127], v[44:47], a[108:111], v[124:127]
  v_bitop3_b32 v14, v14, s48, v192 bitop3:0xf6
  v_bitop3_b32 v14, v14, s48, v196 bitop3:0xf6
  v_mfma_f32_16x16x32_bf16 v[128:131], v[44:47], a[140:143], v[128:131]
  v_bitop3_b32 v14, v14, s48, v200 bitop3:0xf6
  v_bitop3_b32 v14, v14, s48, v204 bitop3:0xf6
  v_mfma_f32_16x16x32_bf16 v[132:135], v[44:47], a[172:175], v[132:135]
  v_and_b32 v14, 1, v14
  v_cmp_ne_u32 vcc, 0, v14
  v_mfma_f32_16x16x32_bf16 v[136:139], v[44:47], a[204:207], v[136:139]
  v_mfma_f32_16x16x32_bf16 v[140:143], v[44:47], a[236:239], v[140:143]
  s_cbranch_vccnz aowf1_pr
aowf1_pok:
  v_mfma_f32_16x16x32_bf16 v[80:83], v[176:179], a[16:19], v[80:83]
  s_mov_b64 exec, 1
  buffer_store_dword v9, off, s[8:11], s42
  s_mov_b64 exec, -1
  v_mfma_f32_16x16x32_bf16 v[84:87], v[176:179], a[48:51], v[84:87]
  v_mfma_f32_16x16x32_bf16 v[88:91], v[176:179], a[80:83], v[88:91]
  v_mfma_f32_16x16x32_bf16 v[92:95], v[176:179], a[112:115], v[92:95]
  v_mfma_f32_16x16x32_bf16 v[96:99], v[176:179], a[144:147], v[96:99]
  v_mfma_f32_16x16x32_bf16 v[100:103], v[176:179], a[176:179], v[100:103]
  v_mfma_f32_16x16x32_bf16 v[104:107], v[176:179], a[208:211], v[104:107]
  v_mfma_f32_16x16x32_bf16 v[108:111], v[176:179], a[240:243], v[108:111]
  v_mfma_f32_16x16x32_bf16 v[80:83], v[180:183], a[20:23], v[80:83]
  buffer_load_dword v11, v12, s[8:11], s39 offen sc1
  v_mfma_f32_16x16x32_bf16 v[84:87], v[180:183], a[52:55], v[84:87]
  v_mfma_f32_16x16x32_bf16 v[88:91], v[180:183], a[84:87], v[88:91]
  v_mfma_f32_16x16x32_bf16 v[92:95], v[180:183], a[116:119], v[92:95]
  v_mfma_f32_16x16x32_bf16 v[96:99], v[180:183], a[148:151], v[96:99]
  buffer_load_dwordx4 v[144:147], v15, s[8:11], s52 offen offset:0 sc1
  v_mfma_f32_16x16x32_bf16 v[100:103], v[180:183], a[180:183], v[100:103]
  v_mfma_f32_16x16x32_bf16 v[104:107], v[180:183], a[212:215], v[104:107]
  buffer_load_dwordx4 v[148:151], v15, s[8:11], s52 offen offset:2048 sc1
  v_mfma_f32_16x16x32_bf16 v[108:111], v[180:183], a[244:247], v[108:111]
  v_mfma_f32_16x16x32_bf16 v[80:83], v[184:187], a[24:27], v[80:83]
  buffer_load_dwordx4 v[152:155], v15, s[8:11], s53 offen offset:0 sc1
  v_mfma_f32_16x16x32_bf16 v[84:87], v[184:187], a[56:59], v[84:87]
  v_mfma_f32_16x16x32_bf16 v[88:91], v[184:187], a[88:91], v[88:91]
  buffer_load_dwordx4 v[156:159], v15, s[8:11], s53 offen offset:2048 sc1
  v_mfma_f32_16x16x32_bf16 v[92:95], v[184:187], a[120:123], v[92:95]
  v_mfma_f32_16x16x32_bf16 v[96:99], v[184:187], a[152:155], v[96:99]
  buffer_load_dwordx4 v[160:163], v15, s[8:11], s52 offen offset:256 sc1
  v_mfma_f32_16x16x32_bf16 v[100:103], v[184:187], a[184:187], v[100:103]
  v_mfma_f32_16x16x32_bf16 v[104:107], v[184:187], a[216:219], v[104:107]
  buffer_load_dwordx4 v[164:167], v15, s[8:11], s52 offen offset:2304 sc1
  v_mfma_f32_16x16x32_bf16 v[108:111], v[184:187], a[248:251], v[108:111]
  v_mfma_f32_16x16x32_bf16 v[80:83], v[188:191], a[28:31], v[80:83]
  buffer_load_dwordx4 v[168:171], v15, s[8:11], s53 offen offset:256 sc1
  v_mfma_f32_16x16x32_bf16 v[84:87], v[188:191], a[60:63], v[84:87]
  v_mfma_f32_16x16x32_bf16 v[88:91], v[188:191], a[92:95], v[88:91]
  buffer_load_dwordx4 v[172:175], v15, s[8:11], s53 offen offset:2304 sc1
  v_mfma_f32_16x16x32_bf16 v[92:95], v[188:191], a[124:127], v[92:95]
  v_mfma_f32_16x16x32_bf16 v[96:99], v[188:191], a[156:159], v[96:99]
  s_waitcnt vmcnt(10)
  v_cmp_gt_i32 vcc, s40, v13
  v_mfma_f32_16x16x32_bf16 v[100:103], v[188:191], a[188:191], v[100:103]
  v_mfma_f32_16x16x32_bf16 v[104:107], v[188:191], a[220:223], v[104:107]
  s_and_b32 s33, vcc_lo, 0xffff
  v_mfma_f32_16x16x32_bf16 v[108:111], v[188:191], a[252:255], v[108:111]
  s_cbranch_scc1 aowf1_rw0
aowf1_rok0:
  v_mfma_f32_16x16x32_bf16 v[112:115], v[192:195], a[16:19], v[112:115]
  v_mfma_f32_16x16x32_bf16 v[116:119], v[192:195], a[48:51], v[116:119]
  v_cvt_pk_bf16_f32 v48, v80, v84
  v_cvt_pk_bf16_f32 v49, v88, v92
  v_mfma_f32_16x16x32_bf16 v[120:123], v[192:195], a[80:83], v[120:123]
  v_cvt_pk_bf16_f32 v50, v96, v100
  v_cvt_pk_bf16_f32 v51, v104, v108
  v_mfma_f32_16x16x32_bf16 v[124:127], v[192:195], a[112:115], v[124:127]
  v_and_or_b32 v48, v48, -2, s22
  v_mfma_f32_16x16x32_bf16 v[128:131], v[192:195], a[144:147], v[128:131]
  s_add_u32 s33, s23, 0
  v_mfma_f32_16x16x32_bf16 v[132:135], v[192:195], a[176:179], v[132:135]
  buffer_store_dwordx4 v[48:51], v6, s[8:11], s33 offen
  v_cvt_pk_bf16_f32 v52, v81, v85
  v_cvt_pk_bf16_f32 v53, v89, v93
  v_mfma_f32_16x16x32_bf16 v[136:139], v[192:195], a[208:211], v[136:139]
  v_cvt_pk_bf16_f32 v54, v97, v101
  v_cvt_pk_bf16_f32 v55, v105, v109
  v_mfma_f32_16x16x32_bf16 v[140:143], v[192:195], a[240:243], v[140:143]
  v_and_or_b32 v52, v52, -2, s22
  v_mfma_f32_16x16x32_bf16 v[112:115], v[196:199], a[20:23], v[112:115]
  s_add_u32 s33, s23, 16384
  v_mfma_f32_16x16x32_bf16 v[116:119], v[196:199], a[52:55], v[116:119]
  buffer_store_dwordx4 v[52:55], v6, s[8:11], s33 offen
  v_cvt_pk_bf16_f32 v56, v82, v86
  v_cvt_pk_bf16_f32 v57, v90, v94
  v_mfma_f32_16x16x32_bf16 v[120:123], v[196:199], a[84:87], v[120:123]
  v_cvt_pk_bf16_f32 v58, v98, v102
  v_cvt_pk_bf16_f32 v59, v106, v110
  v_mfma_f32_16x16x32_bf16 v[124:127], v[196:199], a[116:119], v[124:127]
  v_and_or_b32 v56, v56, -2, s22
  v_mfma_f32_16x16x32_bf16 v[128:131], v[196:199], a[148:151], v[128:131]
  s_add_u32 s33, s23, 32768
  v_mfma_f32_16x16x32_bf16 v[132:135], v[196:199], a[180:183], v[132:135]
  buffer_store_dwordx4 v[56:59], v6, s[8:11], s33 offen
  v_cvt_pk_bf16_f32 v60, v83, v87
  v_cvt_pk_bf16_f32 v61, v91, v95
  v_mfma_f32_16x16x32_bf16 v[136:139], v[196:199], a[212:215], v[136:139]
  v_cvt_pk_bf16_f32 v62, v99, v103
  v_cvt_pk_bf16_f32 v63, v107, v111
  v_mfma_f32_16x16x32_bf16 v[140:143], v[196:199], a[244:247], v[140:143]
  v_and_or_b32 v60, v60, -2, s22
  v_mfma_f32_16x16x32_bf16 v[112:115], v[200:203], a[24:27], v[112:115]
  s_add_u32 s33, s23, 49152
  v_mfma_f32_16x16x32_bf16 v[116:119], v[200:203], a[56:59], v[116:119]
  buffer_store_dwordx4 v[60:63], v6, s[8:11], s33 offen
  v_mfma_f32_16x16x32_bf16 v[120:123], v[200:203], a[88:91], v[120:123]
  ds_write_b32 v7, v9 offset:12
  v_mfma_f32_16x16x32_bf16 v[124:127], v[200:203], a[120:123], v[124:127]
  v_mfma_f32_16x16x32_bf16 v[128:131], v[200:203], a[152:155], v[128:131]
  v_mfma_f32_16x16x32_bf16 v[132:135], v[200:203], a[184:187], v[132:135]
  v_mfma_f32_16x16x32_bf16 v[136:139], v[200:203], a[216:219], v[136:139]
  v_mfma_f32_16x16x32_bf16 v[140:143], v[200:203], a[248:251], v[140:143]
  v_mfma_f32_16x16x32_bf16 v[112:115], v[204:207], a[28:31], v[112:115]
  v_mfma_f32_16x16x32_bf16 v[116:119], v[204:207], a[60:63], v[116:119]
  v_mfma_f32_16x16x32_bf16 v[120:123], v[204:207], a[92:95], v[120:123]
  v_mfma_f32_16x16x32_bf16 v[124:127], v[204:207], a[124:127], v[124:127]
  s_waitcnt vmcnt(12)
  v_cmp_gt_i32 vcc, s40, v11
  v_mfma_f32_16x16x32_bf16 v[128:131], v[204:207], a[156:159], v[128:131]
  v_mfma_f32_16x16x32_bf16 v[132:135], v[204:207], a[188:191], v[132:135]
  v_mfma_f32_16x16x32_bf16 v[136:139], v[204:207], a[220:223], v[136:139]
  s_cbranch_vccnz aowf1_rw1
aowf1_rok1:
  v_mfma_f32_16x16x32_bf16 v[140:143], v[204:207], a[252:255], v[140:143]
  v_cvt_pk_bf16_f32 v64, v112, v116
  v_cvt_pk_bf16_f32 v65, v120, v124
  v_cvt_pk_bf16_f32 v66, v128, v132
  s_nop 4
  v_cvt_pk_bf16_f32 v67, v136, v140
  v_and_or_b32 v64, v64, -2, s22
  s_add_u32 s33, s23, 262144
  buffer_store_dwordx4 v[64:67], v6, s[8:11], s33 offen
  v_cvt_pk_bf16_f32 v68, v113, v117
  v_cvt_pk_bf16_f32 v69, v121, v125
  v_cvt_pk_bf16_f32 v70, v129, v133
  v_cvt_pk_bf16_f32 v71, v137, v141
  v_and_or_b32 v68, v68, -2, s22
  s_add_u32 s33, s23, 278528
  buffer_store_dwordx4 v[68:71], v6, s[8:11], s33 offen
  v_cvt_pk_bf16_f32 v72, v114, v118
  v_cvt_pk_bf16_f32 v73, v122, v126
  v_cvt_pk_bf16_f32 v74, v130, v134
  v_cvt_pk_bf16_f32 v75, v138, v142
  v_and_or_b32 v72, v72, -2, s22
  s_add_u32 s33, s23, 294912
  buffer_store_dwordx4 v[72:75], v6, s[8:11], s33 offen
  v_cvt_pk_bf16_f32 v76, v115, v119
  v_cvt_pk_bf16_f32 v77, v123, v127
  v_cvt_pk_bf16_f32 v78, v131, v135
  v_cvt_pk_bf16_f32 v79, v139, v143
  v_and_or_b32 v76, v76, -2, s22
  s_add_u32 s33, s23, 311296
  buffer_store_dwordx4 v[76:79], v6, s[8:11], s33 offen
  ds_write_b32 v7, v9 offset:20
  s_mov_b32 s20, s21
  s_cmp_lt_u32 s20, 64
  s_cbranch_scc1 aowf_top0
  s_branch the_end
aowf0_rw0:
  s_sub_u32 s3, s3, 1
  s_cbranch_scc1 bail_29
  buffer_load_dword v13, v12, s[8:11], s39 offen sc1
  s_waitcnt vmcnt(0)
  v_cmp_gt_i32 vcc, s40, v13
  s_and_b32 s33, vcc_lo, 0xffff
  s_cbranch_scc1 aowf0_rw0
  s_branch aowf0_rok0
aowf0_rw1:
  s_sub_u32 s3, s3, 1
  s_cbranch_scc1 bail_29
  buffer_load_dword v13, v12, s[8:11], s39 offen sc1
  s_waitcnt vmcnt(0)
  v_cmp_gt_i32 vcc, s40, v13
  s_and_b32 s33, vcc_lo, -1
  s_cbranch_scc1 aowf0_rw1
  s_branch aowf0_rok1
aowf0_ld:
  buffer_load_dwordx4 v[144:147], v15, s[8:11], s49 offen offset:0 sc1
  buffer_load_dwordx4 v[148:151], v15, s[8:11], s49 offen offset:2048 sc1
  buffer_load_dwordx4 v[152:155], v15, s[8:11], s50 offen offset:0 sc1
  buffer_load_dwordx4 v[156:159], v15, s[8:11], s50 offen offset:2048 sc1
  buffer_load_dwordx4 v[160:163], v15, s[8:11], s49 offen offset:256 sc1
  buffer_load_dwordx4 v[164:167], v15, s[8:11], s49 offen offset:2304 sc1
  buffer_load_dwordx4 v[168:171], v15, s[8:11], s50 offen offset:256 sc1
  buffer_load_dwordx4 v[172:175], v15, s[8:11], s50 offen offset:2304 sc1
  s_branch aowf0_lk
aowf0_pr:
  s_sub_u32 s3, s3, 1
  s_cbranch_scc1 bail_19
  buffer_load_dwordx4 v[144:147], v15, s[8:11], s49 offen offset:0 sc1
  buffer_load_dwordx4 v[148:151], v15, s[8:11], s49 offen offset:2048 sc1
  buffer_load_dwordx4 v[152:155], v15, s[8:11], s50 offen offset:0 sc1
  buffer_load_dwordx4 v[156:159], v15, s[8:11], s50 offen offset:2048 sc1
  buffer_load_dwordx4 v[160:163], v15, s[8:11], s49 offen offset:256 sc1
  buffer_load_dwordx4 v[164:167], v15, s[8:11], s49 offen offset:2304 sc1
  buffer_load_dwordx4 v[168:171], v15, s[8:11], s50 offen offset:256 sc1
  buffer_load_dwordx4 v[172:175], v15, s[8:11], s50 offen offset:2304 sc1
  s_waitcnt vmcnt(0)
  v_xor_b32 v14, s48, v144
  v_bitop3_b32 v14, v14, s48, v148 bitop3:0xf6
  v_bitop3_b32 v14, v14, s48, v152 bitop3:0xf6
  v_bitop3_b32 v14, v14, s48, v156 bitop3:0xf6
  v_bitop3_b32 v14, v14, s48, v160 bitop3:0xf6
  v_bitop3_b32 v14, v14, s48, v164 bitop3:0xf6
  v_bitop3_b32 v14, v14, s48, v168 bitop3:0xf6
  v_bitop3_b32 v14, v14, s48, v172 bitop3:0xf6
  v_and_b32 v14, 1, v14
  v_cmp_ne_u32 vcc, 0, v14
  s_cbranch_vccnz aowf0_pr
  s_branch aowf0_pok
aowf1_rw0:
  s_sub_u32 s3, s3, 1
  s_cbranch_scc1 bail_29
  buffer_load_dword v13, v12, s[8:11], s39 offen sc1
  s_waitcnt vmcnt(0)
  v_cmp_gt_i32 vcc, s40, v13
  s_and_b32 s33, vcc_lo, 0xffff
  s_cbranch_scc1 aowf1_rw0
  s_branch aowf1_rok0
aowf1_rw1:
  s_sub_u32 s3, s3, 1
  s_cbranch_scc1 bail_29
  buffer_load_dword v13, v12, s[8:11], s39 offen sc1
  s_waitcnt vmcnt(0)
  v_cmp_gt_i32 vcc, s40, v13
  s_and_b32 s33, vcc_lo, -1
  s_cbranch_scc1 aowf1_rw1
  s_branch aowf1_rok1
aowf1_ld:
  buffer_load_dwordx4 v[176:179], v15, s[8:11], s49 offen offset:0 sc1
  buffer_load_dwordx4 v[180:183], v15, s[8:11], s49 offen offset:2048 sc1
  buffer_load_dwordx4 v[184:187], v15, s[8:11], s50 offen offset:0 sc1
  buffer_load_dwordx4 v[188:191], v15, s[8:11], s50 offen offset:2048 sc1
  buffer_load_dwordx4 v[192:195], v15, s[8:11], s49 offen offset:256 sc1
  buffer_load_dwordx4 v[196:199], v15, s[8:11], s49 offen offset:2304 sc1
  buffer_load_dwordx4 v[200:203], v15, s[8:11], s50 offen offset:256 sc1
  buffer_load_dwordx4 v[204:207], v15, s[8:11], s50 offen offset:2304 sc1
  s_branch aowf1_lk
aowf1_pr:
  s_sub_u32 s3, s3, 1
  s_cbranch_scc1 bail_19
  buffer_load_dwordx4 v[176:179], v15, s[8:11], s49 offen offset:0 sc1
  buffer_load_dwordx4 v[180:183], v15, s[8:11], s49 offen offset:2048 sc1
  buffer_load_dwordx4 v[184:187], v15, s[8:11], s50 offen offset:0 sc1
  buffer_load_dwordx4 v[188:191], v15, s[8:11], s50 offen offset:2048 sc1
  buffer_load_dwordx4 v[192:195], v15, s[8:11], s49 offen offset:256 sc1
  buffer_load_dwordx4 v[196:199], v15, s[8:11], s49 offen offset:2304 sc1
  buffer_load_dwordx4 v[200:203], v15, s[8:11], s50 offen offset:256 sc1
  buffer_load_dwordx4 v[204:207], v15, s[8:11], s50 offen offset:2304 sc1
  s_waitcnt vmcnt(0)
  v_xor_b32 v14, s48, v176
  v_bitop3_b32 v14, v14, s48, v180 bitop3:0xf6
  v_bitop3_b32 v14, v14, s48, v184 bitop3:0xf6
  v_bitop3_b32 v14, v14, s48, v188 bitop3:0xf6
  v_bitop3_b32 v14, v14, s48, v192 bitop3:0xf6
  v_bitop3_b32 v14, v14, s48, v196 bitop3:0xf6
  v_bitop3_b32 v14, v14, s48, v200 bitop3:0xf6
  v_bitop3_b32 v14, v14, s48, v204 bitop3:0xf6
  v_and_b32 v14, 1, v14
  v_cmp_ne_u32 vcc, 0, v14
  s_cbranch_vccnz aowf1_pr
  s_branch aowf1_pok
aows_top0:
  s_add_u32 s21, s20, 1
ls_18:
  ds_read_b32 v10, v2 offset:0
  s_waitcnt lgkmcnt(0)
  v_cmp_gt_i32 vcc, s21, v10
  s_cbranch_vccz lsd_19
  s_sub_u32 s3, s3, 1
  s_cbranch_scc1 bail_21
  s_sleep 1
  s_branch ls_18
lsd_19:
  ds_read_b128 v[16:19], v8 offset:0
  ds_read_b128 v[20:23], v8 offset:2048
  ds_read_b128 v[24:27], v8 offset:4096
  ds_read_b128 v[28:31], v8 offset:6144
  ds_read_b128 v[32:35], v8 offset:256
  ds_read_b128 v[36:39], v8 offset:2304
  ds_read_b128 v[40:43], v8 offset:4352
  ds_read_b128 v[44:47], v8 offset:6400
  s_lshr_b32 s48, s20, 1
  s_and_b32 s48, s48, 1
  s_xor_b32 s48, s48, 1
  s_add_u32 s49, s47, 0
  s_add_u32 s50, s49, 4096
  s_add_u32 s52, s47, 262144
  s_add_u32 s53, s52, 4096
  v_mov_b32 v9, s21
  s_add_u32 s44, s44, 1
  s_cmp_eq_u32 s44, 2
  s_cselect_b32 s44, 0, s44
  s_cselect_b32 s23, 1, 0
  s_xor_b32 s22, s22, s23
  s_lshl_b32 s23, s44, 19
  s_add_u32 s23, s23, s38
  s_waitcnt lgkmcnt(7)
  v_mfma_f32_16x16x32_bf16 v[80:83], v[16:19], a[0:3], 0
  s_waitcnt vmcnt(8)
  v_xor_b32 v14, s48, v144
  v_bitop3_b32 v14, v14, s48, v148 bitop3:0xf6
  v_mfma_f32_16x16x32_bf16 v[84:87], v[16:19], a[32:35], 0
  v_bitop3_b32 v14, v14, s48, v152 bitop3:0xf6
  v_bitop3_b32 v14, v14, s48, v156 bitop3:0xf6
  v_mfma_f32_16x16x32_bf16 v[88:91], v[16:19], a[64:67], 0
  v_bitop3_b32 v14, v14, s48, v160 bitop3:0xf6
  v_bitop3_b32 v14, v14, s48, v164 bitop3:0xf6
  v_mfma_f32_16x16x32_bf16 v[92:95], v[16:19], a[96:99], 0
  v_bitop3_b32 v14, v14, s48, v168 bitop3:0xf6
  v_bitop3_b32 v14, v14, s48, v172 bitop3:0xf6
  v_mfma_f32_16x16x32_bf16 v[96:99], v[16:19], a[128:131], 0
  v_and_b32 v14, 1, v14
  v_cmp_ne_u32 vcc, 0, v14
  v_mfma_f32_16x16x32_bf16 v[100:103], v[16:19], a[160:163], 0
  v_mfma_f32_16x16x32_bf16 v[104:107], v[16:19], a[192:195], 0
  v_mfma_f32_16x16x32_bf16 v[108:111], v[16:19], a[224:227], 0
  s_waitcnt lgkmcnt(6)
  v_mfma_f32_16x16x32_bf16 v[80:83], v[20:23], a[4:7], v[80:83]
  v_mfma_f32_16x16x32_bf16 v[84:87], v[20:23], a[36:39], v[84:87]
  v_mfma_f32_16x16x32_bf16 v[88:91], v[20:23], a[68:71], v[88:91]
  v_mfma_f32_16x16x32_bf16 v[92:95], v[20:23], a[100:103], v[92:95]
  v_mfma_f32_16x16x32_bf16 v[96:99], v[20:23], a[132:135], v[96:99]
  s_cbranch_vccnz aows0_ld
aows0_lk:
  v_mfma_f32_16x16x32_bf16 v[100:103], v[20:23], a[164:167], v[100:103]
  v_mfma_f32_16x16x32_bf16 v[104:107], v[20:23], a[196:199], v[104:107]
  v_mfma_f32_16x16x32_bf16 v[108:111], v[20:23], a[228:231], v[108:111]
  s_waitcnt lgkmcnt(5)
  v_mfma_f32_16x16x32_bf16 v[80:83], v[24:27], a[8:11], v[80:83]
  v_mfma_f32_16x16x32_bf16 v[84:87], v[24:27], a[40:43], v[84:87]
  v_mfma_f32_16x16x32_bf16 v[88:91], v[24:27], a[72:75], v[88:91]
  v_mfma_f32_16x16x32_bf16 v[92:95], v[24:27], a[104:107], v[92:95]
  v_mfma_f32_16x16x32_bf16 v[96:99], v[24:27], a[136:139], v[96:99]
  v_mfma_f32_16x16x32_bf16 v[100:103], v[24:27], a[168:171], v[100:103]
  v_mfma_f32_16x16x32_bf16 v[104:107], v[24:27], a[200:203], v[104:107]
  v_mfma_f32_16x16x32_bf16 v[108:111], v[24:27], a[232:235], v[108:111]
  s_waitcnt lgkmcnt(4)
  v_mfma_f32_16x16x32_bf16 v[80:83], v[28:31], a[12:15], v[80:83]
  v_mfma_f32_16x16x32_bf16 v[84:87], v[28:31], a[44:47], v[84:87]
  v_mfma_f32_16x16x32_bf16 v[88:91], v[28:31], a[76:79], v[88:91]
  v_mfma_f32_16x16x32_bf16 v[92:95], v[28:31], a[108:111], v[92:95]
  v_mfma_f32_16x16x32_bf16 v[96:99], v[28:31], a[140:143], v[96:99]
  v_mfma_f32_16x16x32_bf16 v[100:103], v[28:31], a[172:175], v[100:103]
  v_mfma_f32_16x16x32_bf16 v[104:107], v[28:31], a[204:207], v[104:107]
  v_mfma_f32_16x16x32_bf16 v[108:111], v[28:31], a[236:239], v[108:111]
  s_waitcnt lgkmcnt(3)
  v_mfma_f32_16x16x32_bf16 v[112:115], v[32:35], a[0:3], 0
  v_mfma_f32_16x16x32_bf16 v[116:119], v[32:35], a[32:35], 0
  v_mfma_f32_16x16x32_bf16 v[120:123], v[32:35], a[64:67], 0
  v_mfma_f32_16x16x32_bf16 v[124:127], v[32:35], a[96:99], 0
  v_mfma_f32_16x16x32_bf16 v[128:131], v[32:35], a[128:131], 0
  v_mfma_f32_16x16x32_bf16 v[132:135], v[32:35], a[160:163], 0
  v_mfma_f32_16x16x32_bf16 v[136:139], v[32:35], a[192:195], 0
  v_mfma_f32_16x16x32_bf16 v[140:143], v[32:35], a[224:227], 0
  s_waitcnt lgkmcnt(2)
  v_mfma_f32_16x16x32_bf16 v[112:115], v[36:39], a[4:7], v[112:115]
  v_mfma_f32_16x16x32_bf16 v[116:119], v[36:39], a[36:39], v[116:119]
  v_mfma_f32_16x16x32_bf16 v[120:123], v[36:39], a[68:71], v[120:123]
  v_mfma_f32_16x16x32_bf16 v[124:127], v[36:39], a[100:103], v[124:127]
  s_sub_u32 s40, s20, 1
  v_mfma_f32_16x16x32_bf16 v[128:131], v[36:39], a[132:135], v[128:131]
  buffer_load_dword v13, v12, s[8:11], s39 offen sc1
  v_mfma_f32_16x16x32_bf16 v[132:135], v[36:39], a[164:167], v[132:135]
  v_mfma_f32_16x16x32_bf16 v[136:139], v[36:39], a[196:199], v[136:139]
  v_mfma_f32_16x16x32_bf16 v[140:143], v[36:39], a[228:231], v[140:143]
  s_waitcnt lgkmcnt(1)
  v_mfma_f32_16x16x32_bf16 v[112:115], v[40:43], a[8:11], v[112:115]
  v_mfma_f32_16x16x32_bf16 v[116:119], v[40:43], a[40:43], v[116:119]
  v_mfma_f32_16x16x32_bf16 v[120:123], v[40:43], a[72:75], v[120:123]
  v_mfma_f32_16x16x32_bf16 v[124:127], v[40:43], a[104:107], v[124:127]
  v_mfma_f32_16x16x32_bf16 v[128:131], v[40:43], a[136:139], v[128:131]
  v_mfma_f32_16x16x32_bf16 v[132:135], v[40:43], a[168:171], v[132:135]
  v_mfma_f32_16x16x32_bf16 v[136:139], v[40:43], a[200:203], v[136:139]
  v_mfma_f32_16x16x32_bf16 v[140:143], v[40:43], a[232:235], v[140:143]
  s_waitcnt lgkmcnt(0)
  v_mfma_f32_16x16x32_bf16 v[112:115], v[44:47], a[12:15], v[112:115]
  ds_write_b32 v7, v9 offset:4
  v_mfma_f32_16x16x32_bf16 v[116:119], v[44:47], a[44:47], v[116:119]
  s_waitcnt vmcnt(1)
  v_xor_b32 v14, s48, v144
  v_bitop3_b32 v14, v14, s48, v148 bitop3:0xf6
  v_mfma_f32_16x16x32_bf16 v[120:123], v[44:47], a[76:79], v[120:123]
  v_bitop3_b32 v14, v14, s48, v152 bitop3:0xf6
  v_bitop3_b32 v14, v14, s48, v156 bitop3:0xf6
  v_mfma_f32_16x16x32_bf16 v[124:127], v[44:47], a[108:111], v[124:127]
  v_bitop3_b32 v14, v14, s48, v160 bitop3:0xf6
  v_bitop3_b32 v14, v14, s48, v164 bitop3:0xf6
  v_mfma_f32_16x16x32_bf16 v[128:131], v[44:47], a[140:143], v[128:131]
  v_bitop3_b32 v14, v14, s48, v168 bitop3:0xf6
  v_bitop3_b32 v14, v14, s48, v172 bitop3:0xf6
  v_mfma_f32_16x16x32_bf16 v[132:135], v[44:47], a[172:175], v[132:135]
  v_and_b32 v14, 1, v14
  v_cmp_ne_u32 vcc, 0, v14
  v_mfma_f32_16x16x32_bf16 v[136:139], v[44:47], a[204:207], v[136:139]
  v_mfma_f32_16x16x32_bf16 v[140:143], v[44:47], a[236:239], v[140:143]
  s_cbranch_vccnz aows0_pr
aows0_pok:
  v_mfma_f32_16x16x32_bf16 v[80:83], v[144:147], a[16:19], v[80:83]
  s_mov_b64 exec, 1
  buffer_store_dword v9, off, s[8:11], s42 sc1
  s_mov_b64 exec, -1
  v_mfma_f32_16x16x32_bf16 v[84:87], v[144:147], a[48:51], v[84:87]
  v_mfma_f32_16x16x32_bf16 v[88:91], v[144:147], a[80:83], v[88:91]
  v_mfma_f32_16x16x32_bf16 v[92:95], v[144:147], a[112:115], v[92:95]
  v_mfma_f32_16x16x32_bf16 v[96:99], v[144:147], a[144:147], v[96:99]
  v_mfma_f32_16x16x32_bf16 v[100:103], v[144:147], a[176:179], v[100:103]
  v_mfma_f32_16x16x32_bf16 v[104:107], v[144:147], a[208:211], v[104:107]
  v_mfma_f32_16x16x32_bf16 v[108:111], v[144:147], a[240:243], v[108:111]
  v_mfma_f32_16x16x32_bf16 v[80:83], v[148:151], a[20:23], v[80:83]
  buffer_load_dword v11, v12, s[8:11], s39 offen sc1
  v_mfma_f32_16x16x32_bf16 v[84:87], v[148:151], a[52:55], v[84:87]
  v_mfma_f32_16x16x32_bf16 v[88:91], v[148:151], a[84:87], v[88:91]
  v_mfma_f32_16x16x32_bf16 v[92:95], v[148:151], a[116:119], v[92:95]
  v_mfma_f32_16x16x32_bf16 v[96:99], v[148:151], a[148:151], v[96:99]
  buffer_load_dwordx4 v[176:179], v15, s[8:11], s52 offen offset:0 sc1
  v_mfma_f32_16x16x32_bf16 v[100:103], v[148:151], a[180:183], v[100:103]
  v_mfma_f32_16x16x32_bf16 v[104:107], v[148:151], a[212:215], v[104:107]
  buffer_load_dwordx4 v[180:183], v15, s[8:11], s52 offen offset:2048 sc1
  v_mfma_f32_16x16x32_bf16 v[108:111], v[148:151], a[244:247], v[108:111]
  v_mfma_f32_16x16x32_bf16 v[80:83], v[152:155], a[24:27], v[80:83]
  buffer_load_dwordx4 v[184:187], v15, s[8:11], s53 offen offset:0 sc1
  v_mfma_f32_16x16x32_bf16 v[84:87], v[152:155], a[56:59], v[84:87]
  v_mfma_f32_16x16x32_bf16 v[88:91], v[152:155], a[88:91], v[88:91]
  buffer_load_dwordx4 v[188:191], v15, s[8:11], s53 offen offset:2048 sc1
  v_mfma_f32_16x16x32_bf16 v[92:95], v[152:155], a[120:123], v[92:95]
  v_mfma_f32_16x16x32_bf16 v[96:99], v[152:155], a[152:155], v[96:99]
  buffer_load_dwordx4 v[192:195], v15, s[8:11], s52 offen offset:256 sc1
  v_mfma_f32_16x16x32_bf16 v[100:103], v[152:155], a[184:187], v[100:103]
  v_mfma_f32_16x16x32_bf16 v[104:107], v[152:155], a[216:219], v[104:107]
  buffer_load_dwordx4 v[196:199], v15, s[8:11], s52 offen offset:2304 sc1
  v_mfma_f32_16x16x32_bf16 v[108:111], v[152:155], a[248:251], v[108:111]
  v_mfma_f32_16x16x32_bf16 v[80:83], v[156:159], a[28:31], v[80:83]
  buffer_load_dwordx4 v[200:203], v15, s[8:11], s53 offen offset:256 sc1
  v_mfma_f32_16x16x32_bf16 v[84:87], v[156:159], a[60:63], v[84:87]
  v_mfma_f32_16x16x32_bf16 v[88:91], v[156:159], a[92:95], v[88:91]
  buffer_load_dwordx4 v[204:207], v15, s[8:11], s53 offen offset:2304 sc1
  v_mfma_f32_16x16x32_bf16 v[92:95], v[156:159], a[124:127], v[92:95]
  v_mfma_f32_16x16x32_bf16 v[96:99], v[156:159], a[156:159], v[96:99]
  s_waitcnt vmcnt(10)
  v_cmp_gt_i32 vcc, s40, v13
  v_mfma_f32_16x16x32_bf16 v[100:103], v[156:159], a[188:191], v[100:103]
  v_mfma_f32_16x16x32_bf16 v[104:107], v[156:159], a[220:223], v[104:107]
  s_and_b32 s33, vcc_lo, 0xffff
  v_mfma_f32_16x16x32_bf16 v[108:111], v[156:159], a[252:255], v[108:111]
  s_cbranch_scc1 aows0_rw0
aows0_rok0:
  v_mfma_f32_16x16x32_bf16 v[112:115], v[160:163], a[16:19], v[112:115]
  v_mfma_f32_16x16x32_bf16 v[116:119], v[160:163], a[48:51], v[116:119]
  v_cvt_pk_bf16_f32 v48, v80, v84
  v_cvt_pk_bf16_f32 v49, v88, v92
  v_mfma_f32_16x16x32_bf16 v[120:123], v[160:163], a[80:83], v[120:123]
  v_cvt_pk_bf16_f32 v50, v96, v100
  v_cvt_pk_bf16_f32 v51, v104, v108
  v_mfma_f32_16x16x32_bf16 v[124:127], v[160:163], a[112:115], v[124:127]
  v_and_or_b32 v48, v48, -2, s22
  v_mfma_f32_16x16x32_bf16 v[128:131], v[160:163], a[144:147], v[128:131]
  s_add_u32 s33, s23, 0
  v_mfma_f32_16x16x32_bf16 v[132:135], v[160:163], a[176:179], v[132:135]
  buffer_store_dwordx4 v[48:51], v6, s[8:11], s33 offen sc1
  v_cvt_pk_bf16_f32 v52, v81, v85
  v_cvt_pk_bf16_f32 v53, v89, v93
  v_mfma_f32_16x16x32_bf16 v[136:139], v[160:163], a[208:211], v[136:139]
  v_cvt_pk_bf16_f32 v54, v97, v101
  v_cvt_pk_bf16_f32 v55, v105, v109
  v_mfma_f32_16x16x32_bf16 v[140:143], v[160:163], a[240:243], v[140:143]
  v_and_or_b32 v52, v52, -2, s22
  v_mfma_f32_16x16x32_bf16 v[112:115], v[164:167], a[20:23], v[112:115]
  s_add_u32 s33, s23, 16384
  v_mfma_f32_16x16x32_bf16 v[116:119], v[164:167], a[52:55], v[116:119]
  buffer_store_dwordx4 v[52:55], v6, s[8:11], s33 offen sc1
  v_cvt_pk_bf16_f32 v56, v82, v86
  v_cvt_pk_bf16_f32 v57, v90, v94
  v_mfma_f32_16x16x32_bf16 v[120:123], v[164:167], a[84:87], v[120:123]
  v_cvt_pk_bf16_f32 v58, v98, v102
  v_cvt_pk_bf16_f32 v59, v106, v110
  v_mfma_f32_16x16x32_bf16 v[124:127], v[164:167], a[116:119], v[124:127]
  v_and_or_b32 v56, v56, -2, s22
  v_mfma_f32_16x16x32_bf16 v[128:131], v[164:167], a[148:151], v[128:131]
  s_add_u32 s33, s23, 32768
  v_mfma_f32_16x16x32_bf16 v[132:135], v[164:167], a[180:183], v[132:135]
  buffer_store_dwordx4 v[56:59], v6, s[8:11], s33 offen sc1
  v_cvt_pk_bf16_f32 v60, v83, v87
  v_cvt_pk_bf16_f32 v61, v91, v95
  v_mfma_f32_16x16x32_bf16 v[136:139], v[164:167], a[212:215], v[136:139]
  v_cvt_pk_bf16_f32 v62, v99, v103
  v_cvt_pk_bf16_f32 v63, v107, v111
  v_mfma_f32_16x16x32_bf16 v[140:143], v[164:167], a[244:247], v[140:143]
  v_and_or_b32 v60, v60, -2, s22
  v_mfma_f32_16x16x32_bf16 v[112:115], v[168:171], a[24:27], v[112:115]
  s_add_u32 s33, s23, 49152
  v_mfma_f32_16x16x32_bf16 v[116:119], v[168:171], a[56:59], v[116:119]
  buffer_store_dwordx4 v[60:63], v6, s[8:11], s33 offen sc1
  v_mfma_f32_16x16x32_bf16 v[120:123], v[168:171], a[88:91], v[120:123]
  ds_write_b32 v7, v9 offset:12
  v_mfma_f32_16x16x32_bf16 v[124:127], v[168:171], a[120:123], v[124:127]
  v_mfma_f32_16x16x32_bf16 v[128:131], v[168:171], a[152:155], v[128:131]
  v_mfma_f32_16x16x32_bf16 v[132:135], v[168:171], a[184:187], v[132:135]
  v_mfma_f32_16x16x32_bf16 v[136:139], v[168:171], a[216:219], v[136:139]
  v_mfma_f32_16x16x32_bf16 v[140:143], v[168:171], a[248:251], v[140:143]
  v_mfma_f32_16x16x32_bf16 v[112:115], v[172:175], a[28:31], v[112:115]
  v_mfma_f32_16x16x32_bf16 v[116:119], v[172:175], a[60:63], v[116:119]
  v_mfma_f32_16x16x32_bf16 v[120:123], v[172:175], a[92:95], v[120:123]
  v_mfma_f32_16x16x32_bf16 v[124:127], v[172:175], a[124:127], v[124:127]
  s_waitcnt vmcnt(12)
  v_cmp_gt_i32 vcc, s40, v11
  v_mfma_f32_16x16x32_bf16 v[128:131], v[172:175], a[156:159], v[128:131]
  v_mfma_f32_16x16x32_bf16 v[132:135], v[172:175], a[188:191], v[132:135]
  v_mfma_f32_16x16x32_bf16 v[136:139], v[172:175], a[220:223], v[136:139]
  s_cbranch_vccnz aows0_rw1
aows0_rok1:
  v_mfma_f32_16x16x32_bf16 v[140:143], v[172:175], a[252:255], v[140:143]
  v_cvt_pk_bf16_f32 v64, v112, v116
  v_cvt_pk_bf16_f32 v65, v120, v124
  v_cvt_pk_bf16_f32 v66, v128, v132
  s_nop 4
  v_cvt_pk_bf16_f32 v67, v136, v140
  v_and_or_b32 v64, v64, -2, s22
  s_add_u32 s33, s23, 262144
  buffer_store_dwordx4 v[64:67], v6, s[8:11], s33 offen sc1
  v_cvt_pk_bf16_f32 v68, v113, v117
  v_cvt_pk_bf16_f32 v69, v121, v125
  v_cvt_pk_bf16_f32 v70, v129, v133
  v_cvt_pk_bf16_f32 v71, v137, v141
  v_and_or_b32 v68, v68, -2, s22
  s_add_u32 s33, s23, 278528
  buffer_store_dwordx4 v[68:71], v6, s[8:11], s33 offen sc1
  v_cvt_pk_bf16_f32 v72, v114, v118
  v_cvt_pk_bf16_f32 v73, v122, v126
  v_cvt_pk_bf16_f32 v74, v130, v134
  v_cvt_pk_bf16_f32 v75, v138, v142
  v_and_or_b32 v72, v72, -2, s22
  s_add_u32 s33, s23, 294912
  buffer_store_dwordx4 v[72:75], v6, s[8:11], s33 offen sc1
  v_cvt_pk_bf16_f32 v76, v115, v119
  v_cvt_pk_bf16_f32 v77, v123, v127
  v_cvt_pk_bf16_f32 v78, v131, v135
  v_cvt_pk_bf16_f32 v79, v139, v143
  v_and_or_b32 v76, v76, -2, s22
  s_add_u32 s33, s23, 311296
  buffer_store_dwordx4 v[76:79], v6, s[8:11], s33 offen sc1
  ds_write_b32 v7, v9 offset:20
  s_mov_b32 s20, s21
aows_top1:
  s_add_u32 s21, s20, 1
ls_20:
  ds_read_b32 v10, v2 offset:0
  s_waitcnt lgkmcnt(0)
  v_cmp_gt_i32 vcc, s21, v10
  s_cbranch_vccz lsd_21
  s_sub_u32 s3, s3, 1
  s_cbranch_scc1 bail_21
  s_sleep 1
  s_branch ls_20
lsd_21:
  ds_read_b128 v[16:19], v8 offset:8192
  ds_read_b128 v[20:23], v8 offset:10240
  ds_read_b128 v[24:27], v8 offset:12288
  ds_read_b128 v[28:31], v8 offset:14336
  ds_read_b128 v[32:35], v8 offset:8448
  ds_read_b128 v[36:39], v8 offset:10496
  ds_read_b128 v[40:43], v8 offset:12544
  ds_read_b128 v[44:47], v8 offset:14592
  s_lshr_b32 s48, s20, 1
  s_and_b32 s48, s48, 1
  s_xor_b32 s48, s48, 1
  s_add_u32 s49, s47, 262144
  s_add_u32 s50, s49, 4096
  s_add_u32 s52, s47, 0
  s_add_u32 s53, s52, 4096
  v_mov_b32 v9, s21
  s_add_u32 s44, s44, 1
  s_cmp_eq_u32 s44, 2
  s_cselect_b32 s44, 0, s44
  s_cselect_b32 s23, 1, 0
  s_xor_b32 s22, s22, s23
  s_lshl_b32 s23, s44, 19
  s_add_u32 s23, s23, s38
  s_waitcnt lgkmcnt(7)
  v_mfma_f32_16x16x32_bf16 v[80:83], v[16:19], a[0:3], 0
  s_waitcnt vmcnt(8)
  v_xor_b32 v14, s48, v176
  v_bitop3_b32 v14, v14, s48, v180 bitop3:0xf6
  v_mfma_f32_16x16x32_bf16 v[84:87], v[16:19], a[32:35], 0
  v_bitop3_b32 v14, v14, s48, v184 bitop3:0xf6
  v_bitop3_b32 v14, v14, s48, v188 bitop3:0xf6
  v_mfma_f32_16x16x32_bf16 v[88:91], v[16:19], a[64:67], 0
  v_bitop3_b32 v14, v14, s48, v192 bitop3:0xf6
  v_bitop3_b32 v14, v14, s48, v196 bitop3:0xf6
  v_mfma_f32_16x16x32_bf16 v[92:95], v[16:19], a[96:99], 0
  v_bitop3_b32 v14, v14, s48, v200 bitop3:0xf6
  v_bitop3_b32 v14, v14, s48, v204 bitop3:0xf6
  v_mfma_f32_16x16x32_bf16 v[96:99], v[16:19], a[128:131], 0
  v_and_b32 v14, 1, v14
  v_cmp_ne_u32 vcc, 0, v14
  v_mfma_f32_16x16x32_bf16 v[100:103], v[16:19], a[160:163], 0
  v_mfma_f32_16x16x32_bf16 v[104:107], v[16:19], a[192:195], 0
  v_mfma_f32_16x16x32_bf16 v[108:111], v[16:19], a[224:227], 0
  s_waitcnt lgkmcnt(6)
  v_mfma_f32_16x16x32_bf16 v[80:83], v[20:23], a[4:7], v[80:83]
  v_mfma_f32_16x16x32_bf16 v[84:87], v[20:23], a[36:39], v[84:87]
  v_mfma_f32_16x16x32_bf16 v[88:91], v[20:23], a[68:71], v[88:91]
  v_mfma_f32_16x16x32_bf16 v[92:95], v[20:23], a[100:103], v[92:95]
  v_mfma_f32_16x16x32_bf16 v[96:99], v[20:23], a[132:135], v[96:99]
  s_cbranch_vccnz aows1_ld
aows1_lk:
  v_mfma_f32_16x16x32_bf16 v[100:103], v[20:23], a[164:167], v[100:103]
  v_mfma_f32_16x16x32_bf16 v[104:107], v[20:23], a[196:199], v[104:107]
  v_mfma_f32_16x16x32_bf16 v[108:111], v[20:23], a[228:231], v[108:111]
  s_waitcnt lgkmcnt(5)
  v_mfma_f32_16x16x32_bf16 v[80:83], v[24:27], a[8:11], v[80:83]
  v_mfma_f32_16x16x32_bf16 v[84:87], v[24:27], a[40:43], v[84:87]
  v_mfma_f32_16x16x32_bf16 v[88:91], v[24:27], a[72:75], v[88:91]
  v_mfma_f32_16x16x32_bf16 v[92:95], v[24:27], a[104:107], v[92:95]
  v_mfma_f32_16x16x32_bf16 v[96:99], v[24:27], a[136:139], v[96:99]
  v_mfma_f32_16x16x32_bf16 v[100:103], v[24:27], a[168:171], v[100:103]
  v_mfma_f32_16x16x32_bf16 v[104:107], v[24:27], a[200:203], v[104:107]
  v_mfma_f32_16x16x32_bf16 v[108:111], v[24:27], a[232:235], v[108:111]
  s_waitcnt lgkmcnt(4)
  v_mfma_f32_16x16x32_bf16 v[80:83], v[28:31], a[12:15], v[80:83]
  v_mfma_f32_16x16x32_bf16 v[84:87], v[28:31], a[44:47], v[84:87]
  v_mfma_f32_16x16x32_bf16 v[88:91], v[28:31], a[76:79], v[88:91]
  v_mfma_f32_16x16x32_bf16 v[92:95], v[28:31], a[108:111], v[92:95]
  v_mfma_f32_16x16x32_bf16 v[96:99], v[28:31], a[140:143], v[96:99]
  v_mfma_f32_16x16x32_bf16 v[100:103], v[28:31], a[172:175], v[100:103]
  v_mfma_f32_16x16x32_bf16 v[104:107], v[28:31], a[204:207], v[104:107]
  v_mfma_f32_16x16x32_bf16 v[108:111], v[28:31], a[236:239], v[108:111]
  s_waitcnt lgkmcnt(3)
  v_mfma_f32_16x16x32_bf16 v[112:115], v[32:35], a[0:3], 0
  v_mfma_f32_16x16x32_bf16 v[116:119], v[32:35], a[32:35], 0
  v_mfma_f32_16x16x32_bf16 v[120:123], v[32:35], a[64:67], 0
  v_mfma_f32_16x16x32_bf16 v[124:127], v[32:35], a[96:99], 0
  v_mfma_f32_16x16x32_bf16 v[128:131], v[32:35], a[128:131], 0
  v_mfma_f32_16x16x32_bf16 v[132:135], v[32:35], a[160:163], 0
  v_mfma_f32_16x16x32_bf16 v[136:139], v[32:35], a[192:195], 0
  v_mfma_f32_16x16x32_bf16 v[140:143], v[32:35], a[224:227], 0
  s_waitcnt lgkmcnt(2)
  v_mfma_f32_16x16x32_bf16 v[112:115], v[36:39], a[4:7], v[112:115]
  v_mfma_f32_16x16x32_bf16 v[116:119], v[36:39], a[36:39], v[116:119]
  v_mfma_f32_16x16x32_bf16 v[120:123], v[36:39], a[68:71], v[120:123]
  v_mfma_f32_16x16x32_bf16 v[124:127], v[36:39], a[100:103], v[124:127]
  s_sub_u32 s40, s20, 1
  v_mfma_f32_16x16x32_bf16 v[128:131], v[36:39], a[132:135], v[128:131]
  buffer_load_dword v13, v12, s[8:11], s39 offen sc1
  v_mfma_f32_16x16x32_bf16 v[132:135], v[36:39], a[164:167], v[132:135]
  v_mfma_f32_16x16x32_bf16 v[136:139], v[36:39], a[196:199], v[136:139]
  v_mfma_f32_16x16x32_bf16 v[140:143], v[36:39], a[228:231], v[140:143]
  s_waitcnt lgkmcnt(1)
  v_mfma_f32_16x16x32_bf16 v[112:115], v[40:43], a[8:11], v[112:115]
  v_mfma_f32_16x16x32_bf16 v[116:119], v[40:43], a[40:43], v[116:119]
  v_mfma_f32_16x16x32_bf16 v[120:123], v[40:43], a[72:75], v[120:123]
  v_mfma_f32_16x16x32_bf16 v[124:127], v[40:43], a[104:107], v[124:127]
  v_mfma_f32_16x16x32_bf16 v[128:131], v[40:43], a[136:139], v[128:131]
  v_mfma_f32_16x16x32_bf16 v[132:135], v[40:43], a[168:171], v[132:135]
  v_mfma_f32_16x16x32_bf16 v[136:139], v[40:43], a[200:203], v[136:139]
  v_mfma_f32_16x16x32_bf16 v[140:143], v[40:43], a[232:235], v[140:143]
  s_waitcnt lgkmcnt(0)
  v_mfma_f32_16x16x32_bf16 v[112:115], v[44:47], a[12:15], v[112:115]
  ds_write_b32 v7, v9 offset:4
  v_mfma_f32_16x16x32_bf16 v[116:119], v[44:47], a[44:47], v[116:119]
  s_waitcnt vmcnt(1)
  v_xor_b32 v14, s48, v176
  v_bitop3_b32 v14, v14, s48, v180 bitop3:0xf6
  v_mfma_f32_16x16x32_bf16 v[120:123], v[44:47], a[76:79], v[120:123]
  v_bitop3_b32 v14, v14, s48, v184 bitop3:0xf6
  v_bitop3_b32 v14, v14, s48, v188 bitop3:0xf6
  v_mfma_f32_16x16x32_bf16 v[124:127], v[44:47], a[108:111], v[124:127]
  v_bitop3_b32 v14, v14, s48, v192 bitop3:0xf6
  v_bitop3_b32 v14, v14, s48, v196 bitop3:0xf6
  v_mfma_f32_16x16x32_bf16 v[128:131], v[44:47], a[140:143], v[128:131]
  v_bitop3_b32 v14, v14, s48, v200 bitop3:0xf6
  v_bitop3_b32 v14, v14, s48, v204 bitop3:0xf6
  v_mfma_f32_16x16x32_bf16 v[132:135], v[44:47], a[172:175], v[132:135]
  v_and_b32 v14, 1, v14
  v_cmp_ne_u32 vcc, 0, v14
  v_mfma_f32_16x16x32_bf16 v[136:139], v[44:47], a[204:207], v[136:139]
  v_mfma_f32_16x16x32_bf16 v[140:143], v[44:47], a[236:239], v[140:143]
  s_cbranch_vccnz aows1_pr
aows1_pok:
  v_mfma_f32_16x16x32_bf16 v[80:83], v[176:179], a[16:19], v[80:83]
  s_mov_b64 exec, 1
  buffer_store_dword v9, off, s[8:11], s42 sc1
  s_mov_b64 exec, -1
  v_mfma_f32_16x16x32_bf16 v[84:87], v[176:179], a[48:51], v[84:87]
  v_mfma_f32_16x16x32_bf16 v[88:91], v[176:179], a[80:83], v[88:91]
  v_mfma_f32_16x16x32_bf16 v[92:95], v[176:179], a[112:115], v[92:95]
  v_mfma_f32_16x16x32_bf16 v[96:99], v[176:179], a[144:147], v[96:99]
  v_mfma_f32_16x16x32_bf16 v[100:103], v[176:179], a[176:179], v[100:103]
  v_mfma_f32_16x16x32_bf16 v[104:107], v[176:179], a[208:211], v[104:107]
  v_mfma_f32_16x16x32_bf16 v[108:111], v[176:179], a[240:243], v[108:111]
  v_mfma_f32_16x16x32_bf16 v[80:83], v[180:183], a[20:23], v[80:83]
  buffer_load_dword v11, v12, s[8:11], s39 offen sc1
  v_mfma_f32_16x16x32_bf16 v[84:87], v[180:183], a[52:55], v[84:87]
  v_mfma_f32_16x16x32_bf16 v[88:91], v[180:183], a[84:87], v[88:91]
  v_mfma_f32_16x16x32_bf16 v[92:95], v[180:183], a[116:119], v[92:95]
  v_mfma_f32_16x16x32_bf16 v[96:99], v[180:183], a[148:151], v[96:99]
  buffer_load_dwordx4 v[144:147], v15, s[8:11], s52 offen offset:0 sc1
  v_mfma_f32_16x16x32_bf16 v[100:103], v[180:183], a[180:183], v[100:103]
  v_mfma_f32_16x16x32_bf16 v[104:107], v[180:183], a[212:215], v[104:107]
  buffer_load_dwordx4 v[148:151], v15, s[8:11], s52 offen offset:2048 sc1
  v_mfma_f32_16x16x32_bf16 v[108:111], v[180:183], a[244:247], v[108:111]
  v_mfma_f32_16x16x32_bf16 v[80:83], v[184:187], a[24:27], v[80:83]
  buffer_load_dwordx4 v[152:155], v15, s[8:11], s53 offen offset:0 sc1
  v_mfma_f32_16x16x32_bf16 v[84:87], v[184:187], a[56:59], v[84:87]
  v_mfma_f32_16x16x32_bf16 v[88:91], v[184:187], a[88:91], v[88:91]
  buffer_load_dwordx4 v[156:159], v15, s[8:11], s53 offen offset:2048 sc1
  v_mfma_f32_16x16x32_bf16 v[92:95], v[184:187], a[120:123], v[92:95]
  v_mfma_f32_16x16x32_bf16 v[96:99], v[184:187], a[152:155], v[96:99]
  buffer_load_dwordx4 v[160:163], v15, s[8:11], s52 offen offset:256 sc1
  v_mfma_f32_16x16x32_bf16 v[100:103], v[184:187], a[184:187], v[100:103]
  v_mfma_f32_16x16x32_bf16 v[104:107], v[184:187], a[216:219], v[104:107]
  buffer_load_dwordx4 v[164:167], v15, s[8:11], s52 offen offset:2304 sc1
  v_mfma_f32_16x16x32_bf16 v[108:111], v[184:187], a[248:251], v[108:111]
  v_mfma_f32_16x16x32_bf16 v[80:83], v[188:191], a[28:31], v[80:83]
  buffer_load_dwordx4 v[168:171], v15, s[8:11], s53 offen offset:256 sc1
  v_mfma_f32_16x16x32_bf16 v[84:87], v[188:191], a[60:63], v[84:87]
  v_mfma_f32_16x16x32_bf16 v[88:91], v[188:191], a[92:95], v[88:91]
  buffer_load_dwordx4 v[172:175], v15, s[8:11], s53 offen offset:2304 sc1
  v_mfma_f32_16x16x32_bf16 v[92:95], v[188:191], a[124:127], v[92:95]
  v_mfma_f32_16x16x32_bf16 v[96:99], v[188:191], a[156:159], v[96:99]
  s_waitcnt vmcnt(10)
  v_cmp_gt_i32 vcc, s40, v13
  v_mfma_f32_16x16x32_bf16 v[100:103], v[188:191], a[188:191], v[100:103]
  v_mfma_f32_16x16x32_bf16 v[104:107], v[188:191], a[220:223], v[104:107]
  s_and_b32 s33, vcc_lo, 0xffff
  v_mfma_f32_16x16x32_bf16 v[108:111], v[188:191], a[252:255], v[108:111]
  s_cbranch_scc1 aows1_rw0
aows1_rok0:
  v_mfma_f32_16x16x32_bf16 v[112:115], v[192:195], a[16:19], v[112:115]
  v_mfma_f32_16x16x32_bf16 v[116:119], v[192:195], a[48:51], v[116:119]
  v_cvt_pk_bf16_f32 v48, v80, v84
  v_cvt_pk_bf16_f32 v49, v88, v92
  v_mfma_f32_16x16x32_bf16 v[120:123], v[192:195], a[80:83], v[120:123]
  v_cvt_pk_bf16_f32 v50, v96, v100
  v_cvt_pk_bf16_f32 v51, v104, v108
  v_mfma_f32_16x16x32_bf16 v[124:127], v[192:195], a[112:115], v[124:127]
  v_and_or_b32 v48, v48, -2, s22
  v_mfma_f32_16x16x32_bf16 v[128:131], v[192:195], a[144:147], v[128:131]
  s_add_u32 s33, s23, 0
  v_mfma_f32_16x16x32_bf16 v[132:135], v[192:195], a[176:179], v[132:135]
  buffer_store_dwordx4 v[48:51], v6, s[8:11], s33 offen sc1
  v_cvt_pk_bf16_f32 v52, v81, v85
  v_cvt_pk_bf16_f32 v53, v89, v93
  v_mfma_f32_16x16x32_bf16 v[136:139], v[192:195], a[208:211], v[136:139]
  v_cvt_pk_bf16_f32 v54, v97, v101
  v_cvt_pk_bf16_f32 v55, v105, v109
  v_mfma_f32_16x16x32_bf16 v[140:143], v[192:195], a[240:243], v[140:143]
  v_and_or_b32 v52, v52, -2, s22
  v_mfma_f32_16x16x32_bf16 v[112:115], v[196:199], a[20:23], v[112:115]
  s_add_u32 s33, s23, 16384
  v_mfma_f32_16x16x32_bf16 v[116:119], v[196:199], a[52:55], v[116:119]
  buffer_store_dwordx4 v[52:55], v6, s[8:11], s33 offen sc1
  v_cvt_pk_bf16_f32 v56, v82, v86
  v_cvt_pk_bf16_f32 v57, v90, v94
  v_mfma_f32_16x16x32_bf16 v[120:123], v[196:199], a[84:87], v[120:123]
  v_cvt_pk_bf16_f32 v58, v98, v102
  v_cvt_pk_bf16_f32 v59, v106, v110
  v_mfma_f32_16x16x32_bf16 v[124:127], v[196:199], a[116:119], v[124:127]
  v_and_or_b32 v56, v56, -2, s22
  v_mfma_f32_16x16x32_bf16 v[128:131], v[196:199], a[148:151], v[128:131]
  s_add_u32 s33, s23, 32768
  v_mfma_f32_16x16x32_bf16 v[132:135], v[196:199], a[180:183], v[132:135]
  buffer_store_dwordx4 v[56:59], v6, s[8:11], s33 offen sc1
  v_cvt_pk_bf16_f32 v60, v83, v87
  v_cvt_pk_bf16_f32 v61, v91, v95
  v_mfma_f32_16x16x32_bf16 v[136:139], v[196:199], a[212:215], v[136:139]
  v_cvt_pk_bf16_f32 v62, v99, v103
  v_cvt_pk_bf16_f32 v63, v107, v111
  v_mfma_f32_16x16x32_bf16 v[140:143], v[196:199], a[244:247], v[140:143]
  v_and_or_b32 v60, v60, -2, s22
  v_mfma_f32_16x16x32_bf16 v[112:115], v[200:203], a[24:27], v[112:115]
  s_add_u32 s33, s23, 49152
  v_mfma_f32_16x16x32_bf16 v[116:119], v[200:203], a[56:59], v[116:119]
  buffer_store_dwordx4 v[60:63], v6, s[8:11], s33 offen sc1
  v_mfma_f32_16x16x32_bf16 v[120:123], v[200:203], a[88:91], v[120:123]
  ds_write_b32 v7, v9 offset:12
  v_mfma_f32_16x16x32_bf16 v[124:127], v[200:203], a[120:123], v[124:127]
  v_mfma_f32_16x16x32_bf16 v[128:131], v[200:203], a[152:155], v[128:131]
  v_mfma_f32_16x16x32_bf16 v[132:135], v[200:203], a[184:187], v[132:135]
  v_mfma_f32_16x16x32_bf16 v[136:139], v[200:203], a[216:219], v[136:139]
  v_mfma_f32_16x16x32_bf16 v[140:143], v[200:203], a[248:251], v[140:143]
  v_mfma_f32_16x16x32_bf16 v[112:115], v[204:207], a[28:31], v[112:115]
  v_mfma_f32_16x16x32_bf16 v[116:119], v[204:207], a[60:63], v[116:119]
  v_mfma_f32_16x16x32_bf16 v[120:123], v[204:207], a[92:95], v[120:123]
  v_mfma_f32_16x16x32_bf16 v[124:127], v[204:207], a[124:127], v[124:127]
  s_waitcnt vmcnt(12)
  v_cmp_gt_i32 vcc, s40, v11
  v_mfma_f32_16x16x32_bf16 v[128:131], v[204:207], a[156:159], v[128:131]
  v_mfma_f32_16x16x32_bf16 v[132:135], v[204:207], a[188:191], v[132:135]
  v_mfma_f32_16x16x32_bf16 v[136:139], v[204:207], a[220:223], v[136:139]
  s_cbranch_vccnz aows1_rw1
aows1_rok1:
  v_mfma_f32_16x16x32_bf16 v[140:143], v[204:207], a[252:255], v[140:143]
  v_cvt_pk_bf16_f32 v64, v112, v116
  v_cvt_pk_bf16_f32 v65, v120, v124
  v_cvt_pk_bf16_f32 v66, v128, v132
  s_nop 4
  v_cvt_pk_bf16_f32 v67, v136, v140
  v_and_or_b32 v64, v64, -2, s22
  s_add_u32 s33, s23, 262144
  buffer_store_dwordx4 v[64:67], v6, s[8:11], s33 offen sc1
  v_cvt_pk_bf16_f32 v68, v113, v117
  v_cvt_pk_bf16_f32 v69, v121, v125
  v_cvt_pk_bf16_f32 v70, v129, v133
  v_cvt_pk_bf16_f32 v71, v137, v141
  v_and_or_b32 v68, v68, -2, s22
  s_add_u32 s33, s23, 278528
  buffer_store_dwordx4 v[68:71], v6, s[8:11], s33 offen sc1
  v_cvt_pk_bf16_f32 v72, v114, v118
  v_cvt_pk_bf16_f32 v73, v122, v126
  v_cvt_pk_bf16_f32 v74, v130, v134
  v_cvt_pk_bf16_f32 v75, v138, v142
  v_and_or_b32 v72, v72, -2, s22
  s_add_u32 s33, s23, 294912
  buffer_store_dwordx4 v[72:75], v6, s[8:11], s33 offen sc1
  v_cvt_pk_bf16_f32 v76, v115, v119
  v_cvt_pk_bf16_f32 v77, v123, v127
  v_cvt_pk_bf16_f32 v78, v131, v135
  v_cvt_pk_bf16_f32 v79, v139, v143
  v_and_or_b32 v76, v76, -2, s22
  s_add_u32 s33, s23, 311296
  buffer_store_dwordx4 v[76:79], v6, s[8:11], s33 offen sc1
  ds_write_b32 v7, v9 offset:20
  s_mov_b32 s20, s21
  s_cmp_lt_u32 s20, 64
  s_cbranch_scc1 aows_top0
  s_branch the_end
aows0_rw0:
  s_sub_u32 s3, s3, 1
  s_cbranch_scc1 bail_29
  buffer_load_dword v13, v12, s[8:11], s39 offen sc1
  s_waitcnt vmcnt(0)
  v_cmp_gt_i32 vcc, s40, v13
  s_and_b32 s33, vcc_lo, 0xffff
  s_cbranch_scc1 aows0_rw0
  s_branch aows0_rok0
aows0_rw1:
  s_sub_u32 s3, s3, 1
  s_cbranch_scc1 bail_29
  buffer_load_dword v13, v12, s[8:11], s39 offen sc1
  s_waitcnt vmcnt(0)
  v_cmp_gt_i32 vcc, s40, v13
  s_and_b32 s33, vcc_lo, -1
  s_cbranch_scc1 aows0_rw1
  s_branch aows0_rok1
aows0_ld:
  buffer_load_dwordx4 v[144:147], v15, s[8:11], s49 offen offset:0 sc1
  buffer_load_dwordx4 v[148:151], v15, s[8:11], s49 offen offset:2048 sc1
  buffer_load_dwordx4 v[152:155], v15, s[8:11], s50 offen offset:0 sc1
  buffer_load_dwordx4 v[156:159], v15, s[8:11], s50 offen offset:2048 sc1
  buffer_load_dwordx4 v[160:163], v15, s[8:11], s49 offen offset:256 sc1
  buffer_load_dwordx4 v[164:167], v15, s[8:11], s49 offen offset:2304 sc1
  buffer_load_dwordx4 v[168:171], v15, s[8:11], s50 offen offset:256 sc1
  buffer_load_dwordx4 v[172:175], v15, s[8:11], s50 offen offset:2304 sc1
  s_branch aows0_lk
aows0_pr:
  s_sub_u32 s3, s3, 1
  s_cbranch_scc1 bail_19
  buffer_load_dwordx4 v[144:147], v15, s[8:11], s49 offen offset:0 sc1
  buffer_load_dwordx4 v[148:151], v15, s[8:11], s49 offen offset:2048 sc1
  buffer_load_dwordx4 v[152:155], v15, s[8:11], s50 offen offset:0 sc1
  buffer_load_dwordx4 v[156:159], v15, s[8:11], s50 offen offset:2048 sc1
  buffer_load_dwordx4 v[160:163], v15, s[8:11], s49 offen offset:256 sc1
  buffer_load_dwordx4 v[164:167], v15, s[8:11], s49 offen offset:2304 sc1
  buffer_load_dwordx4 v[168:171], v15, s[8:11], s50 offen offset:256 sc1
  buffer_load_dwordx4 v[172:175], v15, s[8:11], s50 offen offset:2304 sc1
  s_waitcnt vmcnt(0)
  v_xor_b32 v14, s48, v144
  v_bitop3_b32 v14, v14, s48, v148 bitop3:0xf6
  v_bitop3_b32 v14, v14, s48, v152 bitop3:0xf6
  v_bitop3_b32 v14, v14, s48, v156 bitop3:0xf6
  v_bitop3_b32 v14, v14, s48, v160 bitop3:0xf6
  v_bitop3_b32 v14, v14, s48, v164 bitop3:0xf6
  v_bitop3_b32 v14, v14, s48, v168 bitop3:0xf6
  v_bitop3_b32 v14, v14, s48, v172 bitop3:0xf6
  v_and_b32 v14, 1, v14
  v_cmp_ne_u32 vcc, 0, v14
  s_cbranch_vccnz aows0_pr
  s_branch aows0_pok
aows1_rw0:
  s_sub_u32 s3, s3, 1
  s_cbranch_scc1 bail_29
  buffer_load_dword v13, v12, s[8:11], s39 offen sc1
  s_waitcnt vmcnt(0)
  v_cmp_gt_i32 vcc, s40, v13
  s_and_b32 s33, vcc_lo, 0xffff
  s_cbranch_scc1 aows1_rw0
  s_branch aows1_rok0
aows1_rw1:
  s_sub_u32 s3, s3, 1
  s_cbranch_scc1 bail_29
  buffer_load_dword v13, v12, s[8:11], s39 offen sc1
  s_waitcnt vmcnt(0)
  v_cmp_gt_i32 vcc, s40, v13
  s_and_b32 s33, vcc_lo, -1
  s_cbranch_scc1 aows1_rw1
  s_branch aows1_rok1
aows1_ld:
  buffer_load_dwordx4 v[176:179], v15, s[8:11], s49 offen offset:0 sc1
  buffer_load_dwordx4 v[180:183], v15, s[8:11], s49 offen offset:2048 sc1
  buffer_load_dwordx4 v[184:187], v15, s[8:11], s50 offen offset:0 sc1
  buffer_load_dwordx4 v[188:191], v15, s[8:11], s50 offen offset:2048 sc1
  buffer_load_dwordx4 v[192:195], v15, s[8:11], s49 offen offset:256 sc1
  buffer_load_dwordx4 v[196:199], v15, s[8:11], s49 offen offset:2304 sc1
  buffer_load_dwordx4 v[200:203], v15, s[8:11], s50 offen offset:256 sc1
  buffer_load_dwordx4 v[204:207], v15, s[8:11], s50 offen offset:2304 sc1
  s_branch aows1_lk
aows1_pr:
  s_sub_u32 s3, s3, 1
  s_cbranch_scc1 bail_19
  buffer_load_dwordx4 v[176:179], v15, s[8:11], s49 offen offset:0 sc1
  buffer_load_dwordx4 v[180:183], v15, s[8:11], s49 offen offset:2048 sc1
  buffer_load_dwordx4 v[184:187], v15, s[8:11], s50 offen offset:0 sc1
  buffer_load_dwordx4 v[188:191], v15, s[8:11], s50 offen offset:2048 sc1
  buffer_load_dwordx4 v[192:195], v15, s[8:11], s49 offen offset:256 sc1
  buffer_load_dwordx4 v[196:199], v15, s[8:11], s49 offen offset:2304 sc1
  buffer_load_dwordx4 v[200:203], v15, s[8:11], s50 offen offset:256 sc1
  buffer_load_dwordx4 v[204:207], v15, s[8:11], s50 offen offset:2304 sc1
  s_waitcnt vmcnt(0)
  v_xor_b32 v14, s48, v176
  v_bitop3_b32 v14, v14, s48, v180 bitop3:0xf6
  v_bitop3_b32 v14, v14, s48, v184 bitop3:0xf6
  v_bitop3_b32 v14, v14, s48, v188 bitop3:0xf6
  v_bitop3_b32 v14, v14, s48, v192 bitop3:0xf6
  v_bitop3_b32 v14, v14, s48, v196 bitop3:0xf6
  v_bitop3_b32 v14, v14, s48, v200 bitop3:0xf6
  v_bitop3_b32 v14, v14, s48, v204 bitop3:0xf6
  v_and_b32 v14, 1, v14
  v_cmp_ne_u32 vcc, 0, v14
  s_cbranch_vccnz aows1_pr
  s_branch aows1_pok
ao_R:
  s_cmp_eq_u32 s7, 0
  s_cselect_b32 s12, s64, s88
  s_cselect_b32 s13, s65, s89
  s_mov_b32 s14, 0x10000000
  s_cselect_b32 s14, 0x200000, s14
  s_mov_b32 s15, 0x20000
  s_cselect_b32 s36, 0, 13631488
  s_lshl_b32 s33, s6, 10
  s_add_u32 s36, s36, s33
  s_lshl_b32 s34, s7, 21
  s_add_u32 s37, s34, s33
  s_add_u32 s37, s37, 9437184
  s_lshl_b32 s33, s6, 14
  s_lshl_b32 s34, s7, 22
  s_add_u32 s38, s34, s33
  s_add_u32 s38, s38, 142606336
  s_lshl_b32 s33, s7, 7
  s_lshl_b32 s34, s6, 2
  s_add_u32 s33, s33, s34
  s_add_u32 s40, s33, 147456
  s_lshl_b32 s33, s33, 5
  s_add_u32 s39, s33, 114688
  s_lshl_b32 s33, s7, 9
  s_add_u32 s42, s33, 151552
  s_lshr_b32 s33, s6, 4
  s_lshl_b32 s33, s33, 8
  s_add_u32 s42, s42, s33
  v_lshrrev_b32 v6, 4, v1
  v_lshlrev_b32 v6, 10, v6
  v_and_b32 v7, 15, v1
  v_lshl_add_u32 v6, v7, 4, v6
  v_lshlrev_b32 v7, 3, v1
  v_mov_b32 v8, 0
  v_bfe_u32 v10, v1, 1, 3
  v_and_b32 v11, 1, v1
  v_lshlrev_b32 v11, 4, v11
  v_mov_b32 v12, 0x3f80
  v_lshlrev_b32 v11, v11, v12
  v_cmp_eq_u32 vcc, 0, v10
  s_nop 1
  v_cndmask_b32 v16, 0, v11, vcc
  v_cmp_eq_u32 vcc, 4, v10
  s_nop 1
  v_cndmask_b32 v20, 0, v11, vcc
  v_cmp_eq_u32 vcc, 1, v10
  s_nop 1
  v_cndmask_b32 v17, 0, v11, vcc
  v_cmp_eq_u32 vcc, 5, v10
  s_nop 1
  v_cndmask_b32 v21, 0, v11, vcc
  v_cmp_eq_u32 vcc, 2, v10
  s_nop 1
  v_cndmask_b32 v18, 0, v11, vcc
  v_cmp_eq_u32 vcc, 6, v10
  s_nop 1
  v_cndmask_b32 v22, 0, v11, vcc
  v_cmp_eq_u32 vcc, 3, v10
  s_nop 1
  v_cndmask_b32 v19, 0, v11, vcc
  v_cmp_eq_u32 vcc, 7, v10
  s_nop 1
  v_cndmask_b32 v23, 0, v11, vcc
  v_mov_b32 v5, 84
  s_mov_b64 exec, 1
wd_22:
  buffer_load_dword v4, v5, s[24:27], 0 offen sc1
  s_waitcnt vmcnt(0)
  v_cmp_gt_u32 vcc, 1, v4
  s_cbranch_vccz wdd_23
  s_sub_u32 s3, s3, 1
  s_cbranch_scc1 bail_22
  s_sleep 8
  s_branch wd_22
wdd_23:
  s_mov_b64 exec, -1
  s_mov_b32 s41, 1
dm_24:
  v_and_b32 v5, 15, v1
  v_lshlrev_b32 v5, 2, v5
  v_add_u32 v4, 128, v5
  v_cmp_gt_u32 vcc, 4, v5
  s_nop 1
  v_cndmask_b32 v5, v4, v5, vcc
  buffer_load_dword v4, v5, s[24:27], 0 offen sc1
  s_waitcnt vmcnt(0)
  v_readlane_b32 s34, v4, s5
  s_nop 0
  s_cmp_ge_u32 s34, 32
  s_cbranch_scc1 dmf_25
  v_readlane_b32 s33, v4, 0
  v_readlane_b32 s34, v4, 1
  s_nop 0
  s_add_u32 s33, s33, s34
  v_readlane_b32 s34, v4, 2
  s_nop 0
  s_add_u32 s33, s33, s34
  v_readlane_b32 s34, v4, 3
  s_nop 0
  s_add_u32 s33, s33, s34
  v_readlane_b32 s34, v4, 4
  s_nop 0
  s_add_u32 s33, s33, s34
  v_readlane_b32 s34, v4, 5
  s_nop 0
  s_add_u32 s33, s33, s34
  v_readlane_b32 s34, v4, 6
  s_nop 0
  s_add_u32 s33, s33, s34
  v_readlane_b32 s34, v4, 7
  s_nop 0
  s_add_u32 s33, s33, s34
  v_readlane_b32 s34, v4, 8
  s_nop 0
  s_add_u32 s33, s33, s34
  v_readlane_b32 s34, v4, 9
  s_nop 0
  s_add_u32 s33, s33, s34
  v_readlane_b32 s34, v4, 10
  s_nop 0
  s_add_u32 s33, s33, s34
  v_readlane_b32 s34, v4, 11
  s_nop 0
  s_add_u32 s33, s33, s34
  v_readlane_b32 s34, v4, 12
  s_nop 0
  s_add_u32 s33, s33, s34
  v_readlane_b32 s34, v4, 13
  s_nop 0
  s_add_u32 s33, s33, s34
  v_readlane_b32 s34, v4, 14
  s_nop 0
  s_add_u32 s33, s33, s34
  v_readlane_b32 s34, v4, 15
  s_nop 0
  s_add_u32 s33, s33, s34
  s_cmp_ge_u32 s33, 256
  s_cbranch_scc1 aor_top
  s_sub_u32 s3, s3, 1
  s_cbranch_scc1 bail_2
  s_sleep 8
  s_branch dm_24
dmf_25:
  s_mov_b32 s41, 0
aor_top:
  s_lshr_b32 s33, s6, 4
  s_lshl_b32 s33, s33, 3
  s_add_u32 s33, s33, 16396
  v_mov_b32 v4, s33
  s_cmp_eq_u32 s7, 0
  s_cselect_b64 s[46:47], 0, -1
  s_mov_b32 s21, 1
  v_lshlrev_b32 v5, 7, v1
  s_lshl_b32 s33, s6, 13
  s_sub_u32 s34, s38, s33
  s_add_u32 s34, s34, 1048576
  s_add_u32 s33, s38, 0
  buffer_load_dword v10, v5, s[8:11], s33 offen sc1
  s_add_u32 s33, s38, 8192
  buffer_load_dword v10, v5, s[8:11], s33 offen sc1
  s_add_u32 s33, s38, 524288
  buffer_load_dword v10, v5, s[8:11], s33 offen sc1
  s_add_u32 s33, s38, 532480
  buffer_load_dword v10, v5, s[8:11], s33 offen sc1
  s_add_u32 s33, s34, 0
  buffer_load_dword v10, v5, s[8:11], s33 offen sc1
  s_add_u32 s33, s34, 262144
  buffer_load_dword v10, v5, s[8:11], s33 offen sc1
  s_waitcnt vmcnt(0)
ls_26:
  ds_read_b32 v10, v2 offset:0
  s_waitcnt lgkmcnt(0)
  v_cmp_gt_i32 vcc, s21, v10
  s_cbranch_vccz lsd_27
  s_sub_u32 s3, s3, 1
  s_cbranch_scc1 bail_23
  s_sleep 4
  s_branch ls_26
lsd_27:
aor_rx:
  s_sub_u32 s3, s3, 1
  s_cbranch_scc1 bail_26
  buffer_load_dwordx4 v[32:35], v3, s[12:15], s36 offen sc1
  s_waitcnt vmcnt(0)
aor_loop:
  v_cmp_eq_u32 vcc, -1, v32
  s_add_u32 s21, s20, 1
  s_and_b64 vcc, vcc, s[46:47]
  s_cbranch_scc1 aor_rx
  v_permlane16_swap_b32 v32, v34
  v_permlane16_swap_b32 v33, v35
  v_lshlrev_b32 v48, 16, v32
  v_and_b32 v49, 0xffff0000, v32
  v_lshlrev_b32 v50, 16, v33
  v_and_b32 v51, 0xffff0000, v33
  v_lshlrev_b32 v52, 16, v34
  v_and_b32 v53, 0xffff0000, v34
  v_lshlrev_b32 v54, 16, v35
  v_and_b32 v55, 0xffff0000, v35
  s_add_u32 s44, s44, 1
  s_cmp_eq_u32 s44, 2
  s_cselect_b32 s44, 0, s44
  s_cselect_b32 s23, 1, 0
  s_xor_b32 s22, s22, s23
  s_lshl_b32 s23, s44, 19
  s_add_u32 s23, s23, s38
  s_cmp_lt_u32 s20, 63
  s_cselect_b32 s33, 32768, 0
  s_add_u32 s36, s36, s33
ls_28:
  ds_read2_b32 v[12:13], v4 offset0:0 offset1:1
  s_waitcnt lgkmcnt(0)
  v_min_i32 v12, v12, v13
  v_cmp_gt_i32 vcc, s21, v12
  s_cbranch_vccz lsd_29
  s_sub_u32 s3, s3, 1
  s_cbranch_scc1 bail_24
  s_sleep 1
  s_branch ls_28
lsd_29:
aor_p:
  s_sub_u32 s3, s3, 1
  s_cbranch_scc1 bail_25
  buffer_load_dwordx4 v[64:67], v6, s[8:11], s23 offen offset:0 sc1
  buffer_load_dwordx4 v[68:71], v6, s[8:11], s23 offen offset:256 sc1
  buffer_load_dwordx4 v[72:75], v6, s[8:11], s23 offen offset:512 sc1
  buffer_load_dwordx4 v[76:79], v6, s[8:11], s23 offen offset:768 sc1
  s_add_u32 s33, s23, 4096
  buffer_load_dwordx4 v[80:83], v6, s[8:11], s33 offen offset:0 sc1
  buffer_load_dwordx4 v[84:87], v6, s[8:11], s33 offen offset:256 sc1
  buffer_load_dwordx4 v[88:91], v6, s[8:11], s33 offen offset:512 sc1
  buffer_load_dwordx4 v[92:95], v6, s[8:11], s33 offen offset:768 sc1
  s_add_u32 s33, s23, 8192
  buffer_load_dwordx4 v[96:99], v6, s[8:11], s33 offen offset:0 sc1
  buffer_load_dwordx4 v[100:103], v6, s[8:11], s33 offen offset:256 sc1
  buffer_load_dwordx4 v[104:107], v6, s[8:11], s33 offen offset:512 sc1
  buffer_load_dwordx4 v[108:111], v6, s[8:11], s33 offen offset:768 sc1
  s_add_u32 s33, s23, 12288
  buffer_load_dwordx4 v[112:115], v6, s[8:11], s33 offen offset:0 sc1
  buffer_load_dwordx4 v[116:119], v6, s[8:11], s33 offen offset:256 sc1
  buffer_load_dwordx4 v[120:123], v6, s[8:11], s33 offen offset:512 sc1
  buffer_load_dwordx4 v[124:127], v6, s[8:11], s33 offen offset:768 sc1
  s_waitcnt vmcnt(15)
  v_mfma_f32_16x16x32_bf16 v[24:27], v[16:19], v[64:67], v[48:51]
  v_xor_b32 v10, s22, v64
  s_waitcnt vmcnt(14)
  v_mfma_f32_16x16x32_bf16 v[28:31], v[16:19], v[68:71], v[52:55]
  v_bitop3_b32 v10, v10, s22, v68 bitop3:0xf6
  s_waitcnt vmcnt(13)
  v_mfma_f32_16x16x32_bf16 v[24:27], v[20:23], v[72:75], v[24:27]
  v_bitop3_b32 v10, v10, s22, v72 bitop3:0xf6
  s_waitcnt vmcnt(12)
  v_mfma_f32_16x16x32_bf16 v[28:31], v[20:23], v[76:79], v[28:31]
  v_bitop3_b32 v10, v10, s22, v76 bitop3:0xf6
  s_waitcnt vmcnt(11)
  v_mfma_f32_16x16x32_bf16 v[24:27], v[16:19], v[80:83], v[24:27]
  v_bitop3_b32 v10, v10, s22, v80 bitop3:0xf6
  s_waitcnt vmcnt(10)
  v_mfma_f32_16x16x32_bf16 v[28:31], v[16:19], v[84:87], v[28:31]
  v_bitop3_b32 v10, v10, s22, v84 bitop3:0xf6
  s_waitcnt vmcnt(9)
  v_mfma_f32_16x16x32_bf16 v[24:27], v[20:23], v[88:91], v[24:27]
  v_bitop3_b32 v10, v10, s22, v88 bitop3:0xf6
  s_waitcnt vmcnt(8)
  v_mfma_f32_16x16x32_bf16 v[28:31], v[20:23], v[92:95], v[28:31]
  v_bitop3_b32 v10, v10, s22, v92 bitop3:0xf6
  s_waitcnt vmcnt(7)
  v_mfma_f32_16x16x32_bf16 v[24:27], v[16:19], v[96:99], v[24:27]
  v_bitop3_b32 v10, v10, s22, v96 bitop3:0xf6
  s_waitcnt vmcnt(6)
  v_mfma_f32_16x16x32_bf16 v[28:31], v[16:19], v[100:103], v[28:31]
  v_bitop3_b32 v10, v10, s22, v100 bitop3:0xf6
  s_waitcnt vmcnt(5)
  v_mfma_f32_16x16x32_bf16 v[24:27], v[20:23], v[104:107], v[24:27]
  v_bitop3_b32 v10, v10, s22, v104 bitop3:0xf6
  s_waitcnt vmcnt(4)
  v_mfma_f32_16x16x32_bf16 v[28:31], v[20:23], v[108:111], v[28:31]
  v_bitop3_b32 v10, v10, s22, v108 bitop3:0xf6
  s_waitcnt vmcnt(3)
  v_mfma_f32_16x16x32_bf16 v[24:27], v[16:19], v[112:115], v[24:27]
  v_bitop3_b32 v10, v10, s22, v112 bitop3:0xf6
  s_waitcnt vmcnt(2)
  v_mfma_f32_16x16x32_bf16 v[28:31], v[16:19], v[116:119], v[28:31]
  v_bitop3_b32 v10, v10, s22, v116 bitop3:0xf6
  s_waitcnt vmcnt(1)
  v_mfma_f32_16x16x32_bf16 v[24:27], v[20:23], v[120:123], v[24:27]
  v_bitop3_b32 v10, v10, s22, v120 bitop3:0xf6
  s_waitcnt vmcnt(0)
  v_mfma_f32_16x16x32_bf16 v[28:31], v[20:23], v[124:127], v[28:31]
  v_bitop3_b32 v10, v10, s22, v124 bitop3:0xf6
  v_and_b32 v10, 1, v10
  v_cmp_ne_u32 vcc, 0, v10
  s_cbranch_vccnz aor_p
  v_mov_b32 v9, s21
  s_mov_b64 exec, 1
  s_cmp_eq_u32 s41, 0
  s_cbranch_scc0 dn_30
  buffer_store_dword v9, v8, s[8:11], s40 offen
  s_branch dne_31
dn_30:
  buffer_store_dword v9, v8, s[8:11], s40 offen sc1
dne_31:
  s_mov_b64 exec, -1
  buffer_load_dwordx4 v[32:35], v3, s[12:15], s36 offen sc1
  s_sub_u32 s33, s37, 4194304
  v_pk_add_f32 v[12:13], v[24:25], v[26:27]
  v_pk_mul_f32 v[14:15], v[24:25], v[24:25]
  v_pk_add_f32 v[12:13], v[12:13], v[28:29]
  v_pk_fma_f32 v[14:15], v[26:27], v[26:27], v[14:15]
  v_pk_add_f32 v[12:13], v[12:13], v[30:31]
  v_pk_fma_f32 v[14:15], v[28:29], v[28:29], v[14:15]
  v_add_f32 v12, v12, v13
  v_pk_fma_f32 v[14:15], v[30:31], v[30:31], v[14:15]
  v_add_f32 v14, v14, v15
  s_nop 1
  v_permlane32_swap_b32 v12, v14
  v_add_f32 v12, v12, v14
  v_cvt_pk_bf16_f32 v36, v24, v25
  v_cvt_pk_bf16_f32 v37, v26, v27
  v_add_f32_dpp v12, v12, v12 row_ror:8 row_mask:0xf bank_mask:0xf
  v_cvt_pk_bf16_f32 v38, v28, v29
  v_cvt_pk_bf16_f32 v39, v30, v31
  v_add_f32_dpp v12, v12, v12 row_ror:4 row_mask:0xf bank_mask:0xf
  v_permlane16_swap_b32 v36, v38
  v_permlane16_swap_b32 v37, v39
  v_add_f32_dpp v12, v12, v12 row_ror:2 row_mask:0xf bank_mask:0xf
  v_min_u32 v36, -2, v36
  s_nop 0
  v_add_f32_dpp v12, v12, v12 row_ror:1 row_mask:0xf bank_mask:0xf
  v_mov_b32 v13, v12
  s_nop 1
  v_permlane16_swap_b32 v13, v12
  v_add_f32 v14, v12, v13
  v_add_f32 v12, v12, v13
  v_mov_b32 v15, 0x3727c5ac
  s_nop 0
  v_permlane32_swap_b32 v12, v14
  v_mul_f32 v12, 0x3b000000, v12
  v_mul_f32 v14, 0x3b000000, v14
  v_fma_f32 v14, -v12, v12, v14
  v_max_f32 v14, 0, v14
  v_add_f32 v14, v14, v15
  v_rsq_f32 v14, v14
  v_pk_add_f32 v[24:25], v[24:25], v[12:13] op_sel_hi:[1,0] neg_lo:[0,1] neg_hi:[0,1]
  v_pk_add_f32 v[26:27], v[26:27], v[12:13] op_sel_hi:[1,0] neg_lo:[0,1] neg_hi:[0,1]
  v_pk_add_f32 v[28:29], v[28:29], v[12:13] op_sel_hi:[1,0] neg_lo:[0,1] neg_hi:[0,1]
  v_pk_add_f32 v[30:31], v[30:31], v[12:13] op_sel_hi:[1,0] neg_lo:[0,1] neg_hi:[0,1]
  v_pk_mul_f32 v[24:25], v[24:25], v[14:15] op_sel_hi:[1,0]
  v_pk_mul_f32 v[26:27], v[26:27], v[14:15] op_sel_hi:[1,0]
  v_pk_mul_f32 v[28:29], v[28:29], v[14:15] op_sel_hi:[1,0]
  v_pk_mul_f32 v[30:31], v[30:31], v[14:15] op_sel_hi:[1,0]
  v_cvt_pk_bf16_f32 v40, v24, v25
  v_cvt_pk_bf16_f32 v42, v28, v29
  v_cvt_pk_bf16_f32 v41, v26, v27
  v_cvt_pk_bf16_f32 v43, v30, v31
  v_permlane16_swap_b32 v40, v42
  s_nop 0
  v_permlane16_swap_b32 v41, v43
  v_min_u32 v40, -2, v40
  buffer_store_dwordx4 v[40:43], v3, s[8:11], s33 offen sc1
  buffer_store_dwordx4 v[36:39], v3, s[8:11], s37 offen sc1
  s_add_u32 s37, s37, 32768
  s_mov_b32 s20, s21
  s_waitcnt vmcnt(2)
  s_cmp_lt_u32 s20, 64
  s_cbranch_scc1 aor_loop
  s_branch the_end
ao_A:
  v_mov_b32 v5, 84
  s_mov_b64 exec, 1
wd_32:
  buffer_load_dword v4, v5, s[24:27], 0 offen sc1
  s_waitcnt vmcnt(0)
  v_cmp_gt_u32 vcc, 1, v4
  s_cbranch_vccz wdd_33
  s_sub_u32 s3, s3, 1
  s_cbranch_scc1 bail_18
  s_sleep 8
  s_branch wd_32
wdd_33:
  s_mov_b64 exec, -1
  s_mov_b32 s46, 1
dm_34:
  v_and_b32 v5, 15, v1
  v_lshlrev_b32 v5, 2, v5
  v_add_u32 v4, 128, v5
  v_cmp_gt_u32 vcc, 4, v5
  s_nop 1
  v_cndmask_b32 v5, v4, v5, vcc
  buffer_load_dword v4, v5, s[24:27], 0 offen sc1
  s_waitcnt vmcnt(0)
  v_readlane_b32 s34, v4, s5
  s_nop 0
  s_cmp_ge_u32 s34, 32
  s_cbranch_scc1 dmf_35
  v_readlane_b32 s33, v4, 0
  v_readlane_b32 s34, v4, 1
  s_nop 0
  s_add_u32 s33, s33, s34
  v_readlane_b32 s34, v4, 2
  s_nop 0
  s_add_u32 s33, s33, s34
  v_readlane_b32 s34, v4, 3
  s_nop 0
  s_add_u32 s33, s33, s34
  v_readlane_b32 s34, v4, 4
  s_nop 0
  s_add_u32 s33, s33, s34
  v_readlane_b32 s34, v4, 5
  s_nop 0
  s_add_u32 s33, s33, s34
  v_readlane_b32 s34, v4, 6
  s_nop 0
  s_add_u32 s33, s33, s34
  v_readlane_b32 s34, v4, 7
  s_nop 0
  s_add_u32 s33, s33, s34
  v_readlane_b32 s34, v4, 8
  s_nop 0
  s_add_u32 s33, s33, s34
  v_readlane_b32 s34, v4, 9
  s_nop 0
  s_add_u32 s33, s33, s34
  v_readlane_b32 s34, v4, 10
  s_nop 0
  s_add_u32 s33, s33, s34
  v_readlane_b32 s34, v4, 11
  s_nop 0
  s_add_u32 s33, s33, s34
  v_readlane_b32 s34, v4, 12
  s_nop 0
  s_add_u32 s33, s33, s34
  v_readlane_b32 s34, v4, 13
  s_nop 0
  s_add_u32 s33, s33, s34
  v_readlane_b32 s34, v4, 14
  s_nop 0
  s_add_u32 s33, s33, s34
  v_readlane_b32 s34, v4, 15
  s_nop 0
  s_add_u32 s33, s33, s34
  s_cmp_ge_u32 s33, 256
  s_cbranch_scc1 aoa_m
  s_sub_u32 s3, s3, 1
  s_cbranch_scc1 bail_2
  s_sleep 8
  s_branch dm_34
dmf_35:
  s_mov_b32 s46, 0
aoa_m:
  s_lshl_b32 s47, s7, 22
  s_lshl_b32 s33, s6, 13
  s_add_u32 s47, s47, s33
  s_add_u32 s47, s47, 143654912
  s_lshl_b32 s33, s7, 5
  s_add_u32 s33, s33, s6
  s_lshl_b32 s33, s33, 9
  s_add_u32 s40, s33, 49152
  s_add_u32 s41, s33, 0
  s_lshl_b32 s33, s7, 4
  s_lshr_b32 s34, s6, 1
  s_add_u32 s33, s33, s34
  s_lshl_b32 s33, s33, 9
  s_add_u32 s42, s33, 32768
  s_lshl_b32 s33, s7, 7
  s_add_u32 s43, s33, 147328
  v_mov_b32 v4, s42
  v_mov_b32 v6, -100
  v_mov_b32 v10, s42
  v_mov_b32 v11, -100
  v_cmp_gt_u32 vcc, 32, v1
  s_nop 1
  v_cndmask_b32 v4, v4, v10, vcc
  v_cndmask_b32 v6, v6, v11, vcc
  v_cmp_gt_u32 vcc, 12, v1
  s_nop 1
  v_cndmask_b32_e64 v6, v6, 2, vcc
  v_mov_b32 v10, s41
  v_cmp_gt_u32 vcc, 8, v1
  s_nop 1
  v_cndmask_b32 v4, v4, v10, vcc
  v_mov_b32 v10, s40
  v_cmp_gt_u32 vcc, 4, v1
  s_nop 1
  v_cndmask_b32 v4, v4, v10, vcc
  v_and_b32 v10, 3, v1
  v_lshlrev_b32 v10, 7, v10
  v_add_u32 v4, v10, v4
  s_lshl_b32 s33, s7, 8
  s_xor_b32 s34, s6, 1
  s_lshl_b32 s34, s34, 3
  s_add_u32 s33, s33, s34
  s_add_u32 s33, s33, 154576
  v_lshl_add_u32 v10, v1, 2, s33
  v_cmp_lt_u32 vcc, 11, v1
  s_nop 1
  v_cndmask_b32 v4, v4, v10, vcc
  v_bfe_u32 v10, v1, 3, 1
  v_lshlrev_b32 v10, 2, v10
  v_and_b32 v11, 3, v1
  v_add_u32 v10, v10, v11
  v_lshlrev_b32 v10, 5, v10
  v_lshrrev_b32 v11, 5, v1
  v_lshl_add_u32 v7, v11, 4, v10
  v_bfe_u32 v10, v1, 2, 1
  v_bfe_u32 v11, v1, 4, 1
  v_xor_b32 v10, v10, v11
  v_lshl_add_u32 v7, v10, 30, v7
  v_lshrrev_b32 v11, 5, v1
  v_lshlrev_b32 v8, 3, v1
  v_mov_b32 v9, v3
  v_lshlrev_b32 v11, 2, v11
  v_and_b32 v10, 31, v1
  v_sub_u32 v10, v10, v11
  v_mov_b32 v11, 0xf149f2ca
  v_cmp_gt_i32 vcc, 0, v10
  s_nop 1
  v_cndmask_b32 v16, 0, v11, vcc
  v_cmp_gt_i32 vcc, 1, v10
  s_nop 1
  v_cndmask_b32 v17, 0, v11, vcc
  v_cmp_gt_i32 vcc, 2, v10
  s_nop 1
  v_cndmask_b32 v18, 0, v11, vcc
  v_cmp_gt_i32 vcc, 3, v10
  s_nop 1
  v_cndmask_b32 v19, 0, v11, vcc
  v_cmp_gt_i32 vcc, 8, v10
  s_nop 1
  v_cndmask_b32 v20, 0, v11, vcc
  v_cmp_gt_i32 vcc, 9, v10
  s_nop 1
  v_cndmask_b32 v21, 0, v11, vcc
  v_cmp_gt_i32 vcc, 10, v10
  s_nop 1
  v_cndmask_b32 v22, 0, v11, vcc
  v_cmp_gt_i32 vcc, 11, v10
  s_nop 1
  v_cndmask_b32 v23, 0, v11, vcc
  v_cmp_gt_i32 vcc, 16, v10
  s_nop 1
  v_cndmask_b32 v24, 0, v11, vcc
  v_cmp_gt_i32 vcc, 17, v10
  s_nop 1
  v_cndmask_b32 v25, 0, v11, vcc
  v_cmp_gt_i32 vcc, 18, v10
  s_nop 1
  v_cndmask_b32 v26, 0, v11, vcc
  v_cmp_gt_i32 vcc, 19, v10
  s_nop 1
  v_cndmask_b32 v27, 0, v11, vcc
  v_cmp_gt_i32 vcc, 24, v10
  s_nop 1
  v_cndmask_b32 v28, 0, v11, vcc
  v_cmp_gt_i32 vcc, 25, v10
  s_nop 1
  v_cndmask_b32 v29, 0, v11, vcc
  v_cmp_gt_i32 vcc, 26, v10
  s_nop 1
  v_cndmask_b32 v30, 0, v11, vcc
  v_cmp_gt_i32 vcc, 27, v10
  s_nop 1
  v_cndmask_b32 v31, 0, v11, vcc
  s_mul_i32 s33, s7, 50331648
  s_mul_i32 s34, s6, 24576
  s_add_u32 s33, s33, s34
  s_add_u32 s36, s33, 41943040
  s_lshl_b32 s33, s7, 23
  s_lshl_b32 s34, s6, 12
  s_add_u32 s33, s33, s34
  s_add_u32 s37, s33, 25165824
  s_mov_b32 s38, 1040356334
  s_mov_b32 s39, 1040356334
  v_add_u32 v5, -1, v6
  v_min_i32 v5, 64, v5
  s_mov_b64 exec, 0xff0
ap_36:
  buffer_load_dword v10, v4, s[8:11], 0 offen sc1
  s_waitcnt vmcnt(0)
  v_cmp_gt_i32 vcc, v5, v10
  s_cbranch_vccz apd_37
  s_mov_b64 exec, vcc
  s_sub_u32 s3, s3, 1
  s_cbranch_scc1 bail_26
  s_sleep 1
  s_branch ap_36
apd_37:
  s_mov_b64 exec, -1
  s_add_u32 s34, s36, 0
  buffer_load_dwordx4 a[0:3], v3, s[8:11], s34 offen offset:0 sc1
  buffer_load_dwordx4 a[4:7], v3, s[8:11], s34 offen offset:1024 sc1
  buffer_load_dwordx4 a[8:11], v3, s[8:11], s34 offen offset:2048 sc1
  buffer_load_dwordx4 a[12:15], v3, s[8:11], s34 offen offset:3072 sc1
  s_add_u32 s34, s36, 4096
  buffer_load_dwordx4 a[16:19], v3, s[8:11], s34 offen offset:0 sc1
  buffer_load_dwordx4 a[20:23], v3, s[8:11], s34 offen offset:1024 sc1
  buffer_load_dwordx4 a[24:27], v3, s[8:11], s34 offen offset:2048 sc1
  buffer_load_dwordx4 a[28:31], v3, s[8:11], s34 offen offset:3072 sc1
  s_add_u32 s34, s36, 8192
  buffer_load_dwordx4 a[32:35], v3, s[8:11], s34 offen offset:0 sc1
  buffer_load_dwordx4 a[36:39], v3, s[8:11], s34 offen offset:1024 sc1
  buffer_load_dwordx4 a[40:43], v3, s[8:11], s34 offen offset:2048 sc1
  buffer_load_dwordx4 a[44:47], v3, s[8:11], s34 offen offset:3072 sc1
  s_add_u32 s34, s36, 12288
  buffer_load_dwordx4 a[48:51], v3, s[8:11], s34 offen offset:0 sc1
  buffer_load_dwordx4 a[52:55], v3, s[8:11], s34 offen offset:1024 sc1
  buffer_load_dwordx4 a[56:59], v3, s[8:11], s34 offen offset:2048 sc1
  buffer_load_dwordx4 a[60:63], v3, s[8:11], s34 offen offset:3072 sc1
  s_add_u32 s34, s36, 16384
  buffer_load_dwordx4 a[64:67], v3, s[8:11], s34 offen offset:0 sc1
  buffer_load_dwordx4 a[68:71], v3, s[8:11], s34 offen offset:1024 sc1
  buffer_load_dwordx4 a[72:75], v3, s[8:11], s34 offen offset:2048 sc1
  buffer_load_dwordx4 a[76:79], v3, s[8:11], s34 offen offset:3072 sc1
  s_add_u32 s34, s36, 20480
  buffer_load_dwordx4 a[80:83], v3, s[8:11], s34 offen offset:0 sc1
  buffer_load_dwordx4 a[84:87], v3, s[8:11], s34 offen offset:1024 sc1
  buffer_load_dwordx4 a[88:91], v3, s[8:11], s34 offen offset:2048 sc1
  buffer_load_dwordx4 a[92:95], v3, s[8:11], s34 offen offset:3072 sc1
  s_add_u32 s36, s36, 786432
  v_mov_b32 v15, 0
  v_mov_b32 v64, -1
  s_waitcnt vmcnt(0)
aoa_top:
  s_cmp_eq_u32 s20, 63
  s_cselect_b32 s33, 786432, 0
  s_sub_u32 s36, s36, s33
  v_add_u32 v5, s20, v6
  v_min_i32 v5, 64, v5
  s_waitcnt vmcnt(8)
  v_max3_u32 v10, v64, v68, v72
  v_max3_u32 v11, v76, v80, v84
  v_max3_u32 v10, v10, v88, v92
  v_max3_u32 v11, v11, v96, v98
  v_max3_u32 v10, v10, v100, v102
  v_max_u32 v10, v10, v11
  v_cmp_eq_u32 s[52:53], -1, v10
  s_mov_b64 exec, 0xff0
  v_cmp_gt_i32 vcc, v5, v15
  s_mov_b64 exec, -1
  s_or_b64 s[54:55], s[52:53], vcc
  s_cbranch_scc0 aoa_p0
  s_cmp_eq_u64 s[52:53], 0
  s_cbranch_scc1 aoa_q0
  buffer_load_dwordx4 v[64:67], v7, s[8:11], s37 offen offset:0 sc1
  buffer_load_dwordx4 v[68:71], v7, s[8:11], s37 offen offset:256 sc1
  buffer_load_dwordx4 v[72:75], v7, s[8:11], s37 offen offset:512 sc1
  buffer_load_dwordx4 v[76:79], v7, s[8:11], s37 offen offset:768 sc1
  buffer_load_dwordx4 v[80:83], v7, s[8:11], s37 offen offset:1024 sc1
  buffer_load_dwordx4 v[84:87], v7, s[8:11], s37 offen offset:1280 sc1
  buffer_load_dwordx4 v[88:91], v7, s[8:11], s37 offen offset:1536 sc1
  buffer_load_dwordx4 v[92:95], v7, s[8:11], s37 offen offset:1792 sc1
  buffer_load_dwordx2 v[96:97], v8, s[8:11], s37 offen offset:2048 sc1
  buffer_load_dwordx2 v[98:99], v8, s[8:11], s37 offen offset:2560 sc1
  buffer_load_dwordx2 v[100:101], v8, s[8:11], s37 offen offset:3072 sc1
  buffer_load_dwordx2 v[102:103], v8, s[8:11], s37 offen offset:3584 sc1
aoa_q0:
  s_mov_b64 exec, 0x3ff0
  buffer_load_dword v15, v4, s[8:11], 0 offen sc1
  s_mov_b64 exec, -1
  v_mfma_f32_32x32x16_bf16 v[32:47], a[32:35], a[0:3], v[16:31]
  v_mfma_f32_32x32x16_bf16 v[32:47], a[36:39], a[4:7], v[32:47]
  v_mfma_f32_32x32x16_bf16 v[32:47], a[40:43], a[8:11], v[32:47]
  v_mfma_f32_32x32x16_bf16 v[32:47], a[44:47], a[12:15], v[32:47]
  v_mfma_f32_32x32x16_bf16 v[32:47], a[48:51], a[16:19], v[32:47]
  v_mfma_f32_32x32x16_bf16 v[32:47], a[52:55], a[20:23], v[32:47]
  v_mfma_f32_32x32x16_bf16 v[32:47], a[56:59], a[24:27], v[32:47]
  v_mfma_f32_32x32x16_bf16 v[32:47], a[60:63], a[28:31], v[32:47]
aoa_k0:
  s_waitcnt vmcnt(0)
  v_max3_u32 v10, v64, v68, v72
  v_max3_u32 v11, v76, v80, v84
  v_max3_u32 v10, v10, v88, v92
  v_max3_u32 v11, v11, v96, v98
  v_max3_u32 v10, v10, v100, v102
  v_max_u32 v10, v10, v11
  v_cmp_eq_u32 vcc, -1, v10
  s_cbranch_vccz aoa_r0
  s_sub_u32 s3, s3, 1
  s_cbranch_scc1 bail_16
  buffer_load_dwordx4 v[64:67], v7, s[8:11], s37 offen offset:0 sc1
  buffer_load_dwordx4 v[68:71], v7, s[8:11], s37 offen offset:256 sc1
  buffer_load_dwordx4 v[72:75], v7, s[8:11], s37 offen offset:512 sc1
  buffer_load_dwordx4 v[76:79], v7, s[8:11], s37 offen offset:768 sc1
  buffer_load_dwordx4 v[80:83], v7, s[8:11], s37 offen offset:1024 sc1
  buffer_load_dwordx4 v[84:87], v7, s[8:11], s37 offen offset:1280 sc1
  buffer_load_dwordx4 v[88:91], v7, s[8:11], s37 offen offset:1536 sc1
  buffer_load_dwordx4 v[92:95], v7, s[8:11], s37 offen offset:1792 sc1
  buffer_load_dwordx2 v[96:97], v8, s[8:11], s37 offen offset:2048 sc1
  buffer_load_dwordx2 v[98:99], v8, s[8:11], s37 offen offset:2560 sc1
  buffer_load_dwordx2 v[100:101], v8, s[8:11], s37 offen offset:3072 sc1
  buffer_load_dwordx2 v[102:103], v8, s[8:11], s37 offen offset:3584 sc1
  s_mov_b64 exec, 0x3ff0
  buffer_load_dword v15, v4, s[8:11], 0 offen sc1
  s_mov_b64 exec, -1
  s_branch aoa_k0
aoa_r0:
  s_mov_b64 exec, 0xff0
  v_cmp_gt_i32 vcc, v5, v15
  s_mov_b64 exec, -1
  s_cbranch_vccz aoa_t0
  s_mov_b64 exec, 0xff0
ap_38:
  buffer_load_dword v10, v4, s[8:11], 0 offen sc1
  s_waitcnt vmcnt(0)
  v_cmp_gt_i32 vcc, v5, v10
  s_cbranch_vccz apd_39
  s_mov_b64 exec, vcc
  s_sub_u32 s3, s3, 1
  s_cbranch_scc1 bail_27
  s_sleep 1
  s_branch ap_38
apd_39:
  s_mov_b64 exec, -1
aoa_t0:
  v_mfma_f32_16x16x32_bf16 v[48:51], v[64:67], a[0:3], 0
  s_add_u32 s34, s36, 0
  buffer_load_dwordx4 a[96:99], v3, s[8:11], s34 offen offset:0 sc1
  v_mfma_f32_16x16x32_bf16 v[48:51], v[68:71], a[4:7], v[48:51]
  buffer_load_dwordx4 a[100:103], v3, s[8:11], s34 offen offset:1024 sc1
  v_mfma_f32_16x16x32_bf16 v[48:51], v[72:75], a[8:11], v[48:51]
  buffer_load_dwordx4 a[104:107], v3, s[8:11], s34 offen offset:2048 sc1
  v_mfma_f32_16x16x32_bf16 v[48:51], v[76:79], a[12:15], v[48:51]
  buffer_load_dwordx4 a[108:111], v3, s[8:11], s34 offen offset:3072 sc1
  v_mfma_f32_16x16x32_bf16 v[48:51], v[80:83], a[16:19], v[48:51]
  s_add_u32 s34, s36, 4096
  buffer_load_dwordx4 a[112:115], v3, s[8:11], s34 offen offset:0 sc1
  v_mfma_f32_16x16x32_bf16 v[48:51], v[84:87], a[20:23], v[48:51]
  buffer_load_dwordx4 a[116:119], v3, s[8:11], s34 offen offset:1024 sc1
  v_mfma_f32_16x16x32_bf16 v[48:51], v[88:91], a[24:27], v[48:51]
  buffer_load_dwordx4 a[120:123], v3, s[8:11], s34 offen offset:2048 sc1
  v_mfma_f32_16x16x32_bf16 v[48:51], v[92:95], a[28:31], v[48:51]
  buffer_load_dwordx4 a[124:127], v3, s[8:11], s34 offen offset:3072 sc1
  s_branch aoa_j0
aoa_p0:
  v_mfma_f32_32x32x16_bf16 v[32:47], a[32:35], a[0:3], v[16:31]
  s_add_u32 s34, s36, 0
  buffer_load_dwordx4 a[96:99], v3, s[8:11], s34 offen offset:0 sc1
  v_mfma_f32_32x32x16_bf16 v[32:47], a[36:39], a[4:7], v[32:47]
  buffer_load_dwordx4 a[100:103], v3, s[8:11], s34 offen offset:1024 sc1
  v_mfma_f32_32x32x16_bf16 v[32:47], a[40:43], a[8:11], v[32:47]
  buffer_load_dwordx4 a[104:107], v3, s[8:11], s34 offen offset:2048 sc1
  v_mfma_f32_32x32x16_bf16 v[32:47], a[44:47], a[12:15], v[32:47]
  buffer_load_dwordx4 a[108:111], v3, s[8:11], s34 offen offset:3072 sc1
  v_mfma_f32_32x32x16_bf16 v[32:47], a[48:51], a[16:19], v[32:47]
  s_add_u32 s34, s36, 4096
  buffer_load_dwordx4 a[112:115], v3, s[8:11], s34 offen offset:0 sc1
  v_mfma_f32_32x32x16_bf16 v[32:47], a[52:55], a[20:23], v[32:47]
  buffer_load_dwordx4 a[116:119], v3, s[8:11], s34 offen offset:1024 sc1
  v_mfma_f32_32x32x16_bf16 v[32:47], a[56:59], a[24:27], v[32:47]
  buffer_load_dwordx4 a[120:123], v3, s[8:11], s34 offen offset:2048 sc1
  v_mfma_f32_32x32x16_bf16 v[32:47], a[60:63], a[28:31], v[32:47]
  buffer_load_dwordx4 a[124:127], v3, s[8:11], s34 offen offset:3072 sc1
  v_mfma_f32_16x16x32_bf16 v[48:51], v[64:67], a[0:3], 0
  v_mfma_f32_16x16x32_bf16 v[48:51], v[68:71], a[4:7], v[48:51]
  v_mfma_f32_16x16x32_bf16 v[48:51], v[72:75], a[8:11], v[48:51]
  v_mfma_f32_16x16x32_bf16 v[48:51], v[76:79], a[12:15], v[48:51]
  v_mfma_f32_16x16x32_bf16 v[48:51], v[80:83], a[16:19], v[48:51]
  v_mfma_f32_16x16x32_bf16 v[48:51], v[84:87], a[20:23], v[48:51]
  v_mfma_f32_16x16x32_bf16 v[48:51], v[88:91], a[24:27], v[48:51]
  v_mfma_f32_16x16x32_bf16 v[48:51], v[92:95], a[28:31], v[48:51]
aoa_j0:
  s_add_u32 s37, s37, 131072
  v_max3_f32 v12, v32, v33, v34
  v_max3_f32 v13, v35, v36, v37
  v_max3_f32 v12, v12, v38, v39
  v_max3_f32 v13, v13, v40, v41
  v_max3_f32 v12, v12, v42, v43
  v_max3_f32 v13, v13, v44, v45
  v_max3_f32 v12, v12, v46, v47
  s_add_u32 s34, s36, 8192
  buffer_load_dwordx4 a[128:131], v3, s[8:11], s34 offen offset:0 sc1
  buffer_load_dwordx4 a[132:135], v3, s[8:11], s34 offen offset:1024 sc1
  v_permlane16_swap_b32 v96, v97
  v_permlane16_swap_b32 v98, v99
  v_permlane16_swap_b32 v100, v101
  v_permlane16_swap_b32 v102, v103
  v_max3_f32 v12, v12, v48, v49
  v_max3_f32 v13, v13, v50, v51
  v_max_f32 v14, v12, v13
  v_max_f32 v12, v12, v13
  buffer_load_dwordx4 a[136:139], v3, s[8:11], s34 offen offset:2048 sc1
  s_nop 0
  v_permlane32_swap_b32 v14, v12
  v_max_f32 v12, v12, v14
  v_mul_f32 v12, s38, v12
  v_pk_fma_f32 v[32:33], v[32:33], s[38:39], v[12:13] op_sel_hi:[1,0,0] neg_lo:[0,0,1] neg_hi:[0,0,1]
  v_pk_fma_f32 v[34:35], v[34:35], s[38:39], v[12:13] op_sel_hi:[1,0,0] neg_lo:[0,0,1] neg_hi:[0,0,1]
  v_pk_fma_f32 v[36:37], v[36:37], s[38:39], v[12:13] op_sel_hi:[1,0,0] neg_lo:[0,0,1] neg_hi:[0,0,1]
  v_pk_fma_f32 v[38:39], v[38:39], s[38:39], v[12:13] op_sel_hi:[1,0,0] neg_lo:[0,0,1] neg_hi:[0,0,1]
  v_pk_fma_f32 v[40:41], v[40:41], s[38:39], v[12:13] op_sel_hi:[1,0,0] neg_lo:[0,0,1] neg_hi:[0,0,1]
  v_pk_fma_f32 v[42:43], v[42:43], s[38:39], v[12:13] op_sel_hi:[1,0,0] neg_lo:[0,0,1] neg_hi:[0,0,1]
  v_pk_fma_f32 v[44:45], v[44:45], s[38:39], v[12:13] op_sel_hi:[1,0,0] neg_lo:[0,0,1] neg_hi:[0,0,1]
  v_pk_fma_f32 v[46:47], v[46:47], s[38:39], v[12:13] op_sel_hi:[1,0,0] neg_lo:[0,0,1] neg_hi:[0,0,1]
  v_pk_fma_f32 v[48:49], v[48:49], s[38:39], v[12:13] op_sel_hi:[1,0,0] neg_lo:[0,0,1] neg_hi:[0,0,1]
  v_pk_fma_f32 v[50:51], v[50:51], s[38:39], v[12:13] op_sel_hi:[1,0,0] neg_lo:[0,0,1] neg_hi:[0,0,1]
  v_exp_f32 v32, v32
  buffer_load_dwordx4 a[140:143], v3, s[8:11], s34 offen offset:3072 sc1
  v_exp_f32 v33, v33
  v_exp_f32 v34, v34
  v_exp_f32 v35, v35
  v_exp_f32 v36, v36
  s_add_u32 s34, s36, 12288
  buffer_load_dwordx4 a[144:147], v3, s[8:11], s34 offen offset:0 sc1
  v_exp_f32 v37, v37
  v_exp_f32 v38, v38
  v_exp_f32 v39, v39
  v_exp_f32 v40, v40
  buffer_load_dwordx4 a[148:151], v3, s[8:11], s34 offen offset:1024 sc1
  v_exp_f32 v41, v41
  v_exp_f32 v42, v42
  v_exp_f32 v43, v43
  v_exp_f32 v44, v44
  buffer_load_dwordx4 a[152:155], v3, s[8:11], s34 offen offset:2048 sc1
  v_exp_f32 v45, v45
  v_exp_f32 v46, v46
  v_exp_f32 v47, v47
  v_exp_f32 v48, v48
  buffer_load_dwordx4 a[156:159], v3, s[8:11], s34 offen offset:3072 sc1
  v_exp_f32 v49, v49
  v_exp_f32 v50, v50
  v_exp_f32 v51, v51
  v_cvt_pk_bf16_f32 v52, v32, v33
  v_cvt_pk_bf16_f32 v53, v34, v35
  v_cvt_pk_bf16_f32 v54, v36, v37
  v_cvt_pk_bf16_f32 v55, v38, v39
  v_cvt_pk_bf16_f32 v56, v40, v41
  v_cvt_pk_bf16_f32 v57, v42, v43
  v_cvt_pk_bf16_f32 v58, v44, v45
  v_cvt_pk_bf16_f32 v59, v46, v47
  v_cvt_pk_bf16_f32 v60, v48, v49
  v_cvt_pk_bf16_f32 v61, v50, v51
  s_mov_b64 exec, 0x3ff0
  buffer_load_dword v15, v4, s[8:11], 0 offen sc1
  s_mov_b64 exec, -1
  v_mfma_f32_32x32x16_bf16 v[112:127], a[64:67], v[52:55], 0
  s_add_u32 s34, s36, 16384
  buffer_load_dwordx4 a[160:163], v3, s[8:11], s34 offen offset:0 sc1
  v_add_f32 v32, v32, v34
  v_add_f32 v33, v33, v35
  v_add_f32 v32, v32, v36
  v_add_f32 v33, v33, v37
  v_add_f32 v32, v32, v38
  v_add_f32 v33, v33, v39
  v_mfma_f32_32x32x16_bf16 v[112:127], a[68:71], v[56:59], v[112:127]
  buffer_load_dwordx4 a[164:167], v3, s[8:11], s34 offen offset:1024 sc1
  v_add_f32 v32, v32, v40
  v_add_f32 v33, v33, v41
  v_add_f32 v32, v32, v42
  v_add_f32 v33, v33, v43
  v_add_f32 v32, v32, v44
  v_add_f32 v33, v33, v45
  v_mfma_f32_32x32x8_bf16 v[112:127], v[96:97], v[60:61], v[112:127]
  buffer_load_dwordx4 a[168:171], v3, s[8:11], s34 offen offset:2048 sc1
  v_add_f32 v32, v32, v46
  v_add_f32 v33, v33, v47
  v_add_f32 v32, v32, v48
  v_add_f32 v33, v33, v49
  v_add_f32 v32, v32, v50
  v_add_f32 v33, v33, v51
  v_mfma_f32_32x32x16_bf16 v[128:143], a[72:75], v[52:55], 0
  buffer_load_dwordx4 a[172:175], v3, s[8:11], s34 offen offset:3072 sc1
  v_add_f32 v34, v32, v33
  v_add_f32 v32, v32, v33
  v_mfma_f32_32x32x16_bf16 v[128:143], a[76:79], v[56:59], v[128:143]
  s_add_u32 s34, s36, 20480
  buffer_load_dwordx4 a[176:179], v3, s[8:11], s34 offen offset:0 sc1
  v_permlane32_swap_b32 v34, v32
  v_add_f32 v32, v32, v34
  v_rcp_f32 v32, v32
  s_nop 0
  v_mul_f32 v112, v112, v32
  v_mul_f32 v113, v113, v32
  v_cvt_pk_bf16_f32 v176, v112, v113
  v_mfma_f32_32x32x8_bf16 v[128:143], v[98:99], v[60:61], v[128:143]
  buffer_load_dwordx4 a[180:183], v3, s[8:11], s34 offen offset:1024 sc1
  v_mul_f32 v114, v114, v32
  v_mul_f32 v115, v115, v32
  v_cvt_pk_bf16_f32 v177, v114, v115
  v_mul_f32 v116, v116, v32
  v_mul_f32 v117, v117, v32
  v_cvt_pk_bf16_f32 v178, v116, v117
  v_mfma_f32_32x32x16_bf16 v[144:159], a[80:83], v[52:55], 0
  buffer_load_dwordx4 a[184:187], v3, s[8:11], s34 offen offset:2048 sc1
  v_mul_f32 v118, v118, v32
  v_mul_f32 v119, v119, v32
  v_cvt_pk_bf16_f32 v179, v118, v119
  v_mul_f32 v120, v120, v32
  v_mul_f32 v121, v121, v32
  v_cvt_pk_bf16_f32 v180, v120, v121
  v_mfma_f32_32x32x16_bf16 v[144:159], a[84:87], v[56:59], v[144:159]
  buffer_load_dwordx4 a[188:191], v3, s[8:11], s34 offen offset:3072 sc1
  s_add_u32 s36, s36, 786432
  v_mul_f32 v122, v122, v32
  v_mul_f32 v123, v123, v32
  v_cvt_pk_bf16_f32 v181, v122, v123
  v_mul_f32 v124, v124, v32
  v_mul_f32 v125, v125, v32
  v_cvt_pk_bf16_f32 v182, v124, v125
  v_mfma_f32_32x32x8_bf16 v[144:159], v[100:101], v[60:61], v[144:159]
  buffer_load_dwordx4 v[208:211], v7, s[8:11], s37 offen offset:0 sc1
  v_mul_f32 v126, v126, v32
  v_mul_f32 v127, v127, v32
  v_cvt_pk_bf16_f32 v183, v126, v127
  v_mul_f32 v128, v128, v32
  v_mul_f32 v129, v129, v32
  v_cvt_pk_bf16_f32 v184, v128, v129
  v_mfma_f32_32x32x16_bf16 v[160:175], a[88:91], v[52:55], 0
  buffer_load_dwordx4 v[212:215], v7, s[8:11], s37 offen offset:256 sc1
  v_mul_f32 v130, v130, v32
  v_mul_f32 v131, v131, v32
  v_cvt_pk_bf16_f32 v185, v130, v131
  v_mul_f32 v132, v132, v32
  v_mul_f32 v133, v133, v32
  v_cvt_pk_bf16_f32 v186, v132, v133
  v_mfma_f32_32x32x16_bf16 v[160:175], a[92:95], v[56:59], v[160:175]
  buffer_load_dwordx4 v[216:219], v7, s[8:11], s37 offen offset:512 sc1
  v_mul_f32 v134, v134, v32
  v_mul_f32 v135, v135, v32
  v_cvt_pk_bf16_f32 v187, v134, v135
  v_mul_f32 v136, v136, v32
  v_mul_f32 v137, v137, v32
  v_cvt_pk_bf16_f32 v188, v136, v137
  v_mfma_f32_32x32x8_bf16 v[160:175], v[102:103], v[60:61], v[160:175]
  buffer_load_dwordx4 v[220:223], v7, s[8:11], s37 offen offset:768 sc1
  v_mul_f32 v138, v138, v32
  v_mul_f32 v139, v139, v32
  v_cvt_pk_bf16_f32 v189, v138, v139
  v_mul_f32 v140, v140, v32
  v_mul_f32 v141, v141, v32
  v_cvt_pk_bf16_f32 v190, v140, v141
  v_mul_f32 v142, v142, v32
  v_mul_f32 v143, v143, v32
  v_cvt_pk_bf16_f32 v191, v142, v143
  v_pk_mul_f32 v[144:145], v[144:145], v[32:33] op_sel_hi:[1,0]
  buffer_load_dwordx4 v[224:227], v7, s[8:11], s37 offen offset:1024 sc1
  v_cvt_pk_bf16_f32 v192, v144, v145
  v_pk_mul_f32 v[146:147], v[146:147], v[32:33] op_sel_hi:[1,0]
  v_cvt_pk_bf16_f32 v193, v146, v147
  v_pk_mul_f32 v[148:149], v[148:149], v[32:33] op_sel_hi:[1,0]
  buffer_load_dwordx4 v[228:231], v7, s[8:11], s37 offen offset:1280 sc1
  v_cvt_pk_bf16_f32 v194, v148, v149
  v_pk_mul_f32 v[150:151], v[150:151], v[32:33] op_sel_hi:[1,0]
  v_cvt_pk_bf16_f32 v195, v150, v151
  v_pk_mul_f32 v[152:153], v[152:153], v[32:33] op_sel_hi:[1,0]
  buffer_load_dwordx4 v[232:235], v7, s[8:11], s37 offen offset:1536 sc1
  v_cvt_pk_bf16_f32 v196, v152, v153
  v_pk_mul_f32 v[154:155], v[154:155], v[32:33] op_sel_hi:[1,0]
  v_cvt_pk_bf16_f32 v197, v154, v155
  v_pk_mul_f32 v[156:157], v[156:157], v[32:33] op_sel_hi:[1,0]
  buffer_load_dwordx4 v[236:239], v7, s[8:11], s37 offen offset:1792 sc1
  v_cvt_pk_bf16_f32 v198, v156, v157
  v_pk_mul_f32 v[158:159], v[158:159], v[32:33] op_sel_hi:[1,0]
  v_cvt_pk_bf16_f32 v199, v158, v159
  v_pk_mul_f32 v[160:161], v[160:161], v[32:33] op_sel_hi:[1,0]
  buffer_load_dwordx2 v[104:105], v8, s[8:11], s37 offen offset:2048 sc1
  v_cvt_pk_bf16_f32 v200, v160, v161
  v_pk_mul_f32 v[162:163], v[162:163], v[32:33] op_sel_hi:[1,0]
  v_cvt_pk_bf16_f32 v201, v162, v163
  v_pk_mul_f32 v[164:165], v[164:165], v[32:33] op_sel_hi:[1,0]
  buffer_load_dwordx2 v[106:107], v8, s[8:11], s37 offen offset:2560 sc1
  v_cvt_pk_bf16_f32 v202, v164, v165
  v_pk_mul_f32 v[166:167], v[166:167], v[32:33] op_sel_hi:[1,0]
  v_cvt_pk_bf16_f32 v203, v166, v167
  v_pk_mul_f32 v[168:169], v[168:169], v[32:33] op_sel_hi:[1,0]
  buffer_load_dwordx2 v[108:109], v8, s[8:11], s37 offen offset:3072 sc1
  v_cvt_pk_bf16_f32 v204, v168, v169
  v_pk_mul_f32 v[170:171], v[170:171], v[32:33] op_sel_hi:[1,0]
  v_cvt_pk_bf16_f32 v205, v170, v171
  v_pk_mul_f32 v[172:173], v[172:173], v[32:33] op_sel_hi:[1,0]
  buffer_load_dwordx2 v[110:111], v8, s[8:11], s37 offen offset:3584 sc1
  v_cvt_pk_bf16_f32 v206, v172, v173
  v_pk_mul_f32 v[174:175], v[174:175], v[32:33] op_sel_hi:[1,0]
  v_cvt_pk_bf16_f32 v207, v174, v175
  s_sub_u32 s21, s20, 1
ls_40:
  ds_read2_b32 v[10:11], v2 offset0:1 offset1:2
  s_waitcnt lgkmcnt(0)
  v_min_i32 v10, v10, v11
  v_cmp_gt_i32 vcc, s21, v10
  s_cbranch_vccz lsd_41
  s_sub_u32 s3, s3, 1
  s_cbranch_scc1 bail_28
  s_sleep 1
  s_branch ls_40
lsd_41:
  s_mov_b32 s51, s21
  ds_write_b128 v3, v[176:179] offset:0
  ds_write_b128 v3, v[180:183] offset:1024
  ds_write_b128 v3, v[184:187] offset:2048
  ds_write_b128 v3, v[188:191] offset:3072
  ds_write_b128 v3, v[192:195] offset:4096
  ds_write_b128 v3, v[196:199] offset:5120
  ds_write_b128 v3, v[200:203] offset:6144
  ds_write_b128 v3, v[204:207] offset:7168
  s_add_u32 s21, s20, 1
  v_mov_b32 v10, s21
  s_lshr_b32 s48, s20, 1
  s_and_b32 s48, s48, 1
  s_xor_b32 s48, s48, 1
  s_add_u32 s49, s47, 0
  s_add_u32 s50, s49, 4096
  s_waitcnt lgkmcnt(0)
  ds_write_b32 v2, v10
  s_waitcnt vmcnt(20)
  s_mov_b64 exec, 0x3000
  v_cmp_gt_i32 vcc, s51, v15
  s_mov_b64 exec, -1
  v_and_or_b32 v176, v176, -2, s48
  v_and_or_b32 v180, v180, -2, s48
  v_and_or_b32 v184, v184, -2, s48
  v_and_or_b32 v188, v188, -2, s48
  v_and_or_b32 v192, v192, -2, s48
  v_and_or_b32 v196, v196, -2, s48
  v_and_or_b32 v200, v200, -2, s48
  v_and_or_b32 v204, v204, -2, s48
  s_cbranch_vccnz aoa_w0
aoa_o0:
  s_cmp_eq_u32 s46, 0
  s_cbranch_scc0 aoa_s0
  buffer_store_dwordx4 v[176:179], v3, s[8:11], s49 offen offset:0
  buffer_store_dwordx4 v[180:183], v3, s[8:11], s49 offen offset:1024
  buffer_store_dwordx4 v[184:187], v3, s[8:11], s49 offen offset:2048
  buffer_store_dwordx4 v[188:191], v3, s[8:11], s49 offen offset:3072
  buffer_store_dwordx4 v[192:195], v3, s[8:11], s50 offen offset:0
  buffer_store_dwordx4 v[196:199], v3, s[8:11], s50 offen offset:1024
  buffer_store_dwordx4 v[200:203], v3, s[8:11], s50 offen offset:2048
  buffer_store_dwordx4 v[204:207], v3, s[8:11], s50 offen offset:3072
  s_branch aoa_e0
aoa_s0:
  buffer_store_dwordx4 v[176:179], v3, s[8:11], s49 offen offset:0 sc1
  buffer_store_dwordx4 v[180:183], v3, s[8:11], s49 offen offset:1024 sc1
  buffer_store_dwordx4 v[184:187], v3, s[8:11], s49 offen offset:2048 sc1
  buffer_store_dwordx4 v[188:191], v3, s[8:11], s49 offen offset:3072 sc1
  buffer_store_dwordx4 v[192:195], v3, s[8:11], s50 offen offset:0 sc1
  buffer_store_dwordx4 v[196:199], v3, s[8:11], s50 offen offset:1024 sc1
  buffer_store_dwordx4 v[200:203], v3, s[8:11], s50 offen offset:2048 sc1
  buffer_store_dwordx4 v[204:207], v3, s[8:11], s50 offen offset:3072 sc1
aoa_e0:
  s_mov_b32 s20, s21
  s_cmp_eq_u32 s20, 63
  s_cselect_b32 s33, 786432, 0
  s_sub_u32 s36, s36, s33
  v_add_u32 v5, s20, v6
  v_min_i32 v5, 64, v5
  s_waitcnt vmcnt(8)
  v_max3_u32 v10, v208, v212, v216
  v_max3_u32 v11, v220, v224, v228
  v_max3_u32 v10, v10, v232, v236
  v_max3_u32 v11, v11, v104, v106
  v_max3_u32 v10, v10, v108, v110
  v_max_u32 v10, v10, v11
  v_cmp_eq_u32 s[52:53], -1, v10
  s_mov_b64 exec, 0xff0
  v_cmp_gt_i32 vcc, v5, v15
  s_mov_b64 exec, -1
  s_or_b64 s[54:55], s[52:53], vcc
  s_cbranch_scc0 aoa_p1
  s_cmp_eq_u64 s[52:53], 0
  s_cbranch_scc1 aoa_q1
  buffer_load_dwordx4 v[208:211], v7, s[8:11], s37 offen offset:0 sc1
  buffer_load_dwordx4 v[212:215], v7, s[8:11], s37 offen offset:256 sc1
  buffer_load_dwordx4 v[216:219], v7, s[8:11], s37 offen offset:512 sc1
  buffer_load_dwordx4 v[220:223], v7, s[8:11], s37 offen offset:768 sc1
  buffer_load_dwordx4 v[224:227], v7, s[8:11], s37 offen offset:1024 sc1
  buffer_load_dwordx4 v[228:231], v7, s[8:11], s37 offen offset:1280 sc1
  buffer_load_dwordx4 v[232:235], v7, s[8:11], s37 offen offset:1536 sc1
  buffer_load_dwordx4 v[236:239], v7, s[8:11], s37 offen offset:1792 sc1
  buffer_load_dwordx2 v[104:105], v8, s[8:11], s37 offen offset:2048 sc1
  buffer_load_dwordx2 v[106:107], v8, s[8:11], s37 offen offset:2560 sc1
  buffer_load_dwordx2 v[108:109], v8, s[8:11], s37 offen offset:3072 sc1
  buffer_load_dwordx2 v[110:111], v8, s[8:11], s37 offen offset:3584 sc1
aoa_q1:
  s_mov_b64 exec, 0x3ff0
  buffer_load_dword v15, v4, s[8:11], 0 offen sc1
  s_mov_b64 exec, -1
  v_mfma_f32_32x32x16_bf16 v[32:47], a[128:131], a[96:99], v[16:31]
  v_mfma_f32_32x32x16_bf16 v[32:47], a[132:135], a[100:103], v[32:47]
  v_mfma_f32_32x32x16_bf16 v[32:47], a[136:139], a[104:107], v[32:47]
  v_mfma_f32_32x32x16_bf16 v[32:47], a[140:143], a[108:111], v[32:47]
  v_mfma_f32_32x32x16_bf16 v[32:47], a[144:147], a[112:115], v[32:47]
  v_mfma_f32_32x32x16_bf16 v[32:47], a[148:151], a[116:119], v[32:47]
  v_mfma_f32_32x32x16_bf16 v[32:47], a[152:155], a[120:123], v[32:47]
  v_mfma_f32_32x32x16_bf16 v[32:47], a[156:159], a[124:127], v[32:47]
aoa_k1:
  s_waitcnt vmcnt(0)
  v_max3_u32 v10, v208, v212, v216
  v_max3_u32 v11, v220, v224, v228
  v_max3_u32 v10, v10, v232, v236
  v_max3_u32 v11, v11, v104, v106
  v_max3_u32 v10, v10, v108, v110
  v_max_u32 v10, v10, v11
  v_cmp_eq_u32 vcc, -1, v10
  s_cbranch_vccz aoa_r1
  s_sub_u32 s3, s3, 1
  s_cbranch_scc1 bail_16
  buffer_load_dwordx4 v[208:211], v7, s[8:11], s37 offen offset:0 sc1
  buffer_load_dwordx4 v[212:215], v7, s[8:11], s37 offen offset:256 sc1
  buffer_load_dwordx4 v[216:219], v7, s[8:11], s37 offen offset:512 sc1
  buffer_load_dwordx4 v[220:223], v7, s[8:11], s37 offen offset:768 sc1
  buffer_load_dwordx4 v[224:227], v7, s[8:11], s37 offen offset:1024 sc1
  buffer_load_dwordx4 v[228:231], v7, s[8:11], s37 offen offset:1280 sc1
  buffer_load_dwordx4 v[232:235], v7, s[8:11], s37 offen offset:1536 sc1
  buffer_load_dwordx4 v[236:239], v7, s[8:11], s37 offen offset:1792 sc1
  buffer_load_dwordx2 v[104:105], v8, s[8:11], s37 offen offset:2048 sc1
  buffer_load_dwordx2 v[106:107], v8, s[8:11], s37 offen offset:2560 sc1
  buffer_load_dwordx2 v[108:109], v8, s[8:11], s37 offen offset:3072 sc1
  buffer_load_dwordx2 v[110:111], v8, s[8:11], s37 offen offset:3584 sc1
  s_mov_b64 exec, 0x3ff0
  buffer_load_dword v15, v4, s[8:11], 0 offen sc1
  s_mov_b64 exec, -1
  s_branch aoa_k1
aoa_r1:
  s_mov_b64 exec, 0xff0
  v_cmp_gt_i32 vcc, v5, v15
  s_mov_b64 exec, -1
  s_cbranch_vccz aoa_t1
  s_mov_b64 exec, 0xff0
ap_42:
  buffer_load_dword v10, v4, s[8:11], 0 offen sc1
  s_waitcnt vmcnt(0)
  v_cmp_gt_i32 vcc, v5, v10
  s_cbranch_vccz apd_43
  s_mov_b64 exec, vcc
  s_sub_u32 s3, s3, 1
  s_cbranch_scc1 bail_27
  s_sleep 1
  s_branch ap_42
apd_43:
  s_mov_b64 exec, -1
aoa_t1:
  v_mfma_f32_16x16x32_bf16 v[48:51], v[208:211], a[96:99], 0
  s_add_u32 s34, s36, 0
  buffer_load_dwordx4 a[0:3], v3, s[8:11], s34 offen offset:0 sc1
  v_mfma_f32_16x16x32_bf16 v[48:51], v[212:215], a[100:103], v[48:51]
  buffer_load_dwordx4 a[4:7], v3, s[8:11], s34 offen offset:1024 sc1
  v_mfma_f32_16x16x32_bf16 v[48:51], v[216:219], a[104:107], v[48:51]
  buffer_load_dwordx4 a[8:11], v3, s[8:11], s34 offen offset:2048 sc1
  v_mfma_f32_16x16x32_bf16 v[48:51], v[220:223], a[108:111], v[48:51]
  buffer_load_dwordx4 a[12:15], v3, s[8:11], s34 offen offset:3072 sc1
  v_mfma_f32_16x16x32_bf16 v[48:51], v[224:227], a[112:115], v[48:51]
  s_add_u32 s34, s36, 4096
  buffer_load_dwordx4 a[16:19], v3, s[8:11], s34 offen offset:0 sc1
  v_mfma_f32_16x16x32_bf16 v[48:51], v[228:231], a[116:119], v[48:51]
  buffer_load_dwordx4 a[20:23], v3, s[8:11], s34 offen offset:1024 sc1
  v_mfma_f32_16x16x32_bf16 v[48:51], v[232:235], a[120:123], v[48:51]
  buffer_load_dwordx4 a[24:27], v3, s[8:11], s34 offen offset:2048 sc1
  v_mfma_f32_16x16x32_bf16 v[48:51], v[236:239], a[124:127], v[48:51]
  buffer_load_dwordx4 a[28:31], v3, s[8:11], s34 offen offset:3072 sc1
  s_branch aoa_j1
aoa_p1:
  v_mfma_f32_32x32x16_bf16 v[32:47], a[128:131], a[96:99], v[16:31]
  s_add_u32 s34, s36, 0
  buffer_load_dwordx4 a[0:3], v3, s[8:11], s34 offen offset:0 sc1
  v_mfma_f32_32x32x16_bf16 v[32:47], a[132:135], a[100:103], v[32:47]
  buffer_load_dwordx4 a[4:7], v3, s[8:11], s34 offen offset:1024 sc1
  v_mfma_f32_32x32x16_bf16 v[32:47], a[136:139], a[104:107], v[32:47]
  buffer_load_dwordx4 a[8:11], v3, s[8:11], s34 offen offset:2048 sc1
  v_mfma_f32_32x32x16_bf16 v[32:47], a[140:143], a[108:111], v[32:47]
  buffer_load_dwordx4 a[12:15], v3, s[8:11], s34 offen offset:3072 sc1
  v_mfma_f32_32x32x16_bf16 v[32:47], a[144:147], a[112:115], v[32:47]
  s_add_u32 s34, s36, 4096
  buffer_load_dwordx4 a[16:19], v3, s[8:11], s34 offen offset:0 sc1
  v_mfma_f32_32x32x16_bf16 v[32:47], a[148:151], a[116:119], v[32:47]
  buffer_load_dwordx4 a[20:23], v3, s[8:11], s34 offen offset:1024 sc1
  v_mfma_f32_32x32x16_bf16 v[32:47], a[152:155], a[120:123], v[32:47]
  buffer_load_dwordx4 a[24:27], v3, s[8:11], s34 offen offset:2048 sc1
  v_mfma_f32_32x32x16_bf16 v[32:47], a[156:159], a[124:127], v[32:47]
  buffer_load_dwordx4 a[28:31], v3, s[8:11], s34 offen offset:3072 sc1
  v_mfma_f32_16x16x32_bf16 v[48:51], v[208:211], a[96:99], 0
  v_mfma_f32_16x16x32_bf16 v[48:51], v[212:215], a[100:103], v[48:51]
  v_mfma_f32_16x16x32_bf16 v[48:51], v[216:219], a[104:107], v[48:51]
  v_mfma_f32_16x16x32_bf16 v[48:51], v[220:223], a[108:111], v[48:51]
  v_mfma_f32_16x16x32_bf16 v[48:51], v[224:227], a[112:115], v[48:51]
  v_mfma_f32_16x16x32_bf16 v[48:51], v[228:231], a[116:119], v[48:51]
  v_mfma_f32_16x16x32_bf16 v[48:51], v[232:235], a[120:123], v[48:51]
  v_mfma_f32_16x16x32_bf16 v[48:51], v[236:239], a[124:127], v[48:51]
aoa_j1:
  s_add_u32 s37, s37, 131072
  v_max3_f32 v12, v32, v33, v34
  v_max3_f32 v13, v35, v36, v37
  v_max3_f32 v12, v12, v38, v39
  v_max3_f32 v13, v13, v40, v41
  v_max3_f32 v12, v12, v42, v43
  v_max3_f32 v13, v13, v44, v45
  v_max3_f32 v12, v12, v46, v47
  s_add_u32 s34, s36, 8192
  buffer_load_dwordx4 a[32:35], v3, s[8:11], s34 offen offset:0 sc1
  buffer_load_dwordx4 a[36:39], v3, s[8:11], s34 offen offset:1024 sc1
  v_permlane16_swap_b32 v104, v105
  v_permlane16_swap_b32 v106, v107
  v_permlane16_swap_b32 v108, v109
  v_permlane16_swap_b32 v110, v111
  v_max3_f32 v12, v12, v48, v49
  v_max3_f32 v13, v13, v50, v51
  v_max_f32 v14, v12, v13
  v_max_f32 v12, v12, v13
  buffer_load_dwordx4 a[40:43], v3, s[8:11], s34 offen offset:2048 sc1
  s_nop 0
  v_permlane32_swap_b32 v14, v12
  v_max_f32 v12, v12, v14
  v_mul_f32 v12, s38, v12
  v_pk_fma_f32 v[32:33], v[32:33], s[38:39], v[12:13] op_sel_hi:[1,0,0] neg_lo:[0,0,1] neg_hi:[0,0,1]
  v_pk_fma_f32 v[34:35], v[34:35], s[38:39], v[12:13] op_sel_hi:[1,0,0] neg_lo:[0,0,1] neg_hi:[0,0,1]
  v_pk_fma_f32 v[36:37], v[36:37], s[38:39], v[12:13] op_sel_hi:[1,0,0] neg_lo:[0,0,1] neg_hi:[0,0,1]
  v_pk_fma_f32 v[38:39], v[38:39], s[38:39], v[12:13] op_sel_hi:[1,0,0] neg_lo:[0,0,1] neg_hi:[0,0,1]
  v_pk_fma_f32 v[40:41], v[40:41], s[38:39], v[12:13] op_sel_hi:[1,0,0] neg_lo:[0,0,1] neg_hi:[0,0,1]
  v_pk_fma_f32 v[42:43], v[42:43], s[38:39], v[12:13] op_sel_hi:[1,0,0] neg_lo:[0,0,1] neg_hi:[0,0,1]
  v_pk_fma_f32 v[44:45], v[44:45], s[38:39], v[12:13] op_sel_hi:[1,0,0] neg_lo:[0,0,1] neg_hi:[0,0,1]
  v_pk_fma_f32 v[46:47], v[46:47], s[38:39], v[12:13] op_sel_hi:[1,0,0] neg_lo:[0,0,1] neg_hi:[0,0,1]
  v_pk_fma_f32 v[48:49], v[48:49], s[38:39], v[12:13] op_sel_hi:[1,0,0] neg_lo:[0,0,1] neg_hi:[0,0,1]
  v_pk_fma_f32 v[50:51], v[50:51], s[38:39], v[12:13] op_sel_hi:[1,0,0] neg_lo:[0,0,1] neg_hi:[0,0,1]
  v_exp_f32 v32, v32
  buffer_load_dwordx4 a[44:47], v3, s[8:11], s34 offen offset:3072 sc1
  v_exp_f32 v33, v33
  v_exp_f32 v34, v34
  v_exp_f32 v35, v35
  v_exp_f32 v36, v36
  s_add_u32 s34, s36, 12288
  buffer_load_dwordx4 a[48:51], v3, s[8:11], s34 offen offset:0 sc1
  v_exp_f32 v37, v37
  v_exp_f32 v38, v38
  v_exp_f32 v39, v39
  v_exp_f32 v40, v40
  buffer_load_dwordx4 a[52:55], v3, s[8:11], s34 offen offset:1024 sc1
  v_exp_f32 v41, v41
  v_exp_f32 v42, v42
  v_exp_f32 v43, v43
  v_exp_f32 v44, v44
  buffer_load_dwordx4 a[56:59], v3, s[8:11], s34 offen offset:2048 sc1
  v_exp_f32 v45, v45
  v_exp_f32 v46, v46
  v_exp_f32 v47, v47
  v_exp_f32 v48, v48
  buffer_load_dwordx4 a[60:63], v3, s[8:11], s34 offen offset:3072 sc1
  v_exp_f32 v49, v49
  v_exp_f32 v50, v50
  v_exp_f32 v51, v51
  v_cvt_pk_bf16_f32 v52, v32, v33
  v_cvt_pk_bf16_f32 v53, v34, v35
  v_cvt_pk_bf16_f32 v54, v36, v37
  v_cvt_pk_bf16_f32 v55, v38, v39
  v_cvt_pk_bf16_f32 v56, v40, v41
  v_cvt_pk_bf16_f32 v57, v42, v43
  v_cvt_pk_bf16_f32 v58, v44, v45
  v_cvt_pk_bf16_f32 v59, v46, v47
  v_cvt_pk_bf16_f32 v60, v48, v49
  v_cvt_pk_bf16_f32 v61, v50, v51
  s_mov_b64 exec, 0x3ff0
  buffer_load_dword v15, v4, s[8:11], 0 offen sc1
  s_mov_b64 exec, -1
  v_mfma_f32_32x32x16_bf16 v[112:127], a[160:163], v[52:55], 0
  s_add_u32 s34, s36, 16384
  buffer_load_dwordx4 a[64:67], v3, s[8:11], s34 offen offset:0 sc1
  v_add_f32 v32, v32, v34
  v_add_f32 v33, v33, v35
  v_add_f32 v32, v32, v36
  v_add_f32 v33, v33, v37
  v_add_f32 v32, v32, v38
  v_add_f32 v33, v33, v39
  v_mfma_f32_32x32x16_bf16 v[112:127], a[164:167], v[56:59], v[112:127]
  buffer_load_dwordx4 a[68:71], v3, s[8:11], s34 offen offset:1024 sc1
  v_add_f32 v32, v32, v40
  v_add_f32 v33, v33, v41
  v_add_f32 v32, v32, v42
  v_add_f32 v33, v33, v43
  v_add_f32 v32, v32, v44
  v_add_f32 v33, v33, v45
  v_mfma_f32_32x32x8_bf16 v[112:127], v[104:105], v[60:61], v[112:127]
  buffer_load_dwordx4 a[72:75], v3, s[8:11], s34 offen offset:2048 sc1
  v_add_f32 v32, v32, v46
  v_add_f32 v33, v33, v47
  v_add_f32 v32, v32, v48
  v_add_f32 v33, v33, v49
  v_add_f32 v32, v32, v50
  v_add_f32 v33, v33, v51
  v_mfma_f32_32x32x16_bf16 v[128:143], a[168:171], v[52:55], 0
  buffer_load_dwordx4 a[76:79], v3, s[8:11], s34 offen offset:3072 sc1
  v_add_f32 v34, v32, v33
  v_add_f32 v32, v32, v33
  v_mfma_f32_32x32x16_bf16 v[128:143], a[172:175], v[56:59], v[128:143]
  s_add_u32 s34, s36, 20480
  buffer_load_dwordx4 a[80:83], v3, s[8:11], s34 offen offset:0 sc1
  v_permlane32_swap_b32 v34, v32
  v_add_f32 v32, v32, v34
  v_rcp_f32 v32, v32
  s_nop 0
  v_mul_f32 v112, v112, v32
  v_mul_f32 v113, v113, v32
  v_cvt_pk_bf16_f32 v176, v112, v113
  v_mfma_f32_32x32x8_bf16 v[128:143], v[106:107], v[60:61], v[128:143]
  buffer_load_dwordx4 a[84:87], v3, s[8:11], s34 offen offset:1024 sc1
  v_mul_f32 v114, v114, v32
  v_mul_f32 v115, v115, v32
  v_cvt_pk_bf16_f32 v177, v114, v115
  v_mul_f32 v116, v116, v32
  v_mul_f32 v117, v117, v32
  v_cvt_pk_bf16_f32 v178, v116, v117
  v_mfma_f32_32x32x16_bf16 v[144:159], a[176:179], v[52:55], 0
  buffer_load_dwordx4 a[88:91], v3, s[8:11], s34 offen offset:2048 sc1
  v_mul_f32 v118, v118, v32
  v_mul_f32 v119, v119, v32
  v_cvt_pk_bf16_f32 v179, v118, v119
  v_mul_f32 v120, v120, v32
  v_mul_f32 v121, v121, v32
  v_cvt_pk_bf16_f32 v180, v120, v121
  v_mfma_f32_32x32x16_bf16 v[144:159], a[180:183], v[56:59], v[144:159]
  buffer_load_dwordx4 a[92:95], v3, s[8:11], s34 offen offset:3072 sc1
  s_add_u32 s36, s36, 786432
  v_mul_f32 v122, v122, v32
  v_mul_f32 v123, v123, v32
  v_cvt_pk_bf16_f32 v181, v122, v123
  v_mul_f32 v124, v124, v32
  v_mul_f32 v125, v125, v32
  v_cvt_pk_bf16_f32 v182, v124, v125
  v_mfma_f32_32x32x8_bf16 v[144:159], v[108:109], v[60:61], v[144:159]
  buffer_load_dwordx4 v[64:67], v7, s[8:11], s37 offen offset:0 sc1
  v_mul_f32 v126, v126, v32
  v_mul_f32 v127, v127, v32
  v_cvt_pk_bf16_f32 v183, v126, v127
  v_mul_f32 v128, v128, v32
  v_mul_f32 v129, v129, v32
  v_cvt_pk_bf16_f32 v184, v128, v129
  v_mfma_f32_32x32x16_bf16 v[160:175], a[184:187], v[52:55], 0
  buffer_load_dwordx4 v[68:71], v7, s[8:11], s37 offen offset:256 sc1
  v_mul_f32 v130, v130, v32
  v_mul_f32 v131, v131, v32
  v_cvt_pk_bf16_f32 v185, v130, v131
  v_mul_f32 v132, v132, v32
  v_mul_f32 v133, v133, v32
  v_cvt_pk_bf16_f32 v186, v132, v133
  v_mfma_f32_32x32x16_bf16 v[160:175], a[188:191], v[56:59], v[160:175]
  buffer_load_dwordx4 v[72:75], v7, s[8:11], s37 offen offset:512 sc1
  v_mul_f32 v134, v134, v32
  v_mul_f32 v135, v135, v32
  v_cvt_pk_bf16_f32 v187, v134, v135
  v_mul_f32 v136, v136, v32
  v_mul_f32 v137, v137, v32
  v_cvt_pk_bf16_f32 v188, v136, v137
  v_mfma_f32_32x32x8_bf16 v[160:175], v[110:111], v[60:61], v[160:175]
  buffer_load_dwordx4 v[76:79], v7, s[8:11], s37 offen offset:768 sc1
  v_mul_f32 v138, v138, v32
  v_mul_f32 v139, v139, v32
  v_cvt_pk_bf16_f32 v189, v138, v139
  v_mul_f32 v140, v140, v32
  v_mul_f32 v141, v141, v32
  v_cvt_pk_bf16_f32 v190, v140, v141
  v_mul_f32 v142, v142, v32
  v_mul_f32 v143, v143, v32
  v_cvt_pk_bf16_f32 v191, v142, v143
  v_pk_mul_f32 v[144:145], v[144:145], v[32:33] op_sel_hi:[1,0]
  buffer_load_dwordx4 v[80:83], v7, s[8:11], s37 offen offset:1024 sc1
  v_cvt_pk_bf16_f32 v192, v144, v145
  v_pk_mul_f32 v[146:147], v[146:147], v[32:33] op_sel_hi:[1,0]
  v_cvt_pk_bf16_f32 v193, v146, v147
  v_pk_mul_f32 v[148:149], v[148:149], v[32:33] op_sel_hi:[1,0]
  buffer_load_dwordx4 v[84:87], v7, s[8:11], s37 offen offset:1280 sc1
  v_cvt_pk_bf16_f32 v194, v148, v149
  v_pk_mul_f32 v[150:151], v[150:151], v[32:33] op_sel_hi:[1,0]
  v_cvt_pk_bf16_f32 v195, v150, v151
  v_pk_mul_f32 v[152:153], v[152:153], v[32:33] op_sel_hi:[1,0]
  buffer_load_dwordx4 v[88:91], v7, s[8:11], s37 offen offset:1536 sc1
  v_cvt_pk_bf16_f32 v196, v152, v153
  v_pk_mul_f32 v[154:155], v[154:155], v[32:33] op_sel_hi:[1,0]
  v_cvt_pk_bf16_f32 v197, v154, v155
  v_pk_mul_f32 v[156:157], v[156:157], v[32:33] op_sel_hi:[1,0]
  buffer_load_dwordx4 v[92:95], v7, s[8:11], s37 offen offset:1792 sc1
  v_cvt_pk_bf16_f32 v198, v156, v157
  v_pk_mul_f32 v[158:159], v[158:159], v[32:33] op_sel_hi:[1,0]
  v_cvt_pk_bf16_f32 v199, v158, v159
  v_pk_mul_f32 v[160:161], v[160:161], v[32:33] op_sel_hi:[1,0]
  buffer_load_dwordx2 v[96:97], v8, s[8:11], s37 offen offset:2048 sc1
  v_cvt_pk_bf16_f32 v200, v160, v161
  v_pk_mul_f32 v[162:163], v[162:163], v[32:33] op_sel_hi:[1,0]
  v_cvt_pk_bf16_f32 v201, v162, v163
  v_pk_mul_f32 v[164:165], v[164:165], v[32:33] op_sel_hi:[1,0]
  buffer_load_dwordx2 v[98:99], v8, s[8:11], s37 offen offset:2560 sc1
  v_cvt_pk_bf16_f32 v202, v164, v165
  v_pk_mul_f32 v[166:167], v[166:167], v[32:33] op_sel_hi:[1,0]
  v_cvt_pk_bf16_f32 v203, v166, v167
  v_pk_mul_f32 v[168:169], v[168:169], v[32:33] op_sel_hi:[1,0]
  buffer_load_dwordx2 v[100:101], v8, s[8:11], s37 offen offset:3072 sc1
  v_cvt_pk_bf16_f32 v204, v168, v169
  v_pk_mul_f32 v[170:171], v[170:171], v[32:33] op_sel_hi:[1,0]
  v_cvt_pk_bf16_f32 v205, v170, v171
  v_pk_mul_f32 v[172:173], v[172:173], v[32:33] op_sel_hi:[1,0]
  buffer_load_dwordx2 v[102:103], v8, s[8:11], s37 offen offset:3584 sc1
  v_cvt_pk_bf16_f32 v206, v172, v173
  v_pk_mul_f32 v[174:175], v[174:175], v[32:33] op_sel_hi:[1,0]
  v_cvt_pk_bf16_f32 v207, v174, v175
  s_sub_u32 s21, s20, 1
ls_44:
  ds_read2_b32 v[10:11], v2 offset0:1 offset1:2
  s_waitcnt lgkmcnt(0)
  v_min_i32 v10, v10, v11
  v_cmp_gt_i32 vcc, s21, v10
  s_cbranch_vccz lsd_45
  s_sub_u32 s3, s3, 1
  s_cbranch_scc1 bail_28
  s_sleep 1
  s_branch ls_44
lsd_45:
  s_mov_b32 s51, s21
  ds_write_b128 v3, v[176:179] offset:8192
  ds_write_b128 v3, v[180:183] offset:9216
  ds_write_b128 v3, v[184:187] offset:10240
  ds_write_b128 v3, v[188:191] offset:11264
  ds_write_b128 v3, v[192:195] offset:12288
  ds_write_b128 v3, v[196:199] offset:13312
  ds_write_b128 v3, v[200:203] offset:14336
  ds_write_b128 v3, v[204:207] offset:15360
  s_add_u32 s21, s20, 1
  v_mov_b32 v10, s21
  s_lshr_b32 s48, s20, 1
  s_and_b32 s48, s48, 1
  s_xor_b32 s48, s48, 1
  s_add_u32 s49, s47, 262144
  s_add_u32 s50, s49, 4096
  s_waitcnt lgkmcnt(0)
  ds_write_b32 v2, v10
  s_waitcnt vmcnt(20)
  s_mov_b64 exec, 0x3000
  v_cmp_gt_i32 vcc, s51, v15
  s_mov_b64 exec, -1
  v_and_or_b32 v176, v176, -2, s48
  v_and_or_b32 v180, v180, -2, s48
  v_and_or_b32 v184, v184, -2, s48
  v_and_or_b32 v188, v188, -2, s48
  v_and_or_b32 v192, v192, -2, s48
  v_and_or_b32 v196, v196, -2, s48
  v_and_or_b32 v200, v200, -2, s48
  v_and_or_b32 v204, v204, -2, s48
  s_cbranch_vccnz aoa_w1
aoa_o1:
  s_cmp_eq_u32 s46, 0
  s_cbranch_scc0 aoa_s1
  buffer_store_dwordx4 v[176:179], v3, s[8:11], s49 offen offset:0
  buffer_store_dwordx4 v[180:183], v3, s[8:11], s49 offen offset:1024
  buffer_store_dwordx4 v[184:187], v3, s[8:11], s49 offen offset:2048
  buffer_store_dwordx4 v[188:191], v3, s[8:11], s49 offen offset:3072
  buffer_store_dwordx4 v[192:195], v3, s[8:11], s50 offen offset:0
  buffer_store_dwordx4 v[196:199], v3, s[8:11], s50 offen offset:1024
  buffer_store_dwordx4 v[200:203], v3, s[8:11], s50 offen offset:2048
  buffer_store_dwordx4 v[204:207], v3, s[8:11], s50 offen offset:3072
  s_branch aoa_e1
aoa_s1:
  buffer_store_dwordx4 v[176:179], v3, s[8:11], s49 offen offset:0 sc1
  buffer_store_dwordx4 v[180:183], v3, s[8:11], s49 offen offset:1024 sc1
  buffer_store_dwordx4 v[184:187], v3, s[8:11], s49 offen offset:2048 sc1
  buffer_store_dwordx4 v[188:191], v3, s[8:11], s49 offen offset:3072 sc1
  buffer_store_dwordx4 v[192:195], v3, s[8:11], s50 offen offset:0 sc1
  buffer_store_dwordx4 v[196:199], v3, s[8:11], s50 offen offset:1024 sc1
  buffer_store_dwordx4 v[200:203], v3, s[8:11], s50 offen offset:2048 sc1
  buffer_store_dwordx4 v[204:207], v3, s[8:11], s50 offen offset:3072 sc1
aoa_e1:
  s_mov_b32 s20, s21
  s_cmp_lt_u32 s20, 64
  s_cbranch_scc1 aoa_top
  s_waitcnt lgkmcnt(0)
  s_branch the_end
aoa_w0:
  s_sub_u32 s3, s3, 1
  s_cbranch_scc1 bail_17
  s_mov_b64 exec, 0x3000
  buffer_load_dword v10, v4, s[8:11], 0 offen sc1
  s_waitcnt vmcnt(0)
  v_cmp_gt_i32 vcc, s51, v10
  s_mov_b64 exec, -1
  s_cbranch_vccnz aoa_w0
  s_branch aoa_o0
aoa_w1:
  s_sub_u32 s3, s3, 1
  s_cbranch_scc1 bail_17
  s_mov_b64 exec, 0x3000
  buffer_load_dword v10, v4, s[8:11], 0 offen sc1
  s_waitcnt vmcnt(0)
  v_cmp_gt_i32 vcc, s51, v10
  s_mov_b64 exec, -1
  s_cbranch_vccnz aoa_w1
  s_branch aoa_o1
the_end:
  s_waitcnt vmcnt(0)
  s_endpgm
role_qkv:
  s_sub_u32 s20, s5, 5
  s_lshl_b32 s20, s20, 4
  s_and_b32 s31, s6, 15
  s_add_u32 s20, s20, s31
  s_lshr_b32 s7, s6, 4
  s_cmp_lt_u32 s20, 32
  s_cselect_b32 s12, s70, s68
  s_cselect_b32 s13, s71, s69
  s_cselect_b32 s16, s72, s68
  s_cselect_b32 s17, s73, s69
  s_mov_b32 s14, 0x400000
  s_mov_b32 s15, 0x20000
  s_mov_b32 s18, 0x400000
  s_mov_b32 s19, 0x20000
  s_sub_u32 s31, s20, 32
  s_lshl_b32 s31, s31, 1
  s_add_u32 s32, s31, 1
  s_cmp_lt_u32 s20, 32
  s_cselect_b32 s46, s20, s31
  s_cselect_b32 s47, s20, s32
  s_cselect_b32 s48, 8192, 0
  s_cselect_b32 s49, 16384, 0
  s_lshl_b32 s31, s4, 6
  s_lshl_b32 s50, s46, 8
  s_add_u32 s50, s50, s31
  s_lshl_b32 s51, s47, 8
  s_add_u32 s51, s51, s31
  v_lshrrev_b32 v2, 4, v1
  v_lshlrev_b32 v2, 7, v2
  v_bfe_u32 v3, v1, 2, 2
  v_add_u32 v2, v2, v3
  v_lshlrev_b32 v2, 13, v2
  v_and_b32 v4, 3, v1
  v_lshl_add_u32 v2, v4, 4, v2
  s_mul_i32 s52, s4, 40960
  v_lshrrev_b32 v5, 2, v1
  v_lshlrev_b32 v5, 6, v5
  v_add_u32 v5, s52, v5
  v_lshl_add_u32 v10, v4, 3, v5
  v_bfe_u32 v3, v1, 1, 1
  v_lshl_add_u32 v3, v3, 5, v5
  v_and_b32 v4, 1, v1
  v_lshl_add_u32 v3, v4, 3, v3
  s_cmp_lt_u32 s20, 32
  s_cselect_b64 vcc, -1, 0
  s_cselect_b32 s31, 32, 16
  v_cndmask_b32 v10, v3, v10, vcc
  v_add_u32 v11, s31, v10
  s_add_u32 m0, s52, 0
  s_nop 0
  buffer_load_dwordx4 v2, s[12:15], s50 offen lds
  s_add_u32 s50, s50, 32768
  s_add_u32 m0, s52, 1024
  s_nop 0
  buffer_load_dwordx4 v2, s[12:15], s50 offen lds
  s_add_u32 s50, s50, 32768
  s_add_u32 m0, s52, 2048
  s_nop 0
  buffer_load_dwordx4 v2, s[12:15], s50 offen lds
  s_add_u32 s50, s50, 32768
  s_add_u32 m0, s52, 3072
  s_nop 0
  buffer_load_dwordx4 v2, s[12:15], s50 offen lds
  s_add_u32 s50, s50, 32768
  s_add_u32 m0, s52, 4096
  s_nop 0
  buffer_load_dwordx4 v2, s[12:15], s50 offen lds
  s_add_u32 s50, s50, 32768
  s_add_u32 m0, s52, 5120
  s_nop 0
  buffer_load_dwordx4 v2, s[12:15], s50 offen lds
  s_add_u32 s50, s50, 32768
  s_add_u32 m0, s52, 6144
  s_nop 0
  buffer_load_dwordx4 v2, s[12:15], s50 offen lds
  s_add_u32 s50, s50, 32768
  s_add_u32 m0, s52, 7168
  s_nop 0
  buffer_load_dwordx4 v2, s[12:15], s50 offen lds
  s_add_u32 s50, s50, 32768
  s_add_u32 m0, s52, 8192
  s_nop 0
  buffer_load_dwordx4 v2, s[12:15], s50 offen lds
  s_add_u32 s50, s50, 32768
  s_add_u32 m0, s52, 9216
  s_nop 0
  buffer_load_dwordx4 v2, s[12:15], s50 offen lds
  s_add_u32 s50, s50, 32768
  s_add_u32 m0, s52, 10240
  s_nop 0
  buffer_load_dwordx4 v2, s[12:15], s50 offen lds
  s_add_u32 s50, s50, 32768
  s_add_u32 m0, s52, 11264
  s_nop 0
  buffer_load_dwordx4 v2, s[12:15], s50 offen lds
  s_add_u32 s50, s50, 32768
  s_add_u32 m0, s52, 12288
  s_nop 0
  buffer_load_dwordx4 v2, s[12:15], s50 offen lds
  s_add_u32 s50, s50, 32768
  s_add_u32 m0, s52, 13312
  s_nop 0
  buffer_load_dwordx4 v2, s[12:15], s50 offen lds
  s_add_u32 s50, s50, 32768
  s_add_u32 m0, s52, 14336
  s_nop 0
  buffer_load_dwordx4 v2, s[12:15], s50 offen lds
  s_add_u32 s50, s50, 32768
  s_add_u32 m0, s52, 15360
  s_nop 0
  buffer_load_dwordx4 v2, s[12:15], s50 offen lds
  s_add_u32 s50, s50, 32768
  s_add_u32 m0, s52, 16384
  s_nop 0
  buffer_load_dwordx4 v2, s[12:15], s50 offen lds
  s_add_u32 s50, s50, 32768
  s_add_u32 m0, s52, 17408
  s_nop 0
  buffer_load_dwordx4 v2, s[12:15], s50 offen lds
  s_add_u32 s50, s50, 32768
  s_add_u32 m0, s52, 18432
  s_nop 0
  buffer_load_dwordx4 v2, s[12:15], s50 offen lds
  s_add_u32 s50, s50, 32768
  s_add_u32 m0, s52, 19456
  s_nop 0
  buffer_load_dwordx4 v2, s[12:15], s50 offen lds
  s_add_u32 s50, s50, 32768
  s_add_u32 m0, s52, 20480
  s_nop 0
  buffer_load_dwordx4 v2, s[12:15], s50 offen lds
  s_add_u32 s50, s50, 32768
  s_add_u32 m0, s52, 21504
  s_nop 0
  buffer_load_dwordx4 v2, s[12:15], s50 offen lds
  s_add_u32 s50, s50, 32768
  s_add_u32 m0, s52, 22528
  s_nop 0
  buffer_load_dwordx4 v2, s[12:15], s50 offen lds
  s_add_u32 s50, s50, 32768
  s_add_u32 m0, s52, 23552
  s_nop 0
  buffer_load_dwordx4 v2, s[12:15], s50 offen lds
  s_add_u32 s50, s50, 32768
  s_add_u32 m0, s52, 24576
  s_nop 0
  buffer_load_dwordx4 v2, s[12:15], s50 offen lds
  s_add_u32 s50, s50, 32768
  s_add_u32 m0, s52, 25600
  s_nop 0
  buffer_load_dwordx4 v2, s[12:15], s50 offen lds
  s_add_u32 s50, s50, 32768
  s_add_u32 m0, s52, 26624
  s_nop 0
  buffer_load_dwordx4 v2, s[12:15], s50 offen lds
  s_add_u32 s50, s50, 32768
  s_add_u32 m0, s52, 27648
  s_nop 0
  buffer_load_dwordx4 v2, s[12:15], s50 offen lds
  s_add_u32 s50, s50, 32768
  s_add_u32 m0, s52, 28672
  s_nop 0
  buffer_load_dwordx4 v2, s[12:15], s50 offen lds
  s_add_u32 s50, s50, 32768
  s_add_u32 m0, s52, 29696
  s_nop 0
  buffer_load_dwordx4 v2, s[12:15], s50 offen lds
  s_add_u32 s50, s50, 32768
  s_add_u32 m0, s52, 30720
  s_nop 0
  buffer_load_dwordx4 v2, s[12:15], s50 offen lds
  s_add_u32 s50, s50, 32768
  s_add_u32 m0, s52, 31744
  s_nop 0
  buffer_load_dwordx4 v2, s[12:15], s50 offen lds
  s_add_u32 s50, s50, 32768
  s_add_u32 m0, s52, 32768
  s_nop 0
  buffer_load_dwordx4 v2, s[16:19], s51 offen lds
  s_add_u32 s51, s51, 32768
  s_add_u32 m0, s52, 33792
  s_nop 0
  buffer_load_dwordx4 v2, s[16:19], s51 offen lds
  s_add_u32 s51, s51, 32768
  s_add_u32 m0, s52, 34816
  s_nop 0
  buffer_load_dwordx4 v2, s[16:19], s51 offen lds
  s_add_u32 s51, s51, 32768
  s_add_u32 m0, s52, 35840
  s_nop 0
  buffer_load_dwordx4 v2, s[16:19], s51 offen lds
  s_add_u32 s51, s51, 32768
  s_add_u32 m0, s52, 36864
  s_nop 0
  buffer_load_dwordx4 v2, s[16:19], s51 offen lds
  s_add_u32 s51, s51, 32768
  s_add_u32 m0, s52, 37888
  s_nop 0
  buffer_load_dwordx4 v2, s[16:19], s51 offen lds
  s_add_u32 s51, s51, 32768
  s_add_u32 m0, s52, 38912
  s_nop 0
  buffer_load_dwordx4 v2, s[16:19], s51 offen lds
  s_add_u32 s51, s51, 32768
  s_add_u32 m0, s52, 39936
  s_nop 0
  buffer_load_dwordx4 v2, s[16:19], s51 offen lds
  s_add_u32 s51, s51, 32768
  s_waitcnt vmcnt(39)
  ds_read_b64_tr_b16 a[0:1], v3 offset:0
  ds_read_b64_tr_b16 a[4:5], v3 offset:16
  s_waitcnt vmcnt(38)
  ds_read_b64_tr_b16 a[2:3], v3 offset:1024
  ds_read_b64_tr_b16 a[6:7], v3 offset:1040
  s_waitcnt lgkmcnt(2)
  s_add_u32 m0, s52, 0
  s_nop 0
  buffer_load_dwordx4 v2, s[16:19], s51 offen lds
  s_add_u32 s51, s51, 32768
  s_waitcnt vmcnt(38)
  ds_read_b64_tr_b16 a[8:9], v3 offset:2048
  ds_read_b64_tr_b16 a[12:13], v3 offset:2064
  s_waitcnt lgkmcnt(2)
  s_add_u32 m0, s52, 1024
  s_nop 0
  buffer_load_dwordx4 v2, s[16:19], s51 offen lds
  s_add_u32 s51, s51, 32768
  s_waitcnt vmcnt(38)
  ds_read_b64_tr_b16 a[10:11], v3 offset:3072
  ds_read_b64_tr_b16 a[14:15], v3 offset:3088
  s_waitcnt lgkmcnt(2)
  s_add_u32 m0, s52, 2048
  s_nop 0
  buffer_load_dwordx4 v2, s[16:19], s51 offen lds
  s_add_u32 s51, s51, 32768
  s_waitcnt vmcnt(38)
  ds_read_b64_tr_b16 a[16:17], v3 offset:4096
  ds_read_b64_tr_b16 a[20:21], v3 offset:4112
  s_waitcnt lgkmcnt(2)
  s_add_u32 m0, s52, 3072
  s_nop 0
  buffer_load_dwordx4 v2, s[16:19], s51 offen lds
  s_add_u32 s51, s51, 32768
  s_waitcnt vmcnt(38)
  ds_read_b64_tr_b16 a[18:19], v3 offset:5120
  ds_read_b64_tr_b16 a[22:23], v3 offset:5136
  s_waitcnt lgkmcnt(2)
  s_add_u32 m0, s52, 4096
  s_nop 0
  buffer_load_dwordx4 v2, s[16:19], s51 offen lds
  s_add_u32 s51, s51, 32768
  s_waitcnt vmcnt(38)
  ds_read_b64_tr_b16 a[24:25], v3 offset:6144
  ds_read_b64_tr_b16 a[28:29], v3 offset:6160
  s_waitcnt lgkmcnt(2)
  s_add_u32 m0, s52, 5120
  s_nop 0
  buffer_load_dwordx4 v2, s[16:19], s51 offen lds
  s_add_u32 s51, s51, 32768
  s_waitcnt vmcnt(38)
  ds_read_b64_tr_b16 a[26:27], v3 offset:7168
  ds_read_b64_tr_b16 a[30:31], v3 offset:7184
  s_waitcnt lgkmcnt(2)
  s_add_u32 m0, s52, 6144
  s_nop 0
  buffer_load_dwordx4 v2, s[16:19], s51 offen lds
  s_add_u32 s51, s51, 32768
  s_waitcnt vmcnt(38)
  ds_read_b64_tr_b16 a[32:33], v3 offset:8192
  ds_read_b64_tr_b16 a[36:37], v3 offset:8208
  s_waitcnt lgkmcnt(2)
  s_add_u32 m0, s52, 7168
  s_nop 0
  buffer_load_dwordx4 v2, s[16:19], s51 offen lds
  s_add_u32 s51, s51, 32768
  s_waitcnt vmcnt(38)
  ds_read_b64_tr_b16 a[34:35], v3 offset:9216
  ds_read_b64_tr_b16 a[38:39], v3 offset:9232
  s_waitcnt lgkmcnt(2)
  s_add_u32 m0, s52, 8192
  s_nop 0
  buffer_load_dwordx4 v2, s[16:19], s51 offen lds
  s_add_u32 s51, s51, 32768
  s_waitcnt vmcnt(38)
  ds_read_b64_tr_b16 a[40:41], v3 offset:10240
  ds_read_b64_tr_b16 a[44:45], v3 offset:10256
  s_waitcnt lgkmcnt(2)
  s_add_u32 m0, s52, 9216
  s_nop 0
  buffer_load_dwordx4 v2, s[16:19], s51 offen lds
  s_add_u32 s51, s51, 32768
  s_waitcnt vmcnt(38)
  ds_read_b64_tr_b16 a[42:43], v3 offset:11264
  ds_read_b64_tr_b16 a[46:47], v3 offset:11280
  s_waitcnt lgkmcnt(2)
  s_add_u32 m0, s52, 10240
  s_nop 0
  buffer_load_dwordx4 v2, s[16:19], s51 offen lds
  s_add_u32 s51, s51, 32768
  s_waitcnt vmcnt(38)
  ds_read_b64_tr_b16 a[48:49], v3 offset:12288
  ds_read_b64_tr_b16 a[52:53], v3 offset:12304
  s_waitcnt lgkmcnt(2)
  s_add_u32 m0, s52, 11264
  s_nop 0
  buffer_load_dwordx4 v2, s[16:19], s51 offen lds
  s_add_u32 s51, s51, 32768
  s_waitcnt vmcnt(38)
  ds_read_b64_tr_b16 a[50:51], v3 offset:13312
  ds_read_b64_tr_b16 a[54:55], v3 offset:13328
  s_waitcnt lgkmcnt(2)
  s_add_u32 m0, s52, 12288
  s_nop 0
  buffer_load_dwordx4 v2, s[16:19], s51 offen lds
  s_add_u32 s51, s51, 32768
  s_waitcnt vmcnt(38)
  ds_read_b64_tr_b16 a[56:57], v3 offset:14336
  ds_read_b64_tr_b16 a[60:61], v3 offset:14352
  s_waitcnt lgkmcnt(2)
  s_add_u32 m0, s52, 13312
  s_nop 0
  buffer_load_dwordx4 v2, s[16:19], s51 offen lds
  s_add_u32 s51, s51, 32768
  s_waitcnt vmcnt(38)
  ds_read_b64_tr_b16 a[58:59], v3 offset:15360
  ds_read_b64_tr_b16 a[62:63], v3 offset:15376
  s_waitcnt lgkmcnt(2)
  s_add_u32 m0, s52, 14336
  s_nop 0
  buffer_load_dwordx4 v2, s[16:19], s51 offen lds
  s_add_u32 s51, s51, 32768
  s_waitcnt vmcnt(38)
  ds_read_b64_tr_b16 a[64:65], v3 offset:16384
  ds_read_b64_tr_b16 a[68:69], v3 offset:16400
  s_waitcnt lgkmcnt(2)
  s_add_u32 m0, s52, 15360
  s_nop 0
  buffer_load_dwordx4 v2, s[16:19], s51 offen lds
  s_add_u32 s51, s51, 32768
  s_waitcnt vmcnt(38)
  ds_read_b64_tr_b16 a[66:67], v3 offset:17408
  ds_read_b64_tr_b16 a[70:71], v3 offset:17424
  s_waitcnt lgkmcnt(2)
  s_add_u32 m0, s52, 16384
  s_nop 0
  buffer_load_dwordx4 v2, s[16:19], s51 offen lds
  s_add_u32 s51, s51, 32768
  s_waitcnt vmcnt(38)
  ds_read_b64_tr_b16 a[72:73], v3 offset:18432
  ds_read_b64_tr_b16 a[76:77], v3 offset:18448
  s_waitcnt lgkmcnt(2)
  s_add_u32 m0, s52, 17408
  s_nop 0
  buffer_load_dwordx4 v2, s[16:19], s51 offen lds
  s_add_u32 s51, s51, 32768
  s_waitcnt vmcnt(38)
  ds_read_b64_tr_b16 a[74:75], v3 offset:19456
  ds_read_b64_tr_b16 a[78:79], v3 offset:19472
  s_waitcnt lgkmcnt(2)
  s_add_u32 m0, s52, 18432
  s_nop 0
  buffer_load_dwordx4 v2, s[16:19], s51 offen lds
  s_add_u32 s51, s51, 32768
  s_waitcnt vmcnt(38)
  ds_read_b64_tr_b16 a[80:81], v3 offset:20480
  ds_read_b64_tr_b16 a[84:85], v3 offset:20496
  s_waitcnt lgkmcnt(2)
  s_add_u32 m0, s52, 19456
  s_nop 0
  buffer_load_dwordx4 v2, s[16:19], s51 offen lds
  s_add_u32 s51, s51, 32768
  s_waitcnt vmcnt(38)
  ds_read_b64_tr_b16 a[82:83], v3 offset:21504
  ds_read_b64_tr_b16 a[86:87], v3 offset:21520
  s_waitcnt lgkmcnt(2)
  s_add_u32 m0, s52, 20480
  s_nop 0
  buffer_load_dwordx4 v2, s[16:19], s51 offen lds
  s_add_u32 s51, s51, 32768
  s_waitcnt vmcnt(38)
  ds_read_b64_tr_b16 a[88:89], v3 offset:22528
  ds_read_b64_tr_b16 a[92:93], v3 offset:22544
  s_waitcnt lgkmcnt(2)
  s_add_u32 m0, s52, 21504
  s_nop 0
  buffer_load_dwordx4 v2, s[16:19], s51 offen lds
  s_add_u32 s51, s51, 32768
  s_waitcnt vmcnt(38)
  ds_read_b64_tr_b16 a[90:91], v3 offset:23552
  ds_read_b64_tr_b16 a[94:95], v3 offset:23568
  s_waitcnt lgkmcnt(2)
  s_add_u32 m0, s52, 22528
  s_nop 0
  buffer_load_dwordx4 v2, s[16:19], s51 offen lds
  s_add_u32 s51, s51, 32768
  s_waitcnt vmcnt(38)
  ds_read_b64_tr_b16 a[96:97], v3 offset:24576
  ds_read_b64_tr_b16 a[100:101], v3 offset:24592
  s_waitcnt lgkmcnt(2)
  s_add_u32 m0, s52, 23552
  s_nop 0
  buffer_load_dwordx4 v2, s[16:19], s51 offen lds
  s_add_u32 s51, s51, 32768
  s_waitcnt vmcnt(38)
  ds_read_b64_tr_b16 a[98:99], v3 offset:25600
  ds_read_b64_tr_b16 a[102:103], v3 offset:25616
  s_waitcnt vmcnt(37)
  ds_read_b64_tr_b16 a[104:105], v3 offset:26624
  ds_read_b64_tr_b16 a[108:109], v3 offset:26640
  s_waitcnt vmcnt(36)
  ds_read_b64_tr_b16 a[106:107], v3 offset:27648
  ds_read_b64_tr_b16 a[110:111], v3 offset:27664
  s_waitcnt vmcnt(35)
  ds_read_b64_tr_b16 a[112:113], v3 offset:28672
  ds_read_b64_tr_b16 a[116:117], v3 offset:28688
  s_waitcnt vmcnt(34)
  ds_read_b64_tr_b16 a[114:115], v3 offset:29696
  ds_read_b64_tr_b16 a[118:119], v3 offset:29712
  s_waitcnt vmcnt(33)
  ds_read_b64_tr_b16 a[120:121], v3 offset:30720
  ds_read_b64_tr_b16 a[124:125], v3 offset:30736
  s_waitcnt vmcnt(32)
  ds_read_b64_tr_b16 a[122:123], v3 offset:31744
  ds_read_b64_tr_b16 a[126:127], v3 offset:31760
  s_waitcnt vmcnt(31)
  ds_read_b64_tr_b16 a[128:129], v10 offset:32768
  ds_read_b64_tr_b16 a[132:133], v11 offset:32768
  s_waitcnt vmcnt(30)
  ds_read_b64_tr_b16 a[130:131], v10 offset:33792
  ds_read_b64_tr_b16 a[134:135], v11 offset:33792
  s_waitcnt vmcnt(29)
  ds_read_b64_tr_b16 a[136:137], v10 offset:34816
  ds_read_b64_tr_b16 a[140:141], v11 offset:34816
  s_waitcnt vmcnt(28)
  ds_read_b64_tr_b16 a[138:139], v10 offset:35840
  ds_read_b64_tr_b16 a[142:143], v11 offset:35840
  s_waitcnt vmcnt(27)
  ds_read_b64_tr_b16 a[144:145], v10 offset:36864
  ds_read_b64_tr_b16 a[148:149], v11 offset:36864
  s_waitcnt vmcnt(26)
  ds_read_b64_tr_b16 a[146:147], v10 offset:37888
  ds_read_b64_tr_b16 a[150:151], v11 offset:37888
  s_waitcnt vmcnt(25)
  ds_read_b64_tr_b16 a[152:153], v10 offset:38912
  ds_read_b64_tr_b16 a[156:157], v11 offset:38912
  s_waitcnt vmcnt(24)
  ds_read_b64_tr_b16 a[154:155], v10 offset:39936
  ds_read_b64_tr_b16 a[158:159], v11 offset:39936
  s_waitcnt vmcnt(23)
  ds_read_b64_tr_b16 a[160:161], v10 offset:0
  ds_read_b64_tr_b16 a[164:165], v11 offset:0
  s_waitcnt vmcnt(22)
  ds_read_b64_tr_b16 a[162:163], v10 offset:1024
  ds_read_b64_tr_b16 a[166:167], v11 offset:1024
  s_waitcnt vmcnt(21)
  ds_read_b64_tr_b16 a[168:169], v10 offset:2048
  ds_read_b64_tr_b16 a[172:173], v11 offset:2048
  s_waitcnt vmcnt(20)
  ds_read_b64_tr_b16 a[170:171], v10 offset:3072
  ds_read_b64_tr_b16 a[174:175], v11 offset:3072
  s_waitcnt vmcnt(19)
  ds_read_b64_tr_b16 a[176:177], v10 offset:4096
  ds_read_b64_tr_b16 a[180:181], v11 offset:4096
  s_waitcnt vmcnt(18)
  ds_read_b64_tr_b16 a[178:179], v10 offset:5120
  ds_read_b64_tr_b16 a[182:183], v11 offset:5120
  s_waitcnt vmcnt(17)
  ds_read_b64_tr_b16 a[184:185], v10 offset:6144
  ds_read_b64_tr_b16 a[188:189], v11 offset:6144
  s_waitcnt vmcnt(16)
  ds_read_b64_tr_b16 a[186:187], v10 offset:7168
  ds_read_b64_tr_b16 a[190:191], v11 offset:7168
  s_waitcnt vmcnt(15)
  ds_read_b64_tr_b16 a[192:193], v10 offset:8192
  ds_read_b64_tr_b16 a[196:197], v11 offset:8192
  s_waitcnt vmcnt(14)
  ds_read_b64_tr_b16 a[194:195], v10 offset:9216
  ds_read_b64_tr_b16 a[198:199], v11 offset:9216
  s_waitcnt vmcnt(13)
  ds_read_b64_tr_b16 a[200:201], v10 offset:10240
  ds_read_b64_tr_b16 a[204:205], v11 offset:10240
  s_waitcnt vmcnt(12)
  ds_read_b64_tr_b16 a[202:203], v10 offset:11264
  ds_read_b64_tr_b16 a[206:207], v11 offset:11264
  s_waitcnt vmcnt(11)
  ds_read_b64_tr_b16 a[208:209], v10 offset:12288
  ds_read_b64_tr_b16 a[212:213], v11 offset:12288
  s_waitcnt vmcnt(10)
  ds_read_b64_tr_b16 a[210:211], v10 offset:13312
  ds_read_b64_tr_b16 a[214:215], v11 offset:13312
  s_waitcnt vmcnt(9)
  ds_read_b64_tr_b16 a[216:217], v10 offset:14336
  ds_read_b64_tr_b16 a[220:221], v11 offset:14336
  s_waitcnt vmcnt(8)
  ds_read_b64_tr_b16 a[218:219], v10 offset:15360
  ds_read_b64_tr_b16 a[222:223], v11 offset:15360
  s_waitcnt vmcnt(7)
  ds_read_b64_tr_b16 a[224:225], v10 offset:16384
  ds_read_b64_tr_b16 a[228:229], v11 offset:16384
  s_waitcnt vmcnt(6)
  ds_read_b64_tr_b16 a[226:227], v10 offset:17408
  ds_read_b64_tr_b16 a[230:231], v11 offset:17408
  s_waitcnt vmcnt(5)
  ds_read_b64_tr_b16 a[232:233], v10 offset:18432
  ds_read_b64_tr_b16 a[236:237], v11 offset:18432
  s_waitcnt vmcnt(4)
  ds_read_b64_tr_b16 a[234:235], v10 offset:19456
  ds_read_b64_tr_b16 a[238:239], v11 offset:19456
  s_waitcnt vmcnt(3)
  ds_read_b64_tr_b16 a[240:241], v10 offset:20480
  ds_read_b64_tr_b16 a[244:245], v11 offset:20480
  s_waitcnt vmcnt(2)
  ds_read_b64_tr_b16 a[242:243], v10 offset:21504
  ds_read_b64_tr_b16 a[246:247], v11 offset:21504
  s_waitcnt vmcnt(1)
  ds_read_b64_tr_b16 a[248:249], v10 offset:22528
  ds_read_b64_tr_b16 a[252:253], v11 offset:22528
  s_waitcnt vmcnt(0)
  ds_read_b64_tr_b16 a[250:251], v10 offset:23552
  ds_read_b64_tr_b16 a[254:255], v11 offset:23552
  s_waitcnt lgkmcnt(0)
  v_lshlrev_b32 v4, 4, v1
  v_bfe_u32 v2, v1, 3, 1
  v_and_b32 v3, 7, v1
  v_lshl_add_u32 v3, v2, 4, v3
  v_mul_u32_u24 v5, 1040, v3
  v_lshl_add_u32 v5, v2, 7, v5
  v_lshrrev_b32 v2, 4, v1
  v_lshl_add_u32 v5, v2, 8, v5
  v_lshlrev_b32 v2, 9, v2
  v_lshl_add_u32 v13, v3, 4, v2
  v_and_b32 v3, 15, v1
  v_lshl_add_u32 v14, v3, 4, v2
  s_mul_i32 s36, s4, 8320
  s_lshr_b32 s31, s4, 1
  s_lshl_b32 s31, s31, 7
  s_add_u32 s36, s36, s31
  s_lshl_b32 s37, s7, 21
  s_add_u32 s37, s37, 1048576
  s_lshl_b32 s31, s4, 13
  s_add_u32 s37, s37, s31
  s_mul_i32 s31, s7, 50331648
  s_add_u32 s31, s31, 41943040
  s_lshl_b32 s32, s4, 11
  s_add_u32 s31, s31, s32
  s_mul_i32 s38, s46, 24576
  s_add_u32 s38, s38, s31
  s_add_u32 s38, s38, s48
  s_mul_i32 s39, s47, 24576
  s_add_u32 s39, s39, s31
  s_add_u32 s39, s39, s49
  s_lshl_b32 s31, s7, 5
  s_add_u32 s31, s31, s20
  s_lshl_b32 s31, s31, 9
  s_add_u32 s31, s31, 0
  s_lshl_b32 s32, s7, 4
  s_add_u32 s32, s32, s20
  s_sub_u32 s32, s32, 32
  s_lshl_b32 s32, s32, 9
  s_add_u32 s32, s32, 32768
  s_cmp_lt_u32 s20, 32
  s_cselect_b32 s43, s31, s32
  s_lshl_b32 s31, s4, 7
  s_add_u32 s43, s43, s31
  v_and_b32 v6, 7, v1
  v_lshlrev_b32 v6, 7, v6
  v_lshrrev_b32 v7, 3, v1
  v_lshl_add_u32 v6, v7, 12, v6
  s_lshl_b32 s31, s4, 10
  s_add_u32 s45, s31, 81920
  v_mov_b32 v8, 0
  s_mov_b32 s21, -1
  s_barrier
  s_cmp_eq_u32 s7, 0
  s_cbranch_scc1 qkv_l0
  v_mov_b32 v11, 84
  s_mov_b64 exec, 1
wd_46:
  buffer_load_dword v10, v11, s[24:27], 0 offen sc1
  s_waitcnt vmcnt(0)
  v_cmp_gt_u32 vcc, 1, v10
  s_cbranch_vccz wdd_47
  s_sub_u32 s3, s3, 1
  s_cbranch_scc1 bail_3
  s_sleep 32
  s_branch wd_46
wdd_47:
  s_mov_b64 exec, -1
  s_mov_b64 exec, 1
lw_48:
  s_sub_u32 s3, s3, 1
  s_cbranch_scc1 bail_6
  s_sleep 4
  buffer_load_dword v10, off, s[8:11], s37 sc1
  s_waitcnt vmcnt(0)
  v_cmp_eq_u32 vcc, -1, v10
  s_cbranch_vccnz lw_48
  s_mov_b64 exec, -1
  s_branch qkv_go
qkv_l0:
  v_mov_b32 v11, 80
  s_mov_b64 exec, 1
wd_49:
  buffer_load_dword v10, v11, s[24:27], 0 offen sc1
  s_waitcnt vmcnt(0)
  v_cmp_gt_u32 vcc, 1, v10
  s_cbranch_vccz wdd_50
  s_sub_u32 s3, s3, 1
  s_cbranch_scc1 bail_3
  s_sleep 8
  s_branch wd_49
wdd_50:
  s_mov_b64 exec, -1
qkv_ln:
  s_sub_u32 s3, s3, 1
  s_cbranch_scc1 bail_5
  buffer_load_dword v7, v6, s[8:11], s45 offen sc1
  s_waitcnt vmcnt(0)
  v_cmp_eq_u32 vcc, 0, v7
  s_cbranch_vccnz qkv_ln
qkv_go:
  s_lshl_b32 s33, s7, 2
  s_add_u32 s33, s33, s4
  s_mov_b32 s41, 5242880
  s_cmp_eq_u32 s33, 1
  s_cselect_b32 s41, 9437184, s41
  s_cmp_eq_u32 s33, 2
  s_cselect_b32 s41, 3145728, s41
  s_cmp_eq_u32 s33, 3
  s_cselect_b32 s41, 13631488, s41
  s_cmp_eq_u32 s33, 4
  s_cselect_b32 s41, 7340032, s41
  s_cmp_eq_u32 s33, 5
  s_cselect_b32 s41, 11534336, s41
  s_cmp_eq_u32 s33, 6
  s_cselect_b32 s41, 1073741824, s41
  s_cmp_eq_u32 s33, 7
  s_cselect_b32 s41, 1073741824, s41
  s_lshl_b32 s33, s20, 10
  s_add_u32 s41, s41, s33
  v_mov_b32 v100, -1
  v_mov_b32 v101, -1
  v_mov_b32 v102, -1
  v_mov_b32 v103, -1
  s_lshl_b32 s33, s7, 23
  s_lshl_b32 s34, s20, 12
  s_add_u32 s33, s33, s34
  s_lshl_b32 s34, s4, 9
  s_add_u32 s33, s33, s34
  s_add_u32 s44, s33, 25165824
  v_lshrrev_b32 v15, 5, v1
  v_mul_u32_u24 v15, 1536, v15
  v_add_u32 v15, v15, v4
  v_lshrrev_b32 v12, 3, v1
  v_mul_u32_u24 v12, 1040, v12
  v_and_b32 v9, 7, v1
  v_lshl_add_u32 v12, v9, 7, v12
  v_add_u32 v12, s36, v12
  s_mov_b64 s[64:65], -1
  s_cmp_lt_u32 s20, 32
  s_cbranch_scc0 qq_wait
kv_wait:
  s_sub_u32 s3, s3, 1
  s_cbranch_scc1 bail_4
  s_and_b32 s31, s64, 0xff
  s_cbranch_scc0 xf_51
  s_add_u32 m0, s36, 0
  s_add_u32 s31, s37, 0
  buffer_load_dwordx4 v4, s[8:11], s31 offen sc1 lds
xf_51:
  s_and_b32 s31, s64, 0xff00
  s_cbranch_scc0 xf_52
  s_add_u32 m0, s36, 1040
  s_add_u32 s31, s37, 1024
  buffer_load_dwordx4 v4, s[8:11], s31 offen sc1 lds
xf_52:
  s_and_b32 s31, s64, 0xff0000
  s_cbranch_scc0 xf_53
  s_add_u32 m0, s36, 2080
  s_add_u32 s31, s37, 2048
  buffer_load_dwordx4 v4, s[8:11], s31 offen sc1 lds
xf_53:
  s_and_b32 s31, s64, 0xff000000
  s_cbranch_scc0 xf_54
  s_add_u32 m0, s36, 3120
  s_add_u32 s31, s37, 3072
  buffer_load_dwordx4 v4, s[8:11], s31 offen sc1 lds
xf_54:
  s_and_b32 s31, s65, 0xff
  s_cbranch_scc0 xf_55
  s_add_u32 m0, s36, 4160
  s_add_u32 s31, s37, 4096
  buffer_load_dwordx4 v4, s[8:11], s31 offen sc1 lds
xf_55:
  s_and_b32 s31, s65, 0xff00
  s_cbranch_scc0 xf_56
  s_add_u32 m0, s36, 5200
  s_add_u32 s31, s37, 5120
  buffer_load_dwordx4 v4, s[8:11], s31 offen sc1 lds
xf_56:
  s_and_b32 s31, s65, 0xff0000
  s_cbranch_scc0 xf_57
  s_add_u32 m0, s36, 6240
  s_add_u32 s31, s37, 6144
  buffer_load_dwordx4 v4, s[8:11], s31 offen sc1 lds
xf_57:
  s_and_b32 s31, s65, 0xff000000
  s_cbranch_scc0 xf_58
  s_add_u32 m0, s36, 7280
  s_add_u32 s31, s37, 7168
  buffer_load_dwordx4 v4, s[8:11], s31 offen sc1 lds
xf_58:
  s_waitcnt vmcnt(0)
  ds_read2_b32 v[96:97], v12 offset1:16
  s_waitcnt lgkmcnt(0)
  v_max_u32 v96, v96, v97
  v_cmp_eq_u32 s[64:65], -1, v96
  s_cmp_lg_u64 s[64:65], 0
  s_cbranch_scc1 kv_wait
kv_top:
  s_add_u32 s21, s21, 1
  s_cmp_lt_u32 s21, 63
  s_cselect_b32 s40, 32768, 0
  s_cselect_b32 s42, 0, 0x40000000
  s_add_u32 s41, s41, 32768
  s_or_b32 s41, s41, s42
  s_add_u32 s44, s44, 131072
  s_or_b32 s44, s44, s42
  s_add_u32 s37, s37, s40
  s_xor_b32 s36, s36, 0x10000
  v_xor_b32 v12, 0x10000, v12
kv_again:
  s_barrier
  ds_read_b128 v[16:19], v5 offset:0
  ds_read_b128 v[20:23], v5 offset:8320
  ds_read_b128 v[24:27], v5 offset:16
  ds_read_b128 v[28:31], v5 offset:8336
  ds_read_b128 v[32:35], v5 offset:32
  ds_read_b128 v[36:39], v5 offset:8352
  v_mov_b32 v9, s21
  s_waitcnt lgkmcnt(5)
  v_mfma_f32_16x16x32_bf16 v[48:51], a[0:3], v[16:19], 0
  ds_read_b128 v[40:43], v5 offset:48
  v_mfma_f32_16x16x32_bf16 v[52:55], a[4:7], v[16:19], 0
  v_mfma_f32_16x16x32_bf16 v[64:67], v[16:19], a[128:131], 0
  s_waitcnt lgkmcnt(5)
  v_mfma_f32_16x16x32_bf16 v[68:71], v[16:19], a[132:135], 0
  v_mfma_f32_16x16x32_bf16 v[56:59], a[0:3], v[20:23], 0
  ds_read_b128 v[44:47], v5 offset:8368
  v_mfma_f32_16x16x32_bf16 v[60:63], a[4:7], v[20:23], 0
  v_max_u32 v7, v16, v20
  v_mfma_f32_16x16x32_bf16 v[72:75], v[20:23], a[128:131], 0
  s_waitcnt lgkmcnt(5)
  v_mfma_f32_16x16x32_bf16 v[76:79], v[20:23], a[132:135], 0
  v_mfma_f32_16x16x32_bf16 v[48:51], a[8:11], v[24:27], v[48:51]
  ds_read_b128 v[16:19], v5 offset:64
  v_mfma_f32_16x16x32_bf16 v[52:55], a[12:15], v[24:27], v[52:55]
  v_mfma_f32_16x16x32_bf16 v[64:67], v[24:27], a[136:139], v[64:67]
  s_waitcnt lgkmcnt(5)
  v_mfma_f32_16x16x32_bf16 v[68:71], v[24:27], a[140:143], v[68:71]
  v_mfma_f32_16x16x32_bf16 v[56:59], a[8:11], v[28:31], v[56:59]
  ds_read_b128 v[20:23], v5 offset:8384
  v_mfma_f32_16x16x32_bf16 v[60:63], a[12:15], v[28:31], v[60:63]
  v_max3_u32 v7, v7, v24, v28
  v_mfma_f32_16x16x32_bf16 v[72:75], v[28:31], a[136:139], v[72:75]
  s_waitcnt lgkmcnt(5)
  v_mfma_f32_16x16x32_bf16 v[76:79], v[28:31], a[140:143], v[76:79]
  v_mfma_f32_16x16x32_bf16 v[48:51], a[16:19], v[32:35], v[48:51]
  ds_read_b128 v[24:27], v5 offset:80
  v_mfma_f32_16x16x32_bf16 v[52:55], a[20:23], v[32:35], v[52:55]
  v_mfma_f32_16x16x32_bf16 v[64:67], v[32:35], a[144:147], v[64:67]
  s_add_u32 m0, s36, 0
  s_add_u32 s31, s37, 0
  v_mfma_f32_16x16x32_bf16 v[68:71], v[32:35], a[148:151], v[68:71]
  buffer_load_dwordx4 v4, s[8:11], s31 offen sc1 lds
  s_waitcnt lgkmcnt(5)
  v_mfma_f32_16x16x32_bf16 v[56:59], a[16:19], v[36:39], v[56:59]
  ds_read_b128 v[28:31], v5 offset:8400
  v_mfma_f32_16x16x32_bf16 v[60:63], a[20:23], v[36:39], v[60:63]
  v_max3_u32 v7, v7, v32, v36
  v_mfma_f32_16x16x32_bf16 v[72:75], v[36:39], a[144:147], v[72:75]
  s_waitcnt lgkmcnt(5)
  v_mfma_f32_16x16x32_bf16 v[76:79], v[36:39], a[148:151], v[76:79]
  v_mfma_f32_16x16x32_bf16 v[48:51], a[24:27], v[40:43], v[48:51]
  ds_read_b128 v[32:35], v5 offset:96
  v_mfma_f32_16x16x32_bf16 v[52:55], a[28:31], v[40:43], v[52:55]
  v_mfma_f32_16x16x32_bf16 v[64:67], v[40:43], a[152:155], v[64:67]
  s_add_u32 m0, s36, 1040
  s_add_u32 s31, s37, 1024
  v_mfma_f32_16x16x32_bf16 v[68:71], v[40:43], a[156:159], v[68:71]
  buffer_load_dwordx4 v4, s[8:11], s31 offen sc1 lds
  s_waitcnt lgkmcnt(5)
  v_mfma_f32_16x16x32_bf16 v[56:59], a[24:27], v[44:47], v[56:59]
  ds_read_b128 v[36:39], v5 offset:8416
  v_mfma_f32_16x16x32_bf16 v[60:63], a[28:31], v[44:47], v[60:63]
  v_max3_u32 v7, v7, v40, v44
  v_mfma_f32_16x16x32_bf16 v[72:75], v[44:47], a[152:155], v[72:75]
  s_waitcnt lgkmcnt(5)
  v_mfma_f32_16x16x32_bf16 v[76:79], v[44:47], a[156:159], v[76:79]
  v_mfma_f32_16x16x32_bf16 v[48:51], a[32:35], v[16:19], v[48:51]
  ds_read_b128 v[40:43], v5 offset:112
  v_mfma_f32_16x16x32_bf16 v[52:55], a[36:39], v[16:19], v[52:55]
  v_mfma_f32_16x16x32_bf16 v[64:67], v[16:19], a[160:163], v[64:67]
  s_add_u32 m0, s36, 2080
  s_add_u32 s31, s37, 2048
  v_mfma_f32_16x16x32_bf16 v[68:71], v[16:19], a[164:167], v[68:71]
  buffer_load_dwordx4 v4, s[8:11], s31 offen sc1 lds
  s_waitcnt lgkmcnt(5)
  v_mfma_f32_16x16x32_bf16 v[56:59], a[32:35], v[20:23], v[56:59]
  ds_read_b128 v[44:47], v5 offset:8432
  v_mfma_f32_16x16x32_bf16 v[60:63], a[36:39], v[20:23], v[60:63]
  v_max3_u32 v7, v7, v16, v20
  v_mfma_f32_16x16x32_bf16 v[72:75], v[20:23], a[160:163], v[72:75]
  s_waitcnt lgkmcnt(5)
  v_mfma_f32_16x16x32_bf16 v[76:79], v[20:23], a[164:167], v[76:79]
  v_mfma_f32_16x16x32_bf16 v[48:51], a[40:43], v[24:27], v[48:51]
  ds_read_b128 v[16:19], v5 offset:128
  v_mfma_f32_16x16x32_bf16 v[52:55], a[44:47], v[24:27], v[52:55]
  v_mfma_f32_16x16x32_bf16 v[64:67], v[24:27], a[168:171], v[64:67]
  s_add_u32 m0, s36, 3120
  s_add_u32 s31, s37, 3072
  v_mfma_f32_16x16x32_bf16 v[68:71], v[24:27], a[172:175], v[68:71]
  buffer_load_dwordx4 v4, s[8:11], s31 offen sc1 lds
  s_waitcnt lgkmcnt(5)
  v_mfma_f32_16x16x32_bf16 v[56:59], a[40:43], v[28:31], v[56:59]
  ds_read_b128 v[20:23], v5 offset:8448
  v_mfma_f32_16x16x32_bf16 v[60:63], a[44:47], v[28:31], v[60:63]
  v_max3_u32 v7, v7, v24, v28
  v_mfma_f32_16x16x32_bf16 v[72:75], v[28:31], a[168:171], v[72:75]
  s_waitcnt lgkmcnt(5)
  v_mfma_f32_16x16x32_bf16 v[76:79], v[28:31], a[172:175], v[76:79]
  v_mfma_f32_16x16x32_bf16 v[48:51], a[48:51], v[32:35], v[48:51]
  ds_read_b128 v[24:27], v5 offset:144
  v_mfma_f32_16x16x32_bf16 v[52:55], a[52:55], v[32:35], v[52:55]
  v_mfma_f32_16x16x32_bf16 v[64:67], v[32:35], a[176:179], v[64:67]
  s_add_u32 m0, s36, 4160
  s_add_u32 s31, s37, 4096
  v_mfma_f32_16x16x32_bf16 v[68:71], v[32:35], a[180:183], v[68:71]
  buffer_load_dwordx4 v4, s[8:11], s31 offen sc1 lds
  s_waitcnt lgkmcnt(5)
  v_mfma_f32_16x16x32_bf16 v[56:59], a[48:51], v[36:39], v[56:59]
  ds_read_b128 v[28:31], v5 offset:8464
  v_mfma_f32_16x16x32_bf16 v[60:63], a[52:55], v[36:39], v[60:63]
  v_max3_u32 v7, v7, v32, v36
  v_mfma_f32_16x16x32_bf16 v[72:75], v[36:39], a[176:179], v[72:75]
  s_waitcnt vmcnt(5)
  v_mfma_f32_16x16x32_bf16 v[76:79], v[36:39], a[180:183], v[76:79]
  s_mov_b64 exec, 1
  buffer_store_dword v9, v8, s[8:11], s43 offen sc1
  s_mov_b64 exec, -1
  s_waitcnt lgkmcnt(5)
  v_mfma_f32_16x16x32_bf16 v[48:51], a[56:59], v[40:43], v[48:51]
  ds_read_b128 v[32:35], v5 offset:160
  v_mfma_f32_16x16x32_bf16 v[52:55], a[60:63], v[40:43], v[52:55]
  v_mfma_f32_16x16x32_bf16 v[64:67], v[40:43], a[184:187], v[64:67]
  s_add_u32 m0, s36, 5200
  s_add_u32 s31, s37, 5120
  v_mfma_f32_16x16x32_bf16 v[68:71], v[40:43], a[188:191], v[68:71]
  buffer_load_dwordx4 v4, s[8:11], s31 offen sc1 lds
  s_waitcnt lgkmcnt(5)
  v_mfma_f32_16x16x32_bf16 v[56:59], a[56:59], v[44:47], v[56:59]
  ds_read_b128 v[36:39], v5 offset:8480
  v_mfma_f32_16x16x32_bf16 v[60:63], a[60:63], v[44:47], v[60:63]
  v_max3_u32 v7, v7, v40, v44
  v_mfma_f32_16x16x32_bf16 v[72:75], v[44:47], a[184:187], v[72:75]
  s_waitcnt lgkmcnt(5)
  v_mfma_f32_16x16x32_bf16 v[76:79], v[44:47], a[188:191], v[76:79]
  v_mfma_f32_16x16x32_bf16 v[48:51], a[64:67], v[16:19], v[48:51]
  ds_read_b128 v[40:43], v5 offset:176
  v_mfma_f32_16x16x32_bf16 v[52:55], a[68:71], v[16:19], v[52:55]
  v_mfma_f32_16x16x32_bf16 v[64:67], v[16:19], a[192:195], v[64:67]
  s_add_u32 m0, s36, 6240
  s_add_u32 s31, s37, 6144
  v_mfma_f32_16x16x32_bf16 v[68:71], v[16:19], a[196:199], v[68:71]
  buffer_load_dwordx4 v4, s[8:11], s31 offen sc1 lds
  s_waitcnt lgkmcnt(5)
  v_mfma_f32_16x16x32_bf16 v[56:59], a[64:67], v[20:23], v[56:59]
  ds_read_b128 v[44:47], v5 offset:8496
  v_mfma_f32_16x16x32_bf16 v[60:63], a[68:71], v[20:23], v[60:63]
  v_max3_u32 v7, v7, v16, v20
  v_mfma_f32_16x16x32_bf16 v[72:75], v[20:23], a[192:195], v[72:75]
  s_waitcnt lgkmcnt(5)
  v_mfma_f32_16x16x32_bf16 v[76:79], v[20:23], a[196:199], v[76:79]
  v_mfma_f32_16x16x32_bf16 v[48:51], a[72:75], v[24:27], v[48:51]
  ds_read_b128 v[16:19], v5 offset:192
  v_mfma_f32_16x16x32_bf16 v[52:55], a[76:79], v[24:27], v[52:55]
  v_mfma_f32_16x16x32_bf16 v[64:67], v[24:27], a[200:203], v[64:67]
  s_add_u32 m0, s36, 7280
  s_add_u32 s31, s37, 7168
  v_mfma_f32_16x16x32_bf16 v[68:71], v[24:27], a[204:207], v[68:71]
  buffer_load_dwordx4 v4, s[8:11], s31 offen sc1 lds
  s_waitcnt lgkmcnt(5)
  v_mfma_f32_16x16x32_bf16 v[56:59], a[72:75], v[28:31], v[56:59]
  ds_read_b128 v[20:23], v5 offset:8512
  v_mfma_f32_16x16x32_bf16 v[60:63], a[76:79], v[28:31], v[60:63]
  v_max3_u32 v7, v7, v24, v28
  v_mfma_f32_16x16x32_bf16 v[72:75], v[28:31], a[200:203], v[72:75]
  s_waitcnt lgkmcnt(5)
  v_mfma_f32_16x16x32_bf16 v[76:79], v[28:31], a[204:207], v[76:79]
  v_mfma_f32_16x16x32_bf16 v[48:51], a[80:83], v[32:35], v[48:51]
  ds_read_b128 v[24:27], v5 offset:208
  v_mfma_f32_16x16x32_bf16 v[52:55], a[84:87], v[32:35], v[52:55]
  v_mfma_f32_16x16x32_bf16 v[64:67], v[32:35], a[208:211], v[64:67]
  s_waitcnt lgkmcnt(5)
  v_mfma_f32_16x16x32_bf16 v[68:71], v[32:35], a[212:215], v[68:71]
  v_mfma_f32_16x16x32_bf16 v[56:59], a[80:83], v[36:39], v[56:59]
  ds_read_b128 v[28:31], v5 offset:8528
  v_mfma_f32_16x16x32_bf16 v[60:63], a[84:87], v[36:39], v[60:63]
  v_max3_u32 v7, v7, v32, v36
  v_mfma_f32_16x16x32_bf16 v[72:75], v[36:39], a[208:211], v[72:75]
  s_waitcnt lgkmcnt(5)
  v_mfma_f32_16x16x32_bf16 v[76:79], v[36:39], a[212:215], v[76:79]
  v_mfma_f32_16x16x32_bf16 v[48:51], a[88:91], v[40:43], v[48:51]
  ds_read_b128 v[32:35], v5 offset:224
  v_mfma_f32_16x16x32_bf16 v[52:55], a[92:95], v[40:43], v[52:55]
  v_mfma_f32_16x16x32_bf16 v[64:67], v[40:43], a[216:219], v[64:67]
  s_waitcnt lgkmcnt(5)
  v_mfma_f32_16x16x32_bf16 v[68:71], v[40:43], a[220:223], v[68:71]
  v_mfma_f32_16x16x32_bf16 v[56:59], a[88:91], v[44:47], v[56:59]
  ds_read_b128 v[36:39], v5 offset:8544
  v_mfma_f32_16x16x32_bf16 v[60:63], a[92:95], v[44:47], v[60:63]
  v_max3_u32 v7, v7, v40, v44
  v_mfma_f32_16x16x32_bf16 v[72:75], v[44:47], a[216:219], v[72:75]
  s_waitcnt lgkmcnt(5)
  v_mfma_f32_16x16x32_bf16 v[76:79], v[44:47], a[220:223], v[76:79]
  v_mfma_f32_16x16x32_bf16 v[48:51], a[96:99], v[16:19], v[48:51]
  ds_read_b128 v[40:43], v5 offset:240
  v_mfma_f32_16x16x32_bf16 v[52:55], a[100:103], v[16:19], v[52:55]
  v_mfma_f32_16x16x32_bf16 v[64:67], v[16:19], a[224:227], v[64:67]
  s_waitcnt lgkmcnt(5)
  v_mfma_f32_16x16x32_bf16 v[68:71], v[16:19], a[228:231], v[68:71]
  v_mfma_f32_16x16x32_bf16 v[56:59], a[96:99], v[20:23], v[56:59]
  ds_read_b128 v[44:47], v5 offset:8560
  v_mfma_f32_16x16x32_bf16 v[60:63], a[100:103], v[20:23], v[60:63]
  v_max3_u32 v7, v7, v16, v20
  v_mfma_f32_16x16x32_bf16 v[72:75], v[20:23], a[224:227], v[72:75]
  s_waitcnt lgkmcnt(5)
  v_mfma_f32_16x16x32_bf16 v[76:79], v[20:23], a[228:231], v[76:79]
  v_mfma_f32_16x16x32_bf16 v[48:51], a[104:107], v[24:27], v[48:51]
  v_mfma_f32_16x16x32_bf16 v[52:55], a[108:111], v[24:27], v[52:55]
  v_mfma_f32_16x16x32_bf16 v[64:67], v[24:27], a[232:235], v[64:67]
  s_waitcnt lgkmcnt(4)
  v_mfma_f32_16x16x32_bf16 v[68:71], v[24:27], a[236:239], v[68:71]
  v_mfma_f32_16x16x32_bf16 v[56:59], a[104:107], v[28:31], v[56:59]
  v_max3_u32 v7, v7, v24, v28
  v_mfma_f32_16x16x32_bf16 v[60:63], a[108:111], v[28:31], v[60:63]
  v_mfma_f32_16x16x32_bf16 v[72:75], v[28:31], a[232:235], v[72:75]
  s_waitcnt lgkmcnt(0)
  v_mfma_f32_16x16x32_bf16 v[76:79], v[28:31], a[236:239], v[76:79]
  v_mfma_f32_16x16x32_bf16 v[48:51], a[112:115], v[32:35], v[48:51]
  v_max3_u32 v7, v7, v32, v36
  v_mfma_f32_16x16x32_bf16 v[52:55], a[116:119], v[32:35], v[52:55]
  v_max3_u32 v7, v7, v40, v44
  v_mfma_f32_16x16x32_bf16 v[56:59], a[112:115], v[36:39], v[56:59]
  v_cmp_eq_u32 vcc, -1, v7
  v_mfma_f32_16x16x32_bf16 v[60:63], a[116:119], v[36:39], v[60:63]
  v_mfma_f32_16x16x32_bf16 v[48:51], a[120:123], v[40:43], v[48:51]
  buffer_store_dwordx4 v[100:103], v15, s[8:11], s44 offen sc1
  v_mfma_f32_16x16x32_bf16 v[52:55], a[124:127], v[40:43], v[52:55]
  v_mfma_f32_16x16x32_bf16 v[56:59], a[120:123], v[44:47], v[56:59]
  v_mfma_f32_16x16x32_bf16 v[60:63], a[124:127], v[44:47], v[60:63]
  s_cbranch_vccnz kv_redo
  v_mfma_f32_16x16x32_bf16 v[64:67], v[32:35], a[240:243], v[64:67]
  v_cvt_pk_bf16_f32 v80, v48, v52
  v_cvt_pk_bf16_f32 v81, v49, v53
  v_mfma_f32_16x16x32_bf16 v[68:71], v[32:35], a[244:247], v[68:71]
  v_cvt_pk_bf16_f32 v82, v50, v54
  v_cvt_pk_bf16_f32 v83, v51, v55
  v_mfma_f32_16x16x32_bf16 v[72:75], v[36:39], a[240:243], v[72:75]
  buffer_store_dwordx4 v[80:83], v13, s[8:11], s38 offen offset:0 sc1
  v_cvt_pk_bf16_f32 v84, v56, v60
  v_cvt_pk_bf16_f32 v85, v57, v61
  v_mfma_f32_16x16x32_bf16 v[76:79], v[36:39], a[244:247], v[76:79]
  v_cvt_pk_bf16_f32 v86, v58, v62
  v_cvt_pk_bf16_f32 v87, v59, v63
  v_mfma_f32_16x16x32_bf16 v[64:67], v[40:43], a[248:251], v[64:67]
  buffer_store_dwordx4 v[84:87], v13, s[8:11], s38 offen offset:128 sc1
  v_mfma_f32_16x16x32_bf16 v[68:71], v[40:43], a[252:255], v[68:71]
  v_mfma_f32_16x16x32_bf16 v[72:75], v[44:47], a[248:251], v[72:75]
  buffer_store_dwordx4 v[100:103], v4, s[8:11], s41 offen sc1
  v_mfma_f32_16x16x32_bf16 v[76:79], v[44:47], a[252:255], v[76:79]
  s_waitcnt vmcnt(4)
  ds_read2_b32 v[96:97], v12 offset1:16
  v_xor_b32 v5, 0x10000, v5
  v_cvt_pk_bf16_f32 v88, v64, v65
  v_cvt_pk_bf16_f32 v89, v66, v67
  v_cvt_pk_bf16_f32 v90, v72, v73
  v_cvt_pk_bf16_f32 v91, v74, v75
  buffer_store_dwordx4 v[88:91], v14, s[8:11], s39 offen offset:0 sc1
  v_cvt_pk_bf16_f32 v92, v68, v69
  v_cvt_pk_bf16_f32 v93, v70, v71
  v_cvt_pk_bf16_f32 v94, v76, v77
  v_cvt_pk_bf16_f32 v95, v78, v79
  buffer_store_dwordx4 v[92:95], v14, s[8:11], s39 offen offset:256 sc1
  s_waitcnt lgkmcnt(0)
  v_max_u32 v96, v96, v97
  v_cmp_eq_u32 s[64:65], -1, v96
  s_add_u32 s38, s38, 786432
  s_add_u32 s39, s39, 786432
  s_cmp_eq_u32 s21, 63
  s_cbranch_scc1 qkv_fin
  s_cmp_lg_u64 s[64:65], 0
  s_cbranch_scc0 kv_top
kv_w1:
  s_sub_u32 s3, s3, 1
  s_cbranch_scc1 bail_4
  s_and_b32 s31, s64, 0xff
  s_cbranch_scc0 xf_59
  s_add_u32 m0, s36, 0
  s_add_u32 s31, s37, 0
  buffer_load_dwordx4 v4, s[8:11], s31 offen sc1 lds
xf_59:
  s_and_b32 s31, s64, 0xff00
  s_cbranch_scc0 xf_60
  s_add_u32 m0, s36, 1040
  s_add_u32 s31, s37, 1024
  buffer_load_dwordx4 v4, s[8:11], s31 offen sc1 lds
xf_60:
  s_and_b32 s31, s64, 0xff0000
  s_cbranch_scc0 xf_61
  s_add_u32 m0, s36, 2080
  s_add_u32 s31, s37, 2048
  buffer_load_dwordx4 v4, s[8:11], s31 offen sc1 lds
xf_61:
  s_and_b32 s31, s64, 0xff000000
  s_cbranch_scc0 xf_62
  s_add_u32 m0, s36, 3120
  s_add_u32 s31, s37, 3072
  buffer_load_dwordx4 v4, s[8:11], s31 offen sc1 lds
xf_62:
  s_and_b32 s31, s65, 0xff
  s_cbranch_scc0 xf_63
  s_add_u32 m0, s36, 4160
  s_add_u32 s31, s37, 4096
  buffer_load_dwordx4 v4, s[8:11], s31 offen sc1 lds
xf_63:
  s_and_b32 s31, s65, 0xff00
  s_cbranch_scc0 xf_64
  s_add_u32 m0, s36, 5200
  s_add_u32 s31, s37, 5120
  buffer_load_dwordx4 v4, s[8:11], s31 offen sc1 lds
xf_64:
  s_and_b32 s31, s65, 0xff0000
  s_cbranch_scc0 xf_65
  s_add_u32 m0, s36, 6240
  s_add_u32 s31, s37, 6144
  buffer_load_dwordx4 v4, s[8:11], s31 offen sc1 lds
xf_65:
  s_and_b32 s31, s65, 0xff000000
  s_cbranch_scc0 xf_66
  s_add_u32 m0, s36, 7280
  s_add_u32 s31, s37, 7168
  buffer_load_dwordx4 v4, s[8:11], s31 offen sc1 lds
xf_66:
  s_waitcnt vmcnt(0)
  ds_read2_b32 v[96:97], v12 offset1:16
  s_waitcnt lgkmcnt(0)
  v_max_u32 v96, v96, v97
  v_cmp_eq_u32 s[64:65], -1, v96
  s_cmp_lg_u64 s[64:65], 0
  s_cselect_b32 s22, 1, 0
  s_add_u32 s31, s21, 1
  v_mov_b32 v9, s31
  s_mov_b64 exec, 1
  buffer_store_dword v9, v8, s[8:11], s43 offen sc1
  s_mov_b64 exec, -1
  s_cmp_eq_u32 s22, 1
  s_cbranch_scc1 kv_wait
  s_branch kv_top
kv_redo:
  s_sub_u32 s3, s3, 1
  s_cbranch_scc1 bail_7
  s_waitcnt lgkmcnt(0)
  s_barrier
  s_sub_u32 s32, s37, s40
  s_xor_b32 s31, s36, 0x10000
  s_add_u32 m0, s31, 0
  s_add_u32 s31, s32, 0
  buffer_load_dwordx4 v4, s[8:11], s31 offen sc1 lds
  s_xor_b32 s31, s36, 0x10000
  s_add_u32 m0, s31, 1040
  s_add_u32 s31, s32, 1024
  buffer_load_dwordx4 v4, s[8:11], s31 offen sc1 lds
  s_xor_b32 s31, s36, 0x10000
  s_add_u32 m0, s31, 2080
  s_add_u32 s31, s32, 2048
  buffer_load_dwordx4 v4, s[8:11], s31 offen sc1 lds
  s_xor_b32 s31, s36, 0x10000
  s_add_u32 m0, s31, 3120
  s_add_u32 s31, s32, 3072
  buffer_load_dwordx4 v4, s[8:11], s31 offen sc1 lds
  s_xor_b32 s31, s36, 0x10000
  s_add_u32 m0, s31, 4160
  s_add_u32 s31, s32, 4096
  buffer_load_dwordx4 v4, s[8:11], s31 offen sc1 lds
  s_xor_b32 s31, s36, 0x10000
  s_add_u32 m0, s31, 5200
  s_add_u32 s31, s32, 5120
  buffer_load_dwordx4 v4, s[8:11], s31 offen sc1 lds
  s_xor_b32 s31, s36, 0x10000
  s_add_u32 m0, s31, 6240
  s_add_u32 s31, s32, 6144
  buffer_load_dwordx4 v4, s[8:11], s31 offen sc1 lds
  s_xor_b32 s31, s36, 0x10000
  s_add_u32 m0, s31, 7280
  s_add_u32 s31, s32, 7168
  buffer_load_dwordx4 v4, s[8:11], s31 offen sc1 lds
  s_waitcnt vmcnt(0)
  s_branch kv_again
qq_wait:
  s_sub_u32 s3, s3, 1
  s_cbranch_scc1 bail_4
  s_and_b32 s31, s64, 0xff
  s_cbranch_scc0 xf_67
  s_add_u32 m0, s36, 0
  s_add_u32 s31, s37, 0
  buffer_load_dwordx4 v4, s[8:11], s31 offen sc1 lds
xf_67:
  s_and_b32 s31, s64, 0xff00
  s_cbranch_scc0 xf_68
  s_add_u32 m0, s36, 1040
  s_add_u32 s31, s37, 1024
  buffer_load_dwordx4 v4, s[8:11], s31 offen sc1 lds
xf_68:
  s_and_b32 s31, s64, 0xff0000
  s_cbranch_scc0 xf_69
  s_add_u32 m0, s36, 2080
  s_add_u32 s31, s37, 2048
  buffer_load_dwordx4 v4, s[8:11], s31 offen sc1 lds
xf_69:
  s_and_b32 s31, s64, 0xff000000
  s_cbranch_scc0 xf_70
  s_add_u32 m0, s36, 3120
  s_add_u32 s31, s37, 3072
  buffer_load_dwordx4 v4, s[8:11], s31 offen sc1 lds
xf_70:
  s_and_b32 s31, s65, 0xff
  s_cbranch_scc0 xf_71
  s_add_u32 m0, s36, 4160
  s_add_u32 s31, s37, 4096
  buffer_load_dwordx4 v4, s[8:11], s31 offen sc1 lds
xf_71:
  s_and_b32 s31, s65, 0xff00
  s_cbranch_scc0 xf_72
  s_add_u32 m0, s36, 5200
  s_add_u32 s31, s37, 5120
  buffer_load_dwordx4 v4, s[8:11], s31 offen sc1 lds
xf_72:
  s_and_b32 s31, s65, 0xff0000
  s_cbranch_scc0 xf_73
  s_add_u32 m0, s36, 6240
  s_add_u32 s31, s37, 6144
  buffer_load_dwordx4 v4, s[8:11], s31 offen sc1 lds
xf_73:
  s_and_b32 s31, s65, 0xff000000
  s_cbranch_scc0 xf_74
  s_add_u32 m0, s36, 7280
  s_add_u32 s31, s37, 7168
  buffer_load_dwordx4 v4, s[8:11], s31 offen sc1 lds
xf_74:
  s_waitcnt vmcnt(0)
  ds_read2_b32 v[96:97], v12 offset1:16
  s_waitcnt lgkmcnt(0)
  v_max_u32 v96, v96, v97
  v_cmp_eq_u32 s[64:65], -1, v96
  s_cmp_lg_u64 s[64:65], 0
  s_cbranch_scc1 qq_wait
qq_top:
  s_add_u32 s21, s21, 1
  s_cmp_lt_u32 s21, 63
  s_cselect_b32 s40, 32768, 0
  s_cselect_b32 s42, 0, 0x40000000
  s_add_u32 s41, s41, 32768
  s_or_b32 s41, s41, s42
  s_add_u32 s44, s44, 131072
  s_or_b32 s44, s44, s42
  s_add_u32 s37, s37, s40
  s_xor_b32 s36, s36, 0x10000
  v_xor_b32 v12, 0x10000, v12
qq_again:
  s_barrier
  ds_read_b128 v[16:19], v5 offset:0
  ds_read_b128 v[20:23], v5 offset:8320
  ds_read_b128 v[24:27], v5 offset:16
  ds_read_b128 v[28:31], v5 offset:8336
  ds_read_b128 v[32:35], v5 offset:32
  ds_read_b128 v[36:39], v5 offset:8352
  v_mov_b32 v9, s21
  s_waitcnt lgkmcnt(5)
  v_mfma_f32_16x16x32_bf16 v[48:51], a[0:3], v[16:19], 0
  ds_read_b128 v[40:43], v5 offset:48
  v_mfma_f32_16x16x32_bf16 v[52:55], a[4:7], v[16:19], 0
  v_mfma_f32_16x16x32_bf16 v[64:67], a[128:131], v[16:19], 0
  s_waitcnt lgkmcnt(5)
  v_mfma_f32_16x16x32_bf16 v[68:71], a[132:135], v[16:19], 0
  v_mfma_f32_16x16x32_bf16 v[56:59], a[0:3], v[20:23], 0
  ds_read_b128 v[44:47], v5 offset:8368
  v_mfma_f32_16x16x32_bf16 v[60:63], a[4:7], v[20:23], 0
  v_max_u32 v7, v16, v20
  v_mfma_f32_16x16x32_bf16 v[72:75], a[128:131], v[20:23], 0
  s_waitcnt lgkmcnt(5)
  v_mfma_f32_16x16x32_bf16 v[76:79], a[132:135], v[20:23], 0
  v_mfma_f32_16x16x32_bf16 v[48:51], a[8:11], v[24:27], v[48:51]
  ds_read_b128 v[16:19], v5 offset:64
  v_mfma_f32_16x16x32_bf16 v[52:55], a[12:15], v[24:27], v[52:55]
  v_mfma_f32_16x16x32_bf16 v[64:67], a[136:139], v[24:27], v[64:67]
  s_waitcnt lgkmcnt(5)
  v_mfma_f32_16x16x32_bf16 v[68:71], a[140:143], v[24:27], v[68:71]
  v_mfma_f32_16x16x32_bf16 v[56:59], a[8:11], v[28:31], v[56:59]
  ds_read_b128 v[20:23], v5 offset:8384
  v_mfma_f32_16x16x32_bf16 v[60:63], a[12:15], v[28:31], v[60:63]
  v_max3_u32 v7, v7, v24, v28
  v_mfma_f32_16x16x32_bf16 v[72:75], a[136:139], v[28:31], v[72:75]
  s_waitcnt lgkmcnt(5)
  v_mfma_f32_16x16x32_bf16 v[76:79], a[140:143], v[28:31], v[76:79]
  v_mfma_f32_16x16x32_bf16 v[48:51], a[16:19], v[32:35], v[48:51]
  ds_read_b128 v[24:27], v5 offset:80
  v_mfma_f32_16x16x32_bf16 v[52:55], a[20:23], v[32:35], v[52:55]
  v_mfma_f32_16x16x32_bf16 v[64:67], a[144:147], v[32:35], v[64:67]
  s_add_u32 m0, s36, 0
  s_add_u32 s31, s37, 0
  v_mfma_f32_16x16x32_bf16 v[68:71], a[148:151], v[32:35], v[68:71]
  buffer_load_dwordx4 v4, s[8:11], s31 offen sc1 lds
  s_waitcnt lgkmcnt(5)
  v_mfma_f32_16x16x32_bf16 v[56:59], a[16:19], v[36:39], v[56:59]
  ds_read_b128 v[28:31], v5 offset:8400
  v_mfma_f32_16x16x32_bf16 v[60:63], a[20:23], v[36:39], v[60:63]
  v_max3_u32 v7, v7, v32, v36
  v_mfma_f32_16x16x32_bf16 v[72:75], a[144:147], v[36:39], v[72:75]
  s_waitcnt lgkmcnt(5)
  v_mfma_f32_16x16x32_bf16 v[76:79], a[148:151], v[36:39], v[76:79]
  v_mfma_f32_16x16x32_bf16 v[48:51], a[24:27], v[40:43], v[48:51]
  ds_read_b128 v[32:35], v5 offset:96
  v_mfma_f32_16x16x32_bf16 v[52:55], a[28:31], v[40:43], v[52:55]
  v_mfma_f32_16x16x32_bf16 v[64:67], a[152:155], v[40:43], v[64:67]
  s_add_u32 m0, s36, 1040
  s_add_u32 s31, s37, 1024
  v_mfma_f32_16x16x32_bf16 v[68:71], a[156:159], v[40:43], v[68:71]
  buffer_load_dwordx4 v4, s[8:11], s31 offen sc1 lds
  s_waitcnt lgkmcnt(5)
  v_mfma_f32_16x16x32_bf16 v[56:59], a[24:27], v[44:47], v[56:59]
  ds_read_b128 v[36:39], v5 offset:8416
  v_mfma_f32_16x16x32_bf16 v[60:63], a[28:31], v[44:47], v[60:63]
  v_max3_u32 v7, v7, v40, v44
  v_mfma_f32_16x16x32_bf16 v[72:75], a[152:155], v[44:47], v[72:75]
  s_waitcnt lgkmcnt(5)
  v_mfma_f32_16x16x32_bf16 v[76:79], a[156:159], v[44:47], v[76:79]
  v_mfma_f32_16x16x32_bf16 v[48:51], a[32:35], v[16:19], v[48:51]
  ds_read_b128 v[40:43], v5 offset:112
  v_mfma_f32_16x16x32_bf16 v[52:55], a[36:39], v[16:19], v[52:55]
  v_mfma_f32_16x16x32_bf16 v[64:67], a[160:163], v[16:19], v[64:67]
  s_add_u32 m0, s36, 2080
  s_add_u32 s31, s37, 2048
  v_mfma_f32_16x16x32_bf16 v[68:71], a[164:167], v[16:19], v[68:71]
  buffer_load_dwordx4 v4, s[8:11], s31 offen sc1 lds
  s_waitcnt lgkmcnt(5)
  v_mfma_f32_16x16x32_bf16 v[56:59], a[32:35], v[20:23], v[56:59]
  ds_read_b128 v[44:47], v5 offset:8432
  v_mfma_f32_16x16x32_bf16 v[60:63], a[36:39], v[20:23], v[60:63]
  v_max3_u32 v7, v7, v16, v20
  v_mfma_f32_16x16x32_bf16 v[72:75], a[160:163], v[20:23], v[72:75]
  s_waitcnt lgkmcnt(5)
  v_mfma_f32_16x16x32_bf16 v[76:79], a[164:167], v[20:23], v[76:79]
  v_mfma_f32_16x16x32_bf16 v[48:51], a[40:43], v[24:27], v[48:51]
  ds_read_b128 v[16:19], v5 offset:128
  v_mfma_f32_16x16x32_bf16 v[52:55], a[44:47], v[24:27], v[52:55]
  v_mfma_f32_16x16x32_bf16 v[64:67], a[168:171], v[24:27], v[64:67]
  s_add_u32 m0, s36, 3120
  s_add_u32 s31, s37, 3072
  v_mfma_f32_16x16x32_bf16 v[68:71], a[172:175], v[24:27], v[68:71]
  buffer_load_dwordx4 v4, s[8:11], s31 offen sc1 lds
  s_waitcnt lgkmcnt(5)
  v_mfma_f32_16x16x32_bf16 v[56:59], a[40:43], v[28:31], v[56:59]
  ds_read_b128 v[20:23], v5 offset:8448
  v_mfma_f32_16x16x32_bf16 v[60:63], a[44:47], v[28:31], v[60:63]
  v_max3_u32 v7, v7, v24, v28
  v_mfma_f32_16x16x32_bf16 v[72:75], a[168:171], v[28:31], v[72:75]
  s_waitcnt lgkmcnt(5)
  v_mfma_f32_16x16x32_bf16 v[76:79], a[172:175], v[28:31], v[76:79]
  v_mfma_f32_16x16x32_bf16 v[48:51], a[48:51], v[32:35], v[48:51]
  ds_read_b128 v[24:27], v5 offset:144
  v_mfma_f32_16x16x32_bf16 v[52:55], a[52:55], v[32:35], v[52:55]
  v_mfma_f32_16x16x32_bf16 v[64:67], a[176:179], v[32:35], v[64:67]
  s_add_u32 m0, s36, 4160
  s_add_u32 s31, s37, 4096
  v_mfma_f32_16x16x32_bf16 v[68:71], a[180:183], v[32:35], v[68:71]
  buffer_load_dwordx4 v4, s[8:11], s31 offen sc1 lds
  s_waitcnt lgkmcnt(5)
  v_mfma_f32_16x16x32_bf16 v[56:59], a[48:51], v[36:39], v[56:59]
  ds_read_b128 v[28:31], v5 offset:8464
  v_mfma_f32_16x16x32_bf16 v[60:63], a[52:55], v[36:39], v[60:63]
  v_max3_u32 v7, v7, v32, v36
  v_mfma_f32_16x16x32_bf16 v[72:75], a[176:179], v[36:39], v[72:75]
  s_waitcnt vmcnt(5)
  v_mfma_f32_16x16x32_bf16 v[76:79], a[180:183], v[36:39], v[76:79]
  s_mov_b64 exec, 1
  buffer_store_dword v9, v8, s[8:11], s43 offen sc1
  s_mov_b64 exec, -1
  s_waitcnt lgkmcnt(5)
  v_mfma_f32_16x16x32_bf16 v[48:51], a[56:59], v[40:43], v[48:51]
  ds_read_b128 v[32:35], v5 offset:160
  v_mfma_f32_16x16x32_bf16 v[52:55], a[60:63], v[40:43], v[52:55]
  v_mfma_f32_16x16x32_bf16 v[64:67], a[184:187], v[40:43], v[64:67]
  s_add_u32 m0, s36, 5200
  s_add_u32 s31, s37, 5120
  v_mfma_f32_16x16x32_bf16 v[68:71], a[188:191], v[40:43], v[68:71]
  buffer_load_dwordx4 v4, s[8:11], s31 offen sc1 lds
  s_waitcnt lgkmcnt(5)
  v_mfma_f32_16x16x32_bf16 v[56:59], a[56:59], v[44:47], v[56:59]
  ds_read_b128 v[36:39], v5 offset:8480
  v_mfma_f32_16x16x32_bf16 v[60:63], a[60:63], v[44:47], v[60:63]
  v_max3_u32 v7, v7, v40, v44
  v_mfma_f32_16x16x32_bf16 v[72:75], a[184:187], v[44:47], v[72:75]
  s_waitcnt lgkmcnt(5)
  v_mfma_f32_16x16x32_bf16 v[76:79], a[188:191], v[44:47], v[76:79]
  v_mfma_f32_16x16x32_bf16 v[48:51], a[64:67], v[16:19], v[48:51]
  ds_read_b128 v[40:43], v5 offset:176
  v_mfma_f32_16x16x32_bf16 v[52:55], a[68:71], v[16:19], v[52:55]
  v_mfma_f32_16x16x32_bf16 v[64:67], a[192:195], v[16:19], v[64:67]
  s_add_u32 m0, s36, 6240
  s_add_u32 s31, s37, 6144
  v_mfma_f32_16x16x32_bf16 v[68:71], a[196:199], v[16:19], v[68:71]
  buffer_load_dwordx4 v4, s[8:11], s31 offen sc1 lds
  s_waitcnt lgkmcnt(5)
  v_mfma_f32_16x16x32_bf16 v[56:59], a[64:67], v[20:23], v[56:59]
  ds_read_b128 v[44:47], v5 offset:8496
  v_mfma_f32_16x16x32_bf16 v[60:63], a[68:71], v[20:23], v[60:63]
  v_max3_u32 v7, v7, v16, v20
  v_mfma_f32_16x16x32_bf16 v[72:75], a[192:195], v[20:23], v[72:75]
  s_waitcnt lgkmcnt(5)
  v_mfma_f32_16x16x32_bf16 v[76:79], a[196:199], v[20:23], v[76:79]
  v_mfma_f32_16x16x32_bf16 v[48:51], a[72:75], v[24:27], v[48:51]
  ds_read_b128 v[16:19], v5 offset:192
  v_mfma_f32_16x16x32_bf16 v[52:55], a[76:79], v[24:27], v[52:55]
  v_mfma_f32_16x16x32_bf16 v[64:67], a[200:203], v[24:27], v[64:67]
  s_add_u32 m0, s36, 7280
  s_add_u32 s31, s37, 7168
  v_mfma_f32_16x16x32_bf16 v[68:71], a[204:207], v[24:27], v[68:71]
  buffer_load_dwordx4 v4, s[8:11], s31 offen sc1 lds
  s_waitcnt lgkmcnt(5)
  v_mfma_f32_16x16x32_bf16 v[56:59], a[72:75], v[28:31], v[56:59]
  ds_read_b128 v[20:23], v5 offset:8512
  v_mfma_f32_16x16x32_bf16 v[60:63], a[76:79], v[28:31], v[60:63]
  v_max3_u32 v7, v7, v24, v28
  v_mfma_f32_16x16x32_bf16 v[72:75], a[200:203], v[28:31], v[72:75]
  s_waitcnt lgkmcnt(5)
  v_mfma_f32_16x16x32_bf16 v[76:79], a[204:207], v[28:31], v[76:79]
  v_mfma_f32_16x16x32_bf16 v[48:51], a[80:83], v[32:35], v[48:51]
  ds_read_b128 v[24:27], v5 offset:208
  v_mfma_f32_16x16x32_bf16 v[52:55], a[84:87], v[32:35], v[52:55]
  v_mfma_f32_16x16x32_bf16 v[64:67], a[208:211], v[32:35], v[64:67]
  s_waitcnt lgkmcnt(5)
  v_mfma_f32_16x16x32_bf16 v[68:71], a[212:215], v[32:35], v[68:71]
  v_mfma_f32_16x16x32_bf16 v[56:59], a[80:83], v[36:39], v[56:59]
  ds_read_b128 v[28:31], v5 offset:8528
  v_mfma_f32_16x16x32_bf16 v[60:63], a[84:87], v[36:39], v[60:63]
  v_max3_u32 v7, v7, v32, v36
  v_mfma_f32_16x16x32_bf16 v[72:75], a[208:211], v[36:39], v[72:75]
  s_waitcnt lgkmcnt(5)
  v_mfma_f32_16x16x32_bf16 v[76:79], a[212:215], v[36:39], v[76:79]
  v_mfma_f32_16x16x32_bf16 v[48:51], a[88:91], v[40:43], v[48:51]
  ds_read_b128 v[32:35], v5 offset:224
  v_mfma_f32_16x16x32_bf16 v[52:55], a[92:95], v[40:43], v[52:55]
  v_mfma_f32_16x16x32_bf16 v[64:67], a[216:219], v[40:43], v[64:67]
  s_waitcnt lgkmcnt(5)
  v_mfma_f32_16x16x32_bf16 v[68:71], a[220:223], v[40:43], v[68:71]
  v_mfma_f32_16x16x32_bf16 v[56:59], a[88:91], v[44:47], v[56:59]
  ds_read_b128 v[36:39], v5 offset:8544
  v_mfma_f32_16x16x32_bf16 v[60:63], a[92:95], v[44:47], v[60:63]
  v_max3_u32 v7, v7, v40, v44
  v_mfma_f32_16x16x32_bf16 v[72:75], a[216:219], v[44:47], v[72:75]
  s_waitcnt lgkmcnt(5)
  v_mfma_f32_16x16x32_bf16 v[76:79], a[220:223], v[44:47], v[76:79]
  v_mfma_f32_16x16x32_bf16 v[48:51], a[96:99], v[16:19], v[48:51]
  ds_read_b128 v[40:43], v5 offset:240
  v_mfma_f32_16x16x32_bf16 v[52:55], a[100:103], v[16:19], v[52:55]
  v_mfma_f32_16x16x32_bf16 v[64:67], a[224:227], v[16:19], v[64:67]
  s_waitcnt lgkmcnt(5)
  v_mfma_f32_16x16x32_bf16 v[68:71], a[228:231], v[16:19], v[68:71]
  v_mfma_f32_16x16x32_bf16 v[56:59], a[96:99], v[20:23], v[56:59]
  ds_read_b128 v[44:47], v5 offset:8560
  v_mfma_f32_16x16x32_bf16 v[60:63], a[100:103], v[20:23], v[60:63]
  v_max3_u32 v7, v7, v16, v20
  v_mfma_f32_16x16x32_bf16 v[72:75], a[224:227], v[20:23], v[72:75]
  s_waitcnt lgkmcnt(5)
  v_mfma_f32_16x16x32_bf16 v[76:79], a[228:231], v[20:23], v[76:79]
  v_mfma_f32_16x16x32_bf16 v[48:51], a[104:107], v[24:27], v[48:51]
  v_mfma_f32_16x16x32_bf16 v[52:55], a[108:111], v[24:27], v[52:55]
  v_mfma_f32_16x16x32_bf16 v[64:67], a[232:235], v[24:27], v[64:67]
  s_waitcnt lgkmcnt(4)
  v_mfma_f32_16x16x32_bf16 v[68:71], a[236:239], v[24:27], v[68:71]
  v_mfma_f32_16x16x32_bf16 v[56:59], a[104:107], v[28:31], v[56:59]
  v_max3_u32 v7, v7, v24, v28
  v_mfma_f32_16x16x32_bf16 v[60:63], a[108:111], v[28:31], v[60:63]
  v_mfma_f32_16x16x32_bf16 v[72:75], a[232:235], v[28:31], v[72:75]
  s_waitcnt lgkmcnt(0)
  v_mfma_f32_16x16x32_bf16 v[76:79], a[236:239], v[28:31], v[76:79]
  v_mfma_f32_16x16x32_bf16 v[48:51], a[112:115], v[32:35], v[48:51]
  v_max3_u32 v7, v7, v32, v36
  v_mfma_f32_16x16x32_bf16 v[52:55], a[116:119], v[32:35], v[52:55]
  v_max3_u32 v7, v7, v40, v44
  v_mfma_f32_16x16x32_bf16 v[56:59], a[112:115], v[36:39], v[56:59]
  v_cmp_eq_u32 vcc, -1, v7
  v_mfma_f32_16x16x32_bf16 v[60:63], a[116:119], v[36:39], v[60:63]
  v_mfma_f32_16x16x32_bf16 v[48:51], a[120:123], v[40:43], v[48:51]
  v_mfma_f32_16x16x32_bf16 v[52:55], a[124:127], v[40:43], v[52:55]
  v_mfma_f32_16x16x32_bf16 v[56:59], a[120:123], v[44:47], v[56:59]
  v_mfma_f32_16x16x32_bf16 v[60:63], a[124:127], v[44:47], v[60:63]
  s_cbranch_vccnz qq_redo
  v_mfma_f32_16x16x32_bf16 v[64:67], a[240:243], v[32:35], v[64:67]
  v_cvt_pk_bf16_f32 v80, v48, v52
  v_cvt_pk_bf16_f32 v81, v49, v53
  v_mfma_f32_16x16x32_bf16 v[68:71], a[244:247], v[32:35], v[68:71]
  v_cvt_pk_bf16_f32 v82, v50, v54
  v_cvt_pk_bf16_f32 v83, v51, v55
  v_mfma_f32_16x16x32_bf16 v[72:75], a[240:243], v[36:39], v[72:75]
  buffer_store_dwordx4 v[80:83], v13, s[8:11], s38 offen offset:0 sc1
  v_cvt_pk_bf16_f32 v84, v56, v60
  v_cvt_pk_bf16_f32 v85, v57, v61
  v_mfma_f32_16x16x32_bf16 v[76:79], a[244:247], v[36:39], v[76:79]
  v_cvt_pk_bf16_f32 v86, v58, v62
  v_cvt_pk_bf16_f32 v87, v59, v63
  v_mfma_f32_16x16x32_bf16 v[64:67], a[248:251], v[40:43], v[64:67]
  buffer_store_dwordx4 v[84:87], v13, s[8:11], s38 offen offset:128 sc1
  v_mfma_f32_16x16x32_bf16 v[68:71], a[252:255], v[40:43], v[68:71]
  v_mfma_f32_16x16x32_bf16 v[72:75], a[248:251], v[44:47], v[72:75]
  v_mfma_f32_16x16x32_bf16 v[76:79], a[252:255], v[44:47], v[76:79]
  s_waitcnt vmcnt(2)
  ds_read2_b32 v[96:97], v12 offset1:16
  v_xor_b32 v5, 0x10000, v5
  v_cvt_pk_bf16_f32 v88, v64, v68
  v_cvt_pk_bf16_f32 v89, v65, v69
  v_cvt_pk_bf16_f32 v90, v66, v70
  v_cvt_pk_bf16_f32 v91, v67, v71
  buffer_store_dwordx4 v[88:91], v13, s[8:11], s39 offen offset:0 sc1
  v_cvt_pk_bf16_f32 v92, v72, v76
  v_cvt_pk_bf16_f32 v93, v73, v77
  v_cvt_pk_bf16_f32 v94, v74, v78
  v_cvt_pk_bf16_f32 v95, v75, v79
  buffer_store_dwordx4 v[92:95], v13, s[8:11], s39 offen offset:128 sc1
  s_waitcnt lgkmcnt(0)
  v_max_u32 v96, v96, v97
  v_cmp_eq_u32 s[64:65], -1, v96
  s_add_u32 s38, s38, 786432
  s_add_u32 s39, s39, 786432
  s_cmp_eq_u32 s21, 63
  s_cbranch_scc1 qkv_fin
  s_cmp_lg_u64 s[64:65], 0
  s_cbranch_scc0 qq_top
qq_w1:
  s_sub_u32 s3, s3, 1
  s_cbranch_scc1 bail_4
  s_and_b32 s31, s64, 0xff
  s_cbranch_scc0 xf_75
  s_add_u32 m0, s36, 0
  s_add_u32 s31, s37, 0
  buffer_load_dwordx4 v4, s[8:11], s31 offen sc1 lds
xf_75:
  s_and_b32 s31, s64, 0xff00
  s_cbranch_scc0 xf_76
  s_add_u32 m0, s36, 1040
  s_add_u32 s31, s37, 1024
  buffer_load_dwordx4 v4, s[8:11], s31 offen sc1 lds
xf_76:
  s_and_b32 s31, s64, 0xff0000
  s_cbranch_scc0 xf_77
  s_add_u32 m0, s36, 2080
  s_add_u32 s31, s37, 2048
  buffer_load_dwordx4 v4, s[8:11], s31 offen sc1 lds
xf_77:
  s_and_b32 s31, s64, 0xff000000
  s_cbranch_scc0 xf_78
  s_add_u32 m0, s36, 3120
  s_add_u32 s31, s37, 3072
  buffer_load_dwordx4 v4, s[8:11], s31 offen sc1 lds
xf_78:
  s_and_b32 s31, s65, 0xff
  s_cbranch_scc0 xf_79
  s_add_u32 m0, s36, 4160
  s_add_u32 s31, s37, 4096
  buffer_load_dwordx4 v4, s[8:11], s31 offen sc1 lds
xf_79:
  s_and_b32 s31, s65, 0xff00
  s_cbranch_scc0 xf_80
  s_add_u32 m0, s36, 5200
  s_add_u32 s31, s37, 5120
  buffer_load_dwordx4 v4, s[8:11], s31 offen sc1 lds
xf_80:
  s_and_b32 s31, s65, 0xff0000
  s_cbranch_scc0 xf_81
  s_add_u32 m0, s36, 6240
  s_add_u32 s31, s37, 6144
  buffer_load_dwordx4 v4, s[8:11], s31 offen sc1 lds
xf_81:
  s_and_b32 s31, s65, 0xff000000
  s_cbranch_scc0 xf_82
  s_add_u32 m0, s36, 7280
  s_add_u32 s31, s37, 7168
  buffer_load_dwordx4 v4, s[8:11], s31 offen sc1 lds
xf_82:
  s_waitcnt vmcnt(0)
  ds_read2_b32 v[96:97], v12 offset1:16
  s_waitcnt lgkmcnt(0)
  v_max_u32 v96, v96, v97
  v_cmp_eq_u32 s[64:65], -1, v96
  s_cmp_lg_u64 s[64:65], 0
  s_cselect_b32 s22, 1, 0
  s_add_u32 s31, s21, 1
  v_mov_b32 v9, s31
  s_mov_b64 exec, 1
  buffer_store_dword v9, v8, s[8:11], s43 offen sc1
  s_mov_b64 exec, -1
  s_cmp_eq_u32 s22, 1
  s_cbranch_scc1 qq_wait
  s_branch qq_top
qq_redo:
  s_sub_u32 s3, s3, 1
  s_cbranch_scc1 bail_7
  s_waitcnt lgkmcnt(0)
  s_barrier
  s_sub_u32 s32, s37, s40
  s_xor_b32 s31, s36, 0x10000
  s_add_u32 m0, s31, 0
  s_add_u32 s31, s32, 0
  buffer_load_dwordx4 v4, s[8:11], s31 offen sc1 lds
  s_xor_b32 s31, s36, 0x10000
  s_add_u32 m0, s31, 1040
  s_add_u32 s31, s32, 1024
  buffer_load_dwordx4 v4, s[8:11], s31 offen sc1 lds
  s_xor_b32 s31, s36, 0x10000
  s_add_u32 m0, s31, 2080
  s_add_u32 s31, s32, 2048
  buffer_load_dwordx4 v4, s[8:11], s31 offen sc1 lds
  s_xor_b32 s31, s36, 0x10000
  s_add_u32 m0, s31, 3120
  s_add_u32 s31, s32, 3072
  buffer_load_dwordx4 v4, s[8:11], s31 offen sc1 lds
  s_xor_b32 s31, s36, 0x10000
  s_add_u32 m0, s31, 4160
  s_add_u32 s31, s32, 4096
  buffer_load_dwordx4 v4, s[8:11], s31 offen sc1 lds
  s_xor_b32 s31, s36, 0x10000
  s_add_u32 m0, s31, 5200
  s_add_u32 s31, s32, 5120
  buffer_load_dwordx4 v4, s[8:11], s31 offen sc1 lds
  s_xor_b32 s31, s36, 0x10000
  s_add_u32 m0, s31, 6240
  s_add_u32 s31, s32, 6144
  buffer_load_dwordx4 v4, s[8:11], s31 offen sc1 lds
  s_xor_b32 s31, s36, 0x10000
  s_add_u32 m0, s31, 7280
  s_add_u32 s31, s32, 7168
  buffer_load_dwordx4 v4, s[8:11], s31 offen sc1 lds
  s_waitcnt vmcnt(0)
  s_branch qq_again
qkv_fin:
  s_waitcnt vmcnt(0)
  s_add_u32 s31, s21, 1
  v_mov_b32 v9, s31
  s_mov_b64 exec, 1
  buffer_store_dword v9, v8, s[8:11], s43 offen sc1
  s_mov_b64 exec, -1
  s_branch the_end
role_ffn:
  s_lshr_b32 s7, s6, 4
  s_and_b32 s35, s6, 15
  s_cmp_ge_u32 s35, 11
  s_cbranch_scc1 ffn_R
  s_lshl_b32 s31, s7, 21
  s_and_b32 s32, s6, 15
  s_mul_i32 s32, s32, 98304
  s_add_u32 s31, s31, s32
  s_add_u32 s31, s31, 18874368
  s_lshl_b32 s32, s4, 10
  v_lshl_add_u32 v3, v1, 4, s32
  v_mov_b32 v4, 0
  v_mov_b32 v5, 0
  v_mov_b32 v6, 0
  v_mov_b32 v7, 0
dm_86:
  v_and_b32 v11, 15, v1
  v_lshlrev_b32 v11, 2, v11
  v_add_u32 v10, 128, v11
  v_cmp_gt_u32 vcc, 4, v11
  s_nop 1
  v_cndmask_b32 v11, v10, v11, vcc
  buffer_load_dword v10, v11, s[24:27], 0 offen sc1
  s_waitcnt vmcnt(0)
  v_readlane_b32 s34, v10, s5
  s_nop 0
  s_cmp_ge_u32 s34, 32
  s_cbranch_scc1 dmf_87
  v_readlane_b32 s33, v10, 0
  v_readlane_b32 s34, v10, 1
  s_nop 0
  s_add_u32 s33, s33, s34
  v_readlane_b32 s34, v10, 2
  s_nop 0
  s_add_u32 s33, s33, s34
  v_readlane_b32 s34, v10, 3
  s_nop 0
  s_add_u32 s33, s33, s34
  v_readlane_b32 s34, v10, 4
  s_nop 0
  s_add_u32 s33, s33, s34
  v_readlane_b32 s34, v10, 5
  s_nop 0
  s_add_u32 s33, s33, s34
  v_readlane_b32 s34, v10, 6
  s_nop 0
  s_add_u32 s33, s33, s34
  v_readlane_b32 s34, v10, 7
  s_nop 0
  s_add_u32 s33, s33, s34
  v_readlane_b32 s34, v10, 8
  s_nop 0
  s_add_u32 s33, s33, s34
  v_readlane_b32 s34, v10, 9
  s_nop 0
  s_add_u32 s33, s33, s34
  v_readlane_b32 s34, v10, 10
  s_nop 0
  s_add_u32 s33, s33, s34
  v_readlane_b32 s34, v10, 11
  s_nop 0
  s_add_u32 s33, s33, s34
  v_readlane_b32 s34, v10, 12
  s_nop 0
  s_add_u32 s33, s33, s34
  v_readlane_b32 s34, v10, 13
  s_nop 0
  s_add_u32 s33, s33, s34
  v_readlane_b32 s34, v10, 14
  s_nop 0
  s_add_u32 s33, s33, s34
  v_readlane_b32 s34, v10, 15
  s_nop 0
  s_add_u32 s33, s33, s34
  s_cmp_ge_u32 s33, 256
  s_cbranch_scc1 ri_83
  s_sub_u32 s3, s3, 1
  s_cbranch_scc1 bail_2
  s_sleep 8
  s_branch dm_86
dmf_87:
  buffer_store_dwordx4 v[4:7], v3, s[8:11], s31 offen
  s_add_u32 s31, s31, 4096
  buffer_store_dwordx4 v[4:7], v3, s[8:11], s31 offen
  s_add_u32 s31, s31, 4096
  buffer_store_dwordx4 v[4:7], v3, s[8:11], s31 offen
  s_add_u32 s31, s31, 4096
  buffer_store_dwordx4 v[4:7], v3, s[8:11], s31 offen
  s_add_u32 s31, s31, 4096
  buffer_store_dwordx4 v[4:7], v3, s[8:11], s31 offen
  s_add_u32 s31, s31, 4096
  buffer_store_dwordx4 v[4:7], v3, s[8:11], s31 offen
  s_add_u32 s31, s31, 4096
  buffer_store_dwordx4 v[4:7], v3, s[8:11], s31 offen
  s_add_u32 s31, s31, 4096
  buffer_store_dwordx4 v[4:7], v3, s[8:11], s31 offen
  s_add_u32 s31, s31, 4096
  buffer_store_dwordx4 v[4:7], v3, s[8:11], s31 offen
  s_add_u32 s31, s31, 4096
  buffer_store_dwordx4 v[4:7], v3, s[8:11], s31 offen
  s_add_u32 s31, s31, 4096
  buffer_store_dwordx4 v[4:7], v3, s[8:11], s31 offen
  s_add_u32 s31, s31, 4096
  buffer_store_dwordx4 v[4:7], v3, s[8:11], s31 offen
  s_add_u32 s31, s31, 4096
  buffer_store_dwordx4 v[4:7], v3, s[8:11], s31 offen
  s_add_u32 s31, s31, 4096
  buffer_store_dwordx4 v[4:7], v3, s[8:11], s31 offen
  s_add_u32 s31, s31, 4096
  buffer_store_dwordx4 v[4:7], v3, s[8:11], s31 offen
  s_add_u32 s31, s31, 4096
  buffer_store_dwordx4 v[4:7], v3, s[8:11], s31 offen
  s_add_u32 s31, s31, 4096
  buffer_store_dwordx4 v[4:7], v3, s[8:11], s31 offen
  s_add_u32 s31, s31, 4096
  buffer_store_dwordx4 v[4:7], v3, s[8:11], s31 offen
  s_add_u32 s31, s31, 4096
  buffer_store_dwordx4 v[4:7], v3, s[8:11], s31 offen
  s_add_u32 s31, s31, 4096
  buffer_store_dwordx4 v[4:7], v3, s[8:11], s31 offen
  s_add_u32 s31, s31, 4096
  buffer_store_dwordx4 v[4:7], v3, s[8:11], s31 offen
  s_add_u32 s31, s31, 4096
  buffer_store_dwordx4 v[4:7], v3, s[8:11], s31 offen
  s_add_u32 s31, s31, 4096
  buffer_store_dwordx4 v[4:7], v3, s[8:11], s31 offen
  s_add_u32 s31, s31, 4096
  buffer_store_dwordx4 v[4:7], v3, s[8:11], s31 offen
  s_add_u32 s31, s31, 4096
  s_branch rie_84
ri_83:
  buffer_store_dwordx4 v[4:7], v3, s[8:11], s31 offen sc1
  s_add_u32 s31, s31, 4096
  buffer_store_dwordx4 v[4:7], v3, s[8:11], s31 offen sc1
  s_add_u32 s31, s31, 4096
  buffer_store_dwordx4 v[4:7], v3, s[8:11], s31 offen sc1
  s_add_u32 s31, s31, 4096
  buffer_store_dwordx4 v[4:7], v3, s[8:11], s31 offen sc1
  s_add_u32 s31, s31, 4096
  buffer_store_dwordx4 v[4:7], v3, s[8:11], s31 offen sc1
  s_add_u32 s31, s31, 4096
  buffer_store_dwordx4 v[4:7], v3, s[8:11], s31 offen sc1
  s_add_u32 s31, s31, 4096
  buffer_store_dwordx4 v[4:7], v3, s[8:11], s31 offen sc1
  s_add_u32 s31, s31, 4096
  buffer_store_dwordx4 v[4:7], v3, s[8:11], s31 offen sc1
  s_add_u32 s31, s31, 4096
  buffer_store_dwordx4 v[4:7], v3, s[8:11], s31 offen sc1
  s_add_u32 s31, s31, 4096
  buffer_store_dwordx4 v[4:7], v3, s[8:11], s31 offen sc1
  s_add_u32 s31, s31, 4096
  buffer_store_dwordx4 v[4:7], v3, s[8:11], s31 offen sc1
  s_add_u32 s31, s31, 4096
  buffer_store_dwordx4 v[4:7], v3, s[8:11], s31 offen sc1
  s_add_u32 s31, s31, 4096
  buffer_store_dwordx4 v[4:7], v3, s[8:11], s31 offen sc1
  s_add_u32 s31, s31, 4096
  buffer_store_dwordx4 v[4:7], v3, s[8:11], s31 offen sc1
  s_add_u32 s31, s31, 4096
  buffer_store_dwordx4 v[4:7], v3, s[8:11], s31 offen sc1
  s_add_u32 s31, s31, 4096
  buffer_store_dwordx4 v[4:7], v3, s[8:11], s31 offen sc1
  s_add_u32 s31, s31, 4096
  buffer_store_dwordx4 v[4:7], v3, s[8:11], s31 offen sc1
  s_add_u32 s31, s31, 4096
  buffer_store_dwordx4 v[4:7], v3, s[8:11], s31 offen sc1
  s_add_u32 s31, s31, 4096
  buffer_store_dwordx4 v[4:7], v3, s[8:11], s31 offen sc1
  s_add_u32 s31, s31, 4096
  buffer_store_dwordx4 v[4:7], v3, s[8:11], s31 offen sc1
  s_add_u32 s31, s31, 4096
  buffer_store_dwordx4 v[4:7], v3, s[8:11], s31 offen sc1
  s_add_u32 s31, s31, 4096
  buffer_store_dwordx4 v[4:7], v3, s[8:11], s31 offen sc1
  s_add_u32 s31, s31, 4096
  buffer_store_dwordx4 v[4:7], v3, s[8:11], s31 offen sc1
  s_add_u32 s31, s31, 4096
  buffer_store_dwordx4 v[4:7], v3, s[8:11], s31 offen sc1
  s_add_u32 s31, s31, 4096
rie_84:
  s_waitcnt vmcnt(0)
  s_barrier
  s_cmp_eq_u32 s4, 0
  s_cbranch_scc0 rid_85
  s_mov_b64 exec, 1
  v_mov_b32 v8, 1
  buffer_atomic_add v8, off, s[24:27], 0 offset:196 sc0 sc1
  s_waitcnt vmcnt(0)
  v_cmp_eq_u32 vcc, 95, v8
  s_cbranch_vccz ci_88
  v_mov_b32 v8, 1
  buffer_store_dword v8, off, s[24:27], 0 offset:84 sc1
ci_88:
  s_mov_b64 exec, -1
rid_85:
  s_mov_b32 s12, s80
  s_mov_b32 s13, s81
  s_mov_b32 s14, 1409024
  s_mov_b32 s15, 0x20000
  s_mov_b32 s16, s82
  s_mov_b32 s17, s83
  s_mov_b32 s18, 1409024
  s_mov_b32 s19, 0x20000
  s_lshl_b32 s33, s35, 2
  s_add_u32 s33, s33, s4
  s_lshl_b32 s50, s33, 6
  s_cmp_eq_u32 s33, 43
  s_cselect_b32 s50, 0x200000, s50
  v_lshrrev_b32 v2, 2, v1
  v_mul_u32_u24 v2, 2752, v2
  v_and_b32 v3, 3, v1
  v_lshl_add_u32 v2, v3, 4, v2
  s_mul_i32 s52, s4, 40960
  v_lshrrev_b32 v3, 5, v1
  v_lshlrev_b32 v3, 9, v3
  v_bfe_u32 v4, v1, 2, 2
  v_lshl_add_u32 v3, v4, 6, v3
  v_bfe_u32 v4, v1, 4, 1
  v_lshl_add_u32 v3, v4, 5, v3
  v_and_b32 v4, 3, v1
  v_lshl_add_u32 v3, v4, 3, v3
  v_add_u32 v3, s52, v3
  s_add_u32 m0, s52, 0
  s_nop 0
  buffer_load_dwordx4 v2, s[12:15], s50 offen lds
  s_add_u32 s50, s50, 44032
  s_add_u32 m0, s52, 1024
  s_nop 0
  buffer_load_dwordx4 v2, s[12:15], s50 offen lds
  s_add_u32 s50, s50, 44032
  s_add_u32 m0, s52, 2048
  s_nop 0
  buffer_load_dwordx4 v2, s[12:15], s50 offen lds
  s_add_u32 s50, s50, 44032
  s_add_u32 m0, s52, 3072
  s_nop 0
  buffer_load_dwordx4 v2, s[12:15], s50 offen lds
  s_add_u32 s50, s50, 44032
  s_add_u32 m0, s52, 4096
  s_nop 0
  buffer_load_dwordx4 v2, s[12:15], s50 offen lds
  s_add_u32 s50, s50, 44032
  s_add_u32 m0, s52, 5120
  s_nop 0
  buffer_load_dwordx4 v2, s[12:15], s50 offen lds
  s_add_u32 s50, s50, 44032
  s_add_u32 m0, s52, 6144
  s_nop 0
  buffer_load_dwordx4 v2, s[12:15], s50 offen lds
  s_add_u32 s50, s50, 44032
  s_add_u32 m0, s52, 7168
  s_nop 0
  buffer_load_dwordx4 v2, s[12:15], s50 offen lds
  s_add_u32 s50, s50, 44032
  s_add_u32 m0, s52, 8192
  s_nop 0
  buffer_load_dwordx4 v2, s[12:15], s50 offen lds
  s_add_u32 s50, s50, 44032
  s_add_u32 m0, s52, 9216
  s_nop 0
  buffer_load_dwordx4 v2, s[12:15], s50 offen lds
  s_add_u32 s50, s50, 44032
  s_add_u32 m0, s52, 10240
  s_nop 0
  buffer_load_dwordx4 v2, s[12:15], s50 offen lds
  s_add_u32 s50, s50, 44032
  s_add_u32 m0, s52, 11264
  s_nop 0
  buffer_load_dwordx4 v2, s[12:15], s50 offen lds
  s_add_u32 s50, s50, 44032
  s_add_u32 m0, s52, 12288
  s_nop 0
  buffer_load_dwordx4 v2, s[12:15], s50 offen lds
  s_add_u32 s50, s50, 44032
  s_add_u32 m0, s52, 13312
  s_nop 0
  buffer_load_dwordx4 v2, s[12:15], s50 offen lds
  s_add_u32 s50, s50, 44032
  s_add_u32 m0, s52, 14336
  s_nop 0
  buffer_load_dwordx4 v2, s[12:15], s50 offen lds
  s_add_u32 s50, s50, 44032
  s_add_u32 m0, s52, 15360
  s_nop 0
  buffer_load_dwordx4 v2, s[12:15], s50 offen lds
  s_add_u32 s50, s50, 44032
  s_add_u32 m0, s52, 16384
  s_nop 0
  buffer_load_dwordx4 v2, s[12:15], s50 offen lds
  s_add_u32 s50, s50, 44032
  s_add_u32 m0, s52, 17408
  s_nop 0
  buffer_load_dwordx4 v2, s[12:15], s50 offen lds
  s_add_u32 s50, s50, 44032
  s_add_u32 m0, s52, 18432
  s_nop 0
  buffer_load_dwordx4 v2, s[12:15], s50 offen lds
  s_add_u32 s50, s50, 44032
  s_add_u32 m0, s52, 19456
  s_nop 0
  buffer_load_dwordx4 v2, s[12:15], s50 offen lds
  s_add_u32 s50, s50, 44032
  s_add_u32 m0, s52, 20480
  s_nop 0
  buffer_load_dwordx4 v2, s[12:15], s50 offen lds
  s_add_u32 s50, s50, 44032
  s_add_u32 m0, s52, 21504
  s_nop 0
  buffer_load_dwordx4 v2, s[12:15], s50 offen lds
  s_add_u32 s50, s50, 44032
  s_add_u32 m0, s52, 22528
  s_nop 0
  buffer_load_dwordx4 v2, s[12:15], s50 offen lds
  s_add_u32 s50, s50, 44032
  s_add_u32 m0, s52, 23552
  s_nop 0
  buffer_load_dwordx4 v2, s[12:15], s50 offen lds
  s_add_u32 s50, s50, 44032
  s_add_u32 m0, s52, 24576
  s_nop 0
  buffer_load_dwordx4 v2, s[12:15], s50 offen lds
  s_add_u32 s50, s50, 44032
  s_add_u32 m0, s52, 25600
  s_nop 0
  buffer_load_dwordx4 v2, s[12:15], s50 offen lds
  s_add_u32 s50, s50, 44032
  s_add_u32 m0, s52, 26624
  s_nop 0
  buffer_load_dwordx4 v2, s[12:15], s50 offen lds
  s_add_u32 s50, s50, 44032
  s_add_u32 m0, s52, 27648
  s_nop 0
  buffer_load_dwordx4 v2, s[12:15], s50 offen lds
  s_add_u32 s50, s50, 44032
  s_add_u32 m0, s52, 28672
  s_nop 0
  buffer_load_dwordx4 v2, s[12:15], s50 offen lds
  s_add_u32 s50, s50, 44032
  s_add_u32 m0, s52, 29696
  s_nop 0
  buffer_load_dwordx4 v2, s[12:15], s50 offen lds
  s_add_u32 s50, s50, 44032
  s_add_u32 m0, s52, 30720
  s_nop 0
  buffer_load_dwordx4 v2, s[12:15], s50 offen lds
  s_add_u32 s50, s50, 44032
  s_add_u32 m0, s52, 31744
  s_nop 0
  buffer_load_dwordx4 v2, s[12:15], s50 offen lds
  s_add_u32 s50, s50, 44032
  s_waitcnt vmcnt(31)
  ds_read_b64_tr_b16 a[0:1], v3 offset:0
  ds_read_b64_tr_b16 a[2:3], v3 offset:256
  s_waitcnt vmcnt(30)
  ds_read_b64_tr_b16 a[4:5], v3 offset:1024
  ds_read_b64_tr_b16 a[6:7], v3 offset:1280
  s_waitcnt vmcnt(29)
  ds_read_b64_tr_b16 a[8:9], v3 offset:2048
  ds_read_b64_tr_b16 a[10:11], v3 offset:2304
  s_waitcnt vmcnt(28)
  ds_read_b64_tr_b16 a[12:13], v3 offset:3072
  ds_read_b64_tr_b16 a[14:15], v3 offset:3328
  s_waitcnt vmcnt(27)
  ds_read_b64_tr_b16 a[16:17], v3 offset:4096
  ds_read_b64_tr_b16 a[18:19], v3 offset:4352
  s_waitcnt vmcnt(26)
  ds_read_b64_tr_b16 a[20:21], v3 offset:5120
  ds_read_b64_tr_b16 a[22:23], v3 offset:5376
  s_waitcnt vmcnt(25)
  ds_read_b64_tr_b16 a[24:25], v3 offset:6144
  ds_read_b64_tr_b16 a[26:27], v3 offset:6400
  s_waitcnt vmcnt(24)
  ds_read_b64_tr_b16 a[28:29], v3 offset:7168
  ds_read_b64_tr_b16 a[30:31], v3 offset:7424
  s_waitcnt vmcnt(23)
  ds_read_b64_tr_b16 a[32:33], v3 offset:8192
  ds_read_b64_tr_b16 a[34:35], v3 offset:8448
  s_waitcnt vmcnt(22)
  ds_read_b64_tr_b16 a[36:37], v3 offset:9216
  ds_read_b64_tr_b16 a[38:39], v3 offset:9472
  s_waitcnt vmcnt(21)
  ds_read_b64_tr_b16 a[40:41], v3 offset:10240
  ds_read_b64_tr_b16 a[42:43], v3 offset:10496
  s_waitcnt vmcnt(20)
  ds_read_b64_tr_b16 a[44:45], v3 offset:11264
  ds_read_b64_tr_b16 a[46:47], v3 offset:11520
  s_waitcnt vmcnt(19)
  ds_read_b64_tr_b16 a[48:49], v3 offset:12288
  ds_read_b64_tr_b16 a[50:51], v3 offset:12544
  s_waitcnt vmcnt(18)
  ds_read_b64_tr_b16 a[52:53], v3 offset:13312
  ds_read_b64_tr_b16 a[54:55], v3 offset:13568
  s_waitcnt vmcnt(17)
  ds_read_b64_tr_b16 a[56:57], v3 offset:14336
  ds_read_b64_tr_b16 a[58:59], v3 offset:14592
  s_waitcnt vmcnt(16)
  ds_read_b64_tr_b16 a[60:61], v3 offset:15360
  ds_read_b64_tr_b16 a[62:63], v3 offset:15616
  s_waitcnt vmcnt(15)
  ds_read_b64_tr_b16 a[64:65], v3 offset:16384
  ds_read_b64_tr_b16 a[66:67], v3 offset:16640
  s_waitcnt vmcnt(14)
  ds_read_b64_tr_b16 a[68:69], v3 offset:17408
  ds_read_b64_tr_b16 a[70:71], v3 offset:17664
  s_waitcnt vmcnt(13)
  ds_read_b64_tr_b16 a[72:73], v3 offset:18432
  ds_read_b64_tr_b16 a[74:75], v3 offset:18688
  s_waitcnt vmcnt(12)
  ds_read_b64_tr_b16 a[76:77], v3 offset:19456
  ds_read_b64_tr_b16 a[78:79], v3 offset:19712
  s_waitcnt vmcnt(11)
  ds_read_b64_tr_b16 a[80:81], v3 offset:20480
  ds_read_b64_tr_b16 a[82:83], v3 offset:20736
  s_waitcnt vmcnt(10)
  ds_read_b64_tr_b16 a[84:85], v3 offset:21504
  ds_read_b64_tr_b16 a[86:87], v3 offset:21760
  s_waitcnt vmcnt(9)
  ds_read_b64_tr_b16 a[88:89], v3 offset:22528
  ds_read_b64_tr_b16 a[90:91], v3 offset:22784
  s_waitcnt vmcnt(8)
  ds_read_b64_tr_b16 a[92:93], v3 offset:23552
  ds_read_b64_tr_b16 a[94:95], v3 offset:23808
  s_waitcnt vmcnt(7)
  ds_read_b64_tr_b16 a[96:97], v3 offset:24576
  ds_read_b64_tr_b16 a[98:99], v3 offset:24832
  s_waitcnt vmcnt(6)
  ds_read_b64_tr_b16 a[100:101], v3 offset:25600
  ds_read_b64_tr_b16 a[102:103], v3 offset:25856
  s_waitcnt vmcnt(5)
  ds_read_b64_tr_b16 a[104:105], v3 offset:26624
  ds_read_b64_tr_b16 a[106:107], v3 offset:26880
  s_waitcnt vmcnt(4)
  ds_read_b64_tr_b16 a[108:109], v3 offset:27648
  ds_read_b64_tr_b16 a[110:111], v3 offset:27904
  s_waitcnt vmcnt(3)
  ds_read_b64_tr_b16 a[112:113], v3 offset:28672
  ds_read_b64_tr_b16 a[114:115], v3 offset:28928
  s_waitcnt vmcnt(2)
  ds_read_b64_tr_b16 a[116:117], v3 offset:29696
  ds_read_b64_tr_b16 a[118:119], v3 offset:29952
  s_waitcnt vmcnt(1)
  ds_read_b64_tr_b16 a[120:121], v3 offset:30720
  ds_read_b64_tr_b16 a[122:123], v3 offset:30976
  s_waitcnt vmcnt(0)
  ds_read_b64_tr_b16 a[124:125], v3 offset:31744
  ds_read_b64_tr_b16 a[126:127], v3 offset:32000
  s_waitcnt lgkmcnt(0)
  s_lshl_b32 s37, s35, 17
  s_lshl_b32 s33, s4, 8
  s_add_u32 s37, s37, s33
  s_xor_b32 s33, s4, 0
  s_lshl_b32 s33, s33, 15
  s_add_u32 s40, s37, s33
  s_xor_b32 s33, s4, 1
  s_lshl_b32 s33, s33, 15
  s_add_u32 s41, s37, s33
  s_xor_b32 s33, s4, 2
  s_lshl_b32 s33, s33, 15
  s_add_u32 s42, s37, s33
  s_xor_b32 s33, s4, 3
  s_lshl_b32 s33, s33, 15
  s_add_u32 s43, s37, s33
  v_bfe_u32 v4, v1, 4, 1
  v_lshlrev_b32 v4, 14, v4
  v_lshrrev_b32 v5, 5, v1
  v_lshl_add_u32 v4, v5, 12, v4
  v_and_b32 v5, 15, v1
  v_lshl_add_u32 v4, v5, 4, v4
  s_mov_b32 s58, 0x05040100
  s_mov_b32 s59, 0x07060302
  s_add_u32 s33, s40, 0
  buffer_load_dwordx4 v[16:19], v4, s[16:19], s33 offen
  s_add_u32 s33, s40, 1024
  buffer_load_dwordx4 v[20:23], v4, s[16:19], s33 offen
  s_add_u32 s33, s40, 2048
  buffer_load_dwordx4 v[24:27], v4, s[16:19], s33 offen
  s_add_u32 s33, s40, 3072
  buffer_load_dwordx4 v[28:31], v4, s[16:19], s33 offen
  s_add_u32 s33, s40, 8192
  buffer_load_dwordx4 v[32:35], v4, s[16:19], s33 offen
  s_add_u32 s33, s40, 9216
  buffer_load_dwordx4 v[36:39], v4, s[16:19], s33 offen
  s_add_u32 s33, s40, 10240
  buffer_load_dwordx4 v[40:43], v4, s[16:19], s33 offen
  s_add_u32 s33, s40, 11264
  buffer_load_dwordx4 v[44:47], v4, s[16:19], s33 offen
  s_add_u32 s33, s41, 0
  buffer_load_dwordx4 v[48:51], v4, s[16:19], s33 offen
  s_add_u32 s33, s41, 1024
  buffer_load_dwordx4 v[52:55], v4, s[16:19], s33 offen
  s_add_u32 s33, s41, 2048
  buffer_load_dwordx4 v[56:59], v4, s[16:19], s33 offen
  s_add_u32 s33, s41, 3072
  buffer_load_dwordx4 v[60:63], v4, s[16:19], s33 offen
  s_add_u32 s33, s41, 8192
  buffer_load_dwordx4 v[64:67], v4, s[16:19], s33 offen
  s_add_u32 s33, s41, 9216
  buffer_load_dwordx4 v[68:71], v4, s[16:19], s33 offen
  s_add_u32 s33, s41, 10240
  buffer_load_dwordx4 v[72:75], v4, s[16:19], s33 offen
  s_add_u32 s33, s41, 11264
  buffer_load_dwordx4 v[76:79], v4, s[16:19], s33 offen
  s_add_u32 s33, s42, 0
  buffer_load_dwordx4 v[80:83], v4, s[16:19], s33 offen
  s_add_u32 s33, s42, 1024
  buffer_load_dwordx4 v[84:87], v4, s[16:19], s33 offen
  s_add_u32 s33, s42, 2048
  buffer_load_dwordx4 v[88:91], v4, s[16:19], s33 offen
  s_add_u32 s33, s42, 3072
  buffer_load_dwordx4 v[92:95], v4, s[16:19], s33 offen
  s_add_u32 s33, s42, 8192
  buffer_load_dwordx4 v[96:99], v4, s[16:19], s33 offen
  s_add_u32 s33, s42, 9216
  buffer_load_dwordx4 v[100:103], v4, s[16:19], s33 offen
  s_add_u32 s33, s42, 10240
  buffer_load_dwordx4 v[104:107], v4, s[16:19], s33 offen
  s_add_u32 s33, s42, 11264
  buffer_load_dwordx4 v[108:111], v4, s[16:19], s33 offen
  s_add_u32 s33, s43, 0
  buffer_load_dwordx4 v[112:115], v4, s[16:19], s33 offen
  s_add_u32 s33, s43, 1024
  buffer_load_dwordx4 v[116:119], v4, s[16:19], s33 offen
  s_add_u32 s33, s43, 2048
  buffer_load_dwordx4 v[120:123], v4, s[16:19], s33 offen
  s_add_u32 s33, s43, 3072
  buffer_load_dwordx4 v[124:127], v4, s[16:19], s33 offen
  s_add_u32 s33, s43, 8192
  buffer_load_dwordx4 v[128:131], v4, s[16:19], s33 offen
  s_add_u32 s33, s43, 9216
  buffer_load_dwordx4 v[132:135], v4, s[16:19], s33 offen
  s_add_u32 s33, s43, 10240
  buffer_load_dwordx4 v[136:139], v4, s[16:19], s33 offen
  s_add_u32 s33, s43, 11264
  buffer_load_dwordx4 v[140:143], v4, s[16:19], s33 offen
  s_waitcnt vmcnt(24)
  v_perm_b32 v144, v20, v16, s58
  v_accvgpr_write_b32 a128, v144
  v_perm_b32 v145, v28, v24, s58
  v_accvgpr_write_b32 a129, v145
  v_perm_b32 v144, v36, v32, s58
  v_accvgpr_write_b32 a130, v144
  v_perm_b32 v145, v44, v40, s58
  v_accvgpr_write_b32 a131, v145
  v_perm_b32 v144, v20, v16, s59
  v_accvgpr_write_b32 a144, v144
  v_perm_b32 v145, v28, v24, s59
  v_accvgpr_write_b32 a145, v145
  v_perm_b32 v144, v36, v32, s59
  v_accvgpr_write_b32 a146, v144
  v_perm_b32 v145, v44, v40, s59
  v_accvgpr_write_b32 a147, v145
  v_perm_b32 v144, v21, v17, s58
  v_accvgpr_write_b32 a160, v144
  v_perm_b32 v145, v29, v25, s58
  v_accvgpr_write_b32 a161, v145
  v_perm_b32 v144, v37, v33, s58
  v_accvgpr_write_b32 a162, v144
  v_perm_b32 v145, v45, v41, s58
  v_accvgpr_write_b32 a163, v145
  v_perm_b32 v144, v21, v17, s59
  v_accvgpr_write_b32 a176, v144
  v_perm_b32 v145, v29, v25, s59
  v_accvgpr_write_b32 a177, v145
  v_perm_b32 v144, v37, v33, s59
  v_accvgpr_write_b32 a178, v144
  v_perm_b32 v145, v45, v41, s59
  v_accvgpr_write_b32 a179, v145
  v_perm_b32 v144, v22, v18, s58
  v_accvgpr_write_b32 a192, v144
  v_perm_b32 v145, v30, v26, s58
  v_accvgpr_write_b32 a193, v145
  v_perm_b32 v144, v38, v34, s58
  v_accvgpr_write_b32 a194, v144
  v_perm_b32 v145, v46, v42, s58
  v_accvgpr_write_b32 a195, v145
  v_perm_b32 v144, v22, v18, s59
  v_accvgpr_write_b32 a208, v144
  v_perm_b32 v145, v30, v26, s59
  v_accvgpr_write_b32 a209, v145
  v_perm_b32 v144, v38, v34, s59
  v_accvgpr_write_b32 a210, v144
  v_perm_b32 v145, v46, v42, s59
  v_accvgpr_write_b32 a211, v145
  v_perm_b32 v144, v23, v19, s58
  v_accvgpr_write_b32 a224, v144
  v_perm_b32 v145, v31, v27, s58
  v_accvgpr_write_b32 a225, v145
  v_perm_b32 v144, v39, v35, s58
  v_accvgpr_write_b32 a226, v144
  v_perm_b32 v145, v47, v43, s58
  v_accvgpr_write_b32 a227, v145
  v_perm_b32 v144, v23, v19, s59
  v_accvgpr_write_b32 a240, v144
  v_perm_b32 v145, v31, v27, s59
  v_accvgpr_write_b32 a241, v145
  v_perm_b32 v144, v39, v35, s59
  v_accvgpr_write_b32 a242, v144
  v_perm_b32 v145, v47, v43, s59
  v_accvgpr_write_b32 a243, v145
  s_waitcnt vmcnt(16)
  v_perm_b32 v144, v52, v48, s58
  v_accvgpr_write_b32 a132, v144
  v_perm_b32 v145, v60, v56, s58
  v_accvgpr_write_b32 a133, v145
  v_perm_b32 v144, v68, v64, s58
  v_accvgpr_write_b32 a134, v144
  v_perm_b32 v145, v76, v72, s58
  v_accvgpr_write_b32 a135, v145
  v_perm_b32 v144, v52, v48, s59
  v_accvgpr_write_b32 a148, v144
  v_perm_b32 v145, v60, v56, s59
  v_accvgpr_write_b32 a149, v145
  v_perm_b32 v144, v68, v64, s59
  v_accvgpr_write_b32 a150, v144
  v_perm_b32 v145, v76, v72, s59
  v_accvgpr_write_b32 a151, v145
  v_perm_b32 v144, v53, v49, s58
  v_accvgpr_write_b32 a164, v144
  v_perm_b32 v145, v61, v57, s58
  v_accvgpr_write_b32 a165, v145
  v_perm_b32 v144, v69, v65, s58
  v_accvgpr_write_b32 a166, v144
  v_perm_b32 v145, v77, v73, s58
  v_accvgpr_write_b32 a167, v145
  v_perm_b32 v144, v53, v49, s59
  v_accvgpr_write_b32 a180, v144
  v_perm_b32 v145, v61, v57, s59
  v_accvgpr_write_b32 a181, v145
  v_perm_b32 v144, v69, v65, s59
  v_accvgpr_write_b32 a182, v144
  v_perm_b32 v145, v77, v73, s59
  v_accvgpr_write_b32 a183, v145
  v_perm_b32 v144, v54, v50, s58
  v_accvgpr_write_b32 a196, v144
  v_perm_b32 v145, v62, v58, s58
  v_accvgpr_write_b32 a197, v145
  v_perm_b32 v144, v70, v66, s58
  v_accvgpr_write_b32 a198, v144
  v_perm_b32 v145, v78, v74, s58
  v_accvgpr_write_b32 a199, v145
  v_perm_b32 v144, v54, v50, s59
  v_accvgpr_write_b32 a212, v144
  v_perm_b32 v145, v62, v58, s59
  v_accvgpr_write_b32 a213, v145
  v_perm_b32 v144, v70, v66, s59
  v_accvgpr_write_b32 a214, v144
  v_perm_b32 v145, v78, v74, s59
  v_accvgpr_write_b32 a215, v145
  v_perm_b32 v144, v55, v51, s58
  v_accvgpr_write_b32 a228, v144
  v_perm_b32 v145, v63, v59, s58
  v_accvgpr_write_b32 a229, v145
  v_perm_b32 v144, v71, v67, s58
  v_accvgpr_write_b32 a230, v144
  v_perm_b32 v145, v79, v75, s58
  v_accvgpr_write_b32 a231, v145
  v_perm_b32 v144, v55, v51, s59
  v_accvgpr_write_b32 a244, v144
  v_perm_b32 v145, v63, v59, s59
  v_accvgpr_write_b32 a245, v145
  v_perm_b32 v144, v71, v67, s59
  v_accvgpr_write_b32 a246, v144
  v_perm_b32 v145, v79, v75, s59
  v_accvgpr_write_b32 a247, v145
  s_waitcnt vmcnt(8)
  v_perm_b32 v144, v84, v80, s58
  v_accvgpr_write_b32 a136, v144
  v_perm_b32 v145, v92, v88, s58
  v_accvgpr_write_b32 a137, v145
  v_perm_b32 v144, v100, v96, s58
  v_accvgpr_write_b32 a138, v144
  v_perm_b32 v145, v108, v104, s58
  v_accvgpr_write_b32 a139, v145
  v_perm_b32 v144, v84, v80, s59
  v_accvgpr_write_b32 a152, v144
  v_perm_b32 v145, v92, v88, s59
  v_accvgpr_write_b32 a153, v145
  v_perm_b32 v144, v100, v96, s59
  v_accvgpr_write_b32 a154, v144
  v_perm_b32 v145, v108, v104, s59
  v_accvgpr_write_b32 a155, v145
  v_perm_b32 v144, v85, v81, s58
  v_accvgpr_write_b32 a168, v144
  v_perm_b32 v145, v93, v89, s58
  v_accvgpr_write_b32 a169, v145
  v_perm_b32 v144, v101, v97, s58
  v_accvgpr_write_b32 a170, v144
  v_perm_b32 v145, v109, v105, s58
  v_accvgpr_write_b32 a171, v145
  v_perm_b32 v144, v85, v81, s59
  v_accvgpr_write_b32 a184, v144
  v_perm_b32 v145, v93, v89, s59
  v_accvgpr_write_b32 a185, v145
  v_perm_b32 v144, v101, v97, s59
  v_accvgpr_write_b32 a186, v144
  v_perm_b32 v145, v109, v105, s59
  v_accvgpr_write_b32 a187, v145
  v_perm_b32 v144, v86, v82, s58
  v_accvgpr_write_b32 a200, v144
  v_perm_b32 v145, v94, v90, s58
  v_accvgpr_write_b32 a201, v145
  v_perm_b32 v144, v102, v98, s58
  v_accvgpr_write_b32 a202, v144
  v_perm_b32 v145, v110, v106, s58
  v_accvgpr_write_b32 a203, v145
  v_perm_b32 v144, v86, v82, s59
  v_accvgpr_write_b32 a216, v144
  v_perm_b32 v145, v94, v90, s59
  v_accvgpr_write_b32 a217, v145
  v_perm_b32 v144, v102, v98, s59
  v_accvgpr_write_b32 a218, v144
  v_perm_b32 v145, v110, v106, s59
  v_accvgpr_write_b32 a219, v145
  v_perm_b32 v144, v87, v83, s58
  v_accvgpr_write_b32 a232, v144
  v_perm_b32 v145, v95, v91, s58
  v_accvgpr_write_b32 a233, v145
  v_perm_b32 v144, v103, v99, s58
  v_accvgpr_write_b32 a234, v144
  v_perm_b32 v145, v111, v107, s58
  v_accvgpr_write_b32 a235, v145
  v_perm_b32 v144, v87, v83, s59
  v_accvgpr_write_b32 a248, v144
  v_perm_b32 v145, v95, v91, s59
  v_accvgpr_write_b32 a249, v145
  v_perm_b32 v144, v103, v99, s59
  v_accvgpr_write_b32 a250, v144
  v_perm_b32 v145, v111, v107, s59
  v_accvgpr_write_b32 a251, v145
  s_waitcnt vmcnt(0)
  v_perm_b32 v144, v116, v112, s58
  v_accvgpr_write_b32 a140, v144
  v_perm_b32 v145, v124, v120, s58
  v_accvgpr_write_b32 a141, v145
  v_perm_b32 v144, v132, v128, s58
  v_accvgpr_write_b32 a142, v144
  v_perm_b32 v145, v140, v136, s58
  v_accvgpr_write_b32 a143, v145
  v_perm_b32 v144, v116, v112, s59
  v_accvgpr_write_b32 a156, v144
  v_perm_b32 v145, v124, v120, s59
  v_accvgpr_write_b32 a157, v145
  v_perm_b32 v144, v132, v128, s59
  v_accvgpr_write_b32 a158, v144
  v_perm_b32 v145, v140, v136, s59
  v_accvgpr_write_b32 a159, v145
  v_perm_b32 v144, v117, v113, s58
  v_accvgpr_write_b32 a172, v144
  v_perm_b32 v145, v125, v121, s58
  v_accvgpr_write_b32 a173, v145
  v_perm_b32 v144, v133, v129, s58
  v_accvgpr_write_b32 a174, v144
  v_perm_b32 v145, v141, v137, s58
  v_accvgpr_write_b32 a175, v145
  v_perm_b32 v144, v117, v113, s59
  v_accvgpr_write_b32 a188, v144
  v_perm_b32 v145, v125, v121, s59
  v_accvgpr_write_b32 a189, v145
  v_perm_b32 v144, v133, v129, s59
  v_accvgpr_write_b32 a190, v144
  v_perm_b32 v145, v141, v137, s59
  v_accvgpr_write_b32 a191, v145
  v_perm_b32 v144, v118, v114, s58
  v_accvgpr_write_b32 a204, v144
  v_perm_b32 v145, v126, v122, s58
  v_accvgpr_write_b32 a205, v145
  v_perm_b32 v144, v134, v130, s58
  v_accvgpr_write_b32 a206, v144
  v_perm_b32 v145, v142, v138, s58
  v_accvgpr_write_b32 a207, v145
  v_perm_b32 v144, v118, v114, s59
  v_accvgpr_write_b32 a220, v144
  v_perm_b32 v145, v126, v122, s59
  v_accvgpr_write_b32 a221, v145
  v_perm_b32 v144, v134, v130, s59
  v_accvgpr_write_b32 a222, v144
  v_perm_b32 v145, v142, v138, s59
  v_accvgpr_write_b32 a223, v145
  v_perm_b32 v144, v119, v115, s58
  v_accvgpr_write_b32 a236, v144
  v_perm_b32 v145, v127, v123, s58
  v_accvgpr_write_b32 a237, v145
  v_perm_b32 v144, v135, v131, s58
  v_accvgpr_write_b32 a238, v144
  v_perm_b32 v145, v143, v139, s58
  v_accvgpr_write_b32 a239, v145
  v_perm_b32 v144, v119, v115, s59
  v_accvgpr_write_b32 a252, v144
  v_perm_b32 v145, v127, v123, s59
  v_accvgpr_write_b32 a253, v145
  v_perm_b32 v144, v135, v131, s59
  v_accvgpr_write_b32 a254, v144
  v_perm_b32 v145, v143, v139, s59
  v_accvgpr_write_b32 a255, v145
  v_mov_b32 v11, 84
  s_mov_b64 exec, 1
wd_89:
  buffer_load_dword v10, v11, s[24:27], 0 offen sc1
  s_waitcnt vmcnt(0)
  v_cmp_gt_u32 vcc, 1, v10
  s_cbranch_vccz wdd_90
  s_sub_u32 s3, s3, 1
  s_cbranch_scc1 bail_31
  s_sleep 8
  s_branch wd_89
wdd_90:
  s_mov_b64 exec, -1
  v_lshlrev_b32 v4, 4, v1
  v_and_b32 v5, 31, v1
  v_mul_u32_u24 v5, 1040, v5
  v_lshrrev_b32 v2, 5, v1
  v_lshl_add_u32 v5, v2, 4, v5
  s_mul_i32 s36, s4, 8320
  v_lshrrev_b32 v8, 4, v1
  v_mul_u32_u24 v8, 65536, v8
  v_and_b32 v9, 15, v1
  v_lshl_add_u32 v8, v9, 4, v8
  s_lshl_b32 s37, s7, 21
  s_add_u32 s37, s37, 5242880
  s_lshl_b32 s33, s4, 13
  s_add_u32 s37, s37, s33
  s_lshl_b32 s38, s7, 21
  s_add_u32 s38, s38, 18874368
  s_lshl_b32 s33, s35, 10
  s_add_u32 s38, s38, s33
  s_lshl_b32 s33, s4, 8
  s_add_u32 s38, s38, s33
  s_lshl_b32 s33, s7, 7
  s_add_u32 s33, s33, 147968
  v_min_u32 v6, 19, v1
  v_lshl_add_u32 v6, v6, 2, s33
  v_add_u32 v14, 131072, v4
  s_lshl_b32 s33, s4, 11
  v_add_u32 v13, s33, v14
  v_xor_b32 v14, 0x800, v13
  v_xor_b32 v15, 0x1000, v13
  v_xor_b32 v3, 0x1800, v13
  s_mov_b32 s44, 2
  s_mov_b32 s22, 0
  s_mov_b32 s20, -1
  s_barrier
  s_lshl_b32 s33, s35, 2
  s_add_u32 s33, s33, s4
  s_lshl_b32 s33, s33, 2
  s_lshl_b32 s34, s7, 8
  s_add_u32 s33, s33, s34
  s_add_u32 s47, s33, 153600
  s_add_u32 s46, s37, 4161536
  s_cmp_eq_u32 s35, 0
  s_cselect_b64 s[56:57], -1, 0
  s_mul_i32 s33, s35, 6
  s_lshl_b64 s[60:61], 63, s33
dm_91:
  v_and_b32 v11, 15, v1
  v_lshlrev_b32 v11, 2, v11
  v_add_u32 v10, 128, v11
  v_cmp_gt_u32 vcc, 4, v11
  s_nop 1
  v_cndmask_b32 v11, v10, v11, vcc
  buffer_load_dword v10, v11, s[24:27], 0 offen sc1
  s_waitcnt vmcnt(0)
  v_readlane_b32 s34, v10, s5
  s_nop 0
  s_cmp_ge_u32 s34, 32
  s_cbranch_scc1 dmf_92
  v_readlane_b32 s33, v10, 0
  v_readlane_b32 s34, v10, 1
  s_nop 0
  s_add_u32 s33, s33, s34
  v_readlane_b32 s34, v10, 2
  s_nop 0
  s_add_u32 s33, s33, s34
  v_readlane_b32 s34, v10, 3
  s_nop 0
  s_add_u32 s33, s33, s34
  v_readlane_b32 s34, v10, 4
  s_nop 0
  s_add_u32 s33, s33, s34
  v_readlane_b32 s34, v10, 5
  s_nop 0
  s_add_u32 s33, s33, s34
  v_readlane_b32 s34, v10, 6
  s_nop 0
  s_add_u32 s33, s33, s34
  v_readlane_b32 s34, v10, 7
  s_nop 0
  s_add_u32 s33, s33, s34
  v_readlane_b32 s34, v10, 8
  s_nop 0
  s_add_u32 s33, s33, s34
  v_readlane_b32 s34, v10, 9
  s_nop 0
  s_add_u32 s33, s33, s34
  v_readlane_b32 s34, v10, 10
  s_nop 0
  s_add_u32 s33, s33, s34
  v_readlane_b32 s34, v10, 11
  s_nop 0
  s_add_u32 s33, s33, s34
  v_readlane_b32 s34, v10, 12
  s_nop 0
  s_add_u32 s33, s33, s34
  v_readlane_b32 s34, v10, 13
  s_nop 0
  s_add_u32 s33, s33, s34
  v_readlane_b32 s34, v10, 14
  s_nop 0
  s_add_u32 s33, s33, s34
  v_readlane_b32 s34, v10, 15
  s_nop 0
  s_add_u32 s33, s33, s34
  s_cmp_ge_u32 s33, 256
  s_cbranch_scc1 ffs_pre
  s_sub_u32 s3, s3, 1
  s_cbranch_scc1 bail_2
  s_sleep 8
  s_branch dm_91
dmf_92:
fff_pre:
  v_lshlrev_b32 v11, 7, v1
  v_lshrrev_b32 v12, 3, v1
  v_mul_u32_u24 v12, 1040, v12
  v_and_b32 v9, 7, v1
  v_lshl_add_u32 v12, v9, 7, v12
  v_add_u32 v12, s36, v12
  s_mov_b64 exec, 1
lw_93:
  s_sub_u32 s3, s3, 1
  s_cbranch_scc1 bail_31
  s_sleep 4
  buffer_load_dword v10, off, s[8:11], s37 sc1
  s_waitcnt vmcnt(0)
  v_cmp_eq_u32 vcc, -1, v10
  s_cbranch_vccnz lw_93
  s_mov_b64 exec, -1
  s_mov_b64 s[64:65], -1
fff_wait:
  s_sub_u32 s3, s3, 1
  s_cbranch_scc1 bail_32
  s_and_b32 s33, s64, 0xff
  s_cbranch_scc0 xf_94
  s_add_u32 m0, s36, 0
  s_add_u32 s33, s37, 0
  buffer_load_dwordx4 v4, s[8:11], s33 offen sc1 lds
xf_94:
  s_and_b32 s33, s64, 0xff00
  s_cbranch_scc0 xf_95
  s_add_u32 m0, s36, 1040
  s_add_u32 s33, s37, 1024
  buffer_load_dwordx4 v4, s[8:11], s33 offen sc1 lds
xf_95:
  s_and_b32 s33, s64, 0xff0000
  s_cbranch_scc0 xf_96
  s_add_u32 m0, s36, 2080
  s_add_u32 s33, s37, 2048
  buffer_load_dwordx4 v4, s[8:11], s33 offen sc1 lds
xf_96:
  s_and_b32 s33, s64, 0xff000000
  s_cbranch_scc0 xf_97
  s_add_u32 m0, s36, 3120
  s_add_u32 s33, s37, 3072
  buffer_load_dwordx4 v4, s[8:11], s33 offen sc1 lds
xf_97:
  s_and_b32 s33, s65, 0xff
  s_cbranch_scc0 xf_98
  s_add_u32 m0, s36, 4160
  s_add_u32 s33, s37, 4096
  buffer_load_dwordx4 v4, s[8:11], s33 offen sc1 lds
xf_98:
  s_and_b32 s33, s65, 0xff00
  s_cbranch_scc0 xf_99
  s_add_u32 m0, s36, 5200
  s_add_u32 s33, s37, 5120
  buffer_load_dwordx4 v4, s[8:11], s33 offen sc1 lds
xf_99:
  s_and_b32 s33, s65, 0xff0000
  s_cbranch_scc0 xf_100
  s_add_u32 m0, s36, 6240
  s_add_u32 s33, s37, 6144
  buffer_load_dwordx4 v4, s[8:11], s33 offen sc1 lds
xf_100:
  s_and_b32 s33, s65, 0xff000000
  s_cbranch_scc0 xf_101
  s_add_u32 m0, s36, 7280
  s_add_u32 s33, s37, 7168
  buffer_load_dwordx4 v4, s[8:11], s33 offen sc1 lds
xf_101:
  s_waitcnt vmcnt(0)
  ds_read2_b32 v[192:193], v12 offset1:16
  s_waitcnt lgkmcnt(0)
  v_max_u32 v192, v192, v193
  v_cmp_eq_u32 s[64:65], -1, v192
  s_cmp_lg_u64 s[64:65], 0
  s_cbranch_scc1 fff_wait
  s_add_u32 s20, s20, 1
  s_cmp_lt_u32 s20, 63
  s_cselect_b32 s39, 32768, 0
  s_add_u32 s37, s37, s39
  s_xor_b32 s36, s36, 0x10000
  s_add_u32 s46, s46, 32768
  v_xor_b32 v12, 0x10000, v12
fff_again:
  s_barrier
  ds_read_b128 v[16:19], v5 offset:0
  ds_read_b128 v[20:23], v5 offset:32
  ds_read_b128 v[24:27], v5 offset:64
  ds_read_b128 v[28:31], v5 offset:96
  ds_read_b128 v[32:35], v5 offset:128
  ds_read_b128 v[36:39], v5 offset:160
  s_waitcnt lgkmcnt(5)
  v_mfma_f32_32x32x16_bf16 v[48:63], a[0:3], v[16:19], 0
  ds_read_b128 v[40:43], v5 offset:192
  s_waitcnt lgkmcnt(5)
  v_mfma_f32_32x32x16_bf16 v[48:63], a[4:7], v[20:23], v[48:63]
  ds_read_b128 v[44:47], v5 offset:224
  v_max_u32 v9, v16, v20
  s_waitcnt lgkmcnt(5)
  v_mfma_f32_32x32x16_bf16 v[48:63], a[8:11], v[24:27], v[48:63]
  ds_read_b128 v[16:19], v5 offset:256
  s_waitcnt lgkmcnt(5)
  v_mfma_f32_32x32x16_bf16 v[48:63], a[12:15], v[28:31], v[48:63]
  ds_read_b128 v[20:23], v5 offset:288
  v_max3_u32 v9, v9, v24, v28
  s_waitcnt lgkmcnt(5)
  v_mfma_f32_32x32x16_bf16 v[48:63], a[16:19], v[32:35], v[48:63]
  ds_read_b128 v[24:27], v5 offset:320
  s_waitcnt lgkmcnt(5)
  v_mfma_f32_32x32x16_bf16 v[48:63], a[20:23], v[36:39], v[48:63]
  ds_read_b128 v[28:31], v5 offset:352
  v_max3_u32 v9, v9, v32, v36
  s_waitcnt lgkmcnt(5)
  v_mfma_f32_32x32x16_bf16 v[48:63], a[24:27], v[40:43], v[48:63]
  ds_read_b128 v[32:35], v5 offset:384
  s_waitcnt lgkmcnt(5)
  v_mfma_f32_32x32x16_bf16 v[48:63], a[28:31], v[44:47], v[48:63]
  ds_read_b128 v[36:39], v5 offset:416
  v_max3_u32 v9, v9, v40, v44
  s_branch fff_mid
fff_topp:
  s_barrier
  ds_read_b128 v[16:19], v5 offset:0
  ds_read_b128 v[20:23], v5 offset:32
  ds_read_b128 v[24:27], v5 offset:64
  ds_read_b128 v[28:31], v5 offset:96
  ds_read_b128 v[32:35], v5 offset:128
  ds_read_b128 v[36:39], v5 offset:160
  s_add_u32 s20, s20, 1
  s_cmp_lt_u32 s20, 63
  s_cselect_b32 s39, 32768, 0
  s_add_u32 s37, s37, s39
  s_xor_b32 s36, s36, 0x10000
  s_add_u32 s46, s46, 32768
  v_xor_b32 v12, 0x10000, v12
  v_cvt_pk_bf16_f32 v112, v160, v164
  v_cvt_pk_bf16_f32 v113, v168, v172
  v_cvt_pk_bf16_f32 v114, v176, v180
  v_cvt_pk_bf16_f32 v115, v184, v188
  v_and_or_b32 v112, v112, -2, s22
  s_add_u32 s33, s23, 262144
  buffer_store_dwordx4 v[112:115], v8, s[8:11], s33 offen
  s_waitcnt lgkmcnt(5)
  v_mfma_f32_32x32x16_bf16 v[48:63], a[0:3], v[16:19], 0
  ds_read_b128 v[40:43], v5 offset:192
  v_cvt_pk_bf16_f32 v116, v161, v165
  v_cvt_pk_bf16_f32 v117, v169, v173
  v_cvt_pk_bf16_f32 v118, v177, v181
  s_waitcnt lgkmcnt(5)
  v_mfma_f32_32x32x16_bf16 v[48:63], a[4:7], v[20:23], v[48:63]
  ds_read_b128 v[44:47], v5 offset:224
  v_max_u32 v9, v16, v20
  v_cvt_pk_bf16_f32 v119, v185, v189
  v_and_or_b32 v116, v116, -2, s22
  s_add_u32 s33, s23, 278528
  s_waitcnt lgkmcnt(5)
  v_mfma_f32_32x32x16_bf16 v[48:63], a[8:11], v[24:27], v[48:63]
  ds_read_b128 v[16:19], v5 offset:256
  buffer_store_dwordx4 v[116:119], v8, s[8:11], s33 offen
  v_cvt_pk_bf16_f32 v120, v162, v166
  v_cvt_pk_bf16_f32 v121, v170, v174
  s_waitcnt lgkmcnt(5)
  v_mfma_f32_32x32x16_bf16 v[48:63], a[12:15], v[28:31], v[48:63]
  ds_read_b128 v[20:23], v5 offset:288
  v_max3_u32 v9, v9, v24, v28
  v_cvt_pk_bf16_f32 v122, v178, v182
  v_cvt_pk_bf16_f32 v123, v186, v190
  v_and_or_b32 v120, v120, -2, s22
  s_waitcnt lgkmcnt(5)
  v_mfma_f32_32x32x16_bf16 v[48:63], a[16:19], v[32:35], v[48:63]
  ds_read_b128 v[24:27], v5 offset:320
  s_add_u32 s33, s23, 294912
  buffer_store_dwordx4 v[120:123], v8, s[8:11], s33 offen
  v_cvt_pk_bf16_f32 v124, v163, v167
  s_waitcnt lgkmcnt(5)
  v_mfma_f32_32x32x16_bf16 v[48:63], a[20:23], v[36:39], v[48:63]
  ds_read_b128 v[28:31], v5 offset:352
  v_max3_u32 v9, v9, v32, v36
  v_cvt_pk_bf16_f32 v125, v171, v175
  v_cvt_pk_bf16_f32 v126, v179, v183
  v_cvt_pk_bf16_f32 v127, v187, v191
  s_waitcnt lgkmcnt(5)
  v_mfma_f32_32x32x16_bf16 v[48:63], a[24:27], v[40:43], v[48:63]
  ds_read_b128 v[32:35], v5 offset:384
  v_and_or_b32 v124, v124, -2, s22
  s_add_u32 s33, s23, 311296
  buffer_store_dwordx4 v[124:127], v8, s[8:11], s33 offen
  s_waitcnt lgkmcnt(5)
  v_mfma_f32_32x32x16_bf16 v[48:63], a[28:31], v[44:47], v[48:63]
  ds_read_b128 v[36:39], v5 offset:416
  v_max3_u32 v9, v9, v40, v44
  s_mov_b64 exec, 1
  buffer_store_dword v2, off, s[8:11], s47
  s_mov_b64 exec, -1
fff_mid:
  s_waitcnt lgkmcnt(5)
  v_mfma_f32_32x32x16_bf16 v[48:63], a[32:35], v[16:19], v[48:63]
  ds_read_b128 v[40:43], v5 offset:448
  s_mov_b64 exec, s[56:57]
  buffer_load_dword v10, v11, s[8:11], s46 offen sc1
  s_mov_b64 exec, -1
  s_waitcnt lgkmcnt(5)
  v_mfma_f32_32x32x16_bf16 v[48:63], a[36:39], v[20:23], v[48:63]
  ds_read_b128 v[44:47], v5 offset:480
  v_max3_u32 v9, v9, v16, v20
  s_waitcnt lgkmcnt(5)
  v_mfma_f32_32x32x16_bf16 v[48:63], a[40:43], v[24:27], v[48:63]
  ds_read_b128 v[16:19], v5 offset:512
  s_waitcnt lgkmcnt(5)
  v_mfma_f32_32x32x16_bf16 v[48:63], a[44:47], v[28:31], v[48:63]
  ds_read_b128 v[20:23], v5 offset:544
  v_max3_u32 v9, v9, v24, v28
  s_waitcnt lgkmcnt(5)
  v_mfma_f32_32x32x16_bf16 v[48:63], a[48:51], v[32:35], v[48:63]
  ds_read_b128 v[24:27], v5 offset:576
  s_waitcnt lgkmcnt(5)
  v_mfma_f32_32x32x16_bf16 v[48:63], a[52:55], v[36:39], v[48:63]
  ds_read_b128 v[28:31], v5 offset:608
  v_max3_u32 v9, v9, v32, v36
  s_waitcnt lgkmcnt(5)
  v_mfma_f32_32x32x16_bf16 v[48:63], a[56:59], v[40:43], v[48:63]
  ds_read_b128 v[32:35], v5 offset:640
  s_waitcnt lgkmcnt(5)
  v_mfma_f32_32x32x16_bf16 v[48:63], a[60:63], v[44:47], v[48:63]
  ds_read_b128 v[36:39], v5 offset:672
  v_max3_u32 v9, v9, v40, v44
  s_waitcnt lgkmcnt(5)
  v_mfma_f32_32x32x16_bf16 v[48:63], a[64:67], v[16:19], v[48:63]
  ds_read_b128 v[40:43], v5 offset:704
  s_waitcnt lgkmcnt(5)
  v_mfma_f32_32x32x16_bf16 v[48:63], a[68:71], v[20:23], v[48:63]
  ds_read_b128 v[44:47], v5 offset:736
  v_max3_u32 v9, v9, v16, v20
  s_waitcnt lgkmcnt(5)
  v_mfma_f32_32x32x16_bf16 v[48:63], a[72:75], v[24:27], v[48:63]
  ds_read_b128 v[16:19], v5 offset:768
  s_waitcnt lgkmcnt(5)
  v_mfma_f32_32x32x16_bf16 v[48:63], a[76:79], v[28:31], v[48:63]
  ds_read_b128 v[20:23], v5 offset:800
  v_max3_u32 v9, v9, v24, v28
  s_waitcnt lgkmcnt(5)
  v_mfma_f32_32x32x16_bf16 v[48:63], a[80:83], v[32:35], v[48:63]
  ds_read_b128 v[24:27], v5 offset:832
  s_mov_b64 exec, s[60:61]
  buffer_load_dword v10, v11, s[8:11], s37 offen sc1
  s_mov_b64 exec, -1
  s_waitcnt lgkmcnt(5)
  v_mfma_f32_32x32x16_bf16 v[48:63], a[84:87], v[36:39], v[48:63]
  ds_read_b128 v[28:31], v5 offset:864
  v_max3_u32 v9, v9, v32, v36
  buffer_load_dword v7, v6, s[8:11], 0 offen sc1
  s_sub_u32 s41, s20, 2
  s_add_u32 s40, s20, 2
  s_waitcnt lgkmcnt(5)
  v_mfma_f32_32x32x16_bf16 v[48:63], a[88:91], v[40:43], v[48:63]
  ds_read_b128 v[32:35], v5 offset:896
  s_waitcnt lgkmcnt(5)
  v_mfma_f32_32x32x16_bf16 v[48:63], a[92:95], v[44:47], v[48:63]
  ds_read_b128 v[36:39], v5 offset:928
  v_max3_u32 v9, v9, v40, v44
  s_waitcnt lgkmcnt(5)
  v_mfma_f32_32x32x16_bf16 v[48:63], a[96:99], v[16:19], v[48:63]
  ds_read_b128 v[40:43], v5 offset:960
  s_waitcnt lgkmcnt(5)
  v_mfma_f32_32x32x16_bf16 v[48:63], a[100:103], v[20:23], v[48:63]
  ds_read_b128 v[44:47], v5 offset:992
  v_max3_u32 v9, v9, v16, v20
  s_waitcnt lgkmcnt(5)
  v_mfma_f32_32x32x16_bf16 v[48:63], a[104:107], v[24:27], v[48:63]
  s_waitcnt lgkmcnt(4)
  v_mfma_f32_32x32x16_bf16 v[48:63], a[108:111], v[28:31], v[48:63]
  v_max3_u32 v9, v9, v24, v28
  s_waitcnt lgkmcnt(3)
  v_mfma_f32_32x32x16_bf16 v[48:63], a[112:115], v[32:35], v[48:63]
  s_waitcnt lgkmcnt(2)
  v_mfma_f32_32x32x16_bf16 v[48:63], a[116:119], v[36:39], v[48:63]
  v_max3_u32 v9, v9, v32, v36
  s_waitcnt lgkmcnt(1)
  v_mfma_f32_32x32x16_bf16 v[48:63], a[120:123], v[40:43], v[48:63]
  s_waitcnt lgkmcnt(0)
  v_mfma_f32_32x32x16_bf16 v[48:63], a[124:127], v[44:47], v[48:63]
  v_max3_u32 v9, v9, v40, v44
  v_cmp_eq_u32 vcc, -1, v9
  v_mov_b32 v2, s40
  s_cbranch_vccnz fff_redo
  v_xor_b32 v5, 0x10000, v5
  s_nop 6
  v_cvt_pk_bf16_f32 v64, v48, v49
  v_cvt_pk_bf16_f32 v68, v56, v57
  v_cvt_pk_bf16_f32 v65, v50, v51
  v_cvt_pk_bf16_f32 v69, v58, v59
  v_cvt_pk_bf16_f32 v66, v52, v53
  v_cvt_pk_bf16_f32 v70, v60, v61
  v_cvt_pk_bf16_f32 v67, v54, v55
  v_cvt_pk_bf16_f32 v71, v62, v63
  v_permlane16_swap_b32 v64, v68
  v_permlane16_swap_b32 v65, v69
  v_permlane16_swap_b32 v66, v70
  v_permlane16_swap_b32 v67, v71
  v_pk_max_i16 v64, v64, 0
  v_pk_max_i16 v65, v65, 0
  v_pk_max_i16 v66, v66, 0
  v_pk_max_i16 v67, v67, 0
  v_pk_max_i16 v68, v68, 0
  v_pk_max_i16 v69, v69, 0
  v_pk_max_i16 v70, v70, 0
  v_pk_max_i16 v71, v71, 0
  v_mfma_f32_16x16x32_bf16 v[128:131], v[64:67], a[128:131], 0
  ds_write_b128 v13, v[64:67]
  v_mfma_f32_16x16x32_bf16 v[132:135], v[64:67], a[144:147], 0
  v_mfma_f32_16x16x32_bf16 v[136:139], v[64:67], a[160:163], 0
  s_add_u32 m0, s36, 0
  s_add_u32 s34, s37, 0
  buffer_load_dwordx4 v4, s[8:11], s34 offen sc1 lds
  v_mfma_f32_16x16x32_bf16 v[140:143], v[64:67], a[176:179], 0
  ds_write_b128 v13, v[68:71] offset:1024
  v_mfma_f32_16x16x32_bf16 v[144:147], v[64:67], a[192:195], 0
  v_mfma_f32_16x16x32_bf16 v[148:151], v[64:67], a[208:211], 0
  v_mfma_f32_16x16x32_bf16 v[152:155], v[64:67], a[224:227], 0
  v_mfma_f32_16x16x32_bf16 v[156:159], v[64:67], a[240:243], 0
  s_add_u32 m0, s36, 1040
  s_add_u32 s34, s37, 1024
  buffer_load_dwordx4 v4, s[8:11], s34 offen sc1 lds
  v_mfma_f32_16x16x32_bf16 v[160:163], v[68:71], a[128:131], 0
  v_mfma_f32_16x16x32_bf16 v[164:167], v[68:71], a[144:147], 0
  v_mfma_f32_16x16x32_bf16 v[168:171], v[68:71], a[160:163], 0
  s_waitcnt lgkmcnt(0)
  s_barrier
  ds_read_b128 v[72:75], v14 offset:0
  v_mfma_f32_16x16x32_bf16 v[172:175], v[68:71], a[176:179], 0
  ds_read_b128 v[76:79], v15 offset:0
  v_mfma_f32_16x16x32_bf16 v[176:179], v[68:71], a[192:195], 0
  ds_read_b128 v[80:83], v3 offset:0
  s_add_u32 m0, s36, 2080
  s_add_u32 s34, s37, 2048
  buffer_load_dwordx4 v4, s[8:11], s34 offen sc1 lds
  v_mfma_f32_16x16x32_bf16 v[180:183], v[68:71], a[208:211], 0
  ds_read_b128 v[84:87], v14 offset:1024
  v_mfma_f32_16x16x32_bf16 v[184:187], v[68:71], a[224:227], 0
  ds_read_b128 v[88:91], v15 offset:1024
  v_mfma_f32_16x16x32_bf16 v[188:191], v[68:71], a[240:243], 0
  ds_read_b128 v[92:95], v3 offset:1024
  s_waitcnt lgkmcnt(5)
  v_mfma_f32_16x16x32_bf16 v[128:131], v[72:75], a[132:135], v[128:131]
  v_mfma_f32_16x16x32_bf16 v[132:135], v[72:75], a[148:151], v[132:135]
  s_add_u32 m0, s36, 3120
  s_add_u32 s34, s37, 3072
  buffer_load_dwordx4 v4, s[8:11], s34 offen sc1 lds
  v_mfma_f32_16x16x32_bf16 v[136:139], v[72:75], a[164:167], v[136:139]
  v_mfma_f32_16x16x32_bf16 v[140:143], v[72:75], a[180:183], v[140:143]
  s_add_u32 s44, s44, 1
  s_cmp_eq_u32 s44, 3
  s_cselect_b32 s44, 0, s44
  v_mfma_f32_16x16x32_bf16 v[144:147], v[72:75], a[196:199], v[144:147]
  s_cselect_b32 s23, 1, 0
  s_xor_b32 s22, s22, s23
  v_mfma_f32_16x16x32_bf16 v[148:151], v[72:75], a[212:215], v[148:151]
  s_lshl_b32 s23, s44, 19
  s_add_u32 s23, s23, s38
  v_mfma_f32_16x16x32_bf16 v[152:155], v[72:75], a[228:231], v[152:155]
  s_add_u32 m0, s36, 4160
  s_add_u32 s34, s37, 4096
  buffer_load_dwordx4 v4, s[8:11], s34 offen sc1 lds
  v_mfma_f32_16x16x32_bf16 v[156:159], v[72:75], a[244:247], v[156:159]
  s_waitcnt lgkmcnt(4)
  v_mfma_f32_16x16x32_bf16 v[128:131], v[76:79], a[136:139], v[128:131]
  v_mfma_f32_16x16x32_bf16 v[132:135], v[76:79], a[152:155], v[132:135]
  v_mfma_f32_16x16x32_bf16 v[136:139], v[76:79], a[168:171], v[136:139]
  v_mfma_f32_16x16x32_bf16 v[140:143], v[76:79], a[184:187], v[140:143]
  s_add_u32 m0, s36, 5200
  s_add_u32 s34, s37, 5120
  buffer_load_dwordx4 v4, s[8:11], s34 offen sc1 lds
  v_mfma_f32_16x16x32_bf16 v[144:147], v[76:79], a[200:203], v[144:147]
  v_mfma_f32_16x16x32_bf16 v[148:151], v[76:79], a[216:219], v[148:151]
  v_mfma_f32_16x16x32_bf16 v[152:155], v[76:79], a[232:235], v[152:155]
  v_mfma_f32_16x16x32_bf16 v[156:159], v[76:79], a[248:251], v[156:159]
  s_waitcnt lgkmcnt(3)
  v_mfma_f32_16x16x32_bf16 v[128:131], v[80:83], a[140:143], v[128:131]
  s_add_u32 m0, s36, 6240
  s_add_u32 s34, s37, 6144
  buffer_load_dwordx4 v4, s[8:11], s34 offen sc1 lds
  v_mfma_f32_16x16x32_bf16 v[132:135], v[80:83], a[156:159], v[132:135]
  v_mfma_f32_16x16x32_bf16 v[136:139], v[80:83], a[172:175], v[136:139]
  v_mfma_f32_16x16x32_bf16 v[140:143], v[80:83], a[188:191], v[140:143]
  v_mfma_f32_16x16x32_bf16 v[144:147], v[80:83], a[204:207], v[144:147]
  v_mfma_f32_16x16x32_bf16 v[148:151], v[80:83], a[220:223], v[148:151]
  s_add_u32 m0, s36, 7280
  s_add_u32 s34, s37, 7168
  buffer_load_dwordx4 v4, s[8:11], s34 offen sc1 lds
  v_mfma_f32_16x16x32_bf16 v[152:155], v[80:83], a[236:239], v[152:155]
  s_waitcnt vmcnt(8)
  v_cmp_gt_i32 vcc, s41, v7
  v_mfma_f32_16x16x32_bf16 v[156:159], v[80:83], a[252:255], v[156:159]
  s_waitcnt lgkmcnt(2)
  v_mfma_f32_16x16x32_bf16 v[160:163], v[84:87], a[132:135], v[160:163]
  s_cbranch_vccnz fff_ringwait
fff_ringok:
  v_mfma_f32_16x16x32_bf16 v[164:167], v[84:87], a[148:151], v[164:167]
  v_cvt_pk_bf16_f32 v96, v128, v132
  v_cvt_pk_bf16_f32 v97, v136, v140
  v_mfma_f32_16x16x32_bf16 v[168:171], v[84:87], a[164:167], v[168:171]
  v_cvt_pk_bf16_f32 v98, v144, v148
  v_cvt_pk_bf16_f32 v99, v152, v156
  v_mfma_f32_16x16x32_bf16 v[172:175], v[84:87], a[180:183], v[172:175]
  v_and_or_b32 v96, v96, -2, s22
  v_mfma_f32_16x16x32_bf16 v[176:179], v[84:87], a[196:199], v[176:179]
  s_add_u32 s33, s23, 0
  v_mfma_f32_16x16x32_bf16 v[180:183], v[84:87], a[212:215], v[180:183]
  buffer_store_dwordx4 v[96:99], v8, s[8:11], s33 offen
  v_cvt_pk_bf16_f32 v100, v129, v133
  v_cvt_pk_bf16_f32 v101, v137, v141
  v_mfma_f32_16x16x32_bf16 v[184:187], v[84:87], a[228:231], v[184:187]
  v_cvt_pk_bf16_f32 v102, v145, v149
  v_cvt_pk_bf16_f32 v103, v153, v157
  v_mfma_f32_16x16x32_bf16 v[188:191], v[84:87], a[244:247], v[188:191]
  v_and_or_b32 v100, v100, -2, s22
  s_waitcnt lgkmcnt(1)
  v_mfma_f32_16x16x32_bf16 v[160:163], v[88:91], a[136:139], v[160:163]
  s_add_u32 s33, s23, 16384
  v_mfma_f32_16x16x32_bf16 v[164:167], v[88:91], a[152:155], v[164:167]
  buffer_store_dwordx4 v[100:103], v8, s[8:11], s33 offen
  v_cvt_pk_bf16_f32 v104, v130, v134
  v_cvt_pk_bf16_f32 v105, v138, v142
  v_mfma_f32_16x16x32_bf16 v[168:171], v[88:91], a[168:171], v[168:171]
  v_cvt_pk_bf16_f32 v106, v146, v150
  v_cvt_pk_bf16_f32 v107, v154, v158
  v_mfma_f32_16x16x32_bf16 v[172:175], v[88:91], a[184:187], v[172:175]
  v_and_or_b32 v104, v104, -2, s22
  v_mfma_f32_16x16x32_bf16 v[176:179], v[88:91], a[200:203], v[176:179]
  s_add_u32 s33, s23, 32768
  v_mfma_f32_16x16x32_bf16 v[180:183], v[88:91], a[216:219], v[180:183]
  buffer_store_dwordx4 v[104:107], v8, s[8:11], s33 offen
  v_cvt_pk_bf16_f32 v108, v131, v135
  v_cvt_pk_bf16_f32 v109, v139, v143
  v_mfma_f32_16x16x32_bf16 v[184:187], v[88:91], a[232:235], v[184:187]
  v_cvt_pk_bf16_f32 v110, v147, v151
  v_cvt_pk_bf16_f32 v111, v155, v159
  v_mfma_f32_16x16x32_bf16 v[188:191], v[88:91], a[248:251], v[188:191]
  v_and_or_b32 v108, v108, -2, s22
  s_waitcnt lgkmcnt(0)
  v_mfma_f32_16x16x32_bf16 v[160:163], v[92:95], a[140:143], v[160:163]
  s_add_u32 s33, s23, 49152
  v_mfma_f32_16x16x32_bf16 v[164:167], v[92:95], a[156:159], v[164:167]
  buffer_store_dwordx4 v[108:111], v8, s[8:11], s33 offen
  v_mfma_f32_16x16x32_bf16 v[168:171], v[92:95], a[172:175], v[168:171]
  s_waitcnt vmcnt(4)
  ds_read2_b32 v[192:193], v12 offset1:16
  v_mfma_f32_16x16x32_bf16 v[172:175], v[92:95], a[188:191], v[172:175]
  v_mfma_f32_16x16x32_bf16 v[176:179], v[92:95], a[204:207], v[176:179]
  v_mfma_f32_16x16x32_bf16 v[180:183], v[92:95], a[220:223], v[180:183]
  v_mfma_f32_16x16x32_bf16 v[184:187], v[92:95], a[236:239], v[184:187]
  s_waitcnt lgkmcnt(0)
  v_max_u32 v192, v192, v193
  v_cmp_eq_u32 s[64:65], -1, v192
  v_mfma_f32_16x16x32_bf16 v[188:191], v[92:95], a[252:255], v[188:191]
  s_cmp_eq_u32 s20, 63
  s_cbranch_scc1 fff_last
  s_cmp_lg_u64 s[64:65], 0
  s_cbranch_scc0 fff_topp
fff_last:
  v_cvt_pk_bf16_f32 v112, v160, v164
  v_cvt_pk_bf16_f32 v113, v168, v172
  v_cvt_pk_bf16_f32 v114, v176, v180
  s_nop 2
  v_cvt_pk_bf16_f32 v115, v184, v188
  v_and_or_b32 v112, v112, -2, s22
  s_add_u32 s33, s23, 262144
  buffer_store_dwordx4 v[112:115], v8, s[8:11], s33 offen
  v_cvt_pk_bf16_f32 v116, v161, v165
  v_cvt_pk_bf16_f32 v117, v169, v173
  v_cvt_pk_bf16_f32 v118, v177, v181
  v_cvt_pk_bf16_f32 v119, v185, v189
  v_and_or_b32 v116, v116, -2, s22
  s_add_u32 s33, s23, 278528
  buffer_store_dwordx4 v[116:119], v8, s[8:11], s33 offen
  v_cvt_pk_bf16_f32 v120, v162, v166
  v_cvt_pk_bf16_f32 v121, v170, v174
  v_cvt_pk_bf16_f32 v122, v178, v182
  v_cvt_pk_bf16_f32 v123, v186, v190
  v_and_or_b32 v120, v120, -2, s22
  s_add_u32 s33, s23, 294912
  buffer_store_dwordx4 v[120:123], v8, s[8:11], s33 offen
  v_cvt_pk_bf16_f32 v124, v163, v167
  v_cvt_pk_bf16_f32 v125, v171, v175
  v_cvt_pk_bf16_f32 v126, v179, v183
  v_cvt_pk_bf16_f32 v127, v187, v191
  v_and_or_b32 v124, v124, -2, s22
  s_add_u32 s33, s23, 311296
  buffer_store_dwordx4 v[124:127], v8, s[8:11], s33 offen
  s_mov_b64 exec, 1
  buffer_store_dword v2, off, s[8:11], s47
  s_mov_b64 exec, -1
  s_cmp_eq_u32 s20, 63
  s_cbranch_scc0 fff_wait
  s_branch ffn_fin
fff_redo:
  s_sub_u32 s3, s3, 1
  s_cbranch_scc1 bail_39
  s_waitcnt lgkmcnt(0)
  s_barrier
  s_sub_u32 s34, s37, s39
  s_xor_b32 s33, s36, 0x10000
  s_add_u32 m0, s33, 0
  s_add_u32 s33, s34, 0
  buffer_load_dwordx4 v4, s[8:11], s33 offen sc1 lds
  s_xor_b32 s33, s36, 0x10000
  s_add_u32 m0, s33, 1040
  s_add_u32 s33, s34, 1024
  buffer_load_dwordx4 v4, s[8:11], s33 offen sc1 lds
  s_xor_b32 s33, s36, 0x10000
  s_add_u32 m0, s33, 2080
  s_add_u32 s33, s34, 2048
  buffer_load_dwordx4 v4, s[8:11], s33 offen sc1 lds
  s_xor_b32 s33, s36, 0x10000
  s_add_u32 m0, s33, 3120
  s_add_u32 s33, s34, 3072
  buffer_load_dwordx4 v4, s[8:11], s33 offen sc1 lds
  s_xor_b32 s33, s36, 0x10000
  s_add_u32 m0, s33, 4160
  s_add_u32 s33, s34, 4096
  buffer_load_dwordx4 v4, s[8:11], s33 offen sc1 lds
  s_xor_b32 s33, s36, 0x10000
  s_add_u32 m0, s33, 5200
  s_add_u32 s33, s34, 5120
  buffer_load_dwordx4 v4, s[8:11], s33 offen sc1 lds
  s_xor_b32 s33, s36, 0x10000
  s_add_u32 m0, s33, 6240
  s_add_u32 s33, s34, 6144
  buffer_load_dwordx4 v4, s[8:11], s33 offen sc1 lds
  s_xor_b32 s33, s36, 0x10000
  s_add_u32 m0, s33, 7280
  s_add_u32 s33, s34, 7168
  buffer_load_dwordx4 v4, s[8:11], s33 offen sc1 lds
  s_waitcnt vmcnt(0)
  s_branch fff_again
fff_ringwait:
  s_sub_u32 s3, s3, 1
  s_cbranch_scc1 bail_33
  buffer_load_dword v7, v6, s[8:11], 0 offen sc1
  s_waitcnt vmcnt(0)
  v_cmp_gt_i32 vcc, s41, v7
  s_cbranch_vccz fff_ringok
  s_sleep 1
  s_branch fff_ringwait
ffs_pre:
  v_lshlrev_b32 v11, 7, v1
  v_lshrrev_b32 v12, 3, v1
  v_mul_u32_u24 v12, 1040, v12
  v_and_b32 v9, 7, v1
  v_lshl_add_u32 v12, v9, 7, v12
  v_add_u32 v12, s36, v12
  s_mov_b64 exec, 1
lw_102:
  s_sub_u32 s3, s3, 1
  s_cbranch_scc1 bail_31
  s_sleep 4
  buffer_load_dword v10, off, s[8:11], s37 sc1
  s_waitcnt vmcnt(0)
  v_cmp_eq_u32 vcc, -1, v10
  s_cbranch_vccnz lw_102
  s_mov_b64 exec, -1
  s_mov_b64 s[64:65], -1
ffs_wait:
  s_sub_u32 s3, s3, 1
  s_cbranch_scc1 bail_32
  s_and_b32 s33, s64, 0xff
  s_cbranch_scc0 xf_103
  s_add_u32 m0, s36, 0
  s_add_u32 s33, s37, 0
  buffer_load_dwordx4 v4, s[8:11], s33 offen sc1 lds
xf_103:
  s_and_b32 s33, s64, 0xff00
  s_cbranch_scc0 xf_104
  s_add_u32 m0, s36, 1040
  s_add_u32 s33, s37, 1024
  buffer_load_dwordx4 v4, s[8:11], s33 offen sc1 lds
xf_104:
  s_and_b32 s33, s64, 0xff0000
  s_cbranch_scc0 xf_105
  s_add_u32 m0, s36, 2080
  s_add_u32 s33, s37, 2048
  buffer_load_dwordx4 v4, s[8:11], s33 offen sc1 lds
xf_105:
  s_and_b32 s33, s64, 0xff000000
  s_cbranch_scc0 xf_106
  s_add_u32 m0, s36, 3120
  s_add_u32 s33, s37, 3072
  buffer_load_dwordx4 v4, s[8:11], s33 offen sc1 lds
xf_106:
  s_and_b32 s33, s65, 0xff
  s_cbranch_scc0 xf_107
  s_add_u32 m0, s36, 4160
  s_add_u32 s33, s37, 4096
  buffer_load_dwordx4 v4, s[8:11], s33 offen sc1 lds
xf_107:
  s_and_b32 s33, s65, 0xff00
  s_cbranch_scc0 xf_108
  s_add_u32 m0, s36, 5200
  s_add_u32 s33, s37, 5120
  buffer_load_dwordx4 v4, s[8:11], s33 offen sc1 lds
xf_108:
  s_and_b32 s33, s65, 0xff0000
  s_cbranch_scc0 xf_109
  s_add_u32 m0, s36, 6240
  s_add_u32 s33, s37, 6144
  buffer_load_dwordx4 v4, s[8:11], s33 offen sc1 lds
xf_109:
  s_and_b32 s33, s65, 0xff000000
  s_cbranch_scc0 xf_110
  s_add_u32 m0, s36, 7280
  s_add_u32 s33, s37, 7168
  buffer_load_dwordx4 v4, s[8:11], s33 offen sc1 lds
xf_110:
  s_waitcnt vmcnt(0)
  ds_read2_b32 v[192:193], v12 offset1:16
  s_waitcnt lgkmcnt(0)
  v_max_u32 v192, v192, v193
  v_cmp_eq_u32 s[64:65], -1, v192
  s_cmp_lg_u64 s[64:65], 0
  s_cbranch_scc1 ffs_wait
  s_add_u32 s20, s20, 1
  s_cmp_lt_u32 s20, 63
  s_cselect_b32 s39, 32768, 0
  s_add_u32 s37, s37, s39
  s_xor_b32 s36, s36, 0x10000
  s_add_u32 s46, s46, 32768
  v_xor_b32 v12, 0x10000, v12
ffs_again:
  s_barrier
  ds_read_b128 v[16:19], v5 offset:0
  ds_read_b128 v[20:23], v5 offset:32
  ds_read_b128 v[24:27], v5 offset:64
  ds_read_b128 v[28:31], v5 offset:96
  ds_read_b128 v[32:35], v5 offset:128
  ds_read_b128 v[36:39], v5 offset:160
  s_waitcnt lgkmcnt(5)
  v_mfma_f32_32x32x16_bf16 v[48:63], a[0:3], v[16:19], 0
  ds_read_b128 v[40:43], v5 offset:192
  s_waitcnt lgkmcnt(5)
  v_mfma_f32_32x32x16_bf16 v[48:63], a[4:7], v[20:23], v[48:63]
  ds_read_b128 v[44:47], v5 offset:224
  v_max_u32 v9, v16, v20
  s_waitcnt lgkmcnt(5)
  v_mfma_f32_32x32x16_bf16 v[48:63], a[8:11], v[24:27], v[48:63]
  ds_read_b128 v[16:19], v5 offset:256
  s_waitcnt lgkmcnt(5)
  v_mfma_f32_32x32x16_bf16 v[48:63], a[12:15], v[28:31], v[48:63]
  ds_read_b128 v[20:23], v5 offset:288
  v_max3_u32 v9, v9, v24, v28
  s_waitcnt lgkmcnt(5)
  v_mfma_f32_32x32x16_bf16 v[48:63], a[16:19], v[32:35], v[48:63]
  ds_read_b128 v[24:27], v5 offset:320
  s_waitcnt lgkmcnt(5)
  v_mfma_f32_32x32x16_bf16 v[48:63], a[20:23], v[36:39], v[48:63]
  ds_read_b128 v[28:31], v5 offset:352
  v_max3_u32 v9, v9, v32, v36
  s_waitcnt lgkmcnt(5)
  v_mfma_f32_32x32x16_bf16 v[48:63], a[24:27], v[40:43], v[48:63]
  ds_read_b128 v[32:35], v5 offset:384
  s_waitcnt lgkmcnt(5)
  v_mfma_f32_32x32x16_bf16 v[48:63], a[28:31], v[44:47], v[48:63]
  ds_read_b128 v[36:39], v5 offset:416
  v_max3_u32 v9, v9, v40, v44
  s_branch ffs_mid
ffs_topp:
  s_barrier
  ds_read_b128 v[16:19], v5 offset:0
  ds_read_b128 v[20:23], v5 offset:32
  ds_read_b128 v[24:27], v5 offset:64
  ds_read_b128 v[28:31], v5 offset:96
  ds_read_b128 v[32:35], v5 offset:128
  ds_read_b128 v[36:39], v5 offset:160
  s_add_u32 s20, s20, 1
  s_cmp_lt_u32 s20, 63
  s_cselect_b32 s39, 32768, 0
  s_add_u32 s37, s37, s39
  s_xor_b32 s36, s36, 0x10000
  s_add_u32 s46, s46, 32768
  v_xor_b32 v12, 0x10000, v12
  v_cvt_pk_bf16_f32 v112, v160, v164
  v_cvt_pk_bf16_f32 v113, v168, v172
  v_cvt_pk_bf16_f32 v114, v176, v180
  v_cvt_pk_bf16_f32 v115, v184, v188
  v_and_or_b32 v112, v112, -2, s22
  s_add_u32 s33, s23, 262144
  buffer_store_dwordx4 v[112:115], v8, s[8:11], s33 offen sc1
  s_waitcnt lgkmcnt(5)
  v_mfma_f32_32x32x16_bf16 v[48:63], a[0:3], v[16:19], 0
  ds_read_b128 v[40:43], v5 offset:192
  v_cvt_pk_bf16_f32 v116, v161, v165
  v_cvt_pk_bf16_f32 v117, v169, v173
  v_cvt_pk_bf16_f32 v118, v177, v181
  s_waitcnt lgkmcnt(5)
  v_mfma_f32_32x32x16_bf16 v[48:63], a[4:7], v[20:23], v[48:63]
  ds_read_b128 v[44:47], v5 offset:224
  v_max_u32 v9, v16, v20
  v_cvt_pk_bf16_f32 v119, v185, v189
  v_and_or_b32 v116, v116, -2, s22
  s_add_u32 s33, s23, 278528
  s_waitcnt lgkmcnt(5)
  v_mfma_f32_32x32x16_bf16 v[48:63], a[8:11], v[24:27], v[48:63]
  ds_read_b128 v[16:19], v5 offset:256
  buffer_store_dwordx4 v[116:119], v8, s[8:11], s33 offen sc1
  v_cvt_pk_bf16_f32 v120, v162, v166
  v_cvt_pk_bf16_f32 v121, v170, v174
  s_waitcnt lgkmcnt(5)
  v_mfma_f32_32x32x16_bf16 v[48:63], a[12:15], v[28:31], v[48:63]
  ds_read_b128 v[20:23], v5 offset:288
  v_max3_u32 v9, v9, v24, v28
  v_cvt_pk_bf16_f32 v122, v178, v182
  v_cvt_pk_bf16_f32 v123, v186, v190
  v_and_or_b32 v120, v120, -2, s22
  s_waitcnt lgkmcnt(5)
  v_mfma_f32_32x32x16_bf16 v[48:63], a[16:19], v[32:35], v[48:63]
  ds_read_b128 v[24:27], v5 offset:320
  s_add_u32 s33, s23, 294912
  buffer_store_dwordx4 v[120:123], v8, s[8:11], s33 offen sc1
  v_cvt_pk_bf16_f32 v124, v163, v167
  s_waitcnt lgkmcnt(5)
  v_mfma_f32_32x32x16_bf16 v[48:63], a[20:23], v[36:39], v[48:63]
  ds_read_b128 v[28:31], v5 offset:352
  v_max3_u32 v9, v9, v32, v36
  v_cvt_pk_bf16_f32 v125, v171, v175
  v_cvt_pk_bf16_f32 v126, v179, v183
  v_cvt_pk_bf16_f32 v127, v187, v191
  s_waitcnt lgkmcnt(5)
  v_mfma_f32_32x32x16_bf16 v[48:63], a[24:27], v[40:43], v[48:63]
  ds_read_b128 v[32:35], v5 offset:384
  v_and_or_b32 v124, v124, -2, s22
  s_add_u32 s33, s23, 311296
  buffer_store_dwordx4 v[124:127], v8, s[8:11], s33 offen sc1
  s_waitcnt lgkmcnt(5)
  v_mfma_f32_32x32x16_bf16 v[48:63], a[28:31], v[44:47], v[48:63]
  ds_read_b128 v[36:39], v5 offset:416
  v_max3_u32 v9, v9, v40, v44
  s_mov_b64 exec, 1
  buffer_store_dword v2, off, s[8:11], s47 sc1
  s_mov_b64 exec, -1
ffs_mid:
  s_waitcnt lgkmcnt(5)
  v_mfma_f32_32x32x16_bf16 v[48:63], a[32:35], v[16:19], v[48:63]
  ds_read_b128 v[40:43], v5 offset:448
  s_mov_b64 exec, s[56:57]
  buffer_load_dword v10, v11, s[8:11], s46 offen sc1
  s_mov_b64 exec, -1
  s_waitcnt lgkmcnt(5)
  v_mfma_f32_32x32x16_bf16 v[48:63], a[36:39], v[20:23], v[48:63]
  ds_read_b128 v[44:47], v5 offset:480
  v_max3_u32 v9, v9, v16, v20
  s_waitcnt lgkmcnt(5)
  v_mfma_f32_32x32x16_bf16 v[48:63], a[40:43], v[24:27], v[48:63]
  ds_read_b128 v[16:19], v5 offset:512
  s_waitcnt lgkmcnt(5)
  v_mfma_f32_32x32x16_bf16 v[48:63], a[44:47], v[28:31], v[48:63]
  ds_read_b128 v[20:23], v5 offset:544
  v_max3_u32 v9, v9, v24, v28
  s_waitcnt lgkmcnt(5)
  v_mfma_f32_32x32x16_bf16 v[48:63], a[48:51], v[32:35], v[48:63]
  ds_read_b128 v[24:27], v5 offset:576
  s_waitcnt lgkmcnt(5)
  v_mfma_f32_32x32x16_bf16 v[48:63], a[52:55], v[36:39], v[48:63]
  ds_read_b128 v[28:31], v5 offset:608
  v_max3_u32 v9, v9, v32, v36
  s_waitcnt lgkmcnt(5)
  v_mfma_f32_32x32x16_bf16 v[48:63], a[56:59], v[40:43], v[48:63]
  ds_read_b128 v[32:35], v5 offset:640
  s_waitcnt lgkmcnt(5)
  v_mfma_f32_32x32x16_bf16 v[48:63], a[60:63], v[44:47], v[48:63]
  ds_read_b128 v[36:39], v5 offset:672
  v_max3_u32 v9, v9, v40, v44
  s_waitcnt lgkmcnt(5)
  v_mfma_f32_32x32x16_bf16 v[48:63], a[64:67], v[16:19], v[48:63]
  ds_read_b128 v[40:43], v5 offset:704
  s_waitcnt lgkmcnt(5)
  v_mfma_f32_32x32x16_bf16 v[48:63], a[68:71], v[20:23], v[48:63]
  ds_read_b128 v[44:47], v5 offset:736
  v_max3_u32 v9, v9, v16, v20
  s_waitcnt lgkmcnt(5)
  v_mfma_f32_32x32x16_bf16 v[48:63], a[72:75], v[24:27], v[48:63]
  ds_read_b128 v[16:19], v5 offset:768
  s_waitcnt lgkmcnt(5)
  v_mfma_f32_32x32x16_bf16 v[48:63], a[76:79], v[28:31], v[48:63]
  ds_read_b128 v[20:23], v5 offset:800
  v_max3_u32 v9, v9, v24, v28
  s_waitcnt lgkmcnt(5)
  v_mfma_f32_32x32x16_bf16 v[48:63], a[80:83], v[32:35], v[48:63]
  ds_read_b128 v[24:27], v5 offset:832
  s_mov_b64 exec, s[60:61]
  buffer_load_dword v10, v11, s[8:11], s37 offen sc1
  s_mov_b64 exec, -1
  s_waitcnt lgkmcnt(5)
  v_mfma_f32_32x32x16_bf16 v[48:63], a[84:87], v[36:39], v[48:63]
  ds_read_b128 v[28:31], v5 offset:864
  v_max3_u32 v9, v9, v32, v36
  buffer_load_dword v7, v6, s[8:11], 0 offen sc1
  s_sub_u32 s41, s20, 2
  s_add_u32 s40, s20, 2
  s_waitcnt lgkmcnt(5)
  v_mfma_f32_32x32x16_bf16 v[48:63], a[88:91], v[40:43], v[48:63]
  ds_read_b128 v[32:35], v5 offset:896
  s_waitcnt lgkmcnt(5)
  v_mfma_f32_32x32x16_bf16 v[48:63], a[92:95], v[44:47], v[48:63]
  ds_read_b128 v[36:39], v5 offset:928
  v_max3_u32 v9, v9, v40, v44
  s_waitcnt lgkmcnt(5)
  v_mfma_f32_32x32x16_bf16 v[48:63], a[96:99], v[16:19], v[48:63]
  ds_read_b128 v[40:43], v5 offset:960
  s_waitcnt lgkmcnt(5)
  v_mfma_f32_32x32x16_bf16 v[48:63], a[100:103], v[20:23], v[48:63]
  ds_read_b128 v[44:47], v5 offset:992
  v_max3_u32 v9, v9, v16, v20
  s_waitcnt lgkmcnt(5)
  v_mfma_f32_32x32x16_bf16 v[48:63], a[104:107], v[24:27], v[48:63]
  s_waitcnt lgkmcnt(4)
  v_mfma_f32_32x32x16_bf16 v[48:63], a[108:111], v[28:31], v[48:63]
  v_max3_u32 v9, v9, v24, v28
  s_waitcnt lgkmcnt(3)
  v_mfma_f32_32x32x16_bf16 v[48:63], a[112:115], v[32:35], v[48:63]
  s_waitcnt lgkmcnt(2)
  v_mfma_f32_32x32x16_bf16 v[48:63], a[116:119], v[36:39], v[48:63]
  v_max3_u32 v9, v9, v32, v36
  s_waitcnt lgkmcnt(1)
  v_mfma_f32_32x32x16_bf16 v[48:63], a[120:123], v[40:43], v[48:63]
  s_waitcnt lgkmcnt(0)
  v_mfma_f32_32x32x16_bf16 v[48:63], a[124:127], v[44:47], v[48:63]
  v_max3_u32 v9, v9, v40, v44
  v_cmp_eq_u32 vcc, -1, v9
  v_mov_b32 v2, s40
  s_cbranch_vccnz ffs_redo
  v_xor_b32 v5, 0x10000, v5
  s_nop 6
  v_cvt_pk_bf16_f32 v64, v48, v49
  v_cvt_pk_bf16_f32 v68, v56, v57
  v_cvt_pk_bf16_f32 v65, v50, v51
  v_cvt_pk_bf16_f32 v69, v58, v59
  v_cvt_pk_bf16_f32 v66, v52, v53
  v_cvt_pk_bf16_f32 v70, v60, v61
  v_cvt_pk_bf16_f32 v67, v54, v55
  v_cvt_pk_bf16_f32 v71, v62, v63
  v_permlane16_swap_b32 v64, v68
  v_permlane16_swap_b32 v65, v69
  v_permlane16_swap_b32 v66, v70
  v_permlane16_swap_b32 v67, v71
  v_pk_max_i16 v64, v64, 0
  v_pk_max_i16 v65, v65, 0
  v_pk_max_i16 v66, v66, 0
  v_pk_max_i16 v67, v67, 0
  v_pk_max_i16 v68, v68, 0
  v_pk_max_i16 v69, v69, 0
  v_pk_max_i16 v70, v70, 0
  v_pk_max_i16 v71, v71, 0
  v_mfma_f32_16x16x32_bf16 v[128:131], v[64:67], a[128:131], 0
  ds_write_b128 v13, v[64:67]
  v_mfma_f32_16x16x32_bf16 v[132:135], v[64:67], a[144:147], 0
  v_mfma_f32_16x16x32_bf16 v[136:139], v[64:67], a[160:163], 0
  s_add_u32 m0, s36, 0
  s_add_u32 s34, s37, 0
  buffer_load_dwordx4 v4, s[8:11], s34 offen sc1 lds
  v_mfma_f32_16x16x32_bf16 v[140:143], v[64:67], a[176:179], 0
  ds_write_b128 v13, v[68:71] offset:1024
  v_mfma_f32_16x16x32_bf16 v[144:147], v[64:67], a[192:195], 0
  v_mfma_f32_16x16x32_bf16 v[148:151], v[64:67], a[208:211], 0
  v_mfma_f32_16x16x32_bf16 v[152:155], v[64:67], a[224:227], 0
  v_mfma_f32_16x16x32_bf16 v[156:159], v[64:67], a[240:243], 0
  s_add_u32 m0, s36, 1040
  s_add_u32 s34, s37, 1024
  buffer_load_dwordx4 v4, s[8:11], s34 offen sc1 lds
  v_mfma_f32_16x16x32_bf16 v[160:163], v[68:71], a[128:131], 0
  v_mfma_f32_16x16x32_bf16 v[164:167], v[68:71], a[144:147], 0
  v_mfma_f32_16x16x32_bf16 v[168:171], v[68:71], a[160:163], 0
  s_waitcnt lgkmcnt(0)
  s_barrier
  ds_read_b128 v[72:75], v14 offset:0
  v_mfma_f32_16x16x32_bf16 v[172:175], v[68:71], a[176:179], 0
  ds_read_b128 v[76:79], v15 offset:0
  v_mfma_f32_16x16x32_bf16 v[176:179], v[68:71], a[192:195], 0
  ds_read_b128 v[80:83], v3 offset:0
  s_add_u32 m0, s36, 2080
  s_add_u32 s34, s37, 2048
  buffer_load_dwordx4 v4, s[8:11], s34 offen sc1 lds
  v_mfma_f32_16x16x32_bf16 v[180:183], v[68:71], a[208:211], 0
  ds_read_b128 v[84:87], v14 offset:1024
  v_mfma_f32_16x16x32_bf16 v[184:187], v[68:71], a[224:227], 0
  ds_read_b128 v[88:91], v15 offset:1024
  v_mfma_f32_16x16x32_bf16 v[188:191], v[68:71], a[240:243], 0
  ds_read_b128 v[92:95], v3 offset:1024
  s_waitcnt lgkmcnt(5)
  v_mfma_f32_16x16x32_bf16 v[128:131], v[72:75], a[132:135], v[128:131]
  v_mfma_f32_16x16x32_bf16 v[132:135], v[72:75], a[148:151], v[132:135]
  s_add_u32 m0, s36, 3120
  s_add_u32 s34, s37, 3072
  buffer_load_dwordx4 v4, s[8:11], s34 offen sc1 lds
  v_mfma_f32_16x16x32_bf16 v[136:139], v[72:75], a[164:167], v[136:139]
  v_mfma_f32_16x16x32_bf16 v[140:143], v[72:75], a[180:183], v[140:143]
  s_add_u32 s44, s44, 1
  s_cmp_eq_u32 s44, 3
  s_cselect_b32 s44, 0, s44
  v_mfma_f32_16x16x32_bf16 v[144:147], v[72:75], a[196:199], v[144:147]
  s_cselect_b32 s23, 1, 0
  s_xor_b32 s22, s22, s23
  v_mfma_f32_16x16x32_bf16 v[148:151], v[72:75], a[212:215], v[148:151]
  s_lshl_b32 s23, s44, 19
  s_add_u32 s23, s23, s38
  v_mfma_f32_16x16x32_bf16 v[152:155], v[72:75], a[228:231], v[152:155]
  s_add_u32 m0, s36, 4160
  s_add_u32 s34, s37, 4096
  buffer_load_dwordx4 v4, s[8:11], s34 offen sc1 lds
  v_mfma_f32_16x16x32_bf16 v[156:159], v[72:75], a[244:247], v[156:159]
  s_waitcnt lgkmcnt(4)
  v_mfma_f32_16x16x32_bf16 v[128:131], v[76:79], a[136:139], v[128:131]
  v_mfma_f32_16x16x32_bf16 v[132:135], v[76:79], a[152:155], v[132:135]
  v_mfma_f32_16x16x32_bf16 v[136:139], v[76:79], a[168:171], v[136:139]
  v_mfma_f32_16x16x32_bf16 v[140:143], v[76:79], a[184:187], v[140:143]
  s_add_u32 m0, s36, 5200
  s_add_u32 s34, s37, 5120
  buffer_load_dwordx4 v4, s[8:11], s34 offen sc1 lds
  v_mfma_f32_16x16x32_bf16 v[144:147], v[76:79], a[200:203], v[144:147]
  v_mfma_f32_16x16x32_bf16 v[148:151], v[76:79], a[216:219], v[148:151]
  v_mfma_f32_16x16x32_bf16 v[152:155], v[76:79], a[232:235], v[152:155]
  v_mfma_f32_16x16x32_bf16 v[156:159], v[76:79], a[248:251], v[156:159]
  s_waitcnt lgkmcnt(3)
  v_mfma_f32_16x16x32_bf16 v[128:131], v[80:83], a[140:143], v[128:131]
  s_add_u32 m0, s36, 6240
  s_add_u32 s34, s37, 6144
  buffer_load_dwordx4 v4, s[8:11], s34 offen sc1 lds
  v_mfma_f32_16x16x32_bf16 v[132:135], v[80:83], a[156:159], v[132:135]
  v_mfma_f32_16x16x32_bf16 v[136:139], v[80:83], a[172:175], v[136:139]
  v_mfma_f32_16x16x32_bf16 v[140:143], v[80:83], a[188:191], v[140:143]
  v_mfma_f32_16x16x32_bf16 v[144:147], v[80:83], a[204:207], v[144:147]
  v_mfma_f32_16x16x32_bf16 v[148:151], v[80:83], a[220:223], v[148:151]
  s_add_u32 m0, s36, 7280
  s_add_u32 s34, s37, 7168
  buffer_load_dwordx4 v4, s[8:11], s34 offen sc1 lds
  v_mfma_f32_16x16x32_bf16 v[152:155], v[80:83], a[236:239], v[152:155]
  s_waitcnt vmcnt(8)
  v_cmp_gt_i32 vcc, s41, v7
  v_mfma_f32_16x16x32_bf16 v[156:159], v[80:83], a[252:255], v[156:159]
  s_waitcnt lgkmcnt(2)
  v_mfma_f32_16x16x32_bf16 v[160:163], v[84:87], a[132:135], v[160:163]
  s_cbranch_vccnz ffs_ringwait
ffs_ringok:
  v_mfma_f32_16x16x32_bf16 v[164:167], v[84:87], a[148:151], v[164:167]
  v_cvt_pk_bf16_f32 v96, v128, v132
  v_cvt_pk_bf16_f32 v97, v136, v140
  v_mfma_f32_16x16x32_bf16 v[168:171], v[84:87], a[164:167], v[168:171]
  v_cvt_pk_bf16_f32 v98, v144, v148
  v_cvt_pk_bf16_f32 v99, v152, v156
  v_mfma_f32_16x16x32_bf16 v[172:175], v[84:87], a[180:183], v[172:175]
  v_and_or_b32 v96, v96, -2, s22
  v_mfma_f32_16x16x32_bf16 v[176:179], v[84:87], a[196:199], v[176:179]
  s_add_u32 s33, s23, 0
  v_mfma_f32_16x16x32_bf16 v[180:183], v[84:87], a[212:215], v[180:183]
  buffer_store_dwordx4 v[96:99], v8, s[8:11], s33 offen sc1
  v_cvt_pk_bf16_f32 v100, v129, v133
  v_cvt_pk_bf16_f32 v101, v137, v141
  v_mfma_f32_16x16x32_bf16 v[184:187], v[84:87], a[228:231], v[184:187]
  v_cvt_pk_bf16_f32 v102, v145, v149
  v_cvt_pk_bf16_f32 v103, v153, v157
  v_mfma_f32_16x16x32_bf16 v[188:191], v[84:87], a[244:247], v[188:191]
  v_and_or_b32 v100, v100, -2, s22
  s_waitcnt lgkmcnt(1)
  v_mfma_f32_16x16x32_bf16 v[160:163], v[88:91], a[136:139], v[160:163]
  s_add_u32 s33, s23, 16384
  v_mfma_f32_16x16x32_bf16 v[164:167], v[88:91], a[152:155], v[164:167]
  buffer_store_dwordx4 v[100:103], v8, s[8:11], s33 offen sc1
  v_cvt_pk_bf16_f32 v104, v130, v134
  v_cvt_pk_bf16_f32 v105, v138, v142
  v_mfma_f32_16x16x32_bf16 v[168:171], v[88:91], a[168:171], v[168:171]
  v_cvt_pk_bf16_f32 v106, v146, v150
  v_cvt_pk_bf16_f32 v107, v154, v158
  v_mfma_f32_16x16x32_bf16 v[172:175], v[88:91], a[184:187], v[172:175]
  v_and_or_b32 v104, v104, -2, s22
  v_mfma_f32_16x16x32_bf16 v[176:179], v[88:91], a[200:203], v[176:179]
  s_add_u32 s33, s23, 32768
  v_mfma_f32_16x16x32_bf16 v[180:183], v[88:91], a[216:219], v[180:183]
  buffer_store_dwordx4 v[104:107], v8, s[8:11], s33 offen sc1
  v_cvt_pk_bf16_f32 v108, v131, v135
  v_cvt_pk_bf16_f32 v109, v139, v143
  v_mfma_f32_16x16x32_bf16 v[184:187], v[88:91], a[232:235], v[184:187]
  v_cvt_pk_bf16_f32 v110, v147, v151
  v_cvt_pk_bf16_f32 v111, v155, v159
  v_mfma_f32_16x16x32_bf16 v[188:191], v[88:91], a[248:251], v[188:191]
  v_and_or_b32 v108, v108, -2, s22
  s_waitcnt lgkmcnt(0)
  v_mfma_f32_16x16x32_bf16 v[160:163], v[92:95], a[140:143], v[160:163]
  s_add_u32 s33, s23, 49152
  v_mfma_f32_16x16x32_bf16 v[164:167], v[92:95], a[156:159], v[164:167]
  buffer_store_dwordx4 v[108:111], v8, s[8:11], s33 offen sc1
  v_mfma_f32_16x16x32_bf16 v[168:171], v[92:95], a[172:175], v[168:171]
  s_waitcnt vmcnt(4)
  ds_read2_b32 v[192:193], v12 offset1:16
  v_mfma_f32_16x16x32_bf16 v[172:175], v[92:95], a[188:191], v[172:175]
  v_mfma_f32_16x16x32_bf16 v[176:179], v[92:95], a[204:207], v[176:179]
  v_mfma_f32_16x16x32_bf16 v[180:183], v[92:95], a[220:223], v[180:183]
  v_mfma_f32_16x16x32_bf16 v[184:187], v[92:95], a[236:239], v[184:187]
  s_waitcnt lgkmcnt(0)
  v_max_u32 v192, v192, v193
  v_cmp_eq_u32 s[64:65], -1, v192
  v_mfma_f32_16x16x32_bf16 v[188:191], v[92:95], a[252:255], v[188:191]
  s_cmp_eq_u32 s20, 63
  s_cbranch_scc1 ffs_last
  s_cmp_lg_u64 s[64:65], 0
  s_cbranch_scc0 ffs_topp
ffs_last:
  v_cvt_pk_bf16_f32 v112, v160, v164
  v_cvt_pk_bf16_f32 v113, v168, v172
  v_cvt_pk_bf16_f32 v114, v176, v180
  s_nop 2
  v_cvt_pk_bf16_f32 v115, v184, v188
  v_and_or_b32 v112, v112, -2, s22
  s_add_u32 s33, s23, 262144
  buffer_store_dwordx4 v[112:115], v8, s[8:11], s33 offen sc1
  v_cvt_pk_bf16_f32 v116, v161, v165
  v_cvt_pk_bf16_f32 v117, v169, v173
  v_cvt_pk_bf16_f32 v118, v177, v181
  v_cvt_pk_bf16_f32 v119, v185, v189
  v_and_or_b32 v116, v116, -2, s22
  s_add_u32 s33, s23, 278528
  buffer_store_dwordx4 v[116:119], v8, s[8:11], s33 offen sc1
  v_cvt_pk_bf16_f32 v120, v162, v166
  v_cvt_pk_bf16_f32 v121, v170, v174
  v_cvt_pk_bf16_f32 v122, v178, v182
  v_cvt_pk_bf16_f32 v123, v186, v190
  v_and_or_b32 v120, v120, -2, s22
  s_add_u32 s33, s23, 294912
  buffer_store_dwordx4 v[120:123], v8, s[8:11], s33 offen sc1
  v_cvt_pk_bf16_f32 v124, v163, v167
  v_cvt_pk_bf16_f32 v125, v171, v175
  v_cvt_pk_bf16_f32 v126, v179, v183
  v_cvt_pk_bf16_f32 v127, v187, v191
  v_and_or_b32 v124, v124, -2, s22
  s_add_u32 s33, s23, 311296
  buffer_store_dwordx4 v[124:127], v8, s[8:11], s33 offen sc1
  s_mov_b64 exec, 1
  buffer_store_dword v2, off, s[8:11], s47 sc1
  s_mov_b64 exec, -1
  s_cmp_eq_u32 s20, 63
  s_cbranch_scc0 ffs_wait
  s_branch ffn_fin
ffs_redo:
  s_sub_u32 s3, s3, 1
  s_cbranch_scc1 bail_39
  s_waitcnt lgkmcnt(0)
  s_barrier
  s_sub_u32 s34, s37, s39
  s_xor_b32 s33, s36, 0x10000
  s_add_u32 m0, s33, 0
  s_add_u32 s33, s34, 0
  buffer_load_dwordx4 v4, s[8:11], s33 offen sc1 lds
  s_xor_b32 s33, s36, 0x10000
  s_add_u32 m0, s33, 1040
  s_add_u32 s33, s34, 1024
  buffer_load_dwordx4 v4, s[8:11], s33 offen sc1 lds
  s_xor_b32 s33, s36, 0x10000
  s_add_u32 m0, s33, 2080
  s_add_u32 s33, s34, 2048
  buffer_load_dwordx4 v4, s[8:11], s33 offen sc1 lds
  s_xor_b32 s33, s36, 0x10000
  s_add_u32 m0, s33, 3120
  s_add_u32 s33, s34, 3072
  buffer_load_dwordx4 v4, s[8:11], s33 offen sc1 lds
  s_xor_b32 s33, s36, 0x10000
  s_add_u32 m0, s33, 4160
  s_add_u32 s33, s34, 4096
  buffer_load_dwordx4 v4, s[8:11], s33 offen sc1 lds
  s_xor_b32 s33, s36, 0x10000
  s_add_u32 m0, s33, 5200
  s_add_u32 s33, s34, 5120
  buffer_load_dwordx4 v4, s[8:11], s33 offen sc1 lds
  s_xor_b32 s33, s36, 0x10000
  s_add_u32 m0, s33, 6240
  s_add_u32 s33, s34, 6144
  buffer_load_dwordx4 v4, s[8:11], s33 offen sc1 lds
  s_xor_b32 s33, s36, 0x10000
  s_add_u32 m0, s33, 7280
  s_add_u32 s33, s34, 7168
  buffer_load_dwordx4 v4, s[8:11], s33 offen sc1 lds
  s_waitcnt vmcnt(0)
  s_branch ffs_again
ffs_ringwait:
  s_sub_u32 s3, s3, 1
  s_cbranch_scc1 bail_33
  buffer_load_dword v7, v6, s[8:11], 0 offen sc1
  s_waitcnt vmcnt(0)
  v_cmp_gt_i32 vcc, s41, v7
  s_cbranch_vccz ffs_ringok
  s_sleep 1
  s_branch ffs_ringwait
ffn_fin:
  s_branch the_end
ffn_R:
  s_sub_u32 s35, s35, 11
  s_mul_i32 s33, s7, 5
  s_add_u32 s33, s33, s35
  s_mul_i32 s33, s33, 16384
  v_lshlrev_b32 v2, 4, v0
  v_mov_b32 v4, 0
  v_mov_b32 v5, 0
  v_mov_b32 v6, 0
  v_mov_b32 v7, 0
  buffer_store_dwordx4 v[4:7], v2, s[8:11], s33 offen sc1
  s_add_u32 s33, s33, 4096
  buffer_store_dwordx4 v[4:7], v2, s[8:11], s33 offen sc1
  s_add_u32 s33, s33, 4096
  buffer_store_dwordx4 v[4:7], v2, s[8:11], s33 offen sc1
  s_add_u32 s33, s33, 4096
  buffer_store_dwordx4 v[4:7], v2, s[8:11], s33 offen sc1
  s_add_u32 s33, s33, 4096
  s_waitcnt vmcnt(0)
  s_barrier
  s_cmp_eq_u32 s4, 0
  s_cbranch_scc0 ffr_nz
  s_mov_b64 exec, 1
  v_mov_b32 v8, 1
  buffer_atomic_add v8, off, s[24:27], 0 offset:192 sc0 sc1
  s_waitcnt vmcnt(0)
  v_cmp_eq_u32 vcc, 9, v8
  s_cbranch_vccz ci_111
  v_mov_b32 v8, 1
  buffer_store_dword v8, off, s[24:27], 0 offset:80 sc1
ci_111:
  s_mov_b64 exec, -1
ffr_nz:
  s_lshl_b32 s31, s7, 21
  s_and_b32 s32, s6, 15
  s_mul_i32 s32, s32, 98304
  s_add_u32 s31, s31, s32
  s_add_u32 s31, s31, 18874368
  s_lshl_b32 s32, s4, 10
  v_lshl_add_u32 v3, v1, 4, s32
  v_mov_b32 v4, 0
  v_mov_b32 v5, 0
  v_mov_b32 v6, 0
  v_mov_b32 v7, 0
dm_115:
  v_and_b32 v11, 15, v1
  v_lshlrev_b32 v11, 2, v11
  v_add_u32 v10, 128, v11
  v_cmp_gt_u32 vcc, 4, v11
  s_nop 1
  v_cndmask_b32 v11, v10, v11, vcc
  buffer_load_dword v10, v11, s[24:27], 0 offen sc1
  s_waitcnt vmcnt(0)
  v_readlane_b32 s34, v10, s5
  s_nop 0
  s_cmp_ge_u32 s34, 32
  s_cbranch_scc1 dmf_116
  v_readlane_b32 s33, v10, 0
  v_readlane_b32 s34, v10, 1
  s_nop 0
  s_add_u32 s33, s33, s34
  v_readlane_b32 s34, v10, 2
  s_nop 0
  s_add_u32 s33, s33, s34
  v_readlane_b32 s34, v10, 3
  s_nop 0
  s_add_u32 s33, s33, s34
  v_readlane_b32 s34, v10, 4
  s_nop 0
  s_add_u32 s33, s33, s34
  v_readlane_b32 s34, v10, 5
  s_nop 0
  s_add_u32 s33, s33, s34
  v_readlane_b32 s34, v10, 6
  s_nop 0
  s_add_u32 s33, s33, s34
  v_readlane_b32 s34, v10, 7
  s_nop 0
  s_add_u32 s33, s33, s34
  v_readlane_b32 s34, v10, 8
  s_nop 0
  s_add_u32 s33, s33, s34
  v_readlane_b32 s34, v10, 9
  s_nop 0
  s_add_u32 s33, s33, s34
  v_readlane_b32 s34, v10, 10
  s_nop 0
  s_add_u32 s33, s33, s34
  v_readlane_b32 s34, v10, 11
  s_nop 0
  s_add_u32 s33, s33, s34
  v_readlane_b32 s34, v10, 12
  s_nop 0
  s_add_u32 s33, s33, s34
  v_readlane_b32 s34, v10, 13
  s_nop 0
  s_add_u32 s33, s33, s34
  v_readlane_b32 s34, v10, 14
  s_nop 0
  s_add_u32 s33, s33, s34
  v_readlane_b32 s34, v10, 15
  s_nop 0
  s_add_u32 s33, s33, s34
  s_cmp_ge_u32 s33, 256
  s_cbranch_scc1 ri_112
  s_sub_u32 s3, s3, 1
  s_cbranch_scc1 bail_2
  s_sleep 8
  s_branch dm_115
dmf_116:
  buffer_store_dwordx4 v[4:7], v3, s[8:11], s31 offen
  s_add_u32 s31, s31, 4096
  buffer_store_dwordx4 v[4:7], v3, s[8:11], s31 offen
  s_add_u32 s31, s31, 4096
  buffer_store_dwordx4 v[4:7], v3, s[8:11], s31 offen
  s_add_u32 s31, s31, 4096
  buffer_store_dwordx4 v[4:7], v3, s[8:11], s31 offen
  s_add_u32 s31, s31, 4096
  buffer_store_dwordx4 v[4:7], v3, s[8:11], s31 offen
  s_add_u32 s31, s31, 4096
  buffer_store_dwordx4 v[4:7], v3, s[8:11], s31 offen
  s_add_u32 s31, s31, 4096
  buffer_store_dwordx4 v[4:7], v3, s[8:11], s31 offen
  s_add_u32 s31, s31, 4096
  buffer_store_dwordx4 v[4:7], v3, s[8:11], s31 offen
  s_add_u32 s31, s31, 4096
  buffer_store_dwordx4 v[4:7], v3, s[8:11], s31 offen
  s_add_u32 s31, s31, 4096
  buffer_store_dwordx4 v[4:7], v3, s[8:11], s31 offen
  s_add_u32 s31, s31, 4096
  buffer_store_dwordx4 v[4:7], v3, s[8:11], s31 offen
  s_add_u32 s31, s31, 4096
  buffer_store_dwordx4 v[4:7], v3, s[8:11], s31 offen
  s_add_u32 s31, s31, 4096
  buffer_store_dwordx4 v[4:7], v3, s[8:11], s31 offen
  s_add_u32 s31, s31, 4096
  buffer_store_dwordx4 v[4:7], v3, s[8:11], s31 offen
  s_add_u32 s31, s31, 4096
  buffer_store_dwordx4 v[4:7], v3, s[8:11], s31 offen
  s_add_u32 s31, s31, 4096
  buffer_store_dwordx4 v[4:7], v3, s[8:11], s31 offen
  s_add_u32 s31, s31, 4096
  buffer_store_dwordx4 v[4:7], v3, s[8:11], s31 offen
  s_add_u32 s31, s31, 4096
  buffer_store_dwordx4 v[4:7], v3, s[8:11], s31 offen
  s_add_u32 s31, s31, 4096
  buffer_store_dwordx4 v[4:7], v3, s[8:11], s31 offen
  s_add_u32 s31, s31, 4096
  buffer_store_dwordx4 v[4:7], v3, s[8:11], s31 offen
  s_add_u32 s31, s31, 4096
  buffer_store_dwordx4 v[4:7], v3, s[8:11], s31 offen
  s_add_u32 s31, s31, 4096
  buffer_store_dwordx4 v[4:7], v3, s[8:11], s31 offen
  s_add_u32 s31, s31, 4096
  buffer_store_dwordx4 v[4:7], v3, s[8:11], s31 offen
  s_add_u32 s31, s31, 4096
  buffer_store_dwordx4 v[4:7], v3, s[8:11], s31 offen
  s_add_u32 s31, s31, 4096
  s_branch rie_113
ri_112:
  buffer_store_dwordx4 v[4:7], v3, s[8:11], s31 offen sc1
  s_add_u32 s31, s31, 4096
  buffer_store_dwordx4 v[4:7], v3, s[8:11], s31 offen sc1
  s_add_u32 s31, s31, 4096
  buffer_store_dwordx4 v[4:7], v3, s[8:11], s31 offen sc1
  s_add_u32 s31, s31, 4096
  buffer_store_dwordx4 v[4:7], v3, s[8:11], s31 offen sc1
  s_add_u32 s31, s31, 4096
  buffer_store_dwordx4 v[4:7], v3, s[8:11], s31 offen sc1
  s_add_u32 s31, s31, 4096
  buffer_store_dwordx4 v[4:7], v3, s[8:11], s31 offen sc1
  s_add_u32 s31, s31, 4096
  buffer_store_dwordx4 v[4:7], v3, s[8:11], s31 offen sc1
  s_add_u32 s31, s31, 4096
  buffer_store_dwordx4 v[4:7], v3, s[8:11], s31 offen sc1
  s_add_u32 s31, s31, 4096
  buffer_store_dwordx4 v[4:7], v3, s[8:11], s31 offen sc1
  s_add_u32 s31, s31, 4096
  buffer_store_dwordx4 v[4:7], v3, s[8:11], s31 offen sc1
  s_add_u32 s31, s31, 4096
  buffer_store_dwordx4 v[4:7], v3, s[8:11], s31 offen sc1
  s_add_u32 s31, s31, 4096
  buffer_store_dwordx4 v[4:7], v3, s[8:11], s31 offen sc1
  s_add_u32 s31, s31, 4096
  buffer_store_dwordx4 v[4:7], v3, s[8:11], s31 offen sc1
  s_add_u32 s31, s31, 4096
  buffer_store_dwordx4 v[4:7], v3, s[8:11], s31 offen sc1
  s_add_u32 s31, s31, 4096
  buffer_store_dwordx4 v[4:7], v3, s[8:11], s31 offen sc1
  s_add_u32 s31, s31, 4096
  buffer_store_dwordx4 v[4:7], v3, s[8:11], s31 offen sc1
  s_add_u32 s31, s31, 4096
  buffer_store_dwordx4 v[4:7], v3, s[8:11], s31 offen sc1
  s_add_u32 s31, s31, 4096
  buffer_store_dwordx4 v[4:7], v3, s[8:11], s31 offen sc1
  s_add_u32 s31, s31, 4096
  buffer_store_dwordx4 v[4:7], v3, s[8:11], s31 offen sc1
  s_add_u32 s31, s31, 4096
  buffer_store_dwordx4 v[4:7], v3, s[8:11], s31 offen sc1
  s_add_u32 s31, s31, 4096
  buffer_store_dwordx4 v[4:7], v3, s[8:11], s31 offen sc1
  s_add_u32 s31, s31, 4096
  buffer_store_dwordx4 v[4:7], v3, s[8:11], s31 offen sc1
  s_add_u32 s31, s31, 4096
  buffer_store_dwordx4 v[4:7], v3, s[8:11], s31 offen sc1
  s_add_u32 s31, s31, 4096
  buffer_store_dwordx4 v[4:7], v3, s[8:11], s31 offen sc1
  s_add_u32 s31, s31, 4096
rie_113:
  s_waitcnt vmcnt(0)
  s_barrier
  s_cmp_eq_u32 s4, 0
  s_cbranch_scc0 rid_114
  s_mov_b64 exec, 1
  v_mov_b32 v8, 1
  buffer_atomic_add v8, off, s[24:27], 0 offset:196 sc0 sc1
  s_waitcnt vmcnt(0)
  v_cmp_eq_u32 vcc, 95, v8
  s_cbranch_vccz ci_117
  v_mov_b32 v8, 1
  buffer_store_dword v8, off, s[24:27], 0 offset:84 sc1
ci_117:
  s_mov_b64 exec, -1
rid_114:
  s_mul_i32 s46, s4, 5
  s_add_u32 s46, s46, s35
  s_add_u32 s46, s46, 20
  s_lshl_b32 s35, s35, 2
  s_add_u32 s35, s35, s4
  s_sub_u32 s47, s46, s35
  s_lshl_b32 s48, s47, 14
  s_lshl_b32 s49, s47, 10
  s_cmp_eq_u32 s7, 0
  s_cselect_b32 s12, s88, s84
  s_cselect_b32 s13, s89, s85
  s_mov_b32 s14, 0x200000
  s_cselect_b32 s14, 0x10000000, s14
  s_mov_b32 s15, 0x20000
  s_cselect_b32 s37, 13631488, 0
  s_lshl_b32 s33, s35, 10
  s_add_u32 s37, s37, s33
  s_lshl_b32 s34, s7, 21
  s_add_u32 s36, s34, s33
  s_add_u32 s36, s36, 9404416
  s_lshl_b32 s33, s35, 14
  s_lshl_b32 s34, s7, 21
  s_add_u32 s38, s33, s34
  s_add_u32 s38, s38, 18874368
  s_lshl_b32 s33, s7, 7
  s_lshl_b32 s34, s35, 2
  s_add_u32 s33, s33, s34
  s_add_u32 s40, s33, 147968
  s_lshl_b32 s34, s35, 7
  s_add_u32 s39, s34, 122880
  s_lshl_b32 s33, s7, 8
  s_add_u32 s41, s33, 153600
  v_lshrrev_b32 v6, 4, v1
  v_lshlrev_b32 v6, 10, v6
  v_and_b32 v7, 15, v1
  v_lshl_add_u32 v6, v7, 4, v6
  v_lshlrev_b32 v7, 4, v1
  s_mov_b32 s43, 2
  s_mov_b32 s22, 0
  s_lshl_b32 s33, s47, 7
  v_mul_lo_u32 v2, s33, v1
  v_mov_b32 v8, 0
  v_cmp_gt_u32 vcc, 48, v1
  s_nop 1
  v_cndmask_b32_e64 v5, 0, -1, vcc
  v_mov_b32 v4, 0x40000000
  v_cndmask_b32 v4, v4, v6, vcc
  v_min_u32 v3, 43, v1
  v_lshlrev_b32 v3, 2, v3
  s_mov_b32 s20, 0
  v_bfe_u32 v10, v1, 1, 3
  v_and_b32 v11, 1, v1
  v_lshlrev_b32 v11, 4, v11
  v_mov_b32 v12, 0x3f80
  v_lshlrev_b32 v11, v11, v12
  v_cmp_eq_u32 vcc, 0, v10
  s_nop 1
  v_cndmask_b32 v16, 0, v11, vcc
  v_cmp_eq_u32 vcc, 4, v10
  s_nop 1
  v_cndmask_b32 v20, 0, v11, vcc
  v_cmp_eq_u32 vcc, 1, v10
  s_nop 1
  v_cndmask_b32 v17, 0, v11, vcc
  v_cmp_eq_u32 vcc, 5, v10
  s_nop 1
  v_cndmask_b32 v21, 0, v11, vcc
  v_cmp_eq_u32 vcc, 2, v10
  s_nop 1
  v_cndmask_b32 v18, 0, v11, vcc
  v_cmp_eq_u32 vcc, 6, v10
  s_nop 1
  v_cndmask_b32 v22, 0, v11, vcc
  v_cmp_eq_u32 vcc, 3, v10
  s_nop 1
  v_cndmask_b32 v19, 0, v11, vcc
  v_cmp_eq_u32 vcc, 7, v10
  s_nop 1
  v_cndmask_b32 v23, 0, v11, vcc
  v_mov_b32 v11, 84
  s_mov_b64 exec, 1
wd_118:
  buffer_load_dword v10, v11, s[24:27], 0 offen sc1
  s_waitcnt vmcnt(0)
  v_cmp_gt_u32 vcc, 1, v10
  s_cbranch_vccz wdd_119
  s_sub_u32 s3, s3, 1
  s_cbranch_scc1 bail_35
  s_sleep 8
  s_branch wd_118
wdd_119:
  s_mov_b64 exec, -1
  s_mov_b32 s42, 1
dm_120:
  v_and_b32 v11, 15, v1
  v_lshlrev_b32 v11, 2, v11
  v_add_u32 v10, 128, v11
  v_cmp_gt_u32 vcc, 4, v11
  s_nop 1
  v_cndmask_b32 v11, v10, v11, vcc
  buffer_load_dword v10, v11, s[24:27], 0 offen sc1
  s_waitcnt vmcnt(0)
  v_readlane_b32 s34, v10, s5
  s_nop 0
  s_cmp_ge_u32 s34, 32
  s_cbranch_scc1 dmf_121
  v_readlane_b32 s33, v10, 0
  v_readlane_b32 s34, v10, 1
  s_nop 0
  s_add_u32 s33, s33, s34
  v_readlane_b32 s34, v10, 2
  s_nop 0
  s_add_u32 s33, s33, s34
  v_readlane_b32 s34, v10, 3
  s_nop 0
  s_add_u32 s33, s33, s34
  v_readlane_b32 s34, v10, 4
  s_nop 0
  s_add_u32 s33, s33, s34
  v_readlane_b32 s34, v10, 5
  s_nop 0
  s_add_u32 s33, s33, s34
  v_readlane_b32 s34, v10, 6
  s_nop 0
  s_add_u32 s33, s33, s34
  v_readlane_b32 s34, v10, 7
  s_nop 0
  s_add_u32 s33, s33, s34
  v_readlane_b32 s34, v10, 8
  s_nop 0
  s_add_u32 s33, s33, s34
  v_readlane_b32 s34, v10, 9
  s_nop 0
  s_add_u32 s33, s33, s34
  v_readlane_b32 s34, v10, 10
  s_nop 0
  s_add_u32 s33, s33, s34
  v_readlane_b32 s34, v10, 11
  s_nop 0
  s_add_u32 s33, s33, s34
  v_readlane_b32 s34, v10, 12
  s_nop 0
  s_add_u32 s33, s33, s34
  v_readlane_b32 s34, v10, 13
  s_nop 0
  s_add_u32 s33, s33, s34
  v_readlane_b32 s34, v10, 14
  s_nop 0
  s_add_u32 s33, s33, s34
  v_readlane_b32 s34, v10, 15
  s_nop 0
  s_add_u32 s33, s33, s34
  s_cmp_ge_u32 s33, 256
  s_cbranch_scc1 ffr_sel
  s_sub_u32 s3, s3, 1
  s_cbranch_scc1 bail_2
  s_sleep 8
  s_branch dm_120
dmf_121:
  s_mov_b32 s42, 0
ffr_sel:
  v_mov_b32 v9, 0
  s_cmp_lt_u32 s46, 32
  s_cselect_b32 s33, 2, 0
  s_add_u32 s33, s33, s7
  s_mov_b32 s54, s33
  s_add_u32 s55, s36, 32768
  v_lshlrev_b32 v11, 7, v1
  s_cmp_lt_u32 s46, 32
  s_cselect_b32 s56, s48, 0
  s_add_u32 s56, s56, s38
  s_add_u32 s33, s38, 0
  buffer_load_dword v10, v11, s[8:11], s33 offen sc1
  s_add_u32 s33, s38, 8192
  buffer_load_dword v10, v11, s[8:11], s33 offen sc1
  s_add_u32 s33, s56, 0
  buffer_load_dword v10, v11, s[8:11], s33 offen sc1
  s_add_u32 s33, s56, 8192
  buffer_load_dword v10, v11, s[8:11], s33 offen sc1
  s_add_u32 s33, s38, 524288
  buffer_load_dword v10, v11, s[8:11], s33 offen sc1
  s_add_u32 s33, s38, 532480
  buffer_load_dword v10, v11, s[8:11], s33 offen sc1
  s_add_u32 s33, s56, 524288
  buffer_load_dword v10, v11, s[8:11], s33 offen sc1
  s_add_u32 s33, s56, 532480
  buffer_load_dword v10, v11, s[8:11], s33 offen sc1
  s_add_u32 s33, s38, 1048576
  buffer_load_dword v10, v11, s[8:11], s33 offen sc1
  s_add_u32 s33, s38, 1056768
  buffer_load_dword v10, v11, s[8:11], s33 offen sc1
  s_add_u32 s33, s56, 1048576
  buffer_load_dword v10, v11, s[8:11], s33 offen sc1
  s_add_u32 s33, s56, 1056768
  buffer_load_dword v10, v11, s[8:11], s33 offen sc1
  s_mov_b64 exec, 1
lw_122:
  s_sub_u32 s3, s3, 1
  s_cbranch_scc1 bail_38
  s_sleep 16
  buffer_load_dword v10, off, s[8:11], s55 sc1
  s_waitcnt vmcnt(0)
  v_cmp_eq_u32 vcc, -1, v10
  s_cbranch_vccnz lw_122
  s_mov_b64 exec, -1
  s_cmp_eq_u32 s54, 1
  s_cbranch_scc1 ffr1_loop
  s_cmp_eq_u32 s54, 2
  s_cbranch_scc1 ffr2_loop
  s_cmp_eq_u32 s54, 3
  s_cbranch_scc1 ffr3_loop
ffr0_loop:
  s_add_u32 s21, s20, 1
  s_add_u32 s45, s20, 2
  v_cmp_gt_u32 vcc, s45, v9
  s_add_u32 s43, s43, 1
  s_cmp_eq_u32 s43, 3
  s_cselect_b32 s43, 0, s43
  s_cselect_b32 s23, 1, 0
  s_xor_b32 s22, s22, s23
  s_lshl_b32 s23, s43, 19
  s_add_u32 s23, s23, s38
  s_add_u32 s36, s36, 32768
  s_add_u32 s50, s23, s48
  s_add_u32 s51, s36, s49
  s_cbranch_vccz ffr0_g
ffr0_p:
  buffer_load_dword v9, v3, s[8:11], s41 offen sc1
  s_sub_u32 s3, s3, 1
  s_cbranch_scc1 bail_37
  s_waitcnt vmcnt(0)
  v_cmp_gt_u32 vcc, s45, v9
  s_cbranch_vccnz ffr0_p
ffr0_g:
  buffer_load_dwordx4 v[32:35], v7, s[8:11], s36 offen sc1
  buffer_load_dwordx4 v[64:67], v6, s[8:11], s23 offen offset:0 sc1
  buffer_load_dwordx4 v[68:71], v6, s[8:11], s23 offen offset:256 sc1
  buffer_load_dwordx4 v[72:75], v6, s[8:11], s23 offen offset:512 sc1
  buffer_load_dwordx4 v[76:79], v6, s[8:11], s23 offen offset:768 sc1
  s_add_u32 s33, s23, 4096
  buffer_load_dwordx4 v[80:83], v6, s[8:11], s33 offen offset:0 sc1
  buffer_load_dwordx4 v[84:87], v6, s[8:11], s33 offen offset:256 sc1
  buffer_load_dwordx4 v[88:91], v6, s[8:11], s33 offen offset:512 sc1
  buffer_load_dwordx4 v[92:95], v6, s[8:11], s33 offen offset:768 sc1
  s_add_u32 s33, s23, 8192
  buffer_load_dwordx4 v[96:99], v4, s[8:11], s33 offen offset:0 sc1
  buffer_load_dwordx4 v[100:103], v4, s[8:11], s33 offen offset:256 sc1
  buffer_load_dwordx4 v[104:107], v4, s[8:11], s33 offen offset:512 sc1
  buffer_load_dwordx4 v[108:111], v4, s[8:11], s33 offen offset:768 sc1
  s_sub_u32 s44, s37, 10485760
  s_add_u32 s52, s44, s49
  s_add_u32 s53, s37, s49
  s_waitcnt vmcnt(12)
  v_cmp_eq_u32 vcc, -1, v32
  v_permlane16_swap_b32 v32, v34
  v_permlane16_swap_b32 v33, v35
  v_lshlrev_b32 v40, 16, v32
  v_and_b32 v41, 0xffff0000, v32
  v_lshlrev_b32 v42, 16, v33
  v_and_b32 v43, 0xffff0000, v33
  v_lshlrev_b32 v44, 16, v34
  v_and_b32 v45, 0xffff0000, v34
  v_lshlrev_b32 v46, 16, v35
  v_and_b32 v47, 0xffff0000, v35
  s_cbranch_vccnz ffr0_p
  s_waitcnt vmcnt(11)
  v_mfma_f32_16x16x32_bf16 v[24:27], v[16:19], v[64:67], v[40:43]
  v_xor_b32 v10, s22, v64
  s_waitcnt vmcnt(10)
  v_mfma_f32_16x16x32_bf16 v[28:31], v[16:19], v[68:71], v[44:47]
  v_bitop3_b32 v10, v10, s22, v68 bitop3:0xf6
  s_waitcnt vmcnt(9)
  v_mfma_f32_16x16x32_bf16 v[24:27], v[20:23], v[72:75], v[24:27]
  v_bitop3_b32 v10, v10, s22, v72 bitop3:0xf6
  s_waitcnt vmcnt(8)
  v_mfma_f32_16x16x32_bf16 v[28:31], v[20:23], v[76:79], v[28:31]
  v_bitop3_b32 v10, v10, s22, v76 bitop3:0xf6
  s_waitcnt vmcnt(7)
  v_mfma_f32_16x16x32_bf16 v[24:27], v[16:19], v[80:83], v[24:27]
  v_bitop3_b32 v10, v10, s22, v80 bitop3:0xf6
  s_waitcnt vmcnt(6)
  v_mfma_f32_16x16x32_bf16 v[28:31], v[16:19], v[84:87], v[28:31]
  v_bitop3_b32 v10, v10, s22, v84 bitop3:0xf6
  s_waitcnt vmcnt(5)
  v_mfma_f32_16x16x32_bf16 v[24:27], v[20:23], v[88:91], v[24:27]
  v_bitop3_b32 v10, v10, s22, v88 bitop3:0xf6
  s_waitcnt vmcnt(4)
  v_mfma_f32_16x16x32_bf16 v[28:31], v[20:23], v[92:95], v[28:31]
  v_bitop3_b32 v10, v10, s22, v92 bitop3:0xf6
  s_waitcnt vmcnt(3)
  v_mfma_f32_16x16x32_bf16 v[24:27], v[16:19], v[96:99], v[24:27]
  v_xor_b32 v11, s22, v96
  s_waitcnt vmcnt(2)
  v_mfma_f32_16x16x32_bf16 v[28:31], v[16:19], v[100:103], v[28:31]
  v_bitop3_b32 v11, v11, s22, v100 bitop3:0xf6
  s_waitcnt vmcnt(1)
  v_mfma_f32_16x16x32_bf16 v[24:27], v[20:23], v[104:107], v[24:27]
  v_bitop3_b32 v11, v11, s22, v104 bitop3:0xf6
  s_waitcnt vmcnt(0)
  v_mfma_f32_16x16x32_bf16 v[28:31], v[20:23], v[108:111], v[28:31]
  v_bitop3_b32 v11, v11, s22, v108 bitop3:0xf6
  v_and_or_b32 v10, v11, v5, v10
  v_and_b32 v10, 1, v10
  v_cmp_ne_u32 vcc, 0, v10
  s_cbranch_vccnz ffr0_p
  v_mov_b32 v13, s21
  s_mov_b64 exec, 1
  s_cmp_eq_u32 s42, 0
  s_cbranch_scc0 dn_123
  buffer_store_dword v13, v8, s[8:11], s40 offen
  s_branch dne_124
dn_123:
  buffer_store_dword v13, v8, s[8:11], s40 offen sc1
dne_124:
  s_mov_b64 exec, -1
  buffer_load_dword v9, v3, s[8:11], s41 offen sc1
  v_pk_add_f32 v[12:13], v[24:25], v[26:27]
  v_pk_mul_f32 v[14:15], v[24:25], v[24:25]
  v_pk_add_f32 v[12:13], v[12:13], v[28:29]
  v_pk_fma_f32 v[14:15], v[26:27], v[26:27], v[14:15]
  v_pk_add_f32 v[12:13], v[12:13], v[30:31]
  v_pk_fma_f32 v[14:15], v[28:29], v[28:29], v[14:15]
  v_add_f32 v12, v12, v13
  v_pk_fma_f32 v[14:15], v[30:31], v[30:31], v[14:15]
  v_add_f32 v14, v14, v15
  s_nop 1
  v_permlane32_swap_b32 v12, v14
  v_add_f32 v12, v12, v14
  v_cvt_pk_bf16_f32 v48, v24, v25
  v_cvt_pk_bf16_f32 v49, v26, v27
  v_add_f32_dpp v12, v12, v12 row_ror:8 row_mask:0xf bank_mask:0xf
  v_cvt_pk_bf16_f32 v50, v28, v29
  v_cvt_pk_bf16_f32 v51, v30, v31
  v_add_f32_dpp v12, v12, v12 row_ror:4 row_mask:0xf bank_mask:0xf
  v_permlane16_swap_b32 v48, v50
  v_permlane16_swap_b32 v49, v51
  v_add_f32_dpp v12, v12, v12 row_ror:2 row_mask:0xf bank_mask:0xf
  v_min_u32 v48, -2, v48
  s_nop 0
  v_add_f32_dpp v12, v12, v12 row_ror:1 row_mask:0xf bank_mask:0xf
  v_mov_b32 v13, v12
  s_nop 1
  v_permlane16_swap_b32 v13, v12
  v_add_f32 v14, v12, v13
  v_add_f32 v12, v12, v13
  v_mov_b32 v15, 0x3727c5ac
  s_nop 0
  v_permlane32_swap_b32 v12, v14
  v_mul_f32 v12, 0x3b000000, v12
  v_mul_f32 v14, 0x3b000000, v14
  v_fma_f32 v14, -v12, v12, v14
  v_max_f32 v14, 0, v14
  v_add_f32 v14, v14, v15
  v_rsq_f32 v14, v14
  v_pk_add_f32 v[24:25], v[24:25], v[12:13] op_sel_hi:[1,0] neg_lo:[0,1] neg_hi:[0,1]
  v_pk_add_f32 v[26:27], v[26:27], v[12:13] op_sel_hi:[1,0] neg_lo:[0,1] neg_hi:[0,1]
  v_pk_add_f32 v[28:29], v[28:29], v[12:13] op_sel_hi:[1,0] neg_lo:[0,1] neg_hi:[0,1]
  v_pk_add_f32 v[30:31], v[30:31], v[12:13] op_sel_hi:[1,0] neg_lo:[0,1] neg_hi:[0,1]
  v_pk_mul_f32 v[24:25], v[24:25], v[14:15] op_sel_hi:[1,0]
  v_pk_mul_f32 v[26:27], v[26:27], v[14:15] op_sel_hi:[1,0]
  v_pk_mul_f32 v[28:29], v[28:29], v[14:15] op_sel_hi:[1,0]
  v_pk_mul_f32 v[30:31], v[30:31], v[14:15] op_sel_hi:[1,0]
  v_cvt_pk_bf16_f32 v52, v24, v25
  v_cvt_pk_bf16_f32 v54, v28, v29
  v_cvt_pk_bf16_f32 v53, v26, v27
  v_cvt_pk_bf16_f32 v55, v30, v31
  v_permlane16_swap_b32 v52, v54
  s_nop 0
  v_permlane16_swap_b32 v53, v55
  v_min_u32 v52, -2, v52
  buffer_store_dwordx4 v[52:55], v7, s[8:11], s44 offen sc1
  buffer_store_dwordx4 v[48:51], v7, s[12:15], s37 offen sc1
  s_add_u32 s37, s37, 32768
  s_mov_b32 s20, s21
  s_waitcnt vmcnt(2)
  s_cmp_lt_u32 s20, 64
  s_cbranch_scc1 ffr0_loop
  s_branch the_end
ffr1_loop:
  s_add_u32 s21, s20, 1
  s_add_u32 s45, s20, 2
  v_cmp_gt_u32 vcc, s45, v9
  s_add_u32 s43, s43, 1
  s_cmp_eq_u32 s43, 3
  s_cselect_b32 s43, 0, s43
  s_cselect_b32 s23, 1, 0
  s_xor_b32 s22, s22, s23
  s_lshl_b32 s23, s43, 19
  s_add_u32 s23, s23, s38
  s_add_u32 s36, s36, 32768
  s_add_u32 s50, s23, s48
  s_add_u32 s51, s36, s49
  s_cbranch_vccz ffr1_g
ffr1_p:
  buffer_load_dword v9, v3, s[8:11], s41 offen sc1
  s_sub_u32 s3, s3, 1
  s_cbranch_scc1 bail_37
  s_waitcnt vmcnt(0)
  v_cmp_gt_u32 vcc, s45, v9
  s_cbranch_vccnz ffr1_p
ffr1_g:
  buffer_load_dwordx4 v[32:35], v7, s[8:11], s36 offen sc1
  buffer_load_dwordx4 v[64:67], v6, s[8:11], s23 offen offset:0 sc1
  buffer_load_dwordx4 v[68:71], v6, s[8:11], s23 offen offset:256 sc1
  buffer_load_dwordx4 v[72:75], v6, s[8:11], s23 offen offset:512 sc1
  buffer_load_dwordx4 v[76:79], v6, s[8:11], s23 offen offset:768 sc1
  s_add_u32 s33, s23, 4096
  buffer_load_dwordx4 v[80:83], v6, s[8:11], s33 offen offset:0 sc1
  buffer_load_dwordx4 v[84:87], v6, s[8:11], s33 offen offset:256 sc1
  buffer_load_dwordx4 v[88:91], v6, s[8:11], s33 offen offset:512 sc1
  buffer_load_dwordx4 v[92:95], v6, s[8:11], s33 offen offset:768 sc1
  s_add_u32 s33, s23, 8192
  buffer_load_dwordx4 v[96:99], v4, s[8:11], s33 offen offset:0 sc1
  buffer_load_dwordx4 v[100:103], v4, s[8:11], s33 offen offset:256 sc1
  buffer_load_dwordx4 v[104:107], v4, s[8:11], s33 offen offset:512 sc1
  buffer_load_dwordx4 v[108:111], v4, s[8:11], s33 offen offset:768 sc1
  s_sub_u32 s44, s37, 10485760
  s_add_u32 s52, s44, s49
  s_add_u32 s53, s37, s49
  s_waitcnt vmcnt(12)
  v_cmp_eq_u32 vcc, -1, v32
  v_permlane16_swap_b32 v32, v34
  v_permlane16_swap_b32 v33, v35
  v_lshlrev_b32 v40, 16, v32
  v_and_b32 v41, 0xffff0000, v32
  v_lshlrev_b32 v42, 16, v33
  v_and_b32 v43, 0xffff0000, v33
  v_lshlrev_b32 v44, 16, v34
  v_and_b32 v45, 0xffff0000, v34
  v_lshlrev_b32 v46, 16, v35
  v_and_b32 v47, 0xffff0000, v35
  s_cbranch_vccnz ffr1_p
  s_waitcnt vmcnt(11)
  v_mfma_f32_16x16x32_bf16 v[24:27], v[16:19], v[64:67], v[40:43]
  v_xor_b32 v10, s22, v64
  s_waitcnt vmcnt(10)
  v_mfma_f32_16x16x32_bf16 v[28:31], v[16:19], v[68:71], v[44:47]
  v_bitop3_b32 v10, v10, s22, v68 bitop3:0xf6
  s_waitcnt vmcnt(9)
  v_mfma_f32_16x16x32_bf16 v[24:27], v[20:23], v[72:75], v[24:27]
  v_bitop3_b32 v10, v10, s22, v72 bitop3:0xf6
  s_waitcnt vmcnt(8)
  v_mfma_f32_16x16x32_bf16 v[28:31], v[20:23], v[76:79], v[28:31]
  v_bitop3_b32 v10, v10, s22, v76 bitop3:0xf6
  s_waitcnt vmcnt(7)
  v_mfma_f32_16x16x32_bf16 v[24:27], v[16:19], v[80:83], v[24:27]
  v_bitop3_b32 v10, v10, s22, v80 bitop3:0xf6
  s_waitcnt vmcnt(6)
  v_mfma_f32_16x16x32_bf16 v[28:31], v[16:19], v[84:87], v[28:31]
  v_bitop3_b32 v10, v10, s22, v84 bitop3:0xf6
  s_waitcnt vmcnt(5)
  v_mfma_f32_16x16x32_bf16 v[24:27], v[20:23], v[88:91], v[24:27]
  v_bitop3_b32 v10, v10, s22, v88 bitop3:0xf6
  s_waitcnt vmcnt(4)
  v_mfma_f32_16x16x32_bf16 v[28:31], v[20:23], v[92:95], v[28:31]
  v_bitop3_b32 v10, v10, s22, v92 bitop3:0xf6
  s_waitcnt vmcnt(3)
  v_mfma_f32_16x16x32_bf16 v[24:27], v[16:19], v[96:99], v[24:27]
  v_xor_b32 v11, s22, v96
  s_waitcnt vmcnt(2)
  v_mfma_f32_16x16x32_bf16 v[28:31], v[16:19], v[100:103], v[28:31]
  v_bitop3_b32 v11, v11, s22, v100 bitop3:0xf6
  s_waitcnt vmcnt(1)
  v_mfma_f32_16x16x32_bf16 v[24:27], v[20:23], v[104:107], v[24:27]
  v_bitop3_b32 v11, v11, s22, v104 bitop3:0xf6
  s_waitcnt vmcnt(0)
  v_mfma_f32_16x16x32_bf16 v[28:31], v[20:23], v[108:111], v[28:31]
  v_bitop3_b32 v11, v11, s22, v108 bitop3:0xf6
  v_and_or_b32 v10, v11, v5, v10
  v_and_b32 v10, 1, v10
  v_cmp_ne_u32 vcc, 0, v10
  s_cbranch_vccnz ffr1_p
  v_mov_b32 v13, s21
  s_mov_b64 exec, 1
  s_cmp_eq_u32 s42, 0
  s_cbranch_scc0 dn_125
  buffer_store_dword v13, v8, s[8:11], s40 offen
  s_branch dne_126
dn_125:
  buffer_store_dword v13, v8, s[8:11], s40 offen sc1
dne_126:
  s_mov_b64 exec, -1
  buffer_load_dword v9, v3, s[8:11], s41 offen sc1
  v_cvt_pk_bf16_f32 v48, v24, v25
  v_cvt_pk_bf16_f32 v50, v28, v29
  v_cvt_pk_bf16_f32 v49, v26, v27
  v_cvt_pk_bf16_f32 v51, v30, v31
  v_permlane16_swap_b32 v48, v50
  s_nop 0
  v_permlane16_swap_b32 v49, v51
  buffer_store_dwordx4 v[48:51], v7, s[12:15], s37 offen
  s_add_u32 s37, s37, 32768
  s_mov_b32 s20, s21
  s_waitcnt vmcnt(1)
  s_cmp_lt_u32 s20, 64
  s_cbranch_scc1 ffr1_loop
  s_branch the_end
ffr2_loop:
  s_add_u32 s21, s20, 1
  s_add_u32 s45, s20, 2
  v_cmp_gt_u32 vcc, s45, v9
  s_add_u32 s43, s43, 1
  s_cmp_eq_u32 s43, 3
  s_cselect_b32 s43, 0, s43
  s_cselect_b32 s23, 1, 0
  s_xor_b32 s22, s22, s23
  s_lshl_b32 s23, s43, 19
  s_add_u32 s23, s23, s38
  s_add_u32 s36, s36, 32768
  s_add_u32 s50, s23, s48
  s_add_u32 s51, s36, s49
  s_cbranch_vccz ffr2_g
ffr2_p:
  buffer_load_dword v9, v3, s[8:11], s41 offen sc1
  s_sub_u32 s3, s3, 1
  s_cbranch_scc1 bail_37
  s_waitcnt vmcnt(0)
  v_cmp_gt_u32 vcc, s45, v9
  s_cbranch_vccnz ffr2_p
ffr2_g:
  buffer_load_dwordx4 v[32:35], v7, s[8:11], s36 offen sc1
  buffer_load_dwordx4 v[64:67], v6, s[8:11], s23 offen offset:0 sc1
  buffer_load_dwordx4 v[68:71], v6, s[8:11], s23 offen offset:256 sc1
  buffer_load_dwordx4 v[72:75], v6, s[8:11], s23 offen offset:512 sc1
  buffer_load_dwordx4 v[76:79], v6, s[8:11], s23 offen offset:768 sc1
  s_add_u32 s33, s23, 4096
  buffer_load_dwordx4 v[80:83], v6, s[8:11], s33 offen offset:0 sc1
  buffer_load_dwordx4 v[84:87], v6, s[8:11], s33 offen offset:256 sc1
  buffer_load_dwordx4 v[88:91], v6, s[8:11], s33 offen offset:512 sc1
  buffer_load_dwordx4 v[92:95], v6, s[8:11], s33 offen offset:768 sc1
  s_add_u32 s33, s23, 8192
  buffer_load_dwordx4 v[96:99], v4, s[8:11], s33 offen offset:0 sc1
  buffer_load_dwordx4 v[100:103], v4, s[8:11], s33 offen offset:256 sc1
  buffer_load_dwordx4 v[104:107], v4, s[8:11], s33 offen offset:512 sc1
  buffer_load_dwordx4 v[108:111], v4, s[8:11], s33 offen offset:768 sc1
  buffer_load_dwordx4 v[36:39], v7, s[8:11], s51 offen sc1
  buffer_load_dwordx4 v[112:115], v6, s[8:11], s50 offen offset:0 sc1
  buffer_load_dwordx4 v[116:119], v6, s[8:11], s50 offen offset:256 sc1
  buffer_load_dwordx4 v[120:123], v6, s[8:11], s50 offen offset:512 sc1
  s_sub_u32 s44, s37, 10485760
  s_add_u32 s52, s44, s49
  s_add_u32 s53, s37, s49
  s_waitcnt vmcnt(16)
  v_cmp_eq_u32 vcc, -1, v32
  v_permlane16_swap_b32 v32, v34
  v_permlane16_swap_b32 v33, v35
  v_lshlrev_b32 v40, 16, v32
  v_and_b32 v41, 0xffff0000, v32
  v_lshlrev_b32 v42, 16, v33
  v_and_b32 v43, 0xffff0000, v33
  v_lshlrev_b32 v44, 16, v34
  v_and_b32 v45, 0xffff0000, v34
  v_lshlrev_b32 v46, 16, v35
  v_and_b32 v47, 0xffff0000, v35
  s_cbranch_vccnz ffr2_p
  buffer_load_dwordx4 v[124:127], v6, s[8:11], s50 offen offset:768 sc1
  s_waitcnt vmcnt(16)
  v_mfma_f32_16x16x32_bf16 v[24:27], v[16:19], v[64:67], v[40:43]
  v_xor_b32 v10, s22, v64
  s_add_u32 s33, s50, 4096
  buffer_load_dwordx4 v[128:131], v6, s[8:11], s33 offen offset:0 sc1
  s_waitcnt vmcnt(16)
  v_mfma_f32_16x16x32_bf16 v[28:31], v[16:19], v[68:71], v[44:47]
  v_bitop3_b32 v10, v10, s22, v68 bitop3:0xf6
  buffer_load_dwordx4 v[132:135], v6, s[8:11], s33 offen offset:256 sc1
  s_waitcnt vmcnt(16)
  v_mfma_f32_16x16x32_bf16 v[24:27], v[20:23], v[72:75], v[24:27]
  v_bitop3_b32 v10, v10, s22, v72 bitop3:0xf6
  buffer_load_dwordx4 v[136:139], v6, s[8:11], s33 offen offset:512 sc1
  s_waitcnt vmcnt(16)
  v_mfma_f32_16x16x32_bf16 v[28:31], v[20:23], v[76:79], v[28:31]
  v_bitop3_b32 v10, v10, s22, v76 bitop3:0xf6
  buffer_load_dwordx4 v[140:143], v6, s[8:11], s33 offen offset:768 sc1
  s_waitcnt vmcnt(16)
  v_mfma_f32_16x16x32_bf16 v[24:27], v[16:19], v[80:83], v[24:27]
  v_bitop3_b32 v10, v10, s22, v80 bitop3:0xf6
  s_add_u32 s33, s50, 8192
  buffer_load_dwordx4 v[144:147], v4, s[8:11], s33 offen offset:0 sc1
  s_waitcnt vmcnt(16)
  v_mfma_f32_16x16x32_bf16 v[28:31], v[16:19], v[84:87], v[28:31]
  v_bitop3_b32 v10, v10, s22, v84 bitop3:0xf6
  buffer_load_dwordx4 v[148:151], v4, s[8:11], s33 offen offset:256 sc1
  s_waitcnt vmcnt(16)
  v_mfma_f32_16x16x32_bf16 v[24:27], v[20:23], v[88:91], v[24:27]
  v_bitop3_b32 v10, v10, s22, v88 bitop3:0xf6
  buffer_load_dwordx4 v[152:155], v4, s[8:11], s33 offen offset:512 sc1
  s_waitcnt vmcnt(16)
  v_mfma_f32_16x16x32_bf16 v[28:31], v[20:23], v[92:95], v[28:31]
  v_bitop3_b32 v10, v10, s22, v92 bitop3:0xf6
  buffer_load_dwordx4 v[156:159], v4, s[8:11], s33 offen offset:768 sc1
  s_waitcnt vmcnt(16)
  v_mfma_f32_16x16x32_bf16 v[24:27], v[16:19], v[96:99], v[24:27]
  v_xor_b32 v11, s22, v96
  s_waitcnt vmcnt(15)
  v_mfma_f32_16x16x32_bf16 v[28:31], v[16:19], v[100:103], v[28:31]
  v_bitop3_b32 v11, v11, s22, v100 bitop3:0xf6
  s_waitcnt vmcnt(14)
  v_mfma_f32_16x16x32_bf16 v[24:27], v[20:23], v[104:107], v[24:27]
  v_bitop3_b32 v11, v11, s22, v104 bitop3:0xf6
  s_waitcnt vmcnt(13)
  v_mfma_f32_16x16x32_bf16 v[28:31], v[20:23], v[108:111], v[28:31]
  v_bitop3_b32 v11, v11, s22, v108 bitop3:0xf6
  v_and_or_b32 v10, v11, v5, v10
  v_and_b32 v10, 1, v10
  v_cmp_ne_u32 vcc, 0, v10
  s_cbranch_vccnz ffr2_p
  v_pk_add_f32 v[12:13], v[24:25], v[26:27]
  v_pk_mul_f32 v[14:15], v[24:25], v[24:25]
  s_nop 0
  v_pk_add_f32 v[12:13], v[12:13], v[28:29]
  v_pk_fma_f32 v[14:15], v[26:27], v[26:27], v[14:15]
  v_pk_add_f32 v[12:13], v[12:13], v[30:31]
  v_pk_fma_f32 v[14:15], v[28:29], v[28:29], v[14:15]
  v_add_f32 v12, v12, v13
  v_pk_fma_f32 v[14:15], v[30:31], v[30:31], v[14:15]
  v_add_f32 v14, v14, v15
  s_nop 1
  v_permlane32_swap_b32 v12, v14
  v_add_f32 v12, v12, v14
  v_cvt_pk_bf16_f32 v48, v24, v25
  v_cvt_pk_bf16_f32 v49, v26, v27
  v_add_f32_dpp v12, v12, v12 row_ror:8 row_mask:0xf bank_mask:0xf
  v_cvt_pk_bf16_f32 v50, v28, v29
  v_cvt_pk_bf16_f32 v51, v30, v31
  v_add_f32_dpp v12, v12, v12 row_ror:4 row_mask:0xf bank_mask:0xf
  v_permlane16_swap_b32 v48, v50
  v_permlane16_swap_b32 v49, v51
  v_add_f32_dpp v12, v12, v12 row_ror:2 row_mask:0xf bank_mask:0xf
  v_min_u32 v48, -2, v48
  s_nop 0
  v_add_f32_dpp v12, v12, v12 row_ror:1 row_mask:0xf bank_mask:0xf
  v_mov_b32 v13, v12
  s_nop 1
  v_permlane16_swap_b32 v13, v12
  v_add_f32 v14, v12, v13
  v_add_f32 v12, v12, v13
  v_mov_b32 v15, 0x3727c5ac
  s_nop 0
  v_permlane32_swap_b32 v12, v14
  v_mul_f32 v12, 0x3b000000, v12
  v_mul_f32 v14, 0x3b000000, v14
  v_fma_f32 v14, -v12, v12, v14
  v_max_f32 v14, 0, v14
  v_add_f32 v14, v14, v15
  v_rsq_f32 v14, v14
  v_pk_add_f32 v[24:25], v[24:25], v[12:13] op_sel_hi:[1,0] neg_lo:[0,1] neg_hi:[0,1]
  v_pk_add_f32 v[26:27], v[26:27], v[12:13] op_sel_hi:[1,0] neg_lo:[0,1] neg_hi:[0,1]
  v_pk_add_f32 v[28:29], v[28:29], v[12:13] op_sel_hi:[1,0] neg_lo:[0,1] neg_hi:[0,1]
  v_pk_add_f32 v[30:31], v[30:31], v[12:13] op_sel_hi:[1,0] neg_lo:[0,1] neg_hi:[0,1]
  v_pk_mul_f32 v[24:25], v[24:25], v[14:15] op_sel_hi:[1,0]
  v_pk_mul_f32 v[26:27], v[26:27], v[14:15] op_sel_hi:[1,0]
  v_pk_mul_f32 v[28:29], v[28:29], v[14:15] op_sel_hi:[1,0]
  v_pk_mul_f32 v[30:31], v[30:31], v[14:15] op_sel_hi:[1,0]
  v_cvt_pk_bf16_f32 v52, v24, v25
  v_cvt_pk_bf16_f32 v54, v28, v29
  v_cvt_pk_bf16_f32 v53, v26, v27
  v_cvt_pk_bf16_f32 v55, v30, v31
  v_permlane16_swap_b32 v52, v54
  s_nop 0
  v_permlane16_swap_b32 v53, v55
  v_min_u32 v52, -2, v52
  s_waitcnt vmcnt(12)
  v_cmp_eq_u32 vcc, -1, v36
  v_permlane16_swap_b32 v36, v38
  v_permlane16_swap_b32 v37, v39
  v_lshlrev_b32 v40, 16, v36
  v_and_b32 v41, 0xffff0000, v36
  v_lshlrev_b32 v42, 16, v37
  v_and_b32 v43, 0xffff0000, v37
  v_lshlrev_b32 v44, 16, v38
  v_and_b32 v45, 0xffff0000, v38
  v_lshlrev_b32 v46, 16, v39
  v_and_b32 v47, 0xffff0000, v39
  s_cbranch_vccnz ffr2_p
  s_waitcnt vmcnt(11)
  v_mfma_f32_16x16x32_bf16 v[24:27], v[16:19], v[112:115], v[40:43]
  v_xor_b32 v10, s22, v112
  s_waitcnt vmcnt(10)
  v_mfma_f32_16x16x32_bf16 v[28:31], v[16:19], v[116:119], v[44:47]
  v_bitop3_b32 v10, v10, s22, v116 bitop3:0xf6
  s_waitcnt vmcnt(9)
  v_mfma_f32_16x16x32_bf16 v[24:27], v[20:23], v[120:123], v[24:27]
  v_bitop3_b32 v10, v10, s22, v120 bitop3:0xf6
  s_waitcnt vmcnt(8)
  v_mfma_f32_16x16x32_bf16 v[28:31], v[20:23], v[124:127], v[28:31]
  v_bitop3_b32 v10, v10, s22, v124 bitop3:0xf6
  s_waitcnt vmcnt(7)
  v_mfma_f32_16x16x32_bf16 v[24:27], v[16:19], v[128:131], v[24:27]
  v_bitop3_b32 v10, v10, s22, v128 bitop3:0xf6
  s_waitcnt vmcnt(6)
  v_mfma_f32_16x16x32_bf16 v[28:31], v[16:19], v[132:135], v[28:31]
  v_bitop3_b32 v10, v10, s22, v132 bitop3:0xf6
  s_waitcnt vmcnt(5)
  v_mfma_f32_16x16x32_bf16 v[24:27], v[20:23], v[136:139], v[24:27]
  v_bitop3_b32 v10, v10, s22, v136 bitop3:0xf6
  s_waitcnt vmcnt(4)
  v_mfma_f32_16x16x32_bf16 v[28:31], v[20:23], v[140:143], v[28:31]
  v_bitop3_b32 v10, v10, s22, v140 bitop3:0xf6
  s_waitcnt vmcnt(3)
  v_mfma_f32_16x16x32_bf16 v[24:27], v[16:19], v[144:147], v[24:27]
  v_xor_b32 v11, s22, v144
  s_waitcnt vmcnt(2)
  v_mfma_f32_16x16x32_bf16 v[28:31], v[16:19], v[148:151], v[28:31]
  v_bitop3_b32 v11, v11, s22, v148 bitop3:0xf6
  s_waitcnt vmcnt(1)
  v_mfma_f32_16x16x32_bf16 v[24:27], v[20:23], v[152:155], v[24:27]
  v_bitop3_b32 v11, v11, s22, v152 bitop3:0xf6
  s_waitcnt vmcnt(0)
  v_mfma_f32_16x16x32_bf16 v[28:31], v[20:23], v[156:159], v[28:31]
  v_bitop3_b32 v11, v11, s22, v156 bitop3:0xf6
  v_and_or_b32 v10, v11, v5, v10
  v_and_b32 v10, 1, v10
  v_cmp_ne_u32 vcc, 0, v10
  s_cbranch_vccnz ffr2_p
  v_mov_b32 v13, s21
  s_mov_b64 exec, 1
  s_cmp_eq_u32 s42, 0
  s_cbranch_scc0 dn_127
  buffer_store_dword v13, v8, s[8:11], s40 offen
  s_branch dne_128
dn_127:
  buffer_store_dword v13, v8, s[8:11], s40 offen sc1
dne_128:
  s_mov_b64 exec, -1
  buffer_load_dword v9, v3, s[8:11], s41 offen sc1
  buffer_store_dwordx4 v[52:55], v7, s[8:11], s44 offen sc1
  v_pk_add_f32 v[12:13], v[24:25], v[26:27]
  v_pk_mul_f32 v[14:15], v[24:25], v[24:25]
  v_pk_add_f32 v[12:13], v[12:13], v[28:29]
  v_pk_fma_f32 v[14:15], v[26:27], v[26:27], v[14:15]
  v_pk_add_f32 v[12:13], v[12:13], v[30:31]
  v_pk_fma_f32 v[14:15], v[28:29], v[28:29], v[14:15]
  v_add_f32 v12, v12, v13
  v_pk_fma_f32 v[14:15], v[30:31], v[30:31], v[14:15]
  v_add_f32 v14, v14, v15
  s_nop 1
  v_permlane32_swap_b32 v12, v14
  v_add_f32 v12, v12, v14
  v_cvt_pk_bf16_f32 v56, v24, v25
  v_cvt_pk_bf16_f32 v57, v26, v27
  v_add_f32_dpp v12, v12, v12 row_ror:8 row_mask:0xf bank_mask:0xf
  v_cvt_pk_bf16_f32 v58, v28, v29
  v_cvt_pk_bf16_f32 v59, v30, v31
  v_add_f32_dpp v12, v12, v12 row_ror:4 row_mask:0xf bank_mask:0xf
  v_permlane16_swap_b32 v56, v58
  v_permlane16_swap_b32 v57, v59
  v_add_f32_dpp v12, v12, v12 row_ror:2 row_mask:0xf bank_mask:0xf
  v_min_u32 v56, -2, v56
  s_nop 0
  v_add_f32_dpp v12, v12, v12 row_ror:1 row_mask:0xf bank_mask:0xf
  v_mov_b32 v13, v12
  s_nop 1
  v_permlane16_swap_b32 v13, v12
  v_add_f32 v14, v12, v13
  v_add_f32 v12, v12, v13
  v_mov_b32 v15, 0x3727c5ac
  s_nop 0
  v_permlane32_swap_b32 v12, v14
  v_mul_f32 v12, 0x3b000000, v12
  v_mul_f32 v14, 0x3b000000, v14
  v_fma_f32 v14, -v12, v12, v14
  v_max_f32 v14, 0, v14
  v_add_f32 v14, v14, v15
  v_rsq_f32 v14, v14
  v_pk_add_f32 v[24:25], v[24:25], v[12:13] op_sel_hi:[1,0] neg_lo:[0,1] neg_hi:[0,1]
  v_pk_add_f32 v[26:27], v[26:27], v[12:13] op_sel_hi:[1,0] neg_lo:[0,1] neg_hi:[0,1]
  v_pk_add_f32 v[28:29], v[28:29], v[12:13] op_sel_hi:[1,0] neg_lo:[0,1] neg_hi:[0,1]
  v_pk_add_f32 v[30:31], v[30:31], v[12:13] op_sel_hi:[1,0] neg_lo:[0,1] neg_hi:[0,1]
  v_pk_mul_f32 v[24:25], v[24:25], v[14:15] op_sel_hi:[1,0]
  v_pk_mul_f32 v[26:27], v[26:27], v[14:15] op_sel_hi:[1,0]
  v_pk_mul_f32 v[28:29], v[28:29], v[14:15] op_sel_hi:[1,0]
  v_pk_mul_f32 v[30:31], v[30:31], v[14:15] op_sel_hi:[1,0]
  v_cvt_pk_bf16_f32 v60, v24, v25
  v_cvt_pk_bf16_f32 v62, v28, v29
  v_cvt_pk_bf16_f32 v61, v26, v27
  v_cvt_pk_bf16_f32 v63, v30, v31
  v_permlane16_swap_b32 v60, v62
  s_nop 0
  v_permlane16_swap_b32 v61, v63
  v_min_u32 v60, -2, v60
  buffer_store_dwordx4 v[60:63], v7, s[8:11], s52 offen sc1
  buffer_store_dwordx4 v[48:51], v7, s[12:15], s37 offen sc1
  buffer_store_dwordx4 v[56:59], v7, s[12:15], s53 offen sc1
  s_add_u32 s37, s37, 32768
  s_mov_b32 s20, s21
  s_waitcnt vmcnt(4)
  s_cmp_lt_u32 s20, 64
  s_cbranch_scc1 ffr2_loop
  s_branch the_end
ffr3_loop:
  s_add_u32 s21, s20, 1
  s_add_u32 s45, s20, 2
  v_cmp_gt_u32 vcc, s45, v9
  s_add_u32 s43, s43, 1
  s_cmp_eq_u32 s43, 3
  s_cselect_b32 s43, 0, s43
  s_cselect_b32 s23, 1, 0
  s_xor_b32 s22, s22, s23
  s_lshl_b32 s23, s43, 19
  s_add_u32 s23, s23, s38
  s_add_u32 s36, s36, 32768
  s_add_u32 s50, s23, s48
  s_add_u32 s51, s36, s49
  s_cbranch_vccz ffr3_g
ffr3_p:
  buffer_load_dword v9, v3, s[8:11], s41 offen sc1
  s_sub_u32 s3, s3, 1
  s_cbranch_scc1 bail_37
  s_waitcnt vmcnt(0)
  v_cmp_gt_u32 vcc, s45, v9
  s_cbranch_vccnz ffr3_p
ffr3_g:
  buffer_load_dwordx4 v[32:35], v7, s[8:11], s36 offen sc1
  buffer_load_dwordx4 v[64:67], v6, s[8:11], s23 offen offset:0 sc1
  buffer_load_dwordx4 v[68:71], v6, s[8:11], s23 offen offset:256 sc1
  buffer_load_dwordx4 v[72:75], v6, s[8:11], s23 offen offset:512 sc1
  buffer_load_dwordx4 v[76:79], v6, s[8:11], s23 offen offset:768 sc1
  s_add_u32 s33, s23, 4096
  buffer_load_dwordx4 v[80:83], v6, s[8:11], s33 offen offset:0 sc1
  buffer_load_dwordx4 v[84:87], v6, s[8:11], s33 offen offset:256 sc1
  buffer_load_dwordx4 v[88:91], v6, s[8:11], s33 offen offset:512 sc1
  buffer_load_dwordx4 v[92:95], v6, s[8:11], s33 offen offset:768 sc1
  s_add_u32 s33, s23, 8192
  buffer_load_dwordx4 v[96:99], v4, s[8:11], s33 offen offset:0 sc1
  buffer_load_dwordx4 v[100:103], v4, s[8:11], s33 offen offset:256 sc1
  buffer_load_dwordx4 v[104:107], v4, s[8:11], s33 offen offset:512 sc1
  buffer_load_dwordx4 v[108:111], v4, s[8:11], s33 offen offset:768 sc1
  buffer_load_dwordx4 v[36:39], v7, s[8:11], s51 offen sc1
  buffer_load_dwordx4 v[112:115], v6, s[8:11], s50 offen offset:0 sc1
  buffer_load_dwordx4 v[116:119], v6, s[8:11], s50 offen offset:256 sc1
  buffer_load_dwordx4 v[120:123], v6, s[8:11], s50 offen offset:512 sc1
  s_sub_u32 s44, s37, 10485760
  s_add_u32 s52, s44, s49
  s_add_u32 s53, s37, s49
  s_waitcnt vmcnt(16)
  v_cmp_eq_u32 vcc, -1, v32
  v_permlane16_swap_b32 v32, v34
  v_permlane16_swap_b32 v33, v35
  v_lshlrev_b32 v40, 16, v32
  v_and_b32 v41, 0xffff0000, v32
  v_lshlrev_b32 v42, 16, v33
  v_and_b32 v43, 0xffff0000, v33
  v_lshlrev_b32 v44, 16, v34
  v_and_b32 v45, 0xffff0000, v34
  v_lshlrev_b32 v46, 16, v35
  v_and_b32 v47, 0xffff0000, v35
  s_cbranch_vccnz ffr3_p
  buffer_load_dwordx4 v[124:127], v6, s[8:11], s50 offen offset:768 sc1
  s_waitcnt vmcnt(16)
  v_mfma_f32_16x16x32_bf16 v[24:27], v[16:19], v[64:67], v[40:43]
  v_xor_b32 v10, s22, v64
  s_add_u32 s33, s50, 4096
  buffer_load_dwordx4 v[128:131], v6, s[8:11], s33 offen offset:0 sc1
  s_waitcnt vmcnt(16)
  v_mfma_f32_16x16x32_bf16 v[28:31], v[16:19], v[68:71], v[44:47]
  v_bitop3_b32 v10, v10, s22, v68 bitop3:0xf6
  buffer_load_dwordx4 v[132:135], v6, s[8:11], s33 offen offset:256 sc1
  s_waitcnt vmcnt(16)
  v_mfma_f32_16x16x32_bf16 v[24:27], v[20:23], v[72:75], v[24:27]
  v_bitop3_b32 v10, v10, s22, v72 bitop3:0xf6
  buffer_load_dwordx4 v[136:139], v6, s[8:11], s33 offen offset:512 sc1
  s_waitcnt vmcnt(16)
  v_mfma_f32_16x16x32_bf16 v[28:31], v[20:23], v[76:79], v[28:31]
  v_bitop3_b32 v10, v10, s22, v76 bitop3:0xf6
  buffer_load_dwordx4 v[140:143], v6, s[8:11], s33 offen offset:768 sc1
  s_waitcnt vmcnt(16)
  v_mfma_f32_16x16x32_bf16 v[24:27], v[16:19], v[80:83], v[24:27]
  v_bitop3_b32 v10, v10, s22, v80 bitop3:0xf6
  s_add_u32 s33, s50, 8192
  buffer_load_dwordx4 v[144:147], v4, s[8:11], s33 offen offset:0 sc1
  s_waitcnt vmcnt(16)
  v_mfma_f32_16x16x32_bf16 v[28:31], v[16:19], v[84:87], v[28:31]
  v_bitop3_b32 v10, v10, s22, v84 bitop3:0xf6
  buffer_load_dwordx4 v[148:151], v4, s[8:11], s33 offen offset:256 sc1
  s_waitcnt vmcnt(16)
  v_mfma_f32_16x16x32_bf16 v[24:27], v[20:23], v[88:91], v[24:27]
  v_bitop3_b32 v10, v10, s22, v88 bitop3:0xf6
  buffer_load_dwordx4 v[152:155], v4, s[8:11], s33 offen offset:512 sc1
  s_waitcnt vmcnt(16)
  v_mfma_f32_16x16x32_bf16 v[28:31], v[20:23], v[92:95], v[28:31]
  v_bitop3_b32 v10, v10, s22, v92 bitop3:0xf6
  buffer_load_dwordx4 v[156:159], v4, s[8:11], s33 offen offset:768 sc1
  s_waitcnt vmcnt(16)
  v_mfma_f32_16x16x32_bf16 v[24:27], v[16:19], v[96:99], v[24:27]
  v_xor_b32 v11, s22, v96
  s_waitcnt vmcnt(15)
  v_mfma_f32_16x16x32_bf16 v[28:31], v[16:19], v[100:103], v[28:31]
  v_bitop3_b32 v11, v11, s22, v100 bitop3:0xf6
  s_waitcnt vmcnt(14)
  v_mfma_f32_16x16x32_bf16 v[24:27], v[20:23], v[104:107], v[24:27]
  v_bitop3_b32 v11, v11, s22, v104 bitop3:0xf6
  s_waitcnt vmcnt(13)
  v_mfma_f32_16x16x32_bf16 v[28:31], v[20:23], v[108:111], v[28:31]
  v_bitop3_b32 v11, v11, s22, v108 bitop3:0xf6
  v_and_or_b32 v10, v11, v5, v10
  v_and_b32 v10, 1, v10
  v_cmp_ne_u32 vcc, 0, v10
  s_cbranch_vccnz ffr3_p
  v_cvt_pk_bf16_f32 v48, v24, v25
  s_nop 1
  v_cvt_pk_bf16_f32 v50, v28, v29
  v_cvt_pk_bf16_f32 v49, v26, v27
  v_cvt_pk_bf16_f32 v51, v30, v31
  v_permlane16_swap_b32 v48, v50
  s_nop 0
  v_permlane16_swap_b32 v49, v51
  s_waitcnt vmcnt(12)
  v_cmp_eq_u32 vcc, -1, v36
  v_permlane16_swap_b32 v36, v38
  v_permlane16_swap_b32 v37, v39
  v_lshlrev_b32 v40, 16, v36
  v_and_b32 v41, 0xffff0000, v36
  v_lshlrev_b32 v42, 16, v37
  v_and_b32 v43, 0xffff0000, v37
  v_lshlrev_b32 v44, 16, v38
  v_and_b32 v45, 0xffff0000, v38
  v_lshlrev_b32 v46, 16, v39
  v_and_b32 v47, 0xffff0000, v39
  s_cbranch_vccnz ffr3_p
  s_waitcnt vmcnt(11)
  v_mfma_f32_16x16x32_bf16 v[24:27], v[16:19], v[112:115], v[40:43]
  v_xor_b32 v10, s22, v112
  s_waitcnt vmcnt(10)
  v_mfma_f32_16x16x32_bf16 v[28:31], v[16:19], v[116:119], v[44:47]
  v_bitop3_b32 v10, v10, s22, v116 bitop3:0xf6
  s_waitcnt vmcnt(9)
  v_mfma_f32_16x16x32_bf16 v[24:27], v[20:23], v[120:123], v[24:27]
  v_bitop3_b32 v10, v10, s22, v120 bitop3:0xf6
  s_waitcnt vmcnt(8)
  v_mfma_f32_16x16x32_bf16 v[28:31], v[20:23], v[124:127], v[28:31]
  v_bitop3_b32 v10, v10, s22, v124 bitop3:0xf6
  s_waitcnt vmcnt(7)
  v_mfma_f32_16x16x32_bf16 v[24:27], v[16:19], v[128:131], v[24:27]
  v_bitop3_b32 v10, v10, s22, v128 bitop3:0xf6
  s_waitcnt vmcnt(6)
  v_mfma_f32_16x16x32_bf16 v[28:31], v[16:19], v[132:135], v[28:31]
  v_bitop3_b32 v10, v10, s22, v132 bitop3:0xf6
  s_waitcnt vmcnt(5)
  v_mfma_f32_16x16x32_bf16 v[24:27], v[20:23], v[136:139], v[24:27]
  v_bitop3_b32 v10, v10, s22, v136 bitop3:0xf6
  s_waitcnt vmcnt(4)
  v_mfma_f32_16x16x32_bf16 v[28:31], v[20:23], v[140:143], v[28:31]
  v_bitop3_b32 v10, v10, s22, v140 bitop3:0xf6
  s_waitcnt vmcnt(3)
  v_mfma_f32_16x16x32_bf16 v[24:27], v[16:19], v[144:147], v[24:27]
  v_xor_b32 v11, s22, v144
  s_waitcnt vmcnt(2)
  v_mfma_f32_16x16x32_bf16 v[28:31], v[16:19], v[148:151], v[28:31]
  v_bitop3_b32 v11, v11, s22, v148 bitop3:0xf6
  s_waitcnt vmcnt(1)
  v_mfma_f32_16x16x32_bf16 v[24:27], v[20:23], v[152:155], v[24:27]
  v_bitop3_b32 v11, v11, s22, v152 bitop3:0xf6
  s_waitcnt vmcnt(0)
  v_mfma_f32_16x16x32_bf16 v[28:31], v[20:23], v[156:159], v[28:31]
  v_bitop3_b32 v11, v11, s22, v156 bitop3:0xf6
  v_and_or_b32 v10, v11, v5, v10
  v_and_b32 v10, 1, v10
  v_cmp_ne_u32 vcc, 0, v10
  s_cbranch_vccnz ffr3_p
  v_mov_b32 v13, s21
  s_mov_b64 exec, 1
  s_cmp_eq_u32 s42, 0
  s_cbranch_scc0 dn_129
  buffer_store_dword v13, v8, s[8:11], s40 offen
  s_branch dne_130
dn_129:
  buffer_store_dword v13, v8, s[8:11], s40 offen sc1
dne_130:
  s_mov_b64 exec, -1
  buffer_load_dword v9, v3, s[8:11], s41 offen sc1
  v_cvt_pk_bf16_f32 v56, v24, v25
  v_cvt_pk_bf16_f32 v58, v28, v29
  v_cvt_pk_bf16_f32 v57, v26, v27
  v_cvt_pk_bf16_f32 v59, v30, v31
  v_permlane16_swap_b32 v56, v58
  s_nop 0
  v_permlane16_swap_b32 v57, v59
  buffer_store_dwordx4 v[48:51], v7, s[12:15], s37 offen
  buffer_store_dwordx4 v[56:59], v7, s[12:15], s53 offen
  s_add_u32 s37, s37, 32768
  s_mov_b32 s20, s21
  s_waitcnt vmcnt(2)
  s_cmp_lt_u32 s20, 64
  s_cbranch_scc1 ffr3_loop
  s_branch the_end
role_chain:
  s_mov_b32 s12, s68
  s_mov_b32 s13, s69
  s_mov_b32 s14, 4194304
  s_mov_b32 s15, 0x20000
  s_mov_b32 s16, s72
  s_mov_b32 s17, s73
  s_mov_b32 s18, 4194304
  s_mov_b32 s19, 0x20000
  s_mov_b32 s20, s74
  s_mov_b32 s21, s75
  s_mov_b32 s22, 4194304
  s_mov_b32 s23, 0x20000
  s_mov_b32 s28, s70
  s_mov_b32 s29, s71
  s_mov_b32 s30, 4194304
  s_mov_b32 s31, 0x20000
  s_lshl_b32 s36, s4, 15
  s_lshl_b32 s37, s6, 8
  s_lshl_b32 s33, s4, 20
  s_add_u32 s37, s37, s33
  s_lshl_b32 s39, s6, 17
  s_add_u32 s39, s39, s36
  s_lshl_b32 s38, s4, 13
  v_lshrrev_b32 v2, 4, v1
  v_and_b32 v3, 15, v1
  v_lshlrev_b32 v6, 2, v2
  v_xor_b32 v6, v6, v3
  v_lshlrev_b32 v6, 4, v6
  v_lshl_add_u32 v4, v2, 13, v6
  v_and_b32 v6, 1, v2
  v_lshlrev_b32 v6, 2, v6
  v_xor_b32 v6, v6, v3
  v_lshlrev_b32 v6, 4, v6
  v_lshl_add_u32 v5, v2, 10, v6
  v_xor_b32 v6, 0x80, v5
  v_lshlrev_b32 v13, 4, v1
  v_add_u32 v13, s36, v13
  s_cmp_eq_u32 s4, 3
  s_cbranch_scc0 ch_nocal
  s_sub_u32 s34, s99, 8
ch_cal:
  s_memrealtime s[64:65]
  s_waitcnt lgkmcnt(0)
  s_sub_u32 s33, s34, s64
  s_cmp_lt_u32 s33, 1000
  s_cbranch_scc1 ch_cal
  s_memtime s[96:97]
  s_memrealtime s[64:65]
  s_nop 1
  s_memrealtime s[66:67]
  s_nop 1
  s_memrealtime s[68:69]
  s_nop 1
  s_memrealtime s[70:71]
  s_nop 1
  s_memrealtime s[72:73]
  s_nop 1
  s_memrealtime s[74:75]
  s_nop 1
  s_memrealtime s[76:77]
  s_nop 1
  s_memrealtime s[78:79]
  s_nop 1
  s_memrealtime s[80:81]
  s_nop 1
  s_memrealtime s[82:83]
  s_nop 1
  s_memrealtime s[84:85]
  s_nop 1
  s_memrealtime s[86:87]
  s_nop 1
  s_memrealtime s[88:89]
  s_nop 1
  s_memrealtime s[90:91]
  s_nop 1
  s_memrealtime s[92:93]
  s_nop 1
  s_memrealtime s[94:95]
  s_nop 1
  s_waitcnt lgkmcnt(0)
  s_sub_u32 s33, s99, s64
  s_cmp_lt_u32 s33, 1000
  s_cselect_b32 s33, 12, 0
  s_add_u32 s96, s96, s33
  s_sub_u32 s33, s99, s66
  s_cmp_lt_u32 s33, 1000
  s_cselect_b32 s33, 12, 0
  s_add_u32 s96, s96, s33
  s_sub_u32 s33, s99, s68
  s_cmp_lt_u32 s33, 1000
  s_cselect_b32 s33, 12, 0
  s_add_u32 s96, s96, s33
  s_sub_u32 s33, s99, s70
  s_cmp_lt_u32 s33, 1000
  s_cselect_b32 s33, 12, 0
  s_add_u32 s96, s96, s33
  s_sub_u32 s33, s99, s72
  s_cmp_lt_u32 s33, 1000
  s_cselect_b32 s33, 12, 0
  s_add_u32 s96, s96, s33
  s_sub_u32 s33, s99, s74
  s_cmp_lt_u32 s33, 1000
  s_cselect_b32 s33, 12, 0
  s_add_u32 s96, s96, s33
  s_sub_u32 s33, s99, s76
  s_cmp_lt_u32 s33, 1000
  s_cselect_b32 s33, 12, 0
  s_add_u32 s96, s96, s33
  s_sub_u32 s33, s99, s78
  s_cmp_lt_u32 s33, 1000
  s_cselect_b32 s33, 12, 0
  s_add_u32 s96, s96, s33
  s_sub_u32 s33, s99, s80
  s_cmp_lt_u32 s33, 1000
  s_cselect_b32 s33, 12, 0
  s_add_u32 s96, s96, s33
  s_sub_u32 s33, s99, s82
  s_cmp_lt_u32 s33, 1000
  s_cselect_b32 s33, 12, 0
  s_add_u32 s96, s96, s33
  s_sub_u32 s33, s99, s84
  s_cmp_lt_u32 s33, 1000
  s_cselect_b32 s33, 12, 0
  s_add_u32 s96, s96, s33
  s_sub_u32 s33, s99, s86
  s_cmp_lt_u32 s33, 1000
  s_cselect_b32 s33, 12, 0
  s_add_u32 s96, s96, s33
  s_sub_u32 s33, s99, s88
  s_cmp_lt_u32 s33, 1000
  s_cselect_b32 s33, 12, 0
  s_add_u32 s96, s96, s33
  s_sub_u32 s33, s99, s90
  s_cmp_lt_u32 s33, 1000
  s_cselect_b32 s33, 12, 0
  s_add_u32 s96, s96, s33
  s_sub_u32 s33, s99, s92
  s_cmp_lt_u32 s33, 1000
  s_cselect_b32 s33, 12, 0
  s_add_u32 s96, s96, s33
  s_sub_u32 s33, s99, s94
  s_cmp_lt_u32 s33, 1000
  s_cselect_b32 s33, 12, 0
  s_add_u32 s96, s96, s33
  v_mov_b32 v20, s96
  v_mov_b32 v21, 161792
  ds_write_b32 v21, v20
  s_waitcnt lgkmcnt(0)
ch_nocal:
  s_lshl_b32 s33, s7, 20
  s_add_u32 s54, s33, 16777216
  s_mul_i32 s53, s6, 8448
  s_lshl_b32 s52, s4, 11
  s_add_u32 s53, s53, s52
  s_mul_i32 s33, s7, 50331648
  s_mul_i32 s34, s6, 24576
  s_add_u32 s33, s33, s34
  s_add_u32 s40, s33, 41951232
  s_lshl_b32 s33, s7, 5
  s_add_u32 s33, s33, s6
  s_lshl_b32 s33, s33, 9
  s_lshl_b32 s34, s4, 7
  s_add_u32 s33, s33, s34
  s_add_u32 s41, s33, 0
  s_add_u32 s42, s33, 49152
  s_mul_i32 s44, s5, 33
  s_add_u32 s45, s7, 52
  s_mov_b32 s57, 0
  v_mov_b32 v0, 0
  s_add_u32 m0, s38, 0
  s_add_u32 s33, s37, 0
  buffer_load_dwordx4 v4, s[12:15], s33 offen lds
  s_add_u32 m0, s38, 1024
  s_add_u32 s33, s37, 32768
  buffer_load_dwordx4 v4, s[12:15], s33 offen lds
  s_add_u32 m0, s38, 2048
  s_add_u32 s33, s37, 65536
  buffer_load_dwordx4 v4, s[12:15], s33 offen lds
  s_add_u32 m0, s38, 3072
  s_add_u32 s33, s37, 98304
  buffer_load_dwordx4 v4, s[12:15], s33 offen lds
  s_add_u32 m0, s38, 4096
  s_add_u32 s33, s37, 131072
  buffer_load_dwordx4 v4, s[12:15], s33 offen lds
  s_add_u32 m0, s38, 5120
  s_add_u32 s33, s37, 163840
  buffer_load_dwordx4 v4, s[12:15], s33 offen lds
  s_add_u32 m0, s38, 6144
  s_add_u32 s33, s37, 196608
  buffer_load_dwordx4 v4, s[12:15], s33 offen lds
  s_add_u32 m0, s38, 7168
  s_add_u32 s33, s37, 229376
  buffer_load_dwordx4 v4, s[12:15], s33 offen lds
  s_add_u32 m0, s38, 32768
  s_add_u32 s33, s37, 262144
  buffer_load_dwordx4 v4, s[12:15], s33 offen lds
  s_add_u32 m0, s38, 33792
  s_add_u32 s33, s37, 294912
  buffer_load_dwordx4 v4, s[12:15], s33 offen lds
  s_add_u32 m0, s38, 34816
  s_add_u32 s33, s37, 327680
  buffer_load_dwordx4 v4, s[12:15], s33 offen lds
  s_add_u32 m0, s38, 35840
  s_add_u32 s33, s37, 360448
  buffer_load_dwordx4 v4, s[12:15], s33 offen lds
  s_add_u32 m0, s38, 36864
  s_add_u32 s33, s37, 393216
  buffer_load_dwordx4 v4, s[12:15], s33 offen lds
  s_add_u32 m0, s38, 37888
  s_add_u32 s33, s37, 425984
  buffer_load_dwordx4 v4, s[12:15], s33 offen lds
  s_add_u32 m0, s38, 38912
  s_add_u32 s33, s37, 458752
  buffer_load_dwordx4 v4, s[12:15], s33 offen lds
  s_add_u32 m0, s38, 39936
  s_add_u32 s33, s37, 491520
  buffer_load_dwordx4 v4, s[12:15], s33 offen lds
  s_add_u32 m0, s38, 65536
  s_add_u32 s33, s37, 524288
  buffer_load_dwordx4 v4, s[12:15], s33 offen lds
  s_add_u32 m0, s38, 66560
  s_add_u32 s33, s37, 557056
  buffer_load_dwordx4 v4, s[12:15], s33 offen lds
  s_add_u32 m0, s38, 67584
  s_add_u32 s33, s37, 589824
  buffer_load_dwordx4 v4, s[12:15], s33 offen lds
  s_add_u32 m0, s38, 68608
  s_add_u32 s33, s37, 622592
  buffer_load_dwordx4 v4, s[12:15], s33 offen lds
  s_add_u32 m0, s38, 69632
  s_add_u32 s33, s37, 655360
  buffer_load_dwordx4 v4, s[12:15], s33 offen lds
  s_add_u32 m0, s38, 70656
  s_add_u32 s33, s37, 688128
  buffer_load_dwordx4 v4, s[12:15], s33 offen lds
  s_add_u32 m0, s38, 71680
  s_add_u32 s33, s37, 720896
  buffer_load_dwordx4 v4, s[12:15], s33 offen lds
  s_add_u32 m0, s38, 72704
  s_add_u32 s33, s37, 753664
  buffer_load_dwordx4 v4, s[12:15], s33 offen lds
  v_bfe_u32 v12, v1, 2, 2
  v_xor_b32 v7, s4, v12
  v_lshlrev_b32 v7, 6, v7
  v_lshl_add_u32 v7, v12, 8, v7
  v_lshl_add_u32 v7, v2, 11, v7
  v_bfe_u32 v12, v1, 1, 1
  v_lshl_add_u32 v7, v12, 5, v7
  v_and_b32 v12, 1, v1
  v_lshl_add_u32 v7, v12, 3, v7
  s_add_u32 s33, s4, 0
  s_and_b32 s33, s33, 3
  s_lshl_b32 s33, s33, 13
  v_add_u32 v8, s33, v7
  s_add_u32 s33, s4, 1
  s_and_b32 s33, s33, 3
  s_lshl_b32 s33, s33, 13
  v_add_u32 v9, s33, v7
  s_add_u32 s33, s4, 2
  s_and_b32 s33, s33, 3
  s_lshl_b32 s33, s33, 13
  v_add_u32 v10, s33, v7
  s_add_u32 s33, s4, 3
  s_and_b32 s33, s33, 3
  s_lshl_b32 s33, s33, 13
  v_add_u32 v11, s33, v7
  s_waitcnt vmcnt(16) lgkmcnt(0)
  s_barrier
  ds_read_b64_tr_b16 a[0:1], v8 offset:0
  ds_read_b64_tr_b16 a[2:3], v8 offset:1024
  s_add_u32 m0, s38, 98304
  s_add_u32 s33, s37, 786432
  buffer_load_dwordx4 v4, s[12:15], s33 offen lds
  ds_read_b64_tr_b16 a[8:9], v8 offset:16
  ds_read_b64_tr_b16 a[10:11], v8 offset:1040
  s_add_u32 m0, s38, 99328
  s_add_u32 s33, s37, 819200
  buffer_load_dwordx4 v4, s[12:15], s33 offen lds
  ds_read_b64_tr_b16 a[32:33], v9 offset:0
  ds_read_b64_tr_b16 a[34:35], v9 offset:1024
  s_add_u32 m0, s38, 100352
  s_add_u32 s33, s37, 851968
  buffer_load_dwordx4 v4, s[12:15], s33 offen lds
  ds_read_b64_tr_b16 a[40:41], v9 offset:16
  ds_read_b64_tr_b16 a[42:43], v9 offset:1040
  s_add_u32 m0, s38, 101376
  s_add_u32 s33, s37, 884736
  buffer_load_dwordx4 v4, s[12:15], s33 offen lds
  ds_read_b64_tr_b16 a[64:65], v10 offset:0
  ds_read_b64_tr_b16 a[66:67], v10 offset:1024
  s_add_u32 m0, s38, 102400
  s_add_u32 s33, s37, 917504
  buffer_load_dwordx4 v4, s[12:15], s33 offen lds
  ds_read_b64_tr_b16 a[72:73], v10 offset:16
  ds_read_b64_tr_b16 a[74:75], v10 offset:1040
  s_add_u32 m0, s38, 103424
  s_add_u32 s33, s37, 950272
  buffer_load_dwordx4 v4, s[12:15], s33 offen lds
  ds_read_b64_tr_b16 a[96:97], v11 offset:0
  ds_read_b64_tr_b16 a[98:99], v11 offset:1024
  s_add_u32 m0, s38, 104448
  s_add_u32 s33, s37, 983040
  buffer_load_dwordx4 v4, s[12:15], s33 offen lds
  ds_read_b64_tr_b16 a[104:105], v11 offset:16
  ds_read_b64_tr_b16 a[106:107], v11 offset:1040
  s_add_u32 m0, s38, 105472
  s_add_u32 s33, s37, 1015808
  buffer_load_dwordx4 v4, s[12:15], s33 offen lds
  s_waitcnt vmcnt(16) lgkmcnt(0)
  s_barrier
  ds_read_b64_tr_b16 a[4:5], v8 offset:32768
  ds_read_b64_tr_b16 a[6:7], v8 offset:33792
  s_add_u32 m0, s38, 0
  s_add_u32 s33, s37, 0
  buffer_load_dwordx4 v4, s[16:19], s33 offen lds
  ds_read_b64_tr_b16 a[12:13], v8 offset:32784
  ds_read_b64_tr_b16 a[14:15], v8 offset:33808
  s_add_u32 m0, s38, 1024
  s_add_u32 s33, s37, 32768
  buffer_load_dwordx4 v4, s[16:19], s33 offen lds
  ds_read_b64_tr_b16 a[36:37], v9 offset:32768
  ds_read_b64_tr_b16 a[38:39], v9 offset:33792
  s_add_u32 m0, s38, 2048
  s_add_u32 s33, s37, 65536
  buffer_load_dwordx4 v4, s[16:19], s33 offen lds
  ds_read_b64_tr_b16 a[44:45], v9 offset:32784
  ds_read_b64_tr_b16 a[46:47], v9 offset:33808
  s_add_u32 m0, s38, 3072
  s_add_u32 s33, s37, 98304
  buffer_load_dwordx4 v4, s[16:19], s33 offen lds
  ds_read_b64_tr_b16 a[68:69], v10 offset:32768
  ds_read_b64_tr_b16 a[70:71], v10 offset:33792
  s_add_u32 m0, s38, 4096
  s_add_u32 s33, s37, 131072
  buffer_load_dwordx4 v4, s[16:19], s33 offen lds
  ds_read_b64_tr_b16 a[76:77], v10 offset:32784
  ds_read_b64_tr_b16 a[78:79], v10 offset:33808
  s_add_u32 m0, s38, 5120
  s_add_u32 s33, s37, 163840
  buffer_load_dwordx4 v4, s[16:19], s33 offen lds
  ds_read_b64_tr_b16 a[100:101], v11 offset:32768
  ds_read_b64_tr_b16 a[102:103], v11 offset:33792
  s_add_u32 m0, s38, 6144
  s_add_u32 s33, s37, 196608
  buffer_load_dwordx4 v4, s[16:19], s33 offen lds
  ds_read_b64_tr_b16 a[108:109], v11 offset:32784
  ds_read_b64_tr_b16 a[110:111], v11 offset:33808
  s_add_u32 m0, s38, 7168
  s_add_u32 s33, s37, 229376
  buffer_load_dwordx4 v4, s[16:19], s33 offen lds
  v_xor_b32 v8, 0x10000, v8
  v_xor_b32 v9, 0x10000, v9
  v_xor_b32 v10, 0x10000, v10
  v_xor_b32 v11, 0x10000, v11
  s_waitcnt vmcnt(16) lgkmcnt(0)
  s_barrier
  ds_read_b64_tr_b16 a[16:17], v8 offset:0
  ds_read_b64_tr_b16 a[18:19], v8 offset:1024
  s_add_u32 m0, s38, 32768
  s_add_u32 s33, s37, 262144
  buffer_load_dwordx4 v4, s[16:19], s33 offen lds
  ds_read_b64_tr_b16 a[24:25], v8 offset:16
  ds_read_b64_tr_b16 a[26:27], v8 offset:1040
  s_add_u32 m0, s38, 33792
  s_add_u32 s33, s37, 294912
  buffer_load_dwordx4 v4, s[16:19], s33 offen lds
  ds_read_b64_tr_b16 a[48:49], v9 offset:0
  ds_read_b64_tr_b16 a[50:51], v9 offset:1024
  s_add_u32 m0, s38, 34816
  s_add_u32 s33, s37, 327680
  buffer_load_dwordx4 v4, s[16:19], s33 offen lds
  ds_read_b64_tr_b16 a[56:57], v9 offset:16
  ds_read_b64_tr_b16 a[58:59], v9 offset:1040
  s_add_u32 m0, s38, 35840
  s_add_u32 s33, s37, 360448
  buffer_load_dwordx4 v4, s[16:19], s33 offen lds
  ds_read_b64_tr_b16 a[80:81], v10 offset:0
  ds_read_b64_tr_b16 a[82:83], v10 offset:1024
  s_add_u32 m0, s38, 36864
  s_add_u32 s33, s37, 393216
  buffer_load_dwordx4 v4, s[16:19], s33 offen lds
  ds_read_b64_tr_b16 a[88:89], v10 offset:16
  ds_read_b64_tr_b16 a[90:91], v10 offset:1040
  s_add_u32 m0, s38, 37888
  s_add_u32 s33, s37, 425984
  buffer_load_dwordx4 v4, s[16:19], s33 offen lds
  ds_read_b64_tr_b16 a[112:113], v11 offset:0
  ds_read_b64_tr_b16 a[114:115], v11 offset:1024
  s_add_u32 m0, s38, 38912
  s_add_u32 s33, s37, 458752
  buffer_load_dwordx4 v4, s[16:19], s33 offen lds
  ds_read_b64_tr_b16 a[120:121], v11 offset:16
  ds_read_b64_tr_b16 a[122:123], v11 offset:1040
  s_add_u32 m0, s38, 39936
  s_add_u32 s33, s37, 491520
  buffer_load_dwordx4 v4, s[16:19], s33 offen lds
  s_waitcnt vmcnt(16) lgkmcnt(0)
  s_barrier
  ds_read_b64_tr_b16 a[20:21], v8 offset:32768
  ds_read_b64_tr_b16 a[22:23], v8 offset:33792
  s_add_u32 m0, s38, 65536
  s_add_u32 s33, s37, 524288
  buffer_load_dwordx4 v4, s[16:19], s33 offen lds
  ds_read_b64_tr_b16 a[28:29], v8 offset:32784
  ds_read_b64_tr_b16 a[30:31], v8 offset:33808
  s_add_u32 m0, s38, 66560
  s_add_u32 s33, s37, 557056
  buffer_load_dwordx4 v4, s[16:19], s33 offen lds
  ds_read_b64_tr_b16 a[52:53], v9 offset:32768
  ds_read_b64_tr_b16 a[54:55], v9 offset:33792
  s_add_u32 m0, s38, 67584
  s_add_u32 s33, s37, 589824
  buffer_load_dwordx4 v4, s[16:19], s33 offen lds
  ds_read_b64_tr_b16 a[60:61], v9 offset:32784
  ds_read_b64_tr_b16 a[62:63], v9 offset:33808
  s_add_u32 m0, s38, 68608
  s_add_u32 s33, s37, 622592
  buffer_load_dwordx4 v4, s[16:19], s33 offen lds
  ds_read_b64_tr_b16 a[84:85], v10 offset:32768
  ds_read_b64_tr_b16 a[86:87], v10 offset:33792
  s_add_u32 m0, s38, 69632
  s_add_u32 s33, s37, 655360
  buffer_load_dwordx4 v4, s[16:19], s33 offen lds
  ds_read_b64_tr_b16 a[92:93], v10 offset:32784
  ds_read_b64_tr_b16 a[94:95], v10 offset:33808
  s_add_u32 m0, s38, 70656
  s_add_u32 s33, s37, 688128
  buffer_load_dwordx4 v4, s[16:19], s33 offen lds
  ds_read_b64_tr_b16 a[116:117], v11 offset:32768
  ds_read_b64_tr_b16 a[118:119], v11 offset:33792
  s_add_u32 m0, s38, 71680
  s_add_u32 s33, s37, 720896
  buffer_load_dwordx4 v4, s[16:19], s33 offen lds
  ds_read_b64_tr_b16 a[124:125], v11 offset:32784
  ds_read_b64_tr_b16 a[126:127], v11 offset:33808
  s_add_u32 m0, s38, 72704
  s_add_u32 s33, s37, 753664
  buffer_load_dwordx4 v4, s[16:19], s33 offen lds
  v_bfe_u32 v12, v1, 2, 2
  v_xor_b32 v7, s4, v12
  v_lshlrev_b32 v7, 6, v7
  v_lshl_add_u32 v7, v12, 8, v7
  v_lshl_add_u32 v7, v2, 11, v7
  v_and_b32 v12, 3, v1
  v_lshl_add_u32 v7, v12, 3, v7
  s_add_u32 s33, s4, 0
  s_and_b32 s33, s33, 3
  s_lshl_b32 s33, s33, 13
  v_add_u32 v8, s33, v7
  s_add_u32 s33, s4, 1
  s_and_b32 s33, s33, 3
  s_lshl_b32 s33, s33, 13
  v_add_u32 v9, s33, v7
  s_add_u32 s33, s4, 2
  s_and_b32 s33, s33, 3
  s_lshl_b32 s33, s33, 13
  v_add_u32 v10, s33, v7
  s_add_u32 s33, s4, 3
  s_and_b32 s33, s33, 3
  s_lshl_b32 s33, s33, 13
  v_add_u32 v11, s33, v7
  s_waitcnt vmcnt(16) lgkmcnt(0)
  s_barrier
  ds_read_b64_tr_b16 v[128:129], v8 offset:0
  ds_read_b64_tr_b16 v[130:131], v8 offset:1024
  s_add_u32 m0, s38, 98304
  s_add_u32 s33, s37, 786432
  buffer_load_dwordx4 v4, s[16:19], s33 offen lds
  ds_read_b64_tr_b16 v[136:137], v8 offset:32
  ds_read_b64_tr_b16 v[138:139], v8 offset:1056
  s_add_u32 m0, s38, 99328
  s_add_u32 s33, s37, 819200
  buffer_load_dwordx4 v4, s[16:19], s33 offen lds
  ds_read_b64_tr_b16 v[160:161], v9 offset:0
  ds_read_b64_tr_b16 v[162:163], v9 offset:1024
  s_add_u32 m0, s38, 100352
  s_add_u32 s33, s37, 851968
  buffer_load_dwordx4 v4, s[16:19], s33 offen lds
  ds_read_b64_tr_b16 v[168:169], v9 offset:32
  ds_read_b64_tr_b16 v[170:171], v9 offset:1056
  s_add_u32 m0, s38, 101376
  s_add_u32 s33, s37, 884736
  buffer_load_dwordx4 v4, s[16:19], s33 offen lds
  ds_read_b64_tr_b16 v[192:193], v10 offset:0
  ds_read_b64_tr_b16 v[194:195], v10 offset:1024
  s_add_u32 m0, s38, 102400
  s_add_u32 s33, s37, 917504
  buffer_load_dwordx4 v4, s[16:19], s33 offen lds
  ds_read_b64_tr_b16 v[200:201], v10 offset:32
  ds_read_b64_tr_b16 v[202:203], v10 offset:1056
  s_add_u32 m0, s38, 103424
  s_add_u32 s33, s37, 950272
  buffer_load_dwordx4 v4, s[16:19], s33 offen lds
  ds_read_b64_tr_b16 v[224:225], v11 offset:0
  ds_read_b64_tr_b16 v[226:227], v11 offset:1024
  s_add_u32 m0, s38, 104448
  s_add_u32 s33, s37, 983040
  buffer_load_dwordx4 v4, s[16:19], s33 offen lds
  ds_read_b64_tr_b16 v[232:233], v11 offset:32
  ds_read_b64_tr_b16 v[234:235], v11 offset:1056
  s_add_u32 m0, s38, 105472
  s_add_u32 s33, s37, 1015808
  buffer_load_dwordx4 v4, s[16:19], s33 offen lds
  s_waitcnt vmcnt(16) lgkmcnt(0)
  s_barrier
  ds_read_b64_tr_b16 v[132:133], v8 offset:32768
  ds_read_b64_tr_b16 v[134:135], v8 offset:33792
  s_add_u32 m0, s38, 0
  s_add_u32 s33, s37, 0
  buffer_load_dwordx4 v4, s[28:31], s33 offen lds
  ds_read_b64_tr_b16 v[140:141], v8 offset:32800
  ds_read_b64_tr_b16 v[142:143], v8 offset:33824
  s_add_u32 m0, s38, 1024
  s_add_u32 s33, s37, 32768
  buffer_load_dwordx4 v4, s[28:31], s33 offen lds
  ds_read_b64_tr_b16 v[164:165], v9 offset:32768
  ds_read_b64_tr_b16 v[166:167], v9 offset:33792
  s_add_u32 m0, s38, 2048
  s_add_u32 s33, s37, 65536
  buffer_load_dwordx4 v4, s[28:31], s33 offen lds
  ds_read_b64_tr_b16 v[172:173], v9 offset:32800
  ds_read_b64_tr_b16 v[174:175], v9 offset:33824
  s_add_u32 m0, s38, 3072
  s_add_u32 s33, s37, 98304
  buffer_load_dwordx4 v4, s[28:31], s33 offen lds
  ds_read_b64_tr_b16 v[196:197], v10 offset:32768
  ds_read_b64_tr_b16 v[198:199], v10 offset:33792
  s_add_u32 m0, s38, 4096
  s_add_u32 s33, s37, 131072
  buffer_load_dwordx4 v4, s[28:31], s33 offen lds
  ds_read_b64_tr_b16 v[204:205], v10 offset:32800
  ds_read_b64_tr_b16 v[206:207], v10 offset:33824
  s_add_u32 m0, s38, 5120
  s_add_u32 s33, s37, 163840
  buffer_load_dwordx4 v4, s[28:31], s33 offen lds
  ds_read_b64_tr_b16 v[228:229], v11 offset:32768
  ds_read_b64_tr_b16 v[230:231], v11 offset:33792
  s_add_u32 m0, s38, 6144
  s_add_u32 s33, s37, 196608
  buffer_load_dwordx4 v4, s[28:31], s33 offen lds
  ds_read_b64_tr_b16 v[236:237], v11 offset:32800
  ds_read_b64_tr_b16 v[238:239], v11 offset:33824
  s_add_u32 m0, s38, 7168
  s_add_u32 s33, s37, 229376
  buffer_load_dwordx4 v4, s[28:31], s33 offen lds
  v_xor_b32 v8, 0x10000, v8
  v_xor_b32 v9, 0x10000, v9
  v_xor_b32 v10, 0x10000, v10
  v_xor_b32 v11, 0x10000, v11
  s_waitcnt vmcnt(16) lgkmcnt(0)
  s_barrier
  ds_read_b64_tr_b16 v[144:145], v8 offset:0
  ds_read_b64_tr_b16 v[146:147], v8 offset:1024
  s_add_u32 m0, s38, 32768
  s_add_u32 s33, s37, 262144
  buffer_load_dwordx4 v4, s[28:31], s33 offen lds
  ds_read_b64_tr_b16 v[152:153], v8 offset:32
  ds_read_b64_tr_b16 v[154:155], v8 offset:1056
  s_add_u32 m0, s38, 33792
  s_add_u32 s33, s37, 294912
  buffer_load_dwordx4 v4, s[28:31], s33 offen lds
  ds_read_b64_tr_b16 v[176:177], v9 offset:0
  ds_read_b64_tr_b16 v[178:179], v9 offset:1024
  s_add_u32 m0, s38, 34816
  s_add_u32 s33, s37, 327680
  buffer_load_dwordx4 v4, s[28:31], s33 offen lds
  ds_read_b64_tr_b16 v[184:185], v9 offset:32
  ds_read_b64_tr_b16 v[186:187], v9 offset:1056
  s_add_u32 m0, s38, 35840
  s_add_u32 s33, s37, 360448
  buffer_load_dwordx4 v4, s[28:31], s33 offen lds
  ds_read_b64_tr_b16 v[208:209], v10 offset:0
  ds_read_b64_tr_b16 v[210:211], v10 offset:1024
  s_add_u32 m0, s38, 36864
  s_add_u32 s33, s37, 393216
  buffer_load_dwordx4 v4, s[28:31], s33 offen lds
  ds_read_b64_tr_b16 v[216:217], v10 offset:32
  ds_read_b64_tr_b16 v[218:219], v10 offset:1056
  s_add_u32 m0, s38, 37888
  s_add_u32 s33, s37, 425984
  buffer_load_dwordx4 v4, s[28:31], s33 offen lds
  ds_read_b64_tr_b16 v[240:241], v11 offset:0
  ds_read_b64_tr_b16 v[242:243], v11 offset:1024
  s_add_u32 m0, s38, 38912
  s_add_u32 s33, s37, 458752
  buffer_load_dwordx4 v4, s[28:31], s33 offen lds
  ds_read_b64_tr_b16 v[248:249], v11 offset:32
  ds_read_b64_tr_b16 v[250:251], v11 offset:1056
  s_add_u32 m0, s38, 39936
  s_add_u32 s33, s37, 491520
  buffer_load_dwordx4 v4, s[28:31], s33 offen lds
  s_waitcnt vmcnt(16) lgkmcnt(0)
  s_barrier
  ds_read_b64_tr_b16 v[148:149], v8 offset:32768
  ds_read_b64_tr_b16 v[150:151], v8 offset:33792
  s_add_u32 m0, s38, 65536
  s_add_u32 s33, s37, 524288
  buffer_load_dwordx4 v4, s[28:31], s33 offen lds
  ds_read_b64_tr_b16 v[156:157], v8 offset:32800
  ds_read_b64_tr_b16 v[158:159], v8 offset:33824
  s_add_u32 m0, s38, 66560
  s_add_u32 s33, s37, 557056
  buffer_load_dwordx4 v4, s[28:31], s33 offen lds
  ds_read_b64_tr_b16 v[180:181], v9 offset:32768
  ds_read_b64_tr_b16 v[182:183], v9 offset:33792
  s_add_u32 m0, s38, 67584
  s_add_u32 s33, s37, 589824
  buffer_load_dwordx4 v4, s[28:31], s33 offen lds
  ds_read_b64_tr_b16 v[188:189], v9 offset:32800
  ds_read_b64_tr_b16 v[190:191], v9 offset:33824
  s_add_u32 m0, s38, 68608
  s_add_u32 s33, s37, 622592
  buffer_load_dwordx4 v4, s[28:31], s33 offen lds
  ds_read_b64_tr_b16 v[212:213], v10 offset:32768
  ds_read_b64_tr_b16 v[214:215], v10 offset:33792
  s_add_u32 m0, s38, 69632
  s_add_u32 s33, s37, 655360
  buffer_load_dwordx4 v4, s[28:31], s33 offen lds
  ds_read_b64_tr_b16 v[220:221], v10 offset:32800
  ds_read_b64_tr_b16 v[222:223], v10 offset:33824
  s_add_u32 m0, s38, 70656
  s_add_u32 s33, s37, 688128
  buffer_load_dwordx4 v4, s[28:31], s33 offen lds
  ds_read_b64_tr_b16 v[244:245], v11 offset:32768
  ds_read_b64_tr_b16 v[246:247], v11 offset:33792
  s_add_u32 m0, s38, 71680
  s_add_u32 s33, s37, 720896
  buffer_load_dwordx4 v4, s[28:31], s33 offen lds
  ds_read_b64_tr_b16 v[252:253], v11 offset:32800
  ds_read_b64_tr_b16 v[254:255], v11 offset:33824
  s_add_u32 m0, s38, 72704
  s_add_u32 s33, s37, 753664
  buffer_load_dwordx4 v4, s[28:31], s33 offen lds
  v_bfe_u32 v12, v1, 2, 2
  v_xor_b32 v7, s4, v12
  v_lshlrev_b32 v7, 6, v7
  v_lshl_add_u32 v7, v12, 8, v7
  v_lshl_add_u32 v7, v2, 11, v7
  v_bfe_u32 v12, v1, 1, 1
  v_lshl_add_u32 v7, v12, 5, v7
  v_and_b32 v12, 1, v1
  v_lshl_add_u32 v7, v12, 3, v7
  s_add_u32 s33, s4, 0
  s_and_b32 s33, s33, 3
  s_lshl_b32 s33, s33, 13
  v_add_u32 v8, s33, v7
  s_add_u32 s33, s4, 1
  s_and_b32 s33, s33, 3
  s_lshl_b32 s33, s33, 13
  v_add_u32 v9, s33, v7
  s_add_u32 s33, s4, 2
  s_and_b32 s33, s33, 3
  s_lshl_b32 s33, s33, 13
  v_add_u32 v10, s33, v7
  s_add_u32 s33, s4, 3
  s_and_b32 s33, s33, 3
  s_lshl_b32 s33, s33, 13
  v_add_u32 v11, s33, v7
  s_waitcnt vmcnt(16) lgkmcnt(0)
  s_barrier
  ds_read_b64_tr_b16 v[16:17], v8 offset:0
  ds_read_b64_tr_b16 v[18:19], v8 offset:1024
  s_add_u32 m0, s38, 98304
  s_add_u32 s33, s37, 786432
  buffer_load_dwordx4 v4, s[28:31], s33 offen lds
  ds_read_b64_tr_b16 v[24:25], v8 offset:16
  ds_read_b64_tr_b16 v[26:27], v8 offset:1040
  s_add_u32 m0, s38, 99328
  s_add_u32 s33, s37, 819200
  buffer_load_dwordx4 v4, s[28:31], s33 offen lds
  ds_read_b64_tr_b16 a[128:129], v9 offset:0
  ds_read_b64_tr_b16 a[130:131], v9 offset:1024
  s_add_u32 m0, s38, 100352
  s_add_u32 s33, s37, 851968
  buffer_load_dwordx4 v4, s[28:31], s33 offen lds
  ds_read_b64_tr_b16 a[136:137], v9 offset:16
  ds_read_b64_tr_b16 a[138:139], v9 offset:1040
  s_add_u32 m0, s38, 101376
  s_add_u32 s33, s37, 884736
  buffer_load_dwordx4 v4, s[28:31], s33 offen lds
  ds_read_b64_tr_b16 v[64:65], v10 offset:0
  ds_read_b64_tr_b16 v[66:67], v10 offset:1024
  s_add_u32 m0, s38, 102400
  s_add_u32 s33, s37, 917504
  buffer_load_dwordx4 v4, s[28:31], s33 offen lds
  ds_read_b64_tr_b16 v[72:73], v10 offset:16
  ds_read_b64_tr_b16 v[74:75], v10 offset:1040
  s_add_u32 m0, s38, 103424
  s_add_u32 s33, s37, 950272
  buffer_load_dwordx4 v4, s[28:31], s33 offen lds
  ds_read_b64_tr_b16 a[144:145], v11 offset:0
  ds_read_b64_tr_b16 a[146:147], v11 offset:1024
  s_add_u32 m0, s38, 104448
  s_add_u32 s33, s37, 983040
  buffer_load_dwordx4 v4, s[28:31], s33 offen lds
  ds_read_b64_tr_b16 a[152:153], v11 offset:16
  ds_read_b64_tr_b16 a[154:155], v11 offset:1040
  s_add_u32 m0, s38, 105472
  s_add_u32 s33, s37, 1015808
  buffer_load_dwordx4 v4, s[28:31], s33 offen lds
  s_waitcnt vmcnt(16) lgkmcnt(0)
  s_barrier
  ds_read_b64_tr_b16 v[20:21], v8 offset:32768
  ds_read_b64_tr_b16 v[22:23], v8 offset:33792
  s_add_u32 m0, s38, 0
  s_add_u32 s33, s39, 0
  buffer_load_dwordx4 v5, s[20:23], s33 offen lds
  ds_read_b64_tr_b16 v[28:29], v8 offset:32784
  ds_read_b64_tr_b16 v[30:31], v8 offset:33808
  s_add_u32 m0, s38, 1024
  s_add_u32 s33, s39, 4096
  buffer_load_dwordx4 v5, s[20:23], s33 offen lds
  ds_read_b64_tr_b16 a[132:133], v9 offset:32768
  ds_read_b64_tr_b16 a[134:135], v9 offset:33792
  s_add_u32 m0, s38, 2048
  s_add_u32 s33, s39, 8192
  buffer_load_dwordx4 v5, s[20:23], s33 offen lds
  ds_read_b64_tr_b16 a[140:141], v9 offset:32784
  ds_read_b64_tr_b16 a[142:143], v9 offset:33808
  s_add_u32 m0, s38, 3072
  s_add_u32 s33, s39, 12288
  buffer_load_dwordx4 v5, s[20:23], s33 offen lds
  ds_read_b64_tr_b16 v[68:69], v10 offset:32768
  ds_read_b64_tr_b16 v[70:71], v10 offset:33792
  s_add_u32 m0, s38, 4096
  s_add_u32 s33, s39, 16384
  buffer_load_dwordx4 v6, s[20:23], s33 offen lds
  ds_read_b64_tr_b16 v[76:77], v10 offset:32784
  ds_read_b64_tr_b16 v[78:79], v10 offset:33808
  s_add_u32 m0, s38, 5120
  s_add_u32 s33, s39, 20480
  buffer_load_dwordx4 v6, s[20:23], s33 offen lds
  ds_read_b64_tr_b16 a[148:149], v11 offset:32768
  ds_read_b64_tr_b16 a[150:151], v11 offset:33792
  s_add_u32 m0, s38, 6144
  s_add_u32 s33, s39, 24576
  buffer_load_dwordx4 v6, s[20:23], s33 offen lds
  ds_read_b64_tr_b16 a[156:157], v11 offset:32784
  ds_read_b64_tr_b16 a[158:159], v11 offset:33808
  s_add_u32 m0, s38, 7168
  s_add_u32 s33, s39, 28672
  buffer_load_dwordx4 v6, s[20:23], s33 offen lds
  v_xor_b32 v8, 0x10000, v8
  v_xor_b32 v9, 0x10000, v9
  v_xor_b32 v10, 0x10000, v10
  v_xor_b32 v11, 0x10000, v11
  s_waitcnt vmcnt(16) lgkmcnt(0)
  s_barrier
  ds_read_b64_tr_b16 v[32:33], v8 offset:0
  ds_read_b64_tr_b16 v[34:35], v8 offset:1024
  s_add_u32 m0, s38, 32768
  s_add_u32 s33, s39, 256
  buffer_load_dwordx4 v5, s[20:23], s33 offen lds
  ds_read_b64_tr_b16 v[40:41], v8 offset:16
  ds_read_b64_tr_b16 v[42:43], v8 offset:1040
  s_add_u32 m0, s38, 33792
  s_add_u32 s33, s39, 4352
  buffer_load_dwordx4 v5, s[20:23], s33 offen lds
  ds_read_b64_tr_b16 v[48:49], v9 offset:0
  ds_read_b64_tr_b16 v[50:51], v9 offset:1024
  s_add_u32 m0, s38, 34816
  s_add_u32 s33, s39, 8448
  buffer_load_dwordx4 v5, s[20:23], s33 offen lds
  ds_read_b64_tr_b16 v[56:57], v9 offset:16
  ds_read_b64_tr_b16 v[58:59], v9 offset:1040
  s_add_u32 m0, s38, 35840
  s_add_u32 s33, s39, 12544
  buffer_load_dwordx4 v5, s[20:23], s33 offen lds
  ds_read_b64_tr_b16 v[80:81], v10 offset:0
  ds_read_b64_tr_b16 v[82:83], v10 offset:1024
  s_add_u32 m0, s38, 36864
  s_add_u32 s33, s39, 16640
  buffer_load_dwordx4 v6, s[20:23], s33 offen lds
  ds_read_b64_tr_b16 v[88:89], v10 offset:16
  ds_read_b64_tr_b16 v[90:91], v10 offset:1040
  s_add_u32 m0, s38, 37888
  s_add_u32 s33, s39, 20736
  buffer_load_dwordx4 v6, s[20:23], s33 offen lds
  ds_read_b64_tr_b16 a[160:161], v11 offset:0
  ds_read_b64_tr_b16 a[162:163], v11 offset:1024
  s_add_u32 m0, s38, 38912
  s_add_u32 s33, s39, 24832
  buffer_load_dwordx4 v6, s[20:23], s33 offen lds
  ds_read_b64_tr_b16 a[168:169], v11 offset:16
  ds_read_b64_tr_b16 a[170:171], v11 offset:1040
  s_add_u32 m0, s38, 39936
  s_add_u32 s33, s39, 28928
  buffer_load_dwordx4 v6, s[20:23], s33 offen lds
  v_lshlrev_b32 v3, 2, v1
  buffer_load_dword v3, v3, s[24:27], 0 offen sc1
  s_waitcnt vmcnt(17) lgkmcnt(0)
  s_barrier
  ds_read_b64_tr_b16 v[36:37], v8 offset:32768
  ds_read_b64_tr_b16 v[38:39], v8 offset:33792
  s_add_u32 m0, s38, 65536
  s_add_u32 s33, s39, 512
  buffer_load_dwordx4 v5, s[20:23], s33 offen lds
  ds_read_b64_tr_b16 v[44:45], v8 offset:32784
  ds_read_b64_tr_b16 v[46:47], v8 offset:33808
  s_add_u32 m0, s38, 66560
  s_add_u32 s33, s39, 4608
  buffer_load_dwordx4 v5, s[20:23], s33 offen lds
  ds_read_b64_tr_b16 v[52:53], v9 offset:32768
  ds_read_b64_tr_b16 v[54:55], v9 offset:33792
  s_add_u32 m0, s38, 67584
  s_add_u32 s33, s39, 8704
  buffer_load_dwordx4 v5, s[20:23], s33 offen lds
  ds_read_b64_tr_b16 v[60:61], v9 offset:32784
  ds_read_b64_tr_b16 v[62:63], v9 offset:33808
  s_add_u32 m0, s38, 68608
  s_add_u32 s33, s39, 12800
  buffer_load_dwordx4 v5, s[20:23], s33 offen lds
  ds_read_b64_tr_b16 v[84:85], v10 offset:32768
  ds_read_b64_tr_b16 v[86:87], v10 offset:33792
  s_add_u32 m0, s38, 69632
  s_add_u32 s33, s39, 16896
  buffer_load_dwordx4 v6, s[20:23], s33 offen lds
  ds_read_b64_tr_b16 v[92:93], v10 offset:32784
  ds_read_b64_tr_b16 v[94:95], v10 offset:33808
  s_add_u32 m0, s38, 70656
  s_add_u32 s33, s39, 20992
  buffer_load_dwordx4 v6, s[20:23], s33 offen lds
  ds_read_b64_tr_b16 a[164:165], v11 offset:32768
  ds_read_b64_tr_b16 a[166:167], v11 offset:33792
  s_add_u32 m0, s38, 71680
  s_add_u32 s33, s39, 25088
  buffer_load_dwordx4 v6, s[20:23], s33 offen lds
  ds_read_b64_tr_b16 a[172:173], v11 offset:32784
  ds_read_b64_tr_b16 a[174:175], v11 offset:33808
  s_add_u32 m0, s38, 72704
  s_add_u32 s33, s39, 29184
  buffer_load_dwordx4 v6, s[20:23], s33 offen lds
  v_bfe_u32 v7, v1, 4, 1
  v_lshlrev_b32 v12, 4, v7
  v_bfe_u32 v14, v1, 5, 1
  v_lshl_add_u32 v12, v14, 2, v12
  v_bfe_u32 v14, v1, 2, 1
  v_add_u32 v12, v14, v12
  v_lshl_add_u32 v7, v7, 1, v14
  v_xor_b32 v7, s4, v7
  v_lshlrev_b32 v7, 6, v7
  v_lshl_add_u32 v7, v12, 8, v7
  v_and_b32 v12, 3, v1
  v_lshl_add_u32 v7, v12, 4, v7
  v_bfe_u32 v12, v1, 3, 1
  v_lshl_add_u32 v7, v12, 3, v7
  s_xor_b32 s33, s4, 0
  s_lshl_b32 s33, s33, 13
  v_add_u32 v8, s33, v7
  s_xor_b32 s33, s4, 1
  s_lshl_b32 s33, s33, 13
  v_add_u32 v9, s33, v7
  s_xor_b32 s33, s4, 2
  s_lshl_b32 s33, s33, 13
  v_add_u32 v10, s33, v7
  s_xor_b32 s33, s4, 3
  s_lshl_b32 s33, s33, 13
  v_add_u32 v11, s33, v7
  s_waitcnt vmcnt(17) lgkmcnt(0)
  s_barrier
  v_lshlrev_b32 v15, 4, v1
  s_lshl_b32 s33, s4, 12
  s_add_u32 s33, s33, 131072
  v_add_u32 v15, s33, v15
  ds_write_b128 v15, v[80:83] offset:0
  ds_write_b128 v15, v[84:87] offset:1024
  ds_write_b128 v15, v[88:91] offset:2048
  ds_write_b128 v15, v[92:95] offset:3072
  ds_read_b64_tr_b16 a[176:177], v8 offset:0
  ds_read_b64_tr_b16 a[178:179], v8 offset:512
  s_add_u32 m0, s38, 98304
  s_add_u32 s33, s39, 768
  buffer_load_dwordx4 v5, s[20:23], s33 offen lds
  ds_read_b64_tr_b16 a[180:181], v8 offset:2048
  ds_read_b64_tr_b16 a[182:183], v8 offset:2560
  s_add_u32 m0, s38, 99328
  s_add_u32 s33, s39, 4864
  buffer_load_dwordx4 v5, s[20:23], s33 offen lds
  ds_read_b64_tr_b16 a[184:185], v9 offset:0
  ds_read_b64_tr_b16 a[186:187], v9 offset:512
  s_add_u32 m0, s38, 100352
  s_add_u32 s33, s39, 8960
  buffer_load_dwordx4 v5, s[20:23], s33 offen lds
  ds_read_b64_tr_b16 a[188:189], v9 offset:2048
  ds_read_b64_tr_b16 a[190:191], v9 offset:2560
  s_add_u32 m0, s38, 101376
  s_add_u32 s33, s39, 13056
  buffer_load_dwordx4 v5, s[20:23], s33 offen lds
  ds_read_b64_tr_b16 a[240:241], v10 offset:0
  ds_read_b64_tr_b16 a[242:243], v10 offset:512
  s_add_u32 m0, s38, 102400
  s_add_u32 s33, s39, 17152
  buffer_load_dwordx4 v6, s[20:23], s33 offen lds
  ds_read_b64_tr_b16 a[244:245], v10 offset:2048
  ds_read_b64_tr_b16 a[246:247], v10 offset:2560
  s_add_u32 m0, s38, 103424
  s_add_u32 s33, s39, 21248
  buffer_load_dwordx4 v6, s[20:23], s33 offen lds
  ds_read_b64_tr_b16 a[248:249], v11 offset:0
  ds_read_b64_tr_b16 a[250:251], v11 offset:512
  s_add_u32 m0, s38, 104448
  s_add_u32 s33, s39, 25344
  buffer_load_dwordx4 v6, s[20:23], s33 offen lds
  ds_read_b64_tr_b16 a[252:253], v11 offset:2048
  ds_read_b64_tr_b16 a[254:255], v11 offset:2560
  s_add_u32 m0, s38, 105472
  s_add_u32 s33, s39, 29440
  buffer_load_dwordx4 v6, s[20:23], s33 offen lds
  s_waitcnt vmcnt(16) lgkmcnt(0)
  s_barrier
  ds_read_b64_tr_b16 a[192:193], v8 offset:32768
  ds_read_b64_tr_b16 a[194:195], v8 offset:33280
  ds_read_b64_tr_b16 a[196:197], v8 offset:34816
  ds_read_b64_tr_b16 a[198:199], v8 offset:35328
  ds_read_b64_tr_b16 a[200:201], v9 offset:32768
  ds_read_b64_tr_b16 a[202:203], v9 offset:33280
  ds_read_b64_tr_b16 a[204:205], v9 offset:34816
  ds_read_b64_tr_b16 a[206:207], v9 offset:35328
  ds_read_b64_tr_b16 v[96:97], v10 offset:32768
  ds_read_b64_tr_b16 v[98:99], v10 offset:33280
  ds_read_b64_tr_b16 v[100:101], v10 offset:34816
  ds_read_b64_tr_b16 v[102:103], v10 offset:35328
  ds_read_b64_tr_b16 v[104:105], v11 offset:32768
  ds_read_b64_tr_b16 v[106:107], v11 offset:33280
  ds_read_b64_tr_b16 v[108:109], v11 offset:34816
  ds_read_b64_tr_b16 v[110:111], v11 offset:35328
  v_readlane_b32 s33, v3, s44
  v_readlane_b32 s34, v3, s45
  v_readlane_b32 s35, v3, 48
  v_lshlrev_b32 v3, 5, v1
  s_min_u32 s33, s33, s34
  s_add_u32 s35, s35, 22
  s_min_u32 s33, s33, s35
  s_cmp_ge_u32 s33, 32
  s_cbranch_scc0 e13_131
  s_mov_b32 s57, 1
  s_mov_b64 exec, 1
  buffer_load_dword v0, off, s[8:11], s41 sc1
  s_mov_b64 exec, -1
  s_add_u32 s33, s40, s52
  buffer_load_dword v14, v3, s[8:11], s33 offen sc1
  s_add_u32 s33, s33, 8192
  buffer_load_dword v14, v3, s[8:11], s33 offen sc1
  s_add_u32 s33, s54, s53
  buffer_load_dword v14, v3, s[8:11], s33 offen sc1
  s_add_u32 s33, s33, 327680
  buffer_load_dword v14, v3, s[8:11], s33 offen sc1
  s_add_u32 s33, s54, s52
  s_add_u32 s33, s33, 655360
  buffer_load_dword v14, v3, s[8:11], s33 offen sc1
  s_add_u32 s33, s33, 8192
  buffer_load_dword v14, v3, s[8:11], s33 offen sc1
  s_add_u32 s33, s33, 8192
  buffer_load_dword v14, v3, s[8:11], s33 offen sc1
  s_add_u32 s33, s33, 8192
  buffer_load_dword v14, v3, s[8:11], s33 offen sc1
e13_131:
  v_xor_b32 v8, 0x10000, v8
  v_xor_b32 v9, 0x10000, v9
  v_xor_b32 v10, 0x10000, v10
  v_xor_b32 v11, 0x10000, v11
  s_waitcnt vmcnt(8) lgkmcnt(0)
  s_barrier
  ds_read_b64_tr_b16 a[208:209], v8 offset:0
  ds_read_b64_tr_b16 a[210:211], v8 offset:512
  ds_read_b64_tr_b16 a[212:213], v8 offset:2048
  ds_read_b64_tr_b16 a[214:215], v8 offset:2560
  ds_read_b64_tr_b16 a[216:217], v9 offset:0
  ds_read_b64_tr_b16 a[218:219], v9 offset:512
  ds_read_b64_tr_b16 a[220:221], v9 offset:2048
  ds_read_b64_tr_b16 a[222:223], v9 offset:2560
  ds_read_b64_tr_b16 v[112:113], v10 offset:0
  ds_read_b64_tr_b16 v[114:115], v10 offset:512
  ds_read_b64_tr_b16 v[116:117], v10 offset:2048
  ds_read_b64_tr_b16 v[118:119], v10 offset:2560
  ds_read_b64_tr_b16 v[120:121], v11 offset:0
  ds_read_b64_tr_b16 v[122:123], v11 offset:512
  ds_read_b64_tr_b16 v[124:125], v11 offset:2048
  ds_read_b64_tr_b16 v[126:127], v11 offset:2560
  s_waitcnt vmcnt(0) lgkmcnt(0)
  s_barrier
  ds_read_b64_tr_b16 a[224:225], v8 offset:32768
  ds_read_b64_tr_b16 a[226:227], v8 offset:33280
  ds_read_b64_tr_b16 a[228:229], v8 offset:34816
  ds_read_b64_tr_b16 a[230:231], v8 offset:35328
  ds_read_b64_tr_b16 a[232:233], v9 offset:32768
  ds_read_b64_tr_b16 a[234:235], v9 offset:33280
  ds_read_b64_tr_b16 a[236:237], v9 offset:34816
  ds_read_b64_tr_b16 a[238:239], v9 offset:35328
  ds_read_b64_tr_b16 v[80:81], v10 offset:32768
  ds_read_b64_tr_b16 v[82:83], v10 offset:33280
  ds_read_b64_tr_b16 v[84:85], v10 offset:34816
  ds_read_b64_tr_b16 v[86:87], v10 offset:35328
  ds_read_b64_tr_b16 v[88:89], v11 offset:32768
  ds_read_b64_tr_b16 v[90:91], v11 offset:33280
  ds_read_b64_tr_b16 v[92:93], v11 offset:34816
  ds_read_b64_tr_b16 v[94:95], v11 offset:35328
  s_waitcnt lgkmcnt(0)
  s_barrier
  ds_write_b128 v13, v[16:19] offset:0
  ds_write_b128 v13, v[20:23] offset:1024
  ds_write_b128 v13, v[24:27] offset:2048
  ds_write_b128 v13, v[28:31] offset:3072
  s_waitcnt lgkmcnt(0)
  ds_read_b128 v[16:19], v15 offset:0
  ds_read_b128 v[20:23], v15 offset:1024
  ds_read_b128 v[24:27], v15 offset:2048
  ds_read_b128 v[28:31], v15 offset:3072
  ds_write_b128 v13, v[32:35] offset:4096
  ds_write_b128 v13, v[36:39] offset:5120
  ds_write_b128 v13, v[40:43] offset:6144
  ds_write_b128 v13, v[44:47] offset:7168
  ds_write_b128 v13, v[48:51] offset:8192
  ds_write_b128 v13, v[52:55] offset:9216
  ds_write_b128 v13, v[56:59] offset:10240
  ds_write_b128 v13, v[60:63] offset:11264
  ds_write_b128 v13, v[64:67] offset:12288
  ds_write_b128 v13, v[68:71] offset:13312
  ds_write_b128 v13, v[72:75] offset:14336
  ds_write_b128 v13, v[76:79] offset:15360
  ds_write_b128 v13, v[96:99] offset:20480
  ds_write_b128 v13, v[100:103] offset:21504
  ds_write_b128 v13, v[104:107] offset:22528
  ds_write_b128 v13, v[108:111] offset:23552
  ds_write_b128 v13, v[112:115] offset:24576
  ds_write_b128 v13, v[116:119] offset:25600
  ds_write_b128 v13, v[120:123] offset:26624
  ds_write_b128 v13, v[124:127] offset:27648
  ds_write_b128 v13, v[80:83] offset:28672
  ds_write_b128 v13, v[84:87] offset:29696
  ds_write_b128 v13, v[88:91] offset:30720
  ds_write_b128 v13, v[92:95] offset:31744
  s_waitcnt lgkmcnt(0)
  ds_write_b128 v13, v[16:19] offset:16384
  ds_write_b128 v13, v[20:23] offset:17408
  ds_write_b128 v13, v[24:27] offset:18432
  ds_write_b128 v13, v[28:31] offset:19456
  s_waitcnt lgkmcnt(0)
  v_readfirstlane_b32 s56, v0
  s_barrier
  v_mov_b32 v21, 161792
  ds_read_b32 v20, v21
  s_waitcnt lgkmcnt(0)
  v_readfirstlane_b32 s98, v20
  s_mov_b32 s60, 0
  s_cmp_eq_u32 s57, 1
  s_cbranch_scc1 ch_mode
  v_mov_b32 v5, 80
  s_mov_b64 exec, 1
wd_132:
  buffer_load_dword v4, v5, s[24:27], 0 offen sc1
  s_waitcnt vmcnt(0)
  v_cmp_gt_u32 vcc, 1, v4
  s_cbranch_vccz wdd_133
  s_sub_u32 s3, s3, 1
  s_cbranch_scc1 bail_10
  s_sleep 8
  s_branch wd_132
wdd_133:
  s_mov_b64 exec, -1
  s_lshl_b32 s33, s7, 2
  s_add_u32 s33, s33, 96
  v_mov_b32 v5, s33
  s_mov_b64 exec, 1
wd_134:
  buffer_load_dword v4, v5, s[24:27], 0 offen sc1
  s_waitcnt vmcnt(0)
  v_cmp_gt_u32 vcc, 1, v4
  s_cbranch_vccz wdd_135
  s_sub_u32 s3, s3, 1
  s_cbranch_scc1 bail_11
  s_sleep 8
  s_branch wd_134
wdd_135:
  s_mov_b64 exec, -1
dm_136:
  v_and_b32 v5, 15, v1
  v_lshlrev_b32 v5, 2, v5
  v_add_u32 v4, 128, v5
  v_cmp_gt_u32 vcc, 4, v5
  s_nop 1
  v_cndmask_b32 v5, v4, v5, vcc
  buffer_load_dword v4, v5, s[24:27], 0 offen sc1
  s_waitcnt vmcnt(0)
  v_readlane_b32 s34, v4, s5
  s_nop 0
  s_cmp_ge_u32 s34, 32
  s_cbranch_scc1 dmf_137
  v_readlane_b32 s33, v4, 0
  v_readlane_b32 s34, v4, 1
  s_nop 0
  s_add_u32 s33, s33, s34
  v_readlane_b32 s34, v4, 2
  s_nop 0
  s_add_u32 s33, s33, s34
  v_readlane_b32 s34, v4, 3
  s_nop 0
  s_add_u32 s33, s33, s34
  v_readlane_b32 s34, v4, 4
  s_nop 0
  s_add_u32 s33, s33, s34
  v_readlane_b32 s34, v4, 5
  s_nop 0
  s_add_u32 s33, s33, s34
  v_readlane_b32 s34, v4, 6
  s_nop 0
  s_add_u32 s33, s33, s34
  v_readlane_b32 s34, v4, 7
  s_nop 0
  s_add_u32 s33, s33, s34
  v_readlane_b32 s34, v4, 8
  s_nop 0
  s_add_u32 s33, s33, s34
  v_readlane_b32 s34, v4, 9
  s_nop 0
  s_add_u32 s33, s33, s34
  v_readlane_b32 s34, v4, 10
  s_nop 0
  s_add_u32 s33, s33, s34
  v_readlane_b32 s34, v4, 11
  s_nop 0
  s_add_u32 s33, s33, s34
  v_readlane_b32 s34, v4, 12
  s_nop 0
  s_add_u32 s33, s33, s34
  v_readlane_b32 s34, v4, 13
  s_nop 0
  s_add_u32 s33, s33, s34
  v_readlane_b32 s34, v4, 14
  s_nop 0
  s_add_u32 s33, s33, s34
  v_readlane_b32 s34, v4, 15
  s_nop 0
  s_add_u32 s33, s33, s34
  s_cmp_ge_u32 s33, 256
  s_cbranch_scc1 ch_setslow
  s_sub_u32 s3, s3, 1
  s_cbranch_scc1 bail_2
  s_sleep 8
  s_branch dm_136
dmf_137:
  s_branch ch_mode
ch_setslow:
  s_mov_b32 s60, 1
ch_mode:
  v_and_b32 v28, 15, v1
  v_lshrrev_b32 v29, 4, v1
  v_lshlrev_b32 v3, 4, v1
  v_add_u32 v8, s36, v3
  v_add_u32 v9, 131072, v3
  v_bfe_u32 v30, v1, 1, 1
  v_mul_u32_u24 v30, 0xaaaa, v30
  v_add_u32 v2, 0x4444, v30
  s_add_u32 s33, s4, 0
  s_and_b32 s33, s33, 3
  s_lshl_b32 s33, s33, 11
  v_add_u32 v10, s33, v9
  s_add_u32 s33, s4, 1
  s_and_b32 s33, s33, 3
  s_lshl_b32 s33, s33, 11
  v_add_u32 v11, s33, v9
  s_add_u32 s33, s4, 2
  s_and_b32 s33, s33, 3
  s_lshl_b32 s33, s33, 11
  v_add_u32 v12, s33, v9
  s_add_u32 s33, s4, 3
  s_and_b32 s33, s33, 3
  s_lshl_b32 s33, s33, 11
  v_add_u32 v13, s33, v9
  v_and_b32 v30, 3, v1
  v_lshlrev_b32 v30, 1, v30
  v_bfe_u32 v31, v1, 2, 1
  v_add_u32 v30, v30, v31
  v_bfe_u32 v31, v1, 3, 1
  v_lshlrev_b32 v31, 4, v31
  v_mov_b32 v32, 0x3f80
  v_lshlrev_b32 v31, v31, v32
  v_cmp_eq_u32 vcc, 0, v30
  s_nop 1
  v_cndmask_b32 v4, 0, v31, vcc
  v_cmp_eq_u32 vcc, 1, v30
  s_nop 1
  v_cndmask_b32 v5, 0, v31, vcc
  v_cmp_eq_u32 vcc, 2, v30
  s_nop 1
  v_cndmask_b32 v6, 0, v31, vcc
  v_cmp_eq_u32 vcc, 3, v30
  s_nop 1
  v_cndmask_b32 v7, 0, v31, vcc
  v_bfe_u32 v30, v1, 3, 1
  v_lshl_add_u32 v30, v30, 2, v29
  s_lshl_b32 s33, s4, 3
  v_add_u32 v30, s33, v30
  v_mul_u32_u24 v30, 8448, v30
  v_and_b32 v31, 7, v1
  v_lshl_add_u32 v30, v31, 3, v30
  s_lshl_b32 s33, s6, 6
  v_add_u32 v14, s33, v30
  v_and_b32 v30, 1, v1
  v_lshlrev_b32 v30, 5, v30
  v_bfe_u32 v31, v1, 5, 1
  v_lshl_add_u32 v30, v31, 4, v30
  v_bfe_u32 v31, v1, 1, 1
  v_lshl_add_u32 v30, v31, 3, v30
  v_bfe_u32 v31, v1, 4, 1
  v_lshl_add_u32 v30, v31, 2, v30
  v_bfe_u32 v31, v1, 2, 1
  v_lshl_add_u32 v30, v31, 14, v30
  s_lshr_b32 s33, s6, 1
  s_lshl_b32 s33, s33, 8
  s_and_b32 s34, s6, 1
  s_lshl_b32 s34, s34, 6
  s_add_u32 s33, s33, s34
  s_lshr_b32 s34, s4, 1
  s_lshl_b32 s34, s34, 12
  s_and_b32 s35, s4, 1
  s_lshl_b32 s35, s35, 7
  s_add_u32 s35, s35, s34
  s_add_u32 s33, s33, s35
  s_add_u32 s33, s33, 8192
  v_add_u32 v15, s33, v30
  v_bfe_u32 v24, v1, 2, 1
  v_or_b32 v24, -2, v24
  v_mul_u32_u24 v30, 576, v29
  v_lshl_add_u32 v30, v28, 2, v30
  s_lshl_b32 s33, s4, 6
  s_add_u32 s34, s33, 155648
  v_add_u32 v16, s34, v30
  v_bfe_u32 v30, v1, 2, 2
  v_lshlrev_b32 v30, 1, v30
  v_and_b32 v31, 1, v1
  v_add_u32 v30, v30, v31
  v_mul_u32_u24 v30, 288, v30
  v_lshl_add_u32 v30, v29, 4, v30
  v_add_u32 v17, 155648, v30
  v_bfe_u32 v31, v1, 1, 1
  v_lshl_add_u32 v18, v31, 7, v17
  v_bfe_u32 v30, v1, 2, 3
  v_mul_u32_u24 v30, 288, v30
  v_bfe_u32 v31, v1, 5, 1
  v_lshl_add_u32 v30, v31, 5, v30
  v_and_b32 v31, 3, v1
  v_lshl_add_u32 v30, v31, 3, v30
  s_lshl_b32 s33, s4, 6
  s_add_u32 s33, s33, 158208
  v_add_u32 v22, s33, v30
  v_lshlrev_b32 v30, 4, v28
  v_lshl_add_u32 v30, v29, 2, v30
  v_add_u32 v23, 2048, v30
  v_bfe_u32 v30, v1, 2, 2
  v_lshlrev_b32 v30, 1, v30
  v_and_b32 v31, 1, v1
  v_add_u32 v30, v30, v31
  v_lshlrev_b32 v30, 4, v30
  v_lshl_add_u32 v30, v29, 7, v30
  s_lshl_b32 s33, s4, 9
  s_add_u32 s33, s33, 131072
  v_add_u32 v0, s33, v30
  v_bfe_u32 v31, v1, 1, 1
  v_lshl_add_u32 v19, v31, 3, v0
  v_bfe_u32 v30, v1, 5, 1
  v_lshlrev_b32 v30, 10, v30
  v_bfe_u32 v31, v1, 4, 1
  v_lshl_add_u32 v30, v31, 9, v30
  s_lshl_b32 s33, s4, 11
  v_add_u32 v30, s33, v30
  v_lshl_add_u32 v21, v28, 4, v30
  v_bfe_u32 v31, v1, 3, 1
  v_lshl_add_u32 v20, v31, 7, v21
  v_and_b32 v1, 1, v1
  v_xor_b32 v1, 1, v1
  s_lshl_b32 s33, s7, 20
  s_add_u32 s54, s33, 16777216
  s_add_u32 s37, s54, 655360
  s_mul_i32 s53, s6, 8448
  s_lshl_b32 s33, s4, 11
  s_add_u32 s53, s53, s33
  s_add_u32 s55, s37, s35
  s_add_u32 s43, s33, 139264
  s_lshl_b32 s33, s7, 23
  s_lshl_b32 s34, s6, 12
  s_add_u32 s33, s33, s34
  s_add_u32 s39, s33, 25165824
  s_lshl_b32 s34, s4, 9
  s_add_u32 s39, s39, s34
  s_mul_i32 s33, s7, 50331648
  s_mul_i32 s34, s6, 24576
  s_add_u32 s33, s33, s34
  s_add_u32 s40, s33, 41951232
  s_lshl_b32 s33, s7, 5
  s_add_u32 s33, s33, s6
  s_lshl_b32 s33, s33, 9
  s_lshl_b32 s34, s4, 7
  s_add_u32 s33, s33, s34
  s_add_u32 s41, s33, 0
  s_lshl_b32 s84, s4, 11
  s_mov_b32 s58, 0x3f803f80
  s_mov_b32 s59, 0x3f803f80
  s_add_u32 s42, s33, 49152
  s_mov_b32 s44, 0x33333333
  s_mov_b32 s45, 0x33333333
  s_mov_b32 s46, 0xcccccccc
  s_mov_b32 s47, 0xcccccccc
  s_mov_b32 s48, 0x000f000f
  s_mov_b32 s49, 0x000f000f
  s_mov_b32 s50, 0x00ff00ff
  s_mov_b32 s51, 0x00ff00ff
  s_mov_b32 s52, 1040356334
  s_mov_b32 s20, 0
  s_mov_b32 s38, s55
  s_cmp_lg_u32 s56, 0
  s_cbranch_scc1 ch_kv0ok
  s_cmp_eq_u32 s57, 1
  s_cbranch_scc1 ch_kv0
  s_add_u32 s33, s54, s53
  buffer_load_dwordx4 v[28:31], v3, s[8:11], s33 offen offset:0 sc1
  buffer_load_dwordx4 v[28:31], v3, s[8:11], s33 offen offset:1024 sc1
  s_add_u32 s33, s33, 327680
  buffer_load_dwordx4 v[28:31], v3, s[8:11], s33 offen offset:0 sc1
  buffer_load_dwordx4 v[28:31], v3, s[8:11], s33 offen offset:1024 sc1
  s_add_u32 s33, s33, 327680
  s_add_u32 s33, s37, s84
  s_add_u32 s33, s33, 8192
  buffer_load_dwordx4 v[28:31], v3, s[8:11], s33 offen offset:0 sc1
  buffer_load_dwordx4 v[28:31], v3, s[8:11], s33 offen offset:1024 sc1
  s_add_u32 s33, s37, s84
  s_add_u32 s33, s33, 16384
  buffer_load_dwordx4 v[28:31], v3, s[8:11], s33 offen offset:0 sc1
  buffer_load_dwordx4 v[28:31], v3, s[8:11], s33 offen offset:1024 sc1
  s_add_u32 s33, s37, s84
  s_add_u32 s33, s33, 24576
  buffer_load_dwordx4 v[28:31], v3, s[8:11], s33 offen offset:0 sc1
  buffer_load_dwordx4 v[28:31], v3, s[8:11], s33 offen offset:1024 sc1
ch_kv0:
  s_mov_b64 exec, 1
  buffer_load_dword v25, off, s[8:11], s41 sc1
  s_waitcnt vmcnt(0)
  v_cmp_eq_u32 vcc, 0, v25
  s_cbranch_vccz ch_kv0ok
  s_sub_u32 s3, s3, 1
  s_cbranch_scc1 bail_12
  s_sleep 2
  s_branch ch_kv0
ch_kv0ok:
  s_mov_b64 exec, -1
  s_add_u32 m0, s43, 0
  s_nop 0
  buffer_load_dwordx4 v20, s[8:11], s40 offen offset:0 sc1 lds
  s_add_u32 m0, s43, 896
  s_nop 0
  buffer_load_dwordx4 v20, s[8:11], s40 offen offset:128 sc1 lds
  s_add_u32 s56, s40, 8192
  s_add_u32 m0, s43, 8192
  s_nop 0
  buffer_load_dwordx4 v21, s[8:11], s56 offen offset:0 sc1 lds
  s_add_u32 m0, s43, 8960
  s_nop 0
  buffer_load_dwordx4 v21, s[8:11], s56 offen offset:256 sc1 lds
  s_add_u32 s40, s40, 786432
  s_add_u32 s85, s40, s84
  s_sub_u32 s33, 3, s4
  s_mul_i32 s61, s33, 32
  s_add_u32 s82, s61, 76
  s_mul_i32 s83, s33, 8
  s_add_u32 s83, s83, 590
  s_mov_b32 s63, s98
  s_mov_b32 s62, s63
  s_cmp_eq_u32 s60, 1
  s_cbranch_scc1 chs_entry
chf_entry:
  v_mov_b32 v25, 127
  v_mov_b32 v125, 0
  v_and_b32 v126, 0x380, v3
  v_add_u32 v126, v126, v3
  ds_read_b128 v[60:63], v8 offset:0
  ds_read_b128 v[64:67], v8 offset:1024
  ds_read_b128 v[68:71], v8 offset:2048
  ds_read_b128 v[72:75], v8 offset:3072
  ds_read_b128 v[76:79], v8 offset:4096
  ds_read_b128 v[80:83], v8 offset:5120
  ds_read_b128 v[84:87], v8 offset:6144
  ds_read_b128 v[88:91], v8 offset:7168
  ds_read_b128 v[92:95], v8 offset:8192
  ds_read_b128 v[96:99], v8 offset:9216
  v_mov_b64 v[116:117], 0
  v_mov_b64 v[118:119], 0
  v_mov_b64 v[120:121], 0
  v_mov_b64 v[122:123], 0
chf_h2:
  buffer_load_dwordx4 v[28:31], v126, s[8:11], s38 offen sc1
  buffer_load_dwordx4 v[32:35], v126, s[8:11], s38 offen offset:2048 sc1
  v_lshlrev_b32 v124, 2, v3
  v_and_b32 v127, 0x800, v124
  v_mad_u32_u24 v124, v127, 3, v124
  v_mov_b64 v[100:101], 0
  v_mov_b64 v[102:103], 0
  v_mov_b64 v[104:105], 0
  v_mov_b64 v[106:107], 0
  v_mov_b64 v[108:109], 0
  v_mov_b64 v[110:111], 0
  v_mov_b64 v[112:113], 0
  v_mov_b64 v[114:115], 0
  s_waitcnt lgkmcnt(0)
  s_waitcnt vmcnt(1)
  ds_write_b128 v10, v[28:31]
  v_smfmac_f32_16x16x64_bf16 v[100:103], v[28:31], a[0:7], v2
  s_waitcnt vmcnt(0)
  ds_write_b128 v10, v[32:35] offset:1024
  v_smfmac_f32_16x16x64_bf16 v[104:107], v[28:31], a[8:15], v2
  v_max_u32 v26, v28, v32
  v_smfmac_f32_16x16x64_bf16 v[108:111], v[28:31], v[60:67], v2
  v_cmp_eq_u32 vcc, -1, v26
  v_smfmac_f32_16x16x64_bf16 v[112:115], v[28:31], v[68:75], v2
  v_smfmac_f32_16x16x64_bf16 v[100:103], v[32:35], a[16:23], v2
  s_cbranch_vccnz chf_h2retry
  v_smfmac_f32_16x16x64_bf16 v[104:107], v[32:35], a[24:31], v2
  ds_read_b128 v[60:63], v8 offset:10240
  v_smfmac_f32_16x16x64_bf16 v[108:111], v[32:35], v[76:83], v2
  ds_read_b128 v[64:67], v8 offset:11264
  s_add_u32 m0, s43, 8192
  s_waitcnt lgkmcnt(2)
  s_barrier
  ds_read_b128 v[36:39], v11 offset:0
  ds_read_b128 v[40:43], v11 offset:1024
  v_smfmac_f32_16x16x64_bf16 v[112:115], v[32:35], v[84:91], v2
  buffer_load_dwordx4 v21, s[8:11], s56 offen sc1 lds
  s_add_u32 m0, s43, 8960
  v_smfmac_f32_16x16x64_bf16 v[116:119], v[28:31], v[128:135], v2
  buffer_load_dwordx4 v21, s[8:11], s56 offen offset:256 sc1 lds
  v_smfmac_f32_16x16x64_bf16 v[120:123], v[28:31], v[136:143], v2
  ds_read_b128 v[68:71], v8 offset:12288
  s_waitcnt lgkmcnt(2)
  v_smfmac_f32_16x16x64_bf16 v[100:103], v[36:39], a[32:39], v2
  ds_read_b128 v[72:75], v8 offset:13312
  v_smfmac_f32_16x16x64_bf16 v[104:107], v[36:39], a[40:47], v2
  buffer_load_dword v25, v124, s[8:11], s85 offen sc1
  v_smfmac_f32_16x16x64_bf16 v[108:111], v[36:39], a[128:135], v2
  ds_read_b128 v[44:47], v12 offset:0
  v_smfmac_f32_16x16x64_bf16 v[112:115], v[36:39], a[136:143], v2
  s_mov_b64 exec, 1
  buffer_load_dword v23, off, s[8:11], s41 sc1
  s_mov_b64 exec, -1
  s_waitcnt lgkmcnt(3)
  v_smfmac_f32_16x16x64_bf16 v[108:111], v[40:43], v[92:99], v2
  ds_read_b128 v[76:79], v8 offset:14336
  v_smfmac_f32_16x16x64_bf16 v[100:103], v[40:43], a[48:55], v2
  ds_read_b128 v[80:83], v8 offset:15360
  v_smfmac_f32_16x16x64_bf16 v[104:107], v[40:43], a[56:63], v2
  ds_read_b128 v[48:51], v12 offset:1024
  v_smfmac_f32_16x16x64_bf16 v[112:115], v[40:43], v[60:67], v2
  s_waitcnt lgkmcnt(4)
  s_waitcnt lgkmcnt(3)
  v_smfmac_f32_16x16x64_bf16 v[108:111], v[44:47], v[68:75], v2
  ds_read_b128 v[52:55], v13 offset:0
  v_smfmac_f32_16x16x64_bf16 v[100:103], v[44:47], a[64:71], v2
  ds_read_b128 v[84:87], v8 offset:16384
  s_add_u32 s57, s20, 1
  s_waitcnt lgkmcnt(3)
  v_smfmac_f32_16x16x64_bf16 v[112:115], v[44:47], v[76:83], v2
  ds_read_b128 v[88:91], v8 offset:17408
  v_smfmac_f32_16x16x64_bf16 v[104:107], v[44:47], a[72:79], v2
  ds_read_b128 v[56:59], v13 offset:1024
  s_lshr_b32 s21, s20, 1
  s_waitcnt lgkmcnt(3)
  v_smfmac_f32_16x16x64_bf16 v[108:111], v[52:55], a[144:151], v2
  ds_read_b128 v[92:95], v8 offset:18432
  v_smfmac_f32_16x16x64_bf16 v[112:115], v[52:55], a[152:159], v2
  ds_read_b128 v[96:99], v8 offset:19456
  s_not_b32 s21, s21
  s_waitcnt lgkmcnt(3)
  v_smfmac_f32_16x16x64_bf16 v[108:111], v[48:51], v[84:91], v2
  s_waitcnt lgkmcnt(2)
  v_smfmac_f32_16x16x64_bf16 v[108:111], v[56:59], a[160:167], v2
  ds_read_b128 v[60:63], v9 offset:8192
  s_min_u32 s57, s57, 62
  v_smfmac_f32_16x16x64_bf16 v[112:115], v[56:59], a[168:175], v2
  ds_read_b128 v[64:67], v9 offset:10240
  s_and_b32 s21, s21, 1
  s_waitcnt lgkmcnt(2)
  v_smfmac_f32_16x16x64_bf16 v[112:115], v[48:51], v[92:99], v2
  ds_read_b128 v[68:71], v9 offset:12288
  v_add_f32 v108, v108, v110
  v_smfmac_f32_16x16x64_bf16 v[100:103], v[48:51], a[80:87], v2
  ds_read_b128 v[72:75], v9 offset:14336
  v_add_f32 v109, v109, v111
  v_smfmac_f32_16x16x64_bf16 v[100:103], v[52:55], a[96:103], v2
  ds_read_b128 v[76:79], v9 offset:9216
  v_add_f32 v112, v112, v114
  v_smfmac_f32_16x16x64_bf16 v[100:103], v[56:59], a[112:119], v2
  ds_read_b128 v[80:83], v9 offset:11264
  v_add_f32 v113, v113, v115
  v_smfmac_f32_16x16x64_bf16 v[104:107], v[48:51], a[88:95], v2
  ds_read_b128 v[84:87], v9 offset:13312
  v_cvt_pk_bf16_f32 v124, v108, v112
  v_smfmac_f32_16x16x64_bf16 v[104:107], v[52:55], a[104:111], v2
  ds_read_b128 v[88:91], v9 offset:15360
  v_cvt_pk_bf16_f32 v125, v109, v113
  v_smfmac_f32_16x16x64_bf16 v[104:107], v[56:59], a[120:127], v2
  ds_write_b32 v16, v124 offset:2560
  v_add_f32 v100, v100, v102
  v_smfmac_f32_16x16x64_bf16 v[116:119], v[32:35], v[144:151], v2
  ds_write_b32 v16, v125 offset:2848
  v_add_f32 v101, v101, v103
  v_smfmac_f32_16x16x64_bf16 v[120:123], v[32:35], v[152:159], v2
  ds_read_b64 v[126:127], v22
  v_add_f32 v104, v104, v106
  v_add_f32 v105, v105, v107
  v_cvt_pk_bf16_f32 v102, v100, v104
  v_cvt_pk_bf16_f32 v103, v101, v105
  ds_write2_b32 v16, v102, v103 offset1:72
  v_smfmac_f32_16x16x64_bf16 v[116:119], v[36:39], v[160:167], v2
  v_lshrrev_b32 v124, 1, v3
  v_smfmac_f32_16x16x64_bf16 v[120:123], v[36:39], v[168:175], v2
  s_waitcnt lgkmcnt(1)
  v_min_u32 v126, -2, v126
  v_smfmac_f32_16x16x64_bf16 v[116:119], v[40:43], v[176:183], v2
  buffer_store_dwordx2 v[126:127], v124, s[8:11], s39 offen sc1
  s_waitcnt lgkmcnt(0)
  s_barrier
  ds_read_b128 v[92:95], v17 offset:0
  v_smfmac_f32_16x16x64_bf16 v[120:123], v[40:43], v[184:191], v2
  ds_read_b128 v[96:99], v17 offset:64
  v_smfmac_f32_16x16x64_bf16 v[116:119], v[44:47], v[192:199], v2
  ds_read_b128 v[108:111], v17 offset:128
  v_smfmac_f32_16x16x64_bf16 v[120:123], v[44:47], v[200:207], v2
  ds_read_b128 v[112:115], v17 offset:192
  v_smfmac_f32_16x16x64_bf16 v[116:119], v[48:51], v[208:215], v2
  ds_read_b128 v[28:31], v18 offset:0
  s_add_u32 s56, s40, 8192
  v_smfmac_f32_16x16x64_bf16 v[120:123], v[48:51], v[216:223], v2
  ds_read_b128 v[36:39], v18 offset:2560
  v_smfmac_f32_16x16x64_bf16 v[116:119], v[52:55], v[224:231], v2
  ds_read_b128 v[32:35], v18 offset:64
  v_smfmac_f32_16x16x64_bf16 v[116:119], v[56:59], v[240:247], v2
  ds_read_b128 v[40:43], v18 offset:2624
  v_smfmac_f32_16x16x64_bf16 v[120:123], v[52:55], v[232:239], v2
  s_waitcnt vmcnt(3)
  v_smfmac_f32_16x16x64_bf16 v[120:123], v[56:59], v[248:255], v2
  s_waitcnt lgkmcnt(4)
  v_mfma_f32_16x16x32_bf16 v[100:103], v[60:63], v[92:95], 0
  v_add_f32 v116, v116, v118
  v_mfma_f32_16x16x32_bf16 v[100:103], v[64:67], v[96:99], v[100:103]
  s_and_b32 s33, s20, 1
  v_add_f32 v117, v117, v119
  v_add_f32 v120, v120, v122
  v_mfma_f32_16x16x32_bf16 v[100:103], v[68:71], v[108:111], v[100:103]
  s_mul_i32 s33, s33, 327680
  v_add_f32 v121, v121, v123
  v_cvt_pk_bf16_f32 v118, v116, v117
  v_mfma_f32_16x16x32_bf16 v[100:103], v[72:75], v[112:115], v[100:103]
  s_waitcnt lgkmcnt(0)
  v_cvt_pk_bf16_f32 v119, v120, v121
  v_min_u32 v118, -2, v118
  v_mfma_f32_16x16x32_bf16 v[52:55], v[36:39], v[28:31], 0
  buffer_store_dwordx2 v[118:119], v124, s[8:11], s39 offen offset:2048 sc1
  v_mov_b64 v[120:121], s[58:59]
  v_mfma_f32_16x16x32_bf16 v[52:55], v[40:43], v[32:35], v[52:55]
  ds_read_b128 v[44:47], v10 offset:16384
  v_max3_f32 v26, v100, v101, v102
  v_mfma_f32_16x16x32_bf16 v[104:107], v[76:79], v[92:95], 0
  ds_read_b128 v[48:51], v10 offset:17408
  v_mov_b64 v[122:123], s[58:59]
  v_mfma_f32_16x16x32_bf16 v[104:107], v[80:83], v[96:99], v[104:107]
  s_add_u32 s22, s54, s33
  v_cndmask_b32_e64 v52, v52, v54, s[46:47]
  v_cndmask_b32_e64 v53, v53, v55, s[46:47]
  v_mfma_f32_16x16x32_bf16 v[104:107], v[84:87], v[108:111], v[104:107]
  v_add_f32_dpp v52, v52, v52 quad_perm:[2,3,0,1] row_mask:0xf bank_mask:0xf
  v_add_f32_dpp v53, v53, v53 quad_perm:[2,3,0,1] row_mask:0xf bank_mask:0xf
  v_mfma_f32_16x16x32_bf16 v[104:107], v[88:91], v[112:115], v[104:107]
  v_max3_f32 v26, v26, v103, v52
  v_cndmask_b32_e64 v126, v52, v53, s[46:47]
  v_max_f32 v26, v26, v53
  v_mov_b64 v[60:61], 0
  v_mov_b64 v[62:63], 0
  v_mov_b64 v[64:65], 0
  v_mov_b64 v[66:67], 0
  v_mov_b64 v[68:69], 0
  v_max3_f32 v26, v26, v104, v105
  v_max3_f32 v27, v26, v106, v107
  v_max3_f32 v26, v26, v106, v107
  v_cndmask_b32_e64 v100, v100, v104, s[46:47]
  v_cndmask_b32_e64 v101, v101, v105, s[46:47]
  v_permlane16_swap_b32 v27, v26
  v_max_f32 v127, v26, v27
  v_max_f32 v26, v26, v27
  v_cndmask_b32_e64 v102, v102, v106, s[46:47]
  v_cndmask_b32_e64 v103, v103, v107, s[46:47]
  v_permlane32_swap_b32 v127, v26
  v_max_f32 v26, v26, v127
  v_mul_f32 v26, s52, v26
  v_fma_f32 v100, v100, s52, -v26
  v_fma_f32 v101, v101, s52, -v26
  v_fma_f32 v102, v102, s52, -v26
  v_fma_f32 v103, v103, s52, -v26
  v_exp_f32 v100, v100
  v_exp_f32 v101, v101
  v_exp_f32 v102, v102
  v_exp_f32 v103, v103
  v_cvt_pk_bf16_f32 v82, v100, v101
  v_cvt_pk_bf16_f32 v83, v102, v103
  v_cndmask_b32_e64 v78, 0, v82, s[46:47]
  v_cndmask_b32_e64 v79, 0, v83, s[46:47]
  v_cndmask_b32_e64 v104, v82, 0, s[46:47]
  v_cndmask_b32_e64 v105, v83, 0, s[46:47]
  v_mov_b32_dpp v106, v78 quad_perm:[2,3,0,1] row_mask:0xf bank_mask:0xf
  v_mov_b32_dpp v107, v79 quad_perm:[2,3,0,1] row_mask:0xf bank_mask:0xf
  v_fma_f32 v126, v126, s52, -v26
  s_waitcnt lgkmcnt(0)
  v_mfma_f32_16x16x32_bf16 v[88:91], v[120:123], v[104:107], 0
  v_mov_b32_dpp v76, v104 quad_perm:[2,3,0,1] row_mask:0xf bank_mask:0xf
  v_mov_b32_dpp v77, v105 quad_perm:[2,3,0,1] row_mask:0xf bank_mask:0xf
  v_mfma_f32_16x16x32_bf16 v[84:87], v[44:47], v[104:107], 0
  ds_read_b128 v[28:31], v8 offset:20480
  v_exp_f32 v126, v126
  v_mfma_f32_16x16x32_bf16 v[88:91], v[120:123], v[76:79], v[88:91]
  ds_read_b128 v[32:35], v8 offset:21504
  v_mov_b32_dpp v127, v126 quad_perm:[2,3,0,1] row_mask:0xf bank_mask:0xf
  v_mfma_f32_16x16x32_bf16 v[84:87], v[48:51], v[76:79], v[84:87]
  v_cvt_pk_bf16_f32 v80, v126, v127
  v_cndmask_b32_e64 v80, v80, 0, s[46:47]
  v_mov_b64 v[70:71], 0
  v_mov_b64 v[72:73], 0
  v_mov_b32_dpp v81, v80 quad_perm:[2,3,0,1] row_mask:0xf bank_mask:0xf
  v_mov_b64 v[74:75], 0
  s_nop 0
  v_mfma_f32_16x16x16_bf16 v[88:91], v[120:121], v[80:81], v[88:91]
  ds_read_b128 v[36:39], v8 offset:22528
  v_mfma_f32_16x16x16_bf16 v[84:87], v[118:119], v[80:81], v[84:87]
  ds_read_b128 v[40:43], v8 offset:23552
  s_cmp_lt_u32 s20, 61
  s_cselect_b32 s33, 786432, 0
  s_nop 0
  v_rcp_f32 v88, v88
  s_add_u32 s87, s40, s33
  s_cmp_eq_u32 s20, 63
  s_nop 0
  v_mul_f32 v84, v84, v88
  v_mul_f32 v85, v85, v88
  v_mul_f32 v86, v86, v88
  v_mul_f32 v87, v87, v88
  v_cvt_pk_bf16_f32 v100, v84, v85
  v_cvt_pk_bf16_f32 v101, v86, v87
  ds_write_b64 v19, v[100:101]
  v_mov_b32_dpp v104, v100 quad_perm:[0,1,0,1] row_mask:0xf bank_mask:0xf
  v_mov_b32_dpp v105, v101 quad_perm:[0,1,0,1] row_mask:0xf bank_mask:0xf
  v_mov_b32_dpp v106, v100 quad_perm:[2,3,2,3] row_mask:0xf bank_mask:0xf
  v_mov_b32_dpp v107, v101 quad_perm:[2,3,2,3] row_mask:0xf bank_mask:0xf
  v_xor_b32 v85, 512, v0
  v_xor_b32 v86, 1024, v0
  v_xor_b32 v87, 1536, v0
  v_smfmac_f32_16x16x64_bf16 v[60:63], v[104:107], a[176:183], v2
  s_cbranch_scc1 ch_fin
  s_waitcnt lgkmcnt(0)
  s_barrier
  ds_read_b128 v[44:47], v85
  v_smfmac_f32_16x16x64_bf16 v[64:67], v[104:107], a[192:199], v2
  ds_read_b128 v[48:51], v86
  s_add_u32 s23, s22, 4096
  v_smfmac_f32_16x16x64_bf16 v[68:71], v[104:107], a[208:215], v2
  ds_read_b128 v[76:79], v87
  s_add_u32 s36, s22, s53
  v_smfmac_f32_16x16x64_bf16 v[72:75], v[104:107], a[224:231], v2
  ds_read_b128 v[92:95], v8 offset:24576
  s_add_u32 s20, s20, 1
  s_waitcnt lgkmcnt(3)
  v_smfmac_f32_16x16x64_bf16 v[60:63], v[44:47], a[184:191], v2
  ds_read_b128 v[96:99], v8 offset:25600
  s_waitcnt lgkmcnt(3)
  v_smfmac_f32_16x16x64_bf16 v[60:63], v[48:51], a[240:247], v2
  ds_read_b128 v[108:111], v8 offset:26624
  s_waitcnt lgkmcnt(3)
  v_smfmac_f32_16x16x64_bf16 v[60:63], v[76:79], a[248:255], v2
  ds_read_b128 v[112:115], v8 offset:27648
  v_smfmac_f32_16x16x64_bf16 v[64:67], v[44:47], a[200:207], v2
  ds_read_b128 v[52:55], v8 offset:28672
  v_smfmac_f32_16x16x64_bf16 v[64:67], v[48:51], v[28:35], v2
  ds_read_b128 v[56:59], v8 offset:29696
  v_cvt_pk_bf16_f32 v60, v60, v61
  v_cvt_pk_bf16_f32 v61, v62, v63
  v_bfi_b32 v60, v1, s21, v60
  v_smfmac_f32_16x16x64_bf16 v[64:67], v[76:79], v[36:43], v2
  buffer_store_dwordx2 v[60:61], v14, s[8:11], s22 offen offset:0
  ds_read_b128 v[116:119], v8 offset:30720
  v_smfmac_f32_16x16x64_bf16 v[68:71], v[44:47], a[216:223], v2
  ds_read_b128 v[120:123], v8 offset:31744
  s_waitcnt lgkmcnt(6)
  v_smfmac_f32_16x16x64_bf16 v[68:71], v[48:51], v[92:99], v2
  s_add_u32 s39, s39, 131072
  s_and_b32 s33, s20, 3
  v_cvt_pk_bf16_f32 v64, v64, v65
  v_cvt_pk_bf16_f32 v65, v66, v67
  v_bfi_b32 v64, v1, s21, v64
  s_waitcnt lgkmcnt(4)
  v_smfmac_f32_16x16x64_bf16 v[68:71], v[76:79], v[108:115], v2
  buffer_store_dwordx2 v[64:65], v14, s[8:11], s22 offen offset:2048
  v_smfmac_f32_16x16x64_bf16 v[72:75], v[44:47], a[232:239], v2
  s_lshl_b32 s33, s33, 13
  s_add_u32 s38, s55, s33
  s_waitcnt lgkmcnt(2)
  v_smfmac_f32_16x16x64_bf16 v[72:75], v[48:51], v[52:59], v2
  s_add_u32 s85, s87, s84
  v_cvt_pk_bf16_f32 v68, v68, v69
  s_waitcnt lgkmcnt(0)
  v_smfmac_f32_16x16x64_bf16 v[72:75], v[76:79], v[116:123], v2
  v_cvt_pk_bf16_f32 v69, v70, v71
  v_bfi_b32 v68, v1, s21, v68
  buffer_store_dwordx2 v[68:69], v14, s[8:11], s23 offen offset:0
  s_nop 4
  v_cvt_pk_bf16_f32 v72, v72, v73
  v_cvt_pk_bf16_f32 v73, v74, v75
  v_bfi_b32 v72, v1, s21, v72
  buffer_store_dwordx2 v[72:73], v14, s[8:11], s23 offen offset:2048
  s_memtime s[80:81]
  s_add_u32 s63, s63, 3140
  s_waitcnt lgkmcnt(0)
  s_sub_u32 s33, s63, s80
  s_sub_u32 s34, 661, s33
  s_max_i32 s34, s34, 0
  s_andn2_b32 s34, s34, 511
  s_add_u32 s33, s33, s34
  s_sub_u32 s33, s33, s82
  s_add_u32 s63, s63, s34
  s_sub_u32 s62, s63, s61
chf_ga1:
  s_sub_u32 s33, s33, 32
  s_cmp_gt_i32 s33, 0
  s_cbranch_scc1 chf_ga1
chf_h1a:
  buffer_load_dwordx4 v[36:39], v3, s[8:11], s36 offen sc1
  buffer_load_dwordx4 v[40:43], v3, s[8:11], s36 offen offset:1024 sc1
  s_waitcnt vmcnt(8)
  v_readfirstlane_b32 s86, v23
  v_bfe_i32 v27, v24, 0, 1
  v_and_b32 v126, 0x380, v3
  v_add_u32 v126, v126, v3
  ds_read_b128 v[60:63], v8 offset:0
  ds_read_b128 v[64:67], v8 offset:1024
  ds_read_b128 v[68:71], v8 offset:2048
  ds_read_b128 v[72:75], v8 offset:3072
  ds_read_b128 v[76:79], v8 offset:4096
  ds_read_b128 v[80:83], v8 offset:5120
  ds_read_b128 v[84:87], v8 offset:6144
  ds_read_b128 v[88:91], v8 offset:7168
  ds_read_b128 v[92:95], v8 offset:8192
  ds_read_b128 v[96:99], v8 offset:9216
  v_mov_b64 v[116:117], 0
  v_mov_b64 v[118:119], 0
  v_mov_b64 v[120:121], 0
  v_mov_b64 v[122:123], 0
  s_cmp_ge_u32 s57, s86
  s_cbranch_scc1 chf_kvwait
chf_kvok:
  s_add_u32 m0, s43, 0
  s_nop 0
  buffer_load_dwordx4 v20, s[8:11], s40 offen offset:0 sc1 lds
  s_add_u32 m0, s43, 896
  s_nop 0
  buffer_load_dwordx4 v20, s[8:11], s40 offen offset:128 sc1 lds
  s_waitcnt vmcnt(3)
chf_h1b:
  v_mfma_f32_16x16x32_bf16 v[44:47], v[4:7], v[36:39], 0
  v_xor_b32 v26, s21, v36
  s_waitcnt vmcnt(2)
  v_mfma_f32_16x16x32_bf16 v[44:47], v[4:7], v[40:43], v[44:47]
  v_bitop3_b32 v26, v26, s21, v40 bitop3:0xf6
  v_and_b32 v26, 1, v26
  v_cmp_ne_u32 vcc, 0, v26
  s_nop 4
  v_add_f32_dpp v44, v44, v44 row_ror:4 row_mask:0xf bank_mask:0xf
  v_add_f32_dpp v45, v45, v45 row_ror:4 row_mask:0xf bank_mask:0xf
  s_cbranch_vccnz chf_h1retry
  v_add_f32_dpp v44, v44, v44 row_ror:8 row_mask:0xf bank_mask:0xf
  v_add_f32_dpp v45, v45, v45 row_ror:8 row_mask:0xf bank_mask:0xf
  s_mov_b64 exec, s[50:51]
  v_cvt_pk_bf16_f32 v44, v44, v45
  v_med3_u32 v44, v44, v24, v27
  buffer_store_dword v44, v15, s[8:11], s37 offen
  s_memtime s[80:81]
  s_mov_b64 exec, -1
  v_add_u32 v15, 0x2000, v15
  v_and_b32 v15, 0x7fff, v15
  s_add_u32 s62, s62, s83
  s_mov_b32 s40, s87
chf_gb0:
  s_waitcnt lgkmcnt(0)
  s_sub_u32 s33, s62, s80
  s_sub_u32 s34, 563, s33
  s_max_i32 s34, s34, 0
  s_andn2_b32 s34, s34, 511
  s_add_u32 s33, s33, s34
  s_add_u32 s62, s62, s34
  s_sub_u32 s33, s33, 92
chf_gb1:
  s_sub_u32 s33, s33, 32
  s_cmp_gt_i32 s33, 0
  s_cbranch_scc1 chf_gb1
  s_branch chf_h2
chf_h2retry:
  s_sub_u32 s3, s3, 1
  s_cbranch_scc1 bail_13
  s_memtime s[80:81]
  s_branch chf_gb0
chf_h1retry:
  s_sub_u32 s3, s3, 1
  s_cbranch_scc1 bail_14
  s_memtime s[80:81]
  s_waitcnt lgkmcnt(0)
  s_sub_u32 s33, s62, s80
  s_sub_u32 s34, 563, s33
  s_max_i32 s34, s34, 0
  s_andn2_b32 s34, s34, 511
  s_add_u32 s33, s33, s34
  s_add_u32 s62, s62, s34
  s_sub_u32 s33, s33, 96
chf_gr1:
  s_sub_u32 s33, s33, 32
  s_cmp_gt_i32 s33, 0
  s_cbranch_scc1 chf_gr1
  buffer_load_dwordx4 v[36:39], v3, s[8:11], s36 offen sc1
  buffer_load_dwordx4 v[40:43], v3, s[8:11], s36 offen offset:1024 sc1
  ds_read_b128 v[60:63], v8 offset:0
  ds_read_b128 v[64:67], v8 offset:1024
  ds_read_b128 v[68:71], v8 offset:2048
  ds_read_b128 v[72:75], v8 offset:3072
  ds_read_b128 v[76:79], v8 offset:4096
  ds_read_b128 v[80:83], v8 offset:5120
  ds_read_b128 v[84:87], v8 offset:6144
  ds_read_b128 v[88:91], v8 offset:7168
  ds_read_b128 v[92:95], v8 offset:8192
  ds_read_b128 v[96:99], v8 offset:9216
  v_mov_b64 v[116:117], 0
  v_mov_b64 v[118:119], 0
  v_mov_b64 v[120:121], 0
  v_mov_b64 v[122:123], 0
  s_branch chf_kvok
chf_kvwait:
  s_sub_u32 s3, s3, 1
  s_cbranch_scc1 bail_15
  s_sleep 1
  buffer_load_dword v125, off, s[8:11], s41 sc1
  s_waitcnt vmcnt(0)
  v_cmp_ge_u32 vcc, s57, v125
  s_cbranch_vccnz chf_kvwait
  s_branch chf_kvok
chs_entry:
  v_mov_b32 v25, 127
  v_mov_b32 v125, 0
  v_and_b32 v126, 0x380, v3
  v_add_u32 v126, v126, v3
  ds_read_b128 v[60:63], v8 offset:0
  ds_read_b128 v[64:67], v8 offset:1024
  ds_read_b128 v[68:71], v8 offset:2048
  ds_read_b128 v[72:75], v8 offset:3072
  ds_read_b128 v[76:79], v8 offset:4096
  ds_read_b128 v[80:83], v8 offset:5120
  ds_read_b128 v[84:87], v8 offset:6144
  ds_read_b128 v[88:91], v8 offset:7168
  ds_read_b128 v[92:95], v8 offset:8192
  ds_read_b128 v[96:99], v8 offset:9216
  v_mov_b64 v[116:117], 0
  v_mov_b64 v[118:119], 0
  v_mov_b64 v[120:121], 0
  v_mov_b64 v[122:123], 0
chs_h2:
  buffer_load_dwordx4 v[28:31], v126, s[8:11], s38 offen sc1
  buffer_load_dwordx4 v[32:35], v126, s[8:11], s38 offen offset:2048 sc1
  v_lshlrev_b32 v124, 2, v3
  v_and_b32 v127, 0x800, v124
  v_mad_u32_u24 v124, v127, 3, v124
  v_mov_b64 v[100:101], 0
  v_mov_b64 v[102:103], 0
  v_mov_b64 v[104:105], 0
  v_mov_b64 v[106:107], 0
  v_mov_b64 v[108:109], 0
  v_mov_b64 v[110:111], 0
  v_mov_b64 v[112:113], 0
  v_mov_b64 v[114:115], 0
  s_waitcnt lgkmcnt(0)
  s_waitcnt vmcnt(1)
  ds_write_b128 v10, v[28:31]
  v_smfmac_f32_16x16x64_bf16 v[100:103], v[28:31], a[0:7], v2
  s_waitcnt vmcnt(0)
  ds_write_b128 v10, v[32:35] offset:1024
  v_smfmac_f32_16x16x64_bf16 v[104:107], v[28:31], a[8:15], v2
  v_max_u32 v26, v28, v32
  v_smfmac_f32_16x16x64_bf16 v[108:111], v[28:31], v[60:67], v2
  v_cmp_eq_u32 vcc, -1, v26
  v_smfmac_f32_16x16x64_bf16 v[112:115], v[28:31], v[68:75], v2
  v_smfmac_f32_16x16x64_bf16 v[100:103], v[32:35], a[16:23], v2
  s_cbranch_vccnz chs_h2retry
  v_smfmac_f32_16x16x64_bf16 v[104:107], v[32:35], a[24:31], v2
  ds_read_b128 v[60:63], v8 offset:10240
  v_smfmac_f32_16x16x64_bf16 v[108:111], v[32:35], v[76:83], v2
  ds_read_b128 v[64:67], v8 offset:11264
  s_add_u32 m0, s43, 8192
  s_waitcnt lgkmcnt(2)
  s_barrier
  ds_read_b128 v[36:39], v11 offset:0
  ds_read_b128 v[40:43], v11 offset:1024
  v_smfmac_f32_16x16x64_bf16 v[112:115], v[32:35], v[84:91], v2
  buffer_load_dwordx4 v21, s[8:11], s56 offen sc1 lds
  s_add_u32 m0, s43, 8960
  v_smfmac_f32_16x16x64_bf16 v[116:119], v[28:31], v[128:135], v2
  buffer_load_dwordx4 v21, s[8:11], s56 offen offset:256 sc1 lds
  v_smfmac_f32_16x16x64_bf16 v[120:123], v[28:31], v[136:143], v2
  ds_read_b128 v[68:71], v8 offset:12288
  s_waitcnt lgkmcnt(2)
  v_smfmac_f32_16x16x64_bf16 v[100:103], v[36:39], a[32:39], v2
  ds_read_b128 v[72:75], v8 offset:13312
  v_smfmac_f32_16x16x64_bf16 v[104:107], v[36:39], a[40:47], v2
  buffer_load_dword v25, v124, s[8:11], s85 offen sc1
  v_smfmac_f32_16x16x64_bf16 v[108:111], v[36:39], a[128:135], v2
  ds_read_b128 v[44:47], v12 offset:0
  v_smfmac_f32_16x16x64_bf16 v[112:115], v[36:39], a[136:143], v2
  s_mov_b64 exec, 1
  buffer_load_dword v23, off, s[8:11], s41 sc1
  s_mov_b64 exec, -1
  s_waitcnt lgkmcnt(3)
  v_smfmac_f32_16x16x64_bf16 v[108:111], v[40:43], v[92:99], v2
  ds_read_b128 v[76:79], v8 offset:14336
  v_smfmac_f32_16x16x64_bf16 v[100:103], v[40:43], a[48:55], v2
  ds_read_b128 v[80:83], v8 offset:15360
  v_smfmac_f32_16x16x64_bf16 v[104:107], v[40:43], a[56:63], v2
  ds_read_b128 v[48:51], v12 offset:1024
  v_smfmac_f32_16x16x64_bf16 v[112:115], v[40:43], v[60:67], v2
  s_waitcnt lgkmcnt(4)
  s_waitcnt lgkmcnt(3)
  v_smfmac_f32_16x16x64_bf16 v[108:111], v[44:47], v[68:75], v2
  ds_read_b128 v[52:55], v13 offset:0
  v_smfmac_f32_16x16x64_bf16 v[100:103], v[44:47], a[64:71], v2
  ds_read_b128 v[84:87], v8 offset:16384
  s_add_u32 s57, s20, 1
  s_waitcnt lgkmcnt(3)
  v_smfmac_f32_16x16x64_bf16 v[112:115], v[44:47], v[76:83], v2
  ds_read_b128 v[88:91], v8 offset:17408
  v_smfmac_f32_16x16x64_bf16 v[104:107], v[44:47], a[72:79], v2
  ds_read_b128 v[56:59], v13 offset:1024
  s_lshr_b32 s21, s20, 1
  s_waitcnt lgkmcnt(3)
  v_smfmac_f32_16x16x64_bf16 v[108:111], v[52:55], a[144:151], v2
  ds_read_b128 v[92:95], v8 offset:18432
  v_smfmac_f32_16x16x64_bf16 v[112:115], v[52:55], a[152:159], v2
  ds_read_b128 v[96:99], v8 offset:19456
  s_not_b32 s21, s21
  s_waitcnt lgkmcnt(3)
  v_smfmac_f32_16x16x64_bf16 v[108:111], v[48:51], v[84:91], v2
  s_waitcnt lgkmcnt(2)
  v_smfmac_f32_16x16x64_bf16 v[108:111], v[56:59], a[160:167], v2
  ds_read_b128 v[60:63], v9 offset:8192
  s_min_u32 s57, s57, 62
  v_smfmac_f32_16x16x64_bf16 v[112:115], v[56:59], a[168:175], v2
  ds_read_b128 v[64:67], v9 offset:10240
  s_and_b32 s21, s21, 1
  s_waitcnt lgkmcnt(2)
  v_smfmac_f32_16x16x64_bf16 v[112:115], v[48:51], v[92:99], v2
  ds_read_b128 v[68:71], v9 offset:12288
  v_add_f32 v108, v108, v110
  v_smfmac_f32_16x16x64_bf16 v[100:103], v[48:51], a[80:87], v2
  ds_read_b128 v[72:75], v9 offset:14336
  v_add_f32 v109, v109, v111
  v_smfmac_f32_16x16x64_bf16 v[100:103], v[52:55], a[96:103], v2
  ds_read_b128 v[76:79], v9 offset:9216
  v_add_f32 v112, v112, v114
  v_smfmac_f32_16x16x64_bf16 v[100:103], v[56:59], a[112:119], v2
  ds_read_b128 v[80:83], v9 offset:11264
  v_add_f32 v113, v113, v115
  v_smfmac_f32_16x16x64_bf16 v[104:107], v[48:51], a[88:95], v2
  ds_read_b128 v[84:87], v9 offset:13312
  v_cvt_pk_bf16_f32 v124, v108, v112
  v_smfmac_f32_16x16x64_bf16 v[104:107], v[52:55], a[104:111], v2
  ds_read_b128 v[88:91], v9 offset:15360
  v_cvt_pk_bf16_f32 v125, v109, v113
  v_smfmac_f32_16x16x64_bf16 v[104:107], v[56:59], a[120:127], v2
  ds_write_b32 v16, v124 offset:2560
  v_add_f32 v100, v100, v102
  v_smfmac_f32_16x16x64_bf16 v[116:119], v[32:35], v[144:151], v2
  ds_write_b32 v16, v125 offset:2848
  v_add_f32 v101, v101, v103
  v_smfmac_f32_16x16x64_bf16 v[120:123], v[32:35], v[152:159], v2
  ds_read_b64 v[126:127], v22
  v_add_f32 v104, v104, v106
  v_add_f32 v105, v105, v107
  v_cvt_pk_bf16_f32 v102, v100, v104
  v_cvt_pk_bf16_f32 v103, v101, v105
  ds_write2_b32 v16, v102, v103 offset1:72
  v_smfmac_f32_16x16x64_bf16 v[116:119], v[36:39], v[160:167], v2
  v_lshrrev_b32 v124, 1, v3
  v_smfmac_f32_16x16x64_bf16 v[120:123], v[36:39], v[168:175], v2
  s_waitcnt lgkmcnt(1)
  v_min_u32 v126, -2, v126
  v_smfmac_f32_16x16x64_bf16 v[116:119], v[40:43], v[176:183], v2
  buffer_store_dwordx2 v[126:127], v124, s[8:11], s39 offen sc1
  s_waitcnt lgkmcnt(0)
  s_barrier
  ds_read_b128 v[92:95], v17 offset:0
  v_smfmac_f32_16x16x64_bf16 v[120:123], v[40:43], v[184:191], v2
  ds_read_b128 v[96:99], v17 offset:64
  v_smfmac_f32_16x16x64_bf16 v[116:119], v[44:47], v[192:199], v2
  ds_read_b128 v[108:111], v17 offset:128
  v_smfmac_f32_16x16x64_bf16 v[120:123], v[44:47], v[200:207], v2
  ds_read_b128 v[112:115], v17 offset:192
  v_smfmac_f32_16x16x64_bf16 v[116:119], v[48:51], v[208:215], v2
  ds_read_b128 v[28:31], v18 offset:0
  s_add_u32 s56, s40, 8192
  v_smfmac_f32_16x16x64_bf16 v[120:123], v[48:51], v[216:223], v2
  ds_read_b128 v[36:39], v18 offset:2560
  v_smfmac_f32_16x16x64_bf16 v[116:119], v[52:55], v[224:231], v2
  ds_read_b128 v[32:35], v18 offset:64
  v_smfmac_f32_16x16x64_bf16 v[116:119], v[56:59], v[240:247], v2
  ds_read_b128 v[40:43], v18 offset:2624
  v_smfmac_f32_16x16x64_bf16 v[120:123], v[52:55], v[232:239], v2
  s_waitcnt vmcnt(3)
  v_smfmac_f32_16x16x64_bf16 v[120:123], v[56:59], v[248:255], v2
  s_waitcnt lgkmcnt(4)
  v_mfma_f32_16x16x32_bf16 v[100:103], v[60:63], v[92:95], 0
  v_add_f32 v116, v116, v118
  v_mfma_f32_16x16x32_bf16 v[100:103], v[64:67], v[96:99], v[100:103]
  s_and_b32 s33, s20, 1
  v_add_f32 v117, v117, v119
  v_add_f32 v120, v120, v122
  v_mfma_f32_16x16x32_bf16 v[100:103], v[68:71], v[108:111], v[100:103]
  s_mul_i32 s33, s33, 327680
  v_add_f32 v121, v121, v123
  v_cvt_pk_bf16_f32 v118, v116, v117
  v_mfma_f32_16x16x32_bf16 v[100:103], v[72:75], v[112:115], v[100:103]
  s_waitcnt lgkmcnt(0)
  v_cvt_pk_bf16_f32 v119, v120, v121
  v_min_u32 v118, -2, v118
  v_mfma_f32_16x16x32_bf16 v[52:55], v[36:39], v[28:31], 0
  buffer_store_dwordx2 v[118:119], v124, s[8:11], s39 offen offset:2048 sc1
  v_mov_b64 v[120:121], s[58:59]
  v_mfma_f32_16x16x32_bf16 v[52:55], v[40:43], v[32:35], v[52:55]
  ds_read_b128 v[44:47], v10 offset:16384
  v_max3_f32 v26, v100, v101, v102
  v_mfma_f32_16x16x32_bf16 v[104:107], v[76:79], v[92:95], 0
  ds_read_b128 v[48:51], v10 offset:17408
  v_mov_b64 v[122:123], s[58:59]
  v_mfma_f32_16x16x32_bf16 v[104:107], v[80:83], v[96:99], v[104:107]
  s_add_u32 s22, s54, s33
  v_cndmask_b32_e64 v52, v52, v54, s[46:47]
  v_cndmask_b32_e64 v53, v53, v55, s[46:47]
  v_mfma_f32_16x16x32_bf16 v[104:107], v[84:87], v[108:111], v[104:107]
  v_add_f32_dpp v52, v52, v52 quad_perm:[2,3,0,1] row_mask:0xf bank_mask:0xf
  v_add_f32_dpp v53, v53, v53 quad_perm:[2,3,0,1] row_mask:0xf bank_mask:0xf
  v_mfma_f32_16x16x32_bf16 v[104:107], v[88:91], v[112:115], v[104:107]
  v_max3_f32 v26, v26, v103, v52
  v_cndmask_b32_e64 v126, v52, v53, s[46:47]
  v_max_f32 v26, v26, v53
  v_mov_b64 v[60:61], 0
  v_mov_b64 v[62:63], 0
  v_mov_b64 v[64:65], 0
  v_mov_b64 v[66:67], 0
  v_mov_b64 v[68:69], 0
  v_max3_f32 v26, v26, v104, v105
  v_max3_f32 v27, v26, v106, v107
  v_max3_f32 v26, v26, v106, v107
  v_cndmask_b32_e64 v100, v100, v104, s[46:47]
  v_cndmask_b32_e64 v101, v101, v105, s[46:47]
  v_permlane16_swap_b32 v27, v26
  v_max_f32 v127, v26, v27
  v_max_f32 v26, v26, v27
  v_cndmask_b32_e64 v102, v102, v106, s[46:47]
  v_cndmask_b32_e64 v103, v103, v107, s[46:47]
  v_permlane32_swap_b32 v127, v26
  v_max_f32 v26, v26, v127
  v_mul_f32 v26, s52, v26
  v_fma_f32 v100, v100, s52, -v26
  v_fma_f32 v101, v101, s52, -v26
  v_fma_f32 v102, v102, s52, -v26
  v_fma_f32 v103, v103, s52, -v26
  v_exp_f32 v100, v100
  v_exp_f32 v101, v101
  v_exp_f32 v102, v102
  v_exp_f32 v103, v103
  v_cvt_pk_bf16_f32 v82, v100, v101
  v_cvt_pk_bf16_f32 v83, v102, v103
  v_cndmask_b32_e64 v78, 0, v82, s[46:47]
  v_cndmask_b32_e64 v79, 0, v83, s[46:47]
  v_cndmask_b32_e64 v104, v82, 0, s[46:47]
  v_cndmask_b32_e64 v105, v83, 0, s[46:47]
  v_mov_b32_dpp v106, v78 quad_perm:[2,3,0,1] row_mask:0xf bank_mask:0xf
  v_mov_b32_dpp v107, v79 quad_perm:[2,3,0,1] row_mask:0xf bank_mask:0xf
  v_fma_f32 v126, v126, s52, -v26
  s_waitcnt lgkmcnt(0)
  v_mfma_f32_16x16x32_bf16 v[88:91], v[120:123], v[104:107], 0
  v_mov_b32_dpp v76, v104 quad_perm:[2,3,0,1] row_mask:0xf bank_mask:0xf
  v_mov_b32_dpp v77, v105 quad_perm:[2,3,0,1] row_mask:0xf bank_mask:0xf
  v_mfma_f32_16x16x32_bf16 v[84:87], v[44:47], v[104:107], 0
  ds_read_b128 v[28:31], v8 offset:20480
  v_exp_f32 v126, v126
  v_mfma_f32_16x16x32_bf16 v[88:91], v[120:123], v[76:79], v[88:91]
  ds_read_b128 v[32:35], v8 offset:21504
  v_mov_b32_dpp v127, v126 quad_perm:[2,3,0,1] row_mask:0xf bank_mask:0xf
  v_mfma_f32_16x16x32_bf16 v[84:87], v[48:51], v[76:79], v[84:87]
  v_cvt_pk_bf16_f32 v80, v126, v127
  v_cndmask_b32_e64 v80, v80, 0, s[46:47]
  v_mov_b64 v[70:71], 0
  v_mov_b64 v[72:73], 0
  v_mov_b32_dpp v81, v80 quad_perm:[2,3,0,1] row_mask:0xf bank_mask:0xf
  v_mov_b64 v[74:75], 0
  s_nop 0
  v_mfma_f32_16x16x16_bf16 v[88:91], v[120:121], v[80:81], v[88:91]
  ds_read_b128 v[36:39], v8 offset:22528
  v_mfma_f32_16x16x16_bf16 v[84:87], v[118:119], v[80:81], v[84:87]
  ds_read_b128 v[40:43], v8 offset:23552
  s_cmp_lt_u32 s20, 61
  s_cselect_b32 s33, 786432, 0
  s_nop 0
  v_rcp_f32 v88, v88
  s_add_u32 s87, s40, s33
  s_cmp_eq_u32 s20, 63
  s_nop 0
  v_mul_f32 v84, v84, v88
  v_mul_f32 v85, v85, v88
  v_mul_f32 v86, v86, v88
  v_mul_f32 v87, v87, v88
  v_cvt_pk_bf16_f32 v100, v84, v85
  v_cvt_pk_bf16_f32 v101, v86, v87
  ds_write_b64 v19, v[100:101]
  v_mov_b32_dpp v104, v100 quad_perm:[0,1,0,1] row_mask:0xf bank_mask:0xf
  v_mov_b32_dpp v105, v101 quad_perm:[0,1,0,1] row_mask:0xf bank_mask:0xf
  v_mov_b32_dpp v106, v100 quad_perm:[2,3,2,3] row_mask:0xf bank_mask:0xf
  v_mov_b32_dpp v107, v101 quad_perm:[2,3,2,3] row_mask:0xf bank_mask:0xf
  v_xor_b32 v85, 512, v0
  v_xor_b32 v86, 1024, v0
  v_xor_b32 v87, 1536, v0
  v_smfmac_f32_16x16x64_bf16 v[60:63], v[104:107], a[176:183], v2
  s_cbranch_scc1 ch_fin
  s_waitcnt lgkmcnt(0)
  s_barrier
  ds_read_b128 v[44:47], v85
  v_smfmac_f32_16x16x64_bf16 v[64:67], v[104:107], a[192:199], v2
  ds_read_b128 v[48:51], v86
  s_add_u32 s23, s22, 4096
  v_smfmac_f32_16x16x64_bf16 v[68:71], v[104:107], a[208:215], v2
  ds_read_b128 v[76:79], v87
  s_add_u32 s36, s22, s53
  v_smfmac_f32_16x16x64_bf16 v[72:75], v[104:107], a[224:231], v2
  ds_read_b128 v[92:95], v8 offset:24576
  s_add_u32 s20, s20, 1
  s_waitcnt lgkmcnt(3)
  v_smfmac_f32_16x16x64_bf16 v[60:63], v[44:47], a[184:191], v2
  ds_read_b128 v[96:99], v8 offset:25600
  s_waitcnt lgkmcnt(3)
  v_smfmac_f32_16x16x64_bf16 v[60:63], v[48:51], a[240:247], v2
  ds_read_b128 v[108:111], v8 offset:26624
  s_waitcnt lgkmcnt(3)
  v_smfmac_f32_16x16x64_bf16 v[60:63], v[76:79], a[248:255], v2
  ds_read_b128 v[112:115], v8 offset:27648
  v_smfmac_f32_16x16x64_bf16 v[64:67], v[44:47], a[200:207], v2
  ds_read_b128 v[52:55], v8 offset:28672
  v_smfmac_f32_16x16x64_bf16 v[64:67], v[48:51], v[28:35], v2
  ds_read_b128 v[56:59], v8 offset:29696
  v_cvt_pk_bf16_f32 v60, v60, v61
  v_cvt_pk_bf16_f32 v61, v62, v63
  v_bfi_b32 v60, v1, s21, v60
  v_smfmac_f32_16x16x64_bf16 v[64:67], v[76:79], v[36:43], v2
  buffer_store_dwordx2 v[60:61], v14, s[8:11], s22 offen offset:0 sc1
  ds_read_b128 v[116:119], v8 offset:30720
  v_smfmac_f32_16x16x64_bf16 v[68:71], v[44:47], a[216:223], v2
  ds_read_b128 v[120:123], v8 offset:31744
  s_waitcnt lgkmcnt(6)
  v_smfmac_f32_16x16x64_bf16 v[68:71], v[48:51], v[92:99], v2
  s_add_u32 s39, s39, 131072
  s_and_b32 s33, s20, 3
  v_cvt_pk_bf16_f32 v64, v64, v65
  v_cvt_pk_bf16_f32 v65, v66, v67
  v_bfi_b32 v64, v1, s21, v64
  s_waitcnt lgkmcnt(4)
  v_smfmac_f32_16x16x64_bf16 v[68:71], v[76:79], v[108:115], v2
  buffer_store_dwordx2 v[64:65], v14, s[8:11], s22 offen offset:2048 sc1
  v_smfmac_f32_16x16x64_bf16 v[72:75], v[44:47], a[232:239], v2
  s_lshl_b32 s33, s33, 13
  s_add_u32 s38, s55, s33
  s_waitcnt lgkmcnt(2)
  v_smfmac_f32_16x16x64_bf16 v[72:75], v[48:51], v[52:59], v2
  s_add_u32 s85, s87, s84
  v_cvt_pk_bf16_f32 v68, v68, v69
  s_waitcnt lgkmcnt(0)
  v_smfmac_f32_16x16x64_bf16 v[72:75], v[76:79], v[116:123], v2
  v_cvt_pk_bf16_f32 v69, v70, v71
  v_bfi_b32 v68, v1, s21, v68
  buffer_store_dwordx2 v[68:69], v14, s[8:11], s23 offen offset:0 sc1
  s_nop 4
  v_cvt_pk_bf16_f32 v72, v72, v73
  v_cvt_pk_bf16_f32 v73, v74, v75
  v_bfi_b32 v72, v1, s21, v72
  buffer_store_dwordx2 v[72:73], v14, s[8:11], s23 offen offset:2048 sc1
  s_memtime s[80:81]
  s_add_u32 s63, s63, 3140
  s_waitcnt lgkmcnt(0)
  s_sub_u32 s33, s63, s80
  s_sub_u32 s34, 661, s33
  s_max_i32 s34, s34, 0
  s_andn2_b32 s34, s34, 511
  s_add_u32 s33, s33, s34
  s_sub_u32 s33, s33, s82
  s_add_u32 s63, s63, s34
  s_sub_u32 s62, s63, s61
chs_ga1:
  s_sub_u32 s33, s33, 32
  s_cmp_gt_i32 s33, 0
  s_cbranch_scc1 chs_ga1
chs_h1a:
  buffer_load_dwordx4 v[36:39], v3, s[8:11], s36 offen sc1
  buffer_load_dwordx4 v[40:43], v3, s[8:11], s36 offen offset:1024 sc1
  s_waitcnt vmcnt(8)
  v_readfirstlane_b32 s86, v23
  v_bfe_i32 v27, v24, 0, 1
  v_and_b32 v126, 0x380, v3
  v_add_u32 v126, v126, v3
  ds_read_b128 v[60:63], v8 offset:0
  ds_read_b128 v[64:67], v8 offset:1024
  ds_read_b128 v[68:71], v8 offset:2048
  ds_read_b128 v[72:75], v8 offset:3072
  ds_read_b128 v[76:79], v8 offset:4096
  ds_read_b128 v[80:83], v8 offset:5120
  ds_read_b128 v[84:87], v8 offset:6144
  ds_read_b128 v[88:91], v8 offset:7168
  ds_read_b128 v[92:95], v8 offset:8192
  ds_read_b128 v[96:99], v8 offset:9216
  v_mov_b64 v[116:117], 0
  v_mov_b64 v[118:119], 0
  v_mov_b64 v[120:121], 0
  v_mov_b64 v[122:123], 0
  s_cmp_ge_u32 s57, s86
  s_cbranch_scc1 chs_kvwait
chs_kvok:
  s_add_u32 m0, s43, 0
  s_nop 0
  buffer_load_dwordx4 v20, s[8:11], s40 offen offset:0 sc1 lds
  s_add_u32 m0, s43, 896
  s_nop 0
  buffer_load_dwordx4 v20, s[8:11], s40 offen offset:128 sc1 lds
  s_waitcnt vmcnt(3)
chs_h1b:
  v_mfma_f32_16x16x32_bf16 v[44:47], v[4:7], v[36:39], 0
  v_xor_b32 v26, s21, v36
  s_waitcnt vmcnt(2)
  v_mfma_f32_16x16x32_bf16 v[44:47], v[4:7], v[40:43], v[44:47]
  v_bitop3_b32 v26, v26, s21, v40 bitop3:0xf6
  v_and_b32 v26, 1, v26
  v_cmp_ne_u32 vcc, 0, v26
  s_nop 4
  v_add_f32_dpp v44, v44, v44 row_ror:4 row_mask:0xf bank_mask:0xf
  v_add_f32_dpp v45, v45, v45 row_ror:4 row_mask:0xf bank_mask:0xf
  s_cbranch_vccnz chs_h1retry
  v_add_f32_dpp v44, v44, v44 row_ror:8 row_mask:0xf bank_mask:0xf
  v_add_f32_dpp v45, v45, v45 row_ror:8 row_mask:0xf bank_mask:0xf
  s_mov_b64 exec, s[50:51]
  v_cvt_pk_bf16_f32 v44, v44, v45
  v_med3_u32 v44, v44, v24, v27
  buffer_store_dword v44, v15, s[8:11], s37 offen sc1
  s_memtime s[80:81]
  s_mov_b64 exec, -1
  v_add_u32 v15, 0x2000, v15
  v_and_b32 v15, 0x7fff, v15
  s_add_u32 s62, s62, s83
  s_mov_b32 s40, s87
chs_gb0:
  s_waitcnt lgkmcnt(0)
  s_sub_u32 s33, s62, s80
  s_sub_u32 s34, 563, s33
  s_max_i32 s34, s34, 0
  s_andn2_b32 s34, s34, 511
  s_add_u32 s33, s33, s34
  s_add_u32 s62, s62, s34
  s_sub_u32 s33, s33, 92
chs_gb1:
  s_sub_u32 s33, s33, 32
  s_cmp_gt_i32 s33, 0
  s_cbranch_scc1 chs_gb1
  s_branch chs_h2
chs_h2retry:
  s_sub_u32 s3, s3, 1
  s_cbranch_scc1 bail_13
  s_memtime s[80:81]
  s_branch chs_gb0
chs_h1retry:
  s_sub_u32 s3, s3, 1
  s_cbranch_scc1 bail_14
  s_memtime s[80:81]
  s_waitcnt lgkmcnt(0)
  s_sub_u32 s33, s62, s80
  s_sub_u32 s34, 563, s33
  s_max_i32 s34, s34, 0
  s_andn2_b32 s34, s34, 511
  s_add_u32 s33, s33, s34
  s_add_u32 s62, s62, s34
  s_sub_u32 s33, s33, 96
chs_gr1:
  s_sub_u32 s33, s33, 32
  s_cmp_gt_i32 s33, 0
  s_cbranch_scc1 chs_gr1
  buffer_load_dwordx4 v[36:39], v3, s[8:11], s36 offen sc1
  buffer_load_dwordx4 v[40:43], v3, s[8:11], s36 offen offset:1024 sc1
  ds_read_b128 v[60:63], v8 offset:0
  ds_read_b128 v[64:67], v8 offset:1024
  ds_read_b128 v[68:71], v8 offset:2048
  ds_read_b128 v[72:75], v8 offset:3072
  ds_read_b128 v[76:79], v8 offset:4096
  ds_read_b128 v[80:83], v8 offset:5120
  ds_read_b128 v[84:87], v8 offset:6144
  ds_read_b128 v[88:91], v8 offset:7168
  ds_read_b128 v[92:95], v8 offset:8192
  ds_read_b128 v[96:99], v8 offset:9216
  v_mov_b64 v[116:117], 0
  v_mov_b64 v[118:119], 0
  v_mov_b64 v[120:121], 0
  v_mov_b64 v[122:123], 0
  s_branch chs_kvok
chs_kvwait:
  s_sub_u32 s3, s3, 1
  s_cbranch_scc1 bail_15
  s_sleep 1
  buffer_load_dword v125, off, s[8:11], s41 sc1
  s_waitcnt vmcnt(0)
  v_cmp_ge_u32 vcc, s57, v125
  s_cbranch_vccnz chs_kvwait
  s_branch chs_kvok
ch_fin:
  s_waitcnt vmcnt(0)
  s_branch the_end
bail_1:
  s_movk_i32 s28, 1
  s_branch bail_common
bail_2:
  s_movk_i32 s28, 2
  s_branch bail_common
bail_3:
  s_movk_i32 s28, 3
  s_branch bail_common
bail_4:
  s_movk_i32 s28, 4
  s_branch bail_common
bail_5:
  s_movk_i32 s28, 5
  s_branch bail_common
bail_6:
  s_movk_i32 s28, 6
  s_branch bail_common
bail_7:
  s_movk_i32 s28, 7
  s_branch bail_common
bail_10:
  s_movk_i32 s28, 10
  s_branch bail_common
bail_11:
  s_movk_i32 s28, 11
  s_branch bail_common
bail_12:
  s_movk_i32 s28, 12
  s_branch bail_common
bail_13:
  s_movk_i32 s28, 13
  s_branch bail_common
bail_14:
  s_movk_i32 s28, 14
  s_branch bail_common
bail_15:
  s_movk_i32 s28, 15
  s_branch bail_common
bail_16:
  s_movk_i32 s28, 16
  s_branch bail_common
bail_17:
  s_movk_i32 s28, 17
  s_branch bail_common
bail_18:
  s_movk_i32 s28, 18
  s_branch bail_common
bail_19:
  s_movk_i32 s28, 19
  s_branch bail_common
bail_20:
  s_movk_i32 s28, 20
  s_branch bail_common
bail_21:
  s_movk_i32 s28, 21
  s_branch bail_common
bail_22:
  s_movk_i32 s28, 22
  s_branch bail_common
bail_23:
  s_movk_i32 s28, 23
  s_branch bail_common
bail_24:
  s_movk_i32 s28, 24
  s_branch bail_common
bail_25:
  s_movk_i32 s28, 25
  s_branch bail_common
bail_26:
  s_movk_i32 s28, 26
  s_branch bail_common
bail_27:
  s_movk_i32 s28, 27
  s_branch bail_common
bail_28:
  s_movk_i32 s28, 28
  s_branch bail_common
bail_29:
  s_movk_i32 s28, 29
  s_branch bail_common
bail_31:
  s_movk_i32 s28, 31
  s_branch bail_common
bail_32:
  s_movk_i32 s28, 32
  s_branch bail_common
bail_33:
  s_movk_i32 s28, 33
  s_branch bail_common
bail_35:
  s_movk_i32 s28, 35
  s_branch bail_common
bail_37:
  s_movk_i32 s28, 37
  s_branch bail_common
bail_38:
  s_movk_i32 s28, 38
  s_branch bail_common
bail_39:
  s_movk_i32 s28, 39
  s_branch bail_common
bail_common:
  s_mov_b64 exec, 1
  s_lshl_b32 s29, s5, 16
  s_or_b32 s28, s28, s29
  s_lshl_b32 s29, s6, 8
  s_or_b32 s28, s28, s29
  s_lshl_b32 s29, s4, 24
  s_or_b32 s28, s28, s29
  s_or_b32 s28, s28, 0x80000000
  s_and_b32 s29, s5, 7
  s_lshl_b32 s29, s29, 2
  s_add_u32 s29, s29, 32
  v_mov_b32 v2, s28
  v_mov_b32 v3, s29
  buffer_store_dword v2, v3, s[24:27], 0 offen sc1
  s_waitcnt vmcnt(0)
  s_endpgm
.section .rodata,"a"
.p2align 6
.amdhsa_kernel interleave_layers__memory_aug_recurrent_mem_tr__dense_activation_relu__prompt_kernel
  .amdhsa_next_free_vgpr 512
  .amdhsa_next_free_sgpr 102
  .amdhsa_accum_offset 256
  .amdhsa_group_segment_fixed_size 0
  .amdhsa_kernarg_size 104
  .amdhsa_user_sgpr_count 2
  .amdhsa_user_sgpr_kernarg_segment_ptr 1
  .amdhsa_system_sgpr_workgroup_id_x 1
.end_amdhsa_kernel
```
